```python
import torch

def _softmax(x, axis=-1):
    return torch.softmax(x, dim=axis)
def _gelu(x):
    return torch.nn.functional.gelu(x, approximate="tanh")
def _silu(x):
    return torch.nn.functional.silu(x)
def _sigmoid(x):
    return torch.sigmoid(x)
def _layernorm(x, axis=-1, eps=1e-5):
    m = x.mean(dim=axis, keepdim=True)
    v = x.var(dim=axis, keepdim=True, unbiased=False)
    return (x - m) / torch.sqrt(v + eps)
def _scatter_add(tgt, idx, src, axis=0):
    return tgt.clone().index_add_(axis, idx, src)
def _segment_sum(src, seg, n):
    out = torch.zeros((n,) + src.shape[1:], dtype=src.dtype)
    return out.index_add_(0, seg, src)
def _pad(x, pw):
    flat = tuple(v for pair in reversed(pw) for v in pair)
    return torch.nn.functional.pad(x, flat)

kernel_name = 'concat_heads__gqa_block_cached__gqa_block_cached__near_ridge'

def setup_inputs():

    _w = (lambda a: (lambda t: t.to(torch.bfloat16) if t.is_floating_point() else t)(torch.as_tensor(a)))
    def _A_setup():
        B, Sq, D = 16, 96, 576
        Hq, Hkv, Sk, Dh = 32, 16, 1024, 128
        assert Hq % Hkv == 0, (Hq, Hkv)
        return {
            "x": _w((lambda *s: torch.randn(*s, dtype=torch.bfloat16) * 0.8)(B, Sq, D)),
            "k_cache": _w((lambda *s: torch.randn(*s, dtype=torch.bfloat16) * 0.8)(B, Hkv, Sk, Dh)),
            "v_cache": _w((lambda *s: torch.randn(*s, dtype=torch.bfloat16) * 0.05)(B, Hkv, Sk, Dh)),
            "wq": _w((lambda *s: torch.randn(*s, dtype=torch.bfloat16) * 0.8)(D, Hq * Dh) * (D ** -0.5)),
            "wo": _w((lambda *s: torch.randn(*s, dtype=torch.bfloat16) * 0.05)(Hq * Dh, D) * ((Hq * Dh) ** -0.5)),
        }
    _A_in = _A_setup()

    def _B_setup():
        B, Sq, D = 16, 96, 576
        Hq, Hkv, Sk, Dh = 32, 16, 1024, 128
        assert Hq % Hkv == 0, (Hq, Hkv)
        return {
            "x": _w((lambda *s: torch.randn(*s, dtype=torch.bfloat16) * 0.8)(B, Sq, D)),
            "k_cache": _w((lambda *s: torch.randn(*s, dtype=torch.bfloat16) * 0.8)(B, Hkv, Sk, Dh)),
            "v_cache": _w((lambda *s: torch.randn(*s, dtype=torch.bfloat16) * 0.05)(B, Hkv, Sk, Dh)),
            "wq": _w((lambda *s: torch.randn(*s, dtype=torch.bfloat16) * 0.8)(D, Hq * Dh) * (D ** -0.5)),
            "wo": _w((lambda *s: torch.randn(*s, dtype=torch.bfloat16) * 0.05)(Hq * Dh, D) * ((Hq * Dh) ** -0.5)),
        }
    _B_in = _B_setup()

    return {
        "A_x": _A_in["x"],
        "A_k_cache": _A_in["k_cache"],
        "A_v_cache": _A_in["v_cache"],
        "A_wq": _A_in["wq"],
        "A_wo": _A_in["wo"],
        "B_x": _B_in["x"],
        "B_k_cache": _B_in["k_cache"],
        "B_v_cache": _B_in["v_cache"],
        "B_wq": _B_in["wq"],
        "B_wo": _B_in["wo"],
    }

def reference(A_x, A_k_cache, A_v_cache, A_wq, A_wo, B_x, B_k_cache, B_v_cache, B_wq, B_wo):
    def _A_ref(x, k_cache, v_cache, wq, wo):
        B, Sq, D = x.shape
        Hq, Dh = 32, 128
        Hkv = k_cache.shape[1]
        rep = Hq // Hkv
        q = (lambda x, *d: x.permute(*d))((x @ wq).reshape(B, Sq, Hq, Dh), 0, 2, 1, 3)
        k = (lambda x, n, axis: torch.repeat_interleave(x, n, dim=axis))(k_cache, rep, axis=1)
        v = (lambda x, n, axis: torch.repeat_interleave(x, n, dim=axis))(v_cache, rep, axis=1)
        scores = torch.einsum("bhqd,bhkd->bhqk", q, k) * (Dh ** -0.5)
        p = _softmax(scores, axis=-1)
        o = torch.einsum("bhqk,bhkd->bhqd", p, v)
        return (lambda x, *d: x.permute(*d))(o, 0, 2, 1, 3).reshape(B, Sq, Hq * Dh) @ wo

    def _B_ref(x, k_cache, v_cache, wq, wo):
        B, Sq, D = x.shape
        Hq, Dh = 32, 128
        Hkv = k_cache.shape[1]
        rep = Hq // Hkv
        q = (lambda x, *d: x.permute(*d))((x @ wq).reshape(B, Sq, Hq, Dh), 0, 2, 1, 3)
        k = (lambda x, n, axis: torch.repeat_interleave(x, n, dim=axis))(k_cache, rep, axis=1)
        v = (lambda x, n, axis: torch.repeat_interleave(x, n, dim=axis))(v_cache, rep, axis=1)
        scores = torch.einsum("bhqd,bhkd->bhqk", q, k) * (Dh ** -0.5)
        p = _softmax(scores, axis=-1)
        o = torch.einsum("bhqk,bhkd->bhqd", p, v)
        return (lambda x, *d: x.permute(*d))(o, 0, 2, 1, 3).reshape(B, Sq, Hq * Dh) @ wo

    a = _A_ref(A_x, A_k_cache, A_v_cache, A_wq, A_wo)
    b = _B_ref(B_x, B_k_cache, B_v_cache, B_wq, B_wo)
    return torch.concatenate([a, b], axis=-1)
```

```asm
; @launch grid=(256,1,1) block=(256,1,1) lds=163840
.amdgcn_target "amdgcn-amd-amdhsa--gfx950"
.text
.globl concat_heads__gqa_block_cached__gqa_block_cached__near_ridge_kernel
.p2align 8
.type concat_heads__gqa_block_cached__gqa_block_cached__near_ridge_kernel,@function
concat_heads__gqa_block_cached__gqa_block_cached__near_ridge_kernel:
    s_cmp_ge_u32 s2, 256
    s_cbranch_scc1 L_end
    s_load_dwordx8 s[36:43], s[0:1], 0
    s_load_dwordx2 s[44:45], s[0:1], 32
    s_load_dwordx8 s[48:55], s[0:1], 40
    s_load_dwordx2 s[56:57], s[0:1], 72
    s_load_dwordx2 s[58:59], s[0:1], 96
    s_load_dwordx4 s[92:95], s[0:1], 80
    v_lshrrev_b32 v1, 6, v0
    v_and_b32 v198, 63, v0
    v_readfirstlane_b32 s3, v1
    s_lshr_b32 s7, s2, 3
    s_and_b32 s4, s7, 15
    s_lshr_b32 s5, s7, 4
    s_and_b32 s6, s2, 3
    s_lshl_b32 s6, s6, 1
    s_add_u32 s5, s5, s6
    s_bfe_u32 s6, s2, 0x10002
    s_and_b32 s31, s3, 1
    s_lshr_b32 s33, s3, 1
    s_lshl_b32 s34, s31, 1
    s_add_u32 s34, s34, s33
    s_mul_i32 s28, s34, 34816
    s_lshl_b32 s80, s3, 10
    s_add_u32 s72, s80, 139264
    s_and_b32 s29, s7, 31
    s_lshl_b32 s29, s29, 13
    s_add_u32 s30, s29, 4096
    v_lshrrev_b32 v1, 4, v198
    v_and_b32 v2, 15, v198
    v_lshrrev_b32 v5, 2, v2
    v_and_b32 v6, 3, v198
    v_lshrrev_b32 v8, 3, v198
    v_and_b32 v9, 7, v198
    v_lshrrev_b32 v10, 1, v8
    v_xor_b32 v11, v9, v10
    s_lshl_b32 s34, s31, 2
    v_xor_b32 v11, s34, v11
    v_lshlrev_b32 v11, 4, v11
    s_lshl_b32 s34, s3, 3
    v_add_u32 v12, s34, v8
    v_mul_u32_u24 v12, 1152, v12
    v_add_u32 v224, v12, v11
    v_and_b32 v11, 1, v10
    v_lshlrev_b32 v11, 2, v11
    v_xor_b32 v11, v9, v11
    v_lshlrev_b32 v11, 4, v11
    v_lshl_add_u32 v11, v8, 13, v11
    s_lshl_b32 s34, s5, 2
    s_add_u32 s34, s34, s3
    s_lshl_b32 s34, s34, 8
    v_add_u32 v220, s34, v11
    v_add_u32 v221, 64504, v220
    v_add_u32 v222, 129008, v220
    v_add_u32 v223, 193512, v220
    s_waitcnt lgkmcnt(0)
    s_cmp_eq_u32 s6, 0
    s_cselect_b32 s36, s36, s48
    s_cselect_b32 s37, s37, s49
    s_cselect_b32 s38, s38, s50
    s_cselect_b32 s39, s39, s51
    s_cselect_b32 s40, s40, s52
    s_cselect_b32 s41, s41, s53
    s_cselect_b32 s42, s42, s54
    s_cselect_b32 s43, s43, s55
    s_cselect_b32 s44, s44, s56
    s_cselect_b32 s45, s45, s57
    s_mul_i32 s34, s4, 110592
    s_add_u32 s16, s36, s34
    s_addc_u32 s17, s37, 0
    s_mov_b32 s18, 110592
    s_mov_b32 s19, 0x20000
    s_mov_b32 s12, s42
    s_mov_b32 s13, s43
    s_mov_b32 s14, 4718592
    s_mov_b32 s15, 0x20000
    s_mul_hi_u32 s34, s4, 477218589
    s_mul_i32 s34, s34, 9
    s_sub_u32 s34, s4, s34
    s_mul_i32 s34, s34, 1
    s_lshl_b32 s49, s34, 7
    s_lshl_b32 s48, s34, 19
    s_add_u32 m0, s72, 0
    s_add_u32 s73, s49, 0
    buffer_load_dwordx4 v224, s[16:19], s73 offen lds
    s_add_u32 m0, s72, 4096
    s_add_u32 s73, s49, 36864
    buffer_load_dwordx4 v224, s[16:19], s73 offen lds
    s_add_u32 m0, s72, 8192
    s_add_u32 s73, s49, 73728
    buffer_load_dwordx4 v224, s[16:19], s73 offen lds
    s_add_u32 s49, s49, 128
    s_cmp_eq_u32 s49, 1152
    s_cselect_b32 s49, 0, s49
    s_add_u32 m0, s28, 16512
    s_add_u32 s73, s48, 0
    buffer_load_dwordx4 v220, s[12:15], s73 offen lds
    buffer_load_dwordx4 v221, s[12:15], s73 offen offset:1032 lds
    buffer_load_dwordx4 v222, s[12:15], s73 offen offset:2064 lds
    buffer_load_dwordx4 v223, s[12:15], s73 offen offset:3096 lds
    s_add_u32 m0, s28, 20640
    s_add_u32 s73, s48, 128
    buffer_load_dwordx4 v220, s[12:15], s73 offen lds
    buffer_load_dwordx4 v221, s[12:15], s73 offen offset:1032 lds
    buffer_load_dwordx4 v222, s[12:15], s73 offen offset:2064 lds
    buffer_load_dwordx4 v223, s[12:15], s73 offen offset:3096 lds
    s_add_u32 s48, s48, 262144
    s_cmp_eq_u32 s48, 4718592
    s_cselect_b32 s48, 0, s48
    s_add_u32 m0, s72, 12288
    s_add_u32 s73, s49, 0
    buffer_load_dwordx4 v224, s[16:19], s73 offen lds
    s_add_u32 m0, s72, 16384
    s_add_u32 s73, s49, 36864
    buffer_load_dwordx4 v224, s[16:19], s73 offen lds
    s_add_u32 m0, s72, 20480
    s_add_u32 s73, s49, 73728
    buffer_load_dwordx4 v224, s[16:19], s73 offen lds
    s_add_u32 s49, s49, 128
    s_cmp_eq_u32 s49, 1152
    s_cselect_b32 s49, 0, s49
    s_add_u32 m0, s28, 24768
    s_add_u32 s73, s48, 0
    buffer_load_dwordx4 v220, s[12:15], s73 offen lds
    buffer_load_dwordx4 v221, s[12:15], s73 offen offset:1032 lds
    buffer_load_dwordx4 v222, s[12:15], s73 offen offset:2064 lds
    buffer_load_dwordx4 v223, s[12:15], s73 offen offset:3096 lds
    s_add_u32 m0, s28, 28896
    s_add_u32 s73, s48, 128
    buffer_load_dwordx4 v220, s[12:15], s73 offen lds
    buffer_load_dwordx4 v221, s[12:15], s73 offen offset:1032 lds
    buffer_load_dwordx4 v222, s[12:15], s73 offen offset:2064 lds
    buffer_load_dwordx4 v223, s[12:15], s73 offen offset:3096 lds
    s_add_u32 s48, s48, 262144
    s_cmp_eq_u32 s48, 4718592
    s_cselect_b32 s48, 0, s48
    s_getpc_b64 s[96:97]
    s_lshl_b32 s34, s7, 2
    s_add_u32 s34, s34, s3
    s_and_b32 s34, s34, 15
    s_min_u32 s34, s34, 8
    s_mul_i32 s34, s34, 8192
    v_mul_u32_u24 v228, 128, v198
    v_add_u32 v228, s34, v228
    global_load_dword v253, v228, s[96:97]
    s_cmp_eq_u32 s31, 0
    s_cselect_b32 s38, s38, s40
    s_cselect_b32 s39, s39, s41
    s_lshl_b32 s34, s4, 4
    s_lshl_b32 s35, s5, 1
    s_add_u32 s34, s34, s35
    s_add_u32 s34, s34, s33
    s_lshl_b32 s34, s34, 18
    s_add_u32 s8, s38, s34
    s_addc_u32 s9, s39, 0
    s_mov_b32 s10, 262144
    s_mov_b32 s11, 0x20000
    v_and_b32 v11, 1, v1
    v_lshlrev_b32 v11, 1, v11
    v_lshrrev_b32 v12, 1, v1
    v_lshl_or_b32 v11, v12, 3, v11
    s_cmp_eq_u32 s31, 0
    s_cselect_b64 vcc, -1, 0
    s_nop 1
    v_cndmask_b32 v11, v11, v1, vcc
    v_xor_b32 v11, v2, v11
    v_lshlrev_b32 v11, 4, v11
    v_lshl_add_u32 v197, v1, 8, v11
    s_mul_i32 s34, s5, 589824
    s_add_u32 s20, s44, s34
    s_addc_u32 s21, s45, 0
    s_mov_b32 s22, 589824
    s_mov_b32 s23, 0x20000
    s_lshl_b32 s88, s6, 4
    s_add_u32 s88, s88, s4
    s_lshl_b32 s34, s88, 15
    s_add_u32 s34, s34, 28311552
    s_add_u32 s60, s58, s34
    s_addc_u32 s61, s59, 0
    s_mov_b32 s62, 32768
    s_mov_b32 s63, 0x20000
    s_mov_b32 s64, s94
    s_mov_b32 s65, s95
    s_mov_b32 s66, 256
    s_mov_b32 s67, 0x20000
    s_mov_b32 s68, s92
    s_mov_b32 s69, s93
    s_mov_b32 s70, 3538944
    s_mov_b32 s71, 0x20000
    s_lshl_b32 s83, s5, 2
    s_add_u32 s83, s83, s3
    s_xor_b32 s84, s31, 1
    v_lshlrev_b32 v199, 4, v198
    s_add_u32 s34, s28, 26112
    s_cmp_eq_u32 s31, 0
    s_cselect_b32 s34, s34, 139264
    v_add_u32 v233, s34, v199
    v_add_u32 v199, s28, v199
    s_mul_i32 s34, s88, 884736
    s_add_u32 s24, s58, s34
    s_addc_u32 s25, s59, 0
    s_mov_b32 s26, 884736
    s_mov_b32 s27, 0x20000
    s_mov_b32 s74, 0x3e0293ee
    s_mov_b32 s75, 0x3e0293ee
    s_mov_b32 s76, 0x41000000
    s_mov_b32 s77, 0x53800000
    s_mov_b32 s51, 0
    s_mov_b32 s91, 1152
    s_mov_b32 s50, s29
    v_mul_u32_u24 v11, 1032, v1
    v_lshl_add_u32 v11, v5, 7, v11
    v_lshl_add_u32 v11, v6, 4, v11
    v_add_u32 v11, s28, v11
    v_lshrrev_b32 v12, 1, v5
    v_lshl_add_u32 v216, v12, 6, v11
    v_xor_b32 v12, 1, v12
    v_lshl_add_u32 v217, v12, 6, v11
    v_lshrrev_b32 v11, 3, v2
    v_and_b32 v12, 7, v2
    v_lshlrev_b32 v13, 10, v11
    v_lshl_add_u32 v13, v12, 7, v13
    v_add_u32 v13, 139264, v13
    v_lshrrev_b32 v12, 1, v12
    v_lshlrev_b32 v11, 2, v11
    v_xor_b32 v12, v12, v11
    v_xor_b32 v12, v12, v1
    v_lshl_add_u32 v244, v12, 4, v13
    v_xor_b32 v12, 4, v12
    v_lshl_add_u32 v245, v12, 4, v13
    s_mul_i32 s34, s33, 34816
    v_mul_u32_u24 v11, 1088, v5
    v_lshl_add_u32 v11, v6, 8, v11
    v_xor_b32 v12, v1, v6
    v_lshl_add_u32 v11, v12, 4, v11
    v_add_u32 v192, s34, v11
    s_add_u32 s34, s34, 69632
    v_mul_u32_u24 v11, 1088, v1
    v_lshl_add_u32 v11, v5, 8, v11
    v_lshl_add_u32 v11, v6, 3, v11
    v_add_u32 v11, s34, v11
    v_and_b32 v12, 1, v5
    v_lshrrev_b32 v13, 1, v5
    v_lshl_or_b32 v12, v13, 2, v12
    v_xor_b32 v13, 0, v12
    v_lshl_add_u32 v193, v13, 5, v11
    v_xor_b32 v13, 1, v12
    v_lshl_add_u32 v194, v13, 5, v11
    v_xor_b32 v13, 4, v12
    v_lshl_add_u32 v195, v13, 5, v11
    v_xor_b32 v13, 5, v12
    v_lshl_add_u32 v196, v13, 5, v11
    s_sub_u32 s34, 0, s31
    s_and_b32 s34, s34, 3
    s_mul_i32 s34, s34, 8704
    s_add_u32 s40, s28, s34
    s_sub_u32 s34, 1, s31
    s_and_b32 s34, s34, 3
    s_mul_i32 s34, s34, 8704
    s_add_u32 s41, s28, s34
    s_sub_u32 s34, 2, s31
    s_and_b32 s34, s34, 3
    s_mul_i32 s34, s34, 8704
    s_add_u32 s42, s28, s34
    s_sub_u32 s34, 3, s31
    s_and_b32 s34, s34, 3
    s_mul_i32 s34, s34, 8704
    s_add_u32 s43, s28, s34
    s_mul_i32 s35, s83, 3072
    s_add_u32 s0, s35, 786432
    s_mul_i32 s87, s5, 98304
    s_mul_i32 s73, s3, 3072
    s_add_u32 s87, s87, s73
    s_add_u32 s34, s5, 1
    s_and_b32 s34, s34, 7
    s_mul_i32 s34, s34, 98304
    s_add_u32 s1, s34, s35
    s_sub_u32 s34, s5, 1
    s_and_b32 s34, s34, 7
    s_mul_i32 s34, s34, 12288
    s_add_u32 s95, s34, s87
    s_add_u32 s34, s5, 2
    s_and_b32 s34, s34, 7
    s_mul_i32 s34, s34, 98304
    s_add_u32 s36, s34, s35
    s_sub_u32 s34, s5, 2
    s_and_b32 s34, s34, 7
    s_mul_i32 s34, s34, 12288
    s_add_u32 s96, s34, s87
    s_add_u32 s34, s5, 3
    s_and_b32 s34, s34, 7
    s_mul_i32 s34, s34, 98304
    s_add_u32 s37, s34, s35
    s_sub_u32 s34, s5, 3
    s_and_b32 s34, s34, 7
    s_mul_i32 s34, s34, 12288
    s_add_u32 s97, s34, s87
    s_add_u32 s34, s5, 4
    s_and_b32 s34, s34, 7
    s_mul_i32 s34, s34, 98304
    s_add_u32 s38, s34, s35
    s_sub_u32 s34, s5, 4
    s_and_b32 s34, s34, 7
    s_mul_i32 s34, s34, 12288
    s_add_u32 s98, s34, s87
    s_add_u32 s34, s5, 5
    s_and_b32 s34, s34, 7
    s_mul_i32 s34, s34, 98304
    s_add_u32 s39, s34, s35
    s_sub_u32 s34, s5, 5
    s_and_b32 s34, s34, 7
    s_mul_i32 s34, s34, 12288
    s_add_u32 s99, s34, s87
    s_add_u32 s34, s5, 6
    s_and_b32 s34, s34, 7
    s_mul_i32 s34, s34, 98304
    s_add_u32 s92, s34, s35
    s_sub_u32 s34, s5, 6
    s_and_b32 s34, s34, 7
    s_mul_i32 s34, s34, 12288
    s_add_u32 s100, s34, s87
    s_add_u32 s34, s5, 7
    s_and_b32 s34, s34, 7
    s_mul_i32 s34, s34, 98304
    s_add_u32 s93, s34, s35
    s_sub_u32 s34, s5, 7
    s_and_b32 s34, s34, 7
    s_mul_i32 s34, s34, 12288
    s_add_u32 s101, s34, s87
    s_lshl_b32 s34, s5, 10
    s_add_u32 s34, s34, s73
    s_add_u32 s34, s34, 786432
    s_cmp_lt_u32 s5, 3
    s_cselect_b32 s94, s34, 884736
    s_lshl_b32 s90, s83, 10
    s_mul_i32 s89, s4, 221184
    s_mul_i32 s87, s6, 1152
    s_add_u32 s89, s89, s87
    s_lshl_b32 s87, s3, 5
    s_add_u32 s89, s89, s87
    s_add_u32 s34, s4, 0
    s_and_b32 s34, s34, 3
    s_mul_i32 s44, s34, 147456
    s_add_u32 s34, s4, 1
    s_and_b32 s34, s34, 3
    s_mul_i32 s45, s34, 147456
    s_add_u32 s34, s4, 2
    s_and_b32 s34, s34, 3
    s_mul_i32 s46, s34, 147456
    s_add_u32 s34, s4, 3
    s_and_b32 s34, s34, 3
    s_mul_i32 s47, s34, 147456
    s_waitcnt vmcnt(16)
    s_barrier
    ds_read_b128 a[192:195], v244 offset:0
    ds_read_b128 a[196:199], v244 offset:2048
    ds_read_b128 a[200:203], v244 offset:4096
    ds_read_b128 a[204:207], v244 offset:6144
    ds_read_b128 a[208:211], v244 offset:8192
    ds_read_b128 a[212:215], v244 offset:10240
    ds_read_b64_tr_b16 v[200:201], v216 offset:16512
    ds_read_b64_tr_b16 v[202:203], v216 offset:17024
    ds_read_b64_tr_b16 v[204:205], v216 offset:16520
    ds_read_b64_tr_b16 v[206:207], v216 offset:17032
    ds_read_b64_tr_b16 v[208:209], v217 offset:16512
    ds_read_b64_tr_b16 v[210:211], v217 offset:17024
    s_waitcnt lgkmcnt(4)
    v_mfma_f32_16x16x32_bf16 v[0:3], v[200:203], a[192:195], 0
    s_add_u32 m0, s28, 0
    s_add_u32 s73, s48, 0
    v_mfma_f32_16x16x32_bf16 v[4:7], v[200:203], a[196:199], 0
    buffer_load_dwordx4 v220, s[12:15], s73 offen lds
    v_mfma_f32_16x16x32_bf16 v[8:11], v[200:203], a[200:203], 0
    buffer_load_dwordx4 v221, s[12:15], s73 offen offset:1032 lds
    v_mfma_f32_16x16x32_bf16 v[12:15], v[200:203], a[204:207], 0
    ds_read_b64_tr_b16 v[212:213], v217 offset:16520
    ds_read_b64_tr_b16 v[214:215], v217 offset:17032
    v_mfma_f32_16x16x32_bf16 v[16:19], v[200:203], a[208:211], 0
    buffer_load_dwordx4 v222, s[12:15], s73 offen offset:2064 lds
    v_mfma_f32_16x16x32_bf16 v[20:23], v[200:203], a[212:215], 0
    s_waitcnt vmcnt(15)
    s_waitcnt lgkmcnt(4)
    v_mfma_f32_16x16x32_bf16 v[24:27], v[204:207], a[192:195], 0
    buffer_load_dwordx4 v223, s[12:15], s73 offen offset:3096 lds
    v_mfma_f32_16x16x32_bf16 v[28:31], v[204:207], a[196:199], 0
    ds_read_b64_tr_b16 v[200:201], v216 offset:20640
    ds_read_b64_tr_b16 v[202:203], v216 offset:21152
    v_mfma_f32_16x16x32_bf16 v[32:35], v[204:207], a[200:203], 0
    v_mfma_f32_16x16x32_bf16 v[36:39], v[204:207], a[204:207], 0
    ds_read_b128 a[216:219], v245 offset:0
    v_mfma_f32_16x16x32_bf16 v[40:43], v[204:207], a[208:211], 0
    v_mfma_f32_16x16x32_bf16 v[44:47], v[204:207], a[212:215], 0
    s_waitcnt lgkmcnt(5)
    v_mfma_f32_16x16x32_bf16 v[48:51], v[208:211], a[192:195], 0
    ds_read_b64_tr_b16 v[204:205], v216 offset:20648
    ds_read_b64_tr_b16 v[206:207], v216 offset:21160
    v_mfma_f32_16x16x32_bf16 v[52:55], v[208:211], a[196:199], 0
    v_mfma_f32_16x16x32_bf16 v[56:59], v[208:211], a[200:203], 0
    ds_read_b128 a[220:223], v245 offset:2048
    v_mfma_f32_16x16x32_bf16 v[60:63], v[208:211], a[204:207], 0
    v_mfma_f32_16x16x32_bf16 v[64:67], v[208:211], a[208:211], 0
    v_mfma_f32_16x16x32_bf16 v[68:71], v[208:211], a[212:215], 0
    s_waitcnt lgkmcnt(6)
    v_mfma_f32_16x16x32_bf16 v[72:75], v[212:215], a[192:195], 0
    s_add_u32 m0, s28, 4128
    s_add_u32 s73, s48, 128
    v_mfma_f32_16x16x32_bf16 v[76:79], v[212:215], a[196:199], 0
    buffer_load_dwordx4 v220, s[12:15], s73 offen lds
    v_mfma_f32_16x16x32_bf16 v[80:83], v[212:215], a[200:203], 0
    buffer_load_dwordx4 v221, s[12:15], s73 offen offset:1032 lds
    v_mfma_f32_16x16x32_bf16 v[84:87], v[212:215], a[204:207], 0
    ds_read_b64_tr_b16 v[208:209], v217 offset:20640
    ds_read_b64_tr_b16 v[210:211], v217 offset:21152
    v_mfma_f32_16x16x32_bf16 v[88:91], v[212:215], a[208:211], 0
    buffer_load_dwordx4 v222, s[12:15], s73 offen offset:2064 lds
    v_mfma_f32_16x16x32_bf16 v[92:95], v[212:215], a[212:215], 0
    ds_read_b128 a[224:227], v245 offset:4096
    s_waitcnt lgkmcnt(7)
    v_mfma_f32_16x16x32_bf16 v[96:99], v[200:203], a[192:195], 0
    buffer_load_dwordx4 v223, s[12:15], s73 offen offset:3096 lds
    v_mfma_f32_16x16x32_bf16 v[100:103], v[200:203], a[196:199], 0
    ds_read_b64_tr_b16 v[212:213], v217 offset:20648
    ds_read_b64_tr_b16 v[214:215], v217 offset:21160
    v_mfma_f32_16x16x32_bf16 v[104:107], v[200:203], a[200:203], 0
    s_add_u32 s48, s48, 262144
    s_cmp_eq_u32 s48, 4718592
    s_cselect_b32 s48, 0, s48
    v_mfma_f32_16x16x32_bf16 v[108:111], v[200:203], a[204:207], 0
    ds_read_b128 a[228:231], v245 offset:6144
    v_mfma_f32_16x16x32_bf16 v[112:115], v[200:203], a[208:211], 0
    v_mfma_f32_16x16x32_bf16 v[116:119], v[200:203], a[212:215], 0
    s_waitcnt vmcnt(13)
    s_waitcnt lgkmcnt(7)
    v_mfma_f32_16x16x32_bf16 v[120:123], v[204:207], a[192:195], 0
    ds_read_b64_tr_b16 v[200:201], v216 offset:24768
    ds_read_b64_tr_b16 v[202:203], v216 offset:25280
    v_mfma_f32_16x16x32_bf16 v[124:127], v[204:207], a[196:199], 0
    ds_read_b128 a[232:235], v245 offset:8192
    v_mfma_f32_16x16x32_bf16 v[128:131], v[204:207], a[200:203], 0
    v_mfma_f32_16x16x32_bf16 v[132:135], v[204:207], a[204:207], 0
    v_mfma_f32_16x16x32_bf16 v[136:139], v[204:207], a[208:211], 0
    ds_read_b128 a[236:239], v245 offset:10240
    v_mfma_f32_16x16x32_bf16 v[140:143], v[204:207], a[212:215], 0
    s_waitcnt lgkmcnt(8)
    v_mfma_f32_16x16x32_bf16 v[144:147], v[208:211], a[192:195], 0
    s_add_u32 m0, s28, 8256
    s_add_u32 s73, s48, 0
    v_mfma_f32_16x16x32_bf16 v[148:151], v[208:211], a[196:199], 0
    buffer_load_dwordx4 v220, s[12:15], s73 offen lds
    v_mfma_f32_16x16x32_bf16 v[152:155], v[208:211], a[200:203], 0
    buffer_load_dwordx4 v221, s[12:15], s73 offen offset:1032 lds
    v_mfma_f32_16x16x32_bf16 v[156:159], v[208:211], a[204:207], 0
    ds_read_b64_tr_b16 v[204:205], v216 offset:24776
    ds_read_b64_tr_b16 v[206:207], v216 offset:25288
    v_mfma_f32_16x16x32_bf16 v[160:163], v[208:211], a[208:211], 0
    buffer_load_dwordx4 v222, s[12:15], s73 offen offset:2064 lds
    v_mfma_f32_16x16x32_bf16 v[164:167], v[208:211], a[212:215], 0
    s_waitcnt lgkmcnt(7)
    v_mfma_f32_16x16x32_bf16 v[168:171], v[212:215], a[192:195], 0
    buffer_load_dwordx4 v223, s[12:15], s73 offen offset:3096 lds
    v_mfma_f32_16x16x32_bf16 v[172:175], v[212:215], a[196:199], 0
    ds_read_b64_tr_b16 v[208:209], v217 offset:24768
    ds_read_b64_tr_b16 v[210:211], v217 offset:25280
    v_mfma_f32_16x16x32_bf16 v[176:179], v[212:215], a[200:203], 0
    v_mfma_f32_16x16x32_bf16 v[180:183], v[212:215], a[204:207], 0
    v_mfma_f32_16x16x32_bf16 v[184:187], v[212:215], a[208:211], 0
    v_mfma_f32_16x16x32_bf16 v[188:191], v[212:215], a[212:215], 0
    s_waitcnt lgkmcnt(6)
    v_mfma_f32_16x16x32_bf16 v[0:3], v[200:203], a[216:219], v[0:3]
    ds_read_b64_tr_b16 v[212:213], v217 offset:24776
    ds_read_b64_tr_b16 v[214:215], v217 offset:25288
    v_mfma_f32_16x16x32_bf16 v[4:7], v[200:203], a[220:223], v[4:7]
    v_mfma_f32_16x16x32_bf16 v[8:11], v[200:203], a[224:227], v[8:11]
    v_mfma_f32_16x16x32_bf16 v[12:15], v[200:203], a[228:231], v[12:15]
    s_waitcnt lgkmcnt(7)
    v_mfma_f32_16x16x32_bf16 v[16:19], v[200:203], a[232:235], v[16:19]
    s_waitcnt lgkmcnt(6)
    v_mfma_f32_16x16x32_bf16 v[20:23], v[200:203], a[236:239], v[20:23]
    s_waitcnt vmcnt(13)
    s_waitcnt lgkmcnt(4)
    v_mfma_f32_16x16x32_bf16 v[24:27], v[204:207], a[216:219], v[24:27]
    s_add_u32 m0, s28, 12384
    s_add_u32 s73, s48, 128
    v_mfma_f32_16x16x32_bf16 v[28:31], v[204:207], a[220:223], v[28:31]
    s_barrier
    v_mfma_f32_16x16x32_bf16 v[32:35], v[204:207], a[224:227], v[32:35]
    buffer_load_dwordx4 v220, s[12:15], s73 offen lds
    v_mfma_f32_16x16x32_bf16 v[36:39], v[204:207], a[228:231], v[36:39]
    buffer_load_dwordx4 v221, s[12:15], s73 offen offset:1032 lds
    v_mfma_f32_16x16x32_bf16 v[40:43], v[204:207], a[232:235], v[40:43]
    ds_read_b64_tr_b16 v[200:201], v216 offset:28896
    ds_read_b64_tr_b16 v[202:203], v216 offset:29408
    buffer_load_dwordx4 v222, s[12:15], s73 offen offset:2064 lds
    v_mfma_f32_16x16x32_bf16 v[44:47], v[204:207], a[236:239], v[44:47]
    ds_read_b128 a[192:195], v244 offset:12288
    s_waitcnt lgkmcnt(5)
    v_mfma_f32_16x16x32_bf16 v[48:51], v[208:211], a[216:219], v[48:51]
    buffer_load_dwordx4 v223, s[12:15], s73 offen offset:3096 lds
    v_mfma_f32_16x16x32_bf16 v[52:55], v[208:211], a[220:223], v[52:55]
    ds_read_b64_tr_b16 v[204:205], v216 offset:28904
    ds_read_b64_tr_b16 v[206:207], v216 offset:29416
    v_mfma_f32_16x16x32_bf16 v[56:59], v[208:211], a[224:227], v[56:59]
    s_add_u32 s48, s48, 262144
    s_cmp_eq_u32 s48, 4718592
    s_cselect_b32 s48, 0, s48
    v_lshlrev_b32 v226, 7, v198
    v_mov_b32 v227, 2147483632
    s_cmp_eq_u32 s3, 0
    s_cselect_b32 s87, 32, 0
    v_cmp_gt_u32 vcc, s87, v198
    s_lshl_b32 s87, s5, 12
    s_nop 0
    v_cndmask_b32 v226, v227, v226, vcc
    v_mov_b32 v227, 0
    buffer_store_dword v227, v226, s[60:63], s87 offen sc1
    s_add_u32 m0, s72, 0
    s_add_u32 s73, s49, 0
    buffer_load_dwordx4 v224, s[16:19], s73 offen lds
    s_add_u32 m0, s72, 4096
    s_add_u32 s73, s49, 36864
    buffer_load_dwordx4 v224, s[16:19], s73 offen lds
    v_mfma_f32_16x16x32_bf16 v[60:63], v[208:211], a[228:231], v[60:63]
    v_mfma_f32_16x16x32_bf16 v[64:67], v[208:211], a[232:235], v[64:67]
    s_add_u32 m0, s72, 8192
    s_add_u32 s73, s49, 73728
    v_mfma_f32_16x16x32_bf16 v[68:71], v[208:211], a[236:239], v[68:71]
    buffer_load_dwordx4 v224, s[16:19], s73 offen lds
    s_waitcnt lgkmcnt(5)
    v_mfma_f32_16x16x32_bf16 v[72:75], v[212:215], a[216:219], v[72:75]
    v_mfma_f32_16x16x32_bf16 v[76:79], v[212:215], a[220:223], v[76:79]
    s_add_u32 s49, s49, 128
    s_cmp_eq_u32 s49, 1152
    s_cselect_b32 s49, 0, s49
    v_mfma_f32_16x16x32_bf16 v[80:83], v[212:215], a[224:227], v[80:83]
    v_mfma_f32_16x16x32_bf16 v[84:87], v[212:215], a[228:231], v[84:87]
    v_mfma_f32_16x16x32_bf16 v[88:91], v[212:215], a[232:235], v[88:91]
    ds_read_b64_tr_b16 v[208:209], v217 offset:28896
    ds_read_b64_tr_b16 v[210:211], v217 offset:29408
    v_mfma_f32_16x16x32_bf16 v[92:95], v[212:215], a[236:239], v[92:95]
    s_waitcnt lgkmcnt(5)
    v_mfma_f32_16x16x32_bf16 v[96:99], v[200:203], a[216:219], v[96:99]
    v_mfma_f32_16x16x32_bf16 v[100:103], v[200:203], a[220:223], v[100:103]
    s_add_u32 m0, s28, 16512
    s_add_u32 s73, s48, 0
    v_mfma_f32_16x16x32_bf16 v[104:107], v[200:203], a[224:227], v[104:107]
    buffer_load_dwordx4 v220, s[12:15], s73 offen lds
    v_mfma_f32_16x16x32_bf16 v[108:111], v[200:203], a[228:231], v[108:111]
    buffer_load_dwordx4 v221, s[12:15], s73 offen offset:1032 lds
    v_mfma_f32_16x16x32_bf16 v[112:115], v[200:203], a[232:235], v[112:115]
    ds_read_b64_tr_b16 v[212:213], v217 offset:28904
    ds_read_b64_tr_b16 v[214:215], v217 offset:29416
    v_mfma_f32_16x16x32_bf16 v[116:119], v[200:203], a[236:239], v[116:119]
    buffer_load_dwordx4 v222, s[12:15], s73 offen offset:2064 lds
    s_waitcnt lgkmcnt(4)
    v_mfma_f32_16x16x32_bf16 v[120:123], v[204:207], a[216:219], v[120:123]
    v_mfma_f32_16x16x32_bf16 v[124:127], v[204:207], a[220:223], v[124:127]
    ds_read_b128 a[196:199], v244 offset:14336
    buffer_load_dwordx4 v223, s[12:15], s73 offen offset:3096 lds
    v_mfma_f32_16x16x32_bf16 v[128:131], v[204:207], a[224:227], v[128:131]
    s_waitcnt vmcnt(20)
    ds_read_b128 a[200:203], v244 offset:16384
    v_mfma_f32_16x16x32_bf16 v[132:135], v[204:207], a[228:231], v[132:135]
    ds_read_b128 a[204:207], v244 offset:18432
    v_mfma_f32_16x16x32_bf16 v[136:139], v[204:207], a[232:235], v[136:139]
    ds_read_b64_tr_b16 v[200:201], v216 offset:0
    ds_read_b64_tr_b16 v[202:203], v216 offset:512
    ds_read_b128 a[208:211], v244 offset:20480
    v_mfma_f32_16x16x32_bf16 v[140:143], v[204:207], a[236:239], v[140:143]
    ds_read_b128 a[212:215], v244 offset:22528
    s_waitcnt lgkmcnt(9)
    v_mfma_f32_16x16x32_bf16 v[144:147], v[208:211], a[216:219], v[144:147]
    v_mfma_f32_16x16x32_bf16 v[148:151], v[208:211], a[220:223], v[148:151]
    ds_read_b64_tr_b16 v[204:205], v216 offset:8
    ds_read_b64_tr_b16 v[206:207], v216 offset:520
    v_mfma_f32_16x16x32_bf16 v[152:155], v[208:211], a[224:227], v[152:155]
    v_mfma_f32_16x16x32_bf16 v[156:159], v[208:211], a[228:231], v[156:159]
    v_mfma_f32_16x16x32_bf16 v[160:163], v[208:211], a[232:235], v[160:163]
    v_mfma_f32_16x16x32_bf16 v[164:167], v[208:211], a[236:239], v[164:167]
    s_waitcnt lgkmcnt(9)
    v_mfma_f32_16x16x32_bf16 v[168:171], v[212:215], a[216:219], v[168:171]
    s_add_u32 m0, s28, 20640
    s_add_u32 s73, s48, 128
    v_mfma_f32_16x16x32_bf16 v[172:175], v[212:215], a[220:223], v[172:175]
    buffer_load_dwordx4 v220, s[12:15], s73 offen lds
    v_mfma_f32_16x16x32_bf16 v[176:179], v[212:215], a[224:227], v[176:179]
    buffer_load_dwordx4 v221, s[12:15], s73 offen offset:1032 lds
    v_mfma_f32_16x16x32_bf16 v[180:183], v[212:215], a[228:231], v[180:183]
    ds_read_b64_tr_b16 v[208:209], v217 offset:0
    ds_read_b64_tr_b16 v[210:211], v217 offset:512
    v_mfma_f32_16x16x32_bf16 v[184:187], v[212:215], a[232:235], v[184:187]
    buffer_load_dwordx4 v222, s[12:15], s73 offen offset:2064 lds
    v_mfma_f32_16x16x32_bf16 v[188:191], v[212:215], a[236:239], v[188:191]
    s_waitcnt lgkmcnt(6)
    v_mfma_f32_16x16x32_bf16 v[0:3], v[200:203], a[192:195], v[0:3]
    buffer_load_dwordx4 v223, s[12:15], s73 offen offset:3096 lds
    v_mfma_f32_16x16x32_bf16 v[4:7], v[200:203], a[196:199], v[4:7]
    ds_read_b64_tr_b16 v[212:213], v217 offset:8
    ds_read_b64_tr_b16 v[214:215], v217 offset:520
    v_mfma_f32_16x16x32_bf16 v[8:11], v[200:203], a[200:203], v[8:11]
    s_add_u32 s48, s48, 262144
    s_cmp_eq_u32 s48, 4718592
    s_cselect_b32 s48, 0, s48
    v_mfma_f32_16x16x32_bf16 v[12:15], v[200:203], a[204:207], v[12:15]
    s_waitcnt lgkmcnt(7)
    v_mfma_f32_16x16x32_bf16 v[16:19], v[200:203], a[208:211], v[16:19]
    s_waitcnt lgkmcnt(6)
    v_mfma_f32_16x16x32_bf16 v[20:23], v[200:203], a[212:215], v[20:23]
    s_waitcnt vmcnt(20)
    s_waitcnt lgkmcnt(4)
    v_mfma_f32_16x16x32_bf16 v[24:27], v[204:207], a[192:195], v[24:27]
    ds_read_b64_tr_b16 v[200:201], v216 offset:4128
    ds_read_b64_tr_b16 v[202:203], v216 offset:4640
    v_mfma_f32_16x16x32_bf16 v[28:31], v[204:207], a[196:199], v[28:31]
    v_mfma_f32_16x16x32_bf16 v[32:35], v[204:207], a[200:203], v[32:35]
    v_mfma_f32_16x16x32_bf16 v[36:39], v[204:207], a[204:207], v[36:39]
    ds_read_b128 a[216:219], v245 offset:12288
    v_mfma_f32_16x16x32_bf16 v[40:43], v[204:207], a[208:211], v[40:43]
    v_mfma_f32_16x16x32_bf16 v[44:47], v[204:207], a[212:215], v[44:47]
    s_waitcnt lgkmcnt(5)
    v_mfma_f32_16x16x32_bf16 v[48:51], v[208:211], a[192:195], v[48:51]
    s_add_u32 m0, s28, 24768
    s_add_u32 s73, s48, 0
    v_mfma_f32_16x16x32_bf16 v[52:55], v[208:211], a[196:199], v[52:55]
    buffer_load_dwordx4 v220, s[12:15], s73 offen lds
    v_mfma_f32_16x16x32_bf16 v[56:59], v[208:211], a[200:203], v[56:59]
    buffer_load_dwordx4 v221, s[12:15], s73 offen offset:1032 lds
    v_mfma_f32_16x16x32_bf16 v[60:63], v[208:211], a[204:207], v[60:63]
    ds_read_b64_tr_b16 v[204:205], v216 offset:4136
    ds_read_b64_tr_b16 v[206:207], v216 offset:4648
    v_mfma_f32_16x16x32_bf16 v[64:67], v[208:211], a[208:211], v[64:67]
    buffer_load_dwordx4 v222, s[12:15], s73 offen offset:2064 lds
    v_mfma_f32_16x16x32_bf16 v[68:71], v[208:211], a[212:215], v[68:71]
    ds_read_b128 a[220:223], v245 offset:14336
    s_waitcnt lgkmcnt(6)
    v_mfma_f32_16x16x32_bf16 v[72:75], v[212:215], a[192:195], v[72:75]
    buffer_load_dwordx4 v223, s[12:15], s73 offen offset:3096 lds
    v_mfma_f32_16x16x32_bf16 v[76:79], v[212:215], a[196:199], v[76:79]
    ds_read_b64_tr_b16 v[208:209], v217 offset:4128
    ds_read_b64_tr_b16 v[210:211], v217 offset:4640
    v_mfma_f32_16x16x32_bf16 v[80:83], v[212:215], a[200:203], v[80:83]
    ds_read_b128 a[224:227], v245 offset:16384
    v_mfma_f32_16x16x32_bf16 v[84:87], v[212:215], a[204:207], v[84:87]
    v_mfma_f32_16x16x32_bf16 v[88:91], v[212:215], a[208:211], v[88:91]
    v_mfma_f32_16x16x32_bf16 v[92:95], v[212:215], a[212:215], v[92:95]
    s_waitcnt lgkmcnt(7)
    v_mfma_f32_16x16x32_bf16 v[96:99], v[200:203], a[192:195], v[96:99]
    ds_read_b64_tr_b16 v[212:213], v217 offset:4136
    ds_read_b64_tr_b16 v[214:215], v217 offset:4648
    v_mfma_f32_16x16x32_bf16 v[100:103], v[200:203], a[196:199], v[100:103]
    ds_read_b128 a[228:231], v245 offset:18432
    v_mfma_f32_16x16x32_bf16 v[104:107], v[200:203], a[200:203], v[104:107]
    v_mfma_f32_16x16x32_bf16 v[108:111], v[200:203], a[204:207], v[108:111]
    v_mfma_f32_16x16x32_bf16 v[112:115], v[200:203], a[208:211], v[112:115]
    v_mfma_f32_16x16x32_bf16 v[116:119], v[200:203], a[212:215], v[116:119]
    s_waitcnt vmcnt(20)
    s_waitcnt lgkmcnt(7)
    v_mfma_f32_16x16x32_bf16 v[120:123], v[204:207], a[192:195], v[120:123]
    s_add_u32 m0, s28, 28896
    s_add_u32 s73, s48, 128
    v_mfma_f32_16x16x32_bf16 v[124:127], v[204:207], a[196:199], v[124:127]
    buffer_load_dwordx4 v220, s[12:15], s73 offen lds
    v_mfma_f32_16x16x32_bf16 v[128:131], v[204:207], a[200:203], v[128:131]
    buffer_load_dwordx4 v221, s[12:15], s73 offen offset:1032 lds
    v_mfma_f32_16x16x32_bf16 v[132:135], v[204:207], a[204:207], v[132:135]
    ds_read_b64_tr_b16 v[200:201], v216 offset:8256
    ds_read_b64_tr_b16 v[202:203], v216 offset:8768
    v_mfma_f32_16x16x32_bf16 v[136:139], v[204:207], a[208:211], v[136:139]
    ds_read_b128 a[232:235], v245 offset:20480
    ds_read_b128 a[236:239], v245 offset:22528
    v_mfma_f32_16x16x32_bf16 v[140:143], v[204:207], a[212:215], v[140:143]
    buffer_load_dwordx4 v222, s[12:15], s73 offen offset:2064 lds
    s_waitcnt lgkmcnt(8)
    v_mfma_f32_16x16x32_bf16 v[144:147], v[208:211], a[192:195], v[144:147]
    buffer_load_dwordx4 v223, s[12:15], s73 offen offset:3096 lds
    v_mfma_f32_16x16x32_bf16 v[148:151], v[208:211], a[196:199], v[148:151]
    ds_read_b64_tr_b16 v[204:205], v216 offset:8264
    ds_read_b64_tr_b16 v[206:207], v216 offset:8776
    v_mfma_f32_16x16x32_bf16 v[152:155], v[208:211], a[200:203], v[152:155]
    s_add_u32 s48, s48, 262144
    s_cmp_eq_u32 s48, 4718592
    s_cselect_b32 s48, 0, s48
    v_mfma_f32_16x16x32_bf16 v[156:159], v[208:211], a[204:207], v[156:159]
    v_mfma_f32_16x16x32_bf16 v[160:163], v[208:211], a[208:211], v[160:163]
    v_mfma_f32_16x16x32_bf16 v[164:167], v[208:211], a[212:215], v[164:167]
    s_waitcnt lgkmcnt(7)
    v_mfma_f32_16x16x32_bf16 v[168:171], v[212:215], a[192:195], v[168:171]
    ds_read_b64_tr_b16 v[208:209], v217 offset:8256
    ds_read_b64_tr_b16 v[210:211], v217 offset:8768
    v_mfma_f32_16x16x32_bf16 v[172:175], v[212:215], a[196:199], v[172:175]
    v_mfma_f32_16x16x32_bf16 v[176:179], v[212:215], a[200:203], v[176:179]
    v_mfma_f32_16x16x32_bf16 v[180:183], v[212:215], a[204:207], v[180:183]
    v_mfma_f32_16x16x32_bf16 v[184:187], v[212:215], a[208:211], v[184:187]
    v_mfma_f32_16x16x32_bf16 v[188:191], v[212:215], a[212:215], v[188:191]
    s_waitcnt lgkmcnt(6)
    v_mfma_f32_16x16x32_bf16 v[0:3], v[200:203], a[216:219], v[0:3]
    s_add_u32 m0, s28, 0
    s_add_u32 s73, s48, 0
    v_mfma_f32_16x16x32_bf16 v[4:7], v[200:203], a[220:223], v[4:7]
    buffer_load_dwordx4 v220, s[12:15], s73 offen lds
    v_mfma_f32_16x16x32_bf16 v[8:11], v[200:203], a[224:227], v[8:11]
    buffer_load_dwordx4 v221, s[12:15], s73 offen offset:1032 lds
    v_mfma_f32_16x16x32_bf16 v[12:15], v[200:203], a[228:231], v[12:15]
    ds_read_b64_tr_b16 v[212:213], v217 offset:8264
    ds_read_b64_tr_b16 v[214:215], v217 offset:8776
    s_waitcnt lgkmcnt(7)
    v_mfma_f32_16x16x32_bf16 v[16:19], v[200:203], a[232:235], v[16:19]
    buffer_load_dwordx4 v222, s[12:15], s73 offen offset:2064 lds
    s_waitcnt lgkmcnt(6)
    v_mfma_f32_16x16x32_bf16 v[20:23], v[200:203], a[236:239], v[20:23]
    s_waitcnt vmcnt(23)
    s_waitcnt lgkmcnt(4)
    v_mfma_f32_16x16x32_bf16 v[24:27], v[204:207], a[216:219], v[24:27]
    buffer_load_dwordx4 v223, s[12:15], s73 offen offset:3096 lds
    v_mfma_f32_16x16x32_bf16 v[28:31], v[204:207], a[220:223], v[28:31]
    s_waitcnt vmcnt(20)
    s_barrier
    v_mfma_f32_16x16x32_bf16 v[32:35], v[204:207], a[224:227], v[32:35]
    ds_read_b64_tr_b16 v[200:201], v216 offset:12384
    ds_read_b64_tr_b16 v[202:203], v216 offset:12896
    v_mfma_f32_16x16x32_bf16 v[36:39], v[204:207], a[228:231], v[36:39]
    s_add_u32 m0, s72, 12288
    s_add_u32 s73, s49, 0
    v_mfma_f32_16x16x32_bf16 v[40:43], v[204:207], a[232:235], v[40:43]
    buffer_load_dwordx4 v224, s[16:19], s73 offen lds
    v_mfma_f32_16x16x32_bf16 v[44:47], v[204:207], a[236:239], v[44:47]
    ds_read_b128 a[192:195], v244 offset:0
    s_waitcnt lgkmcnt(5)
    v_mfma_f32_16x16x32_bf16 v[48:51], v[208:211], a[216:219], v[48:51]
    s_add_u32 m0, s72, 16384
    s_add_u32 s73, s49, 36864
    v_mfma_f32_16x16x32_bf16 v[52:55], v[208:211], a[220:223], v[52:55]
    buffer_load_dwordx4 v224, s[16:19], s73 offen lds
    v_mfma_f32_16x16x32_bf16 v[56:59], v[208:211], a[224:227], v[56:59]
    ds_read_b64_tr_b16 v[204:205], v216 offset:12392
    ds_read_b64_tr_b16 v[206:207], v216 offset:12904
    v_mfma_f32_16x16x32_bf16 v[60:63], v[208:211], a[228:231], v[60:63]
    s_add_u32 m0, s72, 20480
    s_add_u32 s73, s49, 73728
    v_mfma_f32_16x16x32_bf16 v[64:67], v[208:211], a[232:235], v[64:67]
    buffer_load_dwordx4 v224, s[16:19], s73 offen lds
    v_mfma_f32_16x16x32_bf16 v[68:71], v[208:211], a[236:239], v[68:71]
    ds_read_b128 a[196:199], v244 offset:2048
    s_waitcnt lgkmcnt(6)
    v_mfma_f32_16x16x32_bf16 v[72:75], v[212:215], a[216:219], v[72:75]
    s_add_u32 s49, s49, 128
    s_cmp_eq_u32 s49, 1152
    s_cselect_b32 s49, 0, s49
    v_mfma_f32_16x16x32_bf16 v[76:79], v[212:215], a[220:223], v[76:79]
    s_add_u32 m0, s28, 4128
    s_add_u32 s73, s48, 128
    v_mfma_f32_16x16x32_bf16 v[80:83], v[212:215], a[224:227], v[80:83]
    buffer_load_dwordx4 v220, s[12:15], s73 offen lds
    v_mfma_f32_16x16x32_bf16 v[84:87], v[212:215], a[228:231], v[84:87]
    buffer_load_dwordx4 v221, s[12:15], s73 offen offset:1032 lds
    v_mfma_f32_16x16x32_bf16 v[88:91], v[212:215], a[232:235], v[88:91]
    ds_read_b64_tr_b16 v[208:209], v217 offset:12384
    ds_read_b64_tr_b16 v[210:211], v217 offset:12896
    v_mfma_f32_16x16x32_bf16 v[92:95], v[212:215], a[236:239], v[92:95]
    buffer_load_dwordx4 v222, s[12:15], s73 offen offset:2064 lds
    s_waitcnt lgkmcnt(6)
    v_mfma_f32_16x16x32_bf16 v[96:99], v[200:203], a[216:219], v[96:99]
    buffer_load_dwordx4 v223, s[12:15], s73 offen offset:3096 lds
    v_mfma_f32_16x16x32_bf16 v[100:103], v[200:203], a[220:223], v[100:103]
    ds_read_b64_tr_b16 v[212:213], v217 offset:12392
    ds_read_b64_tr_b16 v[214:215], v217 offset:12904
    v_mfma_f32_16x16x32_bf16 v[104:107], v[200:203], a[224:227], v[104:107]
    s_add_u32 s48, s48, 262144
    s_cmp_eq_u32 s48, 4718592
    s_cselect_b32 s48, 0, s48
    v_mfma_f32_16x16x32_bf16 v[108:111], v[200:203], a[228:231], v[108:111]
    ds_read_b128 a[200:203], v244 offset:4096
    ds_read_b128 a[204:207], v244 offset:6144
    v_mfma_f32_16x16x32_bf16 v[112:115], v[200:203], a[232:235], v[112:115]
    v_mfma_f32_16x16x32_bf16 v[116:119], v[200:203], a[236:239], v[116:119]
    s_waitcnt vmcnt(23)
    s_waitcnt lgkmcnt(7)
    v_mfma_f32_16x16x32_bf16 v[120:123], v[204:207], a[216:219], v[120:123]
    ds_read_b64_tr_b16 v[200:201], v216 offset:16512
    ds_read_b64_tr_b16 v[202:203], v216 offset:17024
    v_mfma_f32_16x16x32_bf16 v[124:127], v[204:207], a[220:223], v[124:127]
    ds_read_b128 a[208:211], v244 offset:8192
    v_mfma_f32_16x16x32_bf16 v[128:131], v[204:207], a[224:227], v[128:131]
    v_mfma_f32_16x16x32_bf16 v[132:135], v[204:207], a[228:231], v[132:135]
    v_mfma_f32_16x16x32_bf16 v[136:139], v[204:207], a[232:235], v[136:139]
    ds_read_b128 a[212:215], v244 offset:10240
    v_mfma_f32_16x16x32_bf16 v[140:143], v[204:207], a[236:239], v[140:143]
    s_waitcnt lgkmcnt(8)
    v_mfma_f32_16x16x32_bf16 v[144:147], v[208:211], a[216:219], v[144:147]
    s_add_u32 m0, s28, 8256
    s_add_u32 s73, s48, 0
    v_mfma_f32_16x16x32_bf16 v[148:151], v[208:211], a[220:223], v[148:151]
    buffer_load_dwordx4 v220, s[12:15], s73 offen lds
    v_mfma_f32_16x16x32_bf16 v[152:155], v[208:211], a[224:227], v[152:155]
    buffer_load_dwordx4 v221, s[12:15], s73 offen offset:1032 lds
    v_mfma_f32_16x16x32_bf16 v[156:159], v[208:211], a[228:231], v[156:159]
    ds_read_b64_tr_b16 v[204:205], v216 offset:16520
    ds_read_b64_tr_b16 v[206:207], v216 offset:17032
    v_mfma_f32_16x16x32_bf16 v[160:163], v[208:211], a[232:235], v[160:163]
    buffer_load_dwordx4 v222, s[12:15], s73 offen offset:2064 lds
    v_mfma_f32_16x16x32_bf16 v[164:167], v[208:211], a[236:239], v[164:167]
    s_waitcnt lgkmcnt(8)
    v_mfma_f32_16x16x32_bf16 v[168:171], v[212:215], a[216:219], v[168:171]
    buffer_load_dwordx4 v223, s[12:15], s73 offen offset:3096 lds
    v_mfma_f32_16x16x32_bf16 v[172:175], v[212:215], a[220:223], v[172:175]
    ds_read_b64_tr_b16 v[208:209], v217 offset:16512
    ds_read_b64_tr_b16 v[210:211], v217 offset:17024
    v_mfma_f32_16x16x32_bf16 v[176:179], v[212:215], a[224:227], v[176:179]
    v_mfma_f32_16x16x32_bf16 v[180:183], v[212:215], a[228:231], v[180:183]
    v_mfma_f32_16x16x32_bf16 v[184:187], v[212:215], a[232:235], v[184:187]
    v_mfma_f32_16x16x32_bf16 v[188:191], v[212:215], a[236:239], v[188:191]
    s_waitcnt lgkmcnt(6)
    v_mfma_f32_16x16x32_bf16 v[0:3], v[200:203], a[192:195], v[0:3]
    ds_read_b64_tr_b16 v[212:213], v217 offset:16520
    ds_read_b64_tr_b16 v[214:215], v217 offset:17032
    v_mfma_f32_16x16x32_bf16 v[4:7], v[200:203], a[196:199], v[4:7]
    v_mfma_f32_16x16x32_bf16 v[8:11], v[200:203], a[200:203], v[8:11]
    v_mfma_f32_16x16x32_bf16 v[12:15], v[200:203], a[204:207], v[12:15]
    s_waitcnt lgkmcnt(7)
    v_mfma_f32_16x16x32_bf16 v[16:19], v[200:203], a[208:211], v[16:19]
    s_waitcnt lgkmcnt(6)
    v_mfma_f32_16x16x32_bf16 v[20:23], v[200:203], a[212:215], v[20:23]
    s_waitcnt vmcnt(23)
    s_waitcnt lgkmcnt(4)
    v_mfma_f32_16x16x32_bf16 v[24:27], v[204:207], a[192:195], v[24:27]
    s_add_u32 m0, s28, 12384
    s_add_u32 s73, s48, 128
    v_mfma_f32_16x16x32_bf16 v[28:31], v[204:207], a[196:199], v[28:31]
    buffer_load_dwordx4 v220, s[12:15], s73 offen lds
    v_mfma_f32_16x16x32_bf16 v[32:35], v[204:207], a[200:203], v[32:35]
    buffer_load_dwordx4 v221, s[12:15], s73 offen offset:1032 lds
    v_mfma_f32_16x16x32_bf16 v[36:39], v[204:207], a[204:207], v[36:39]
    ds_read_b64_tr_b16 v[200:201], v216 offset:20640
    ds_read_b64_tr_b16 v[202:203], v216 offset:21152
    v_mfma_f32_16x16x32_bf16 v[40:43], v[204:207], a[208:211], v[40:43]
    buffer_load_dwordx4 v222, s[12:15], s73 offen offset:2064 lds
    v_mfma_f32_16x16x32_bf16 v[44:47], v[204:207], a[212:215], v[44:47]
    ds_read_b128 a[216:219], v245 offset:0
    s_waitcnt lgkmcnt(5)
    v_mfma_f32_16x16x32_bf16 v[48:51], v[208:211], a[192:195], v[48:51]
    buffer_load_dwordx4 v223, s[12:15], s73 offen offset:3096 lds
    v_mfma_f32_16x16x32_bf16 v[52:55], v[208:211], a[196:199], v[52:55]
    ds_read_b64_tr_b16 v[204:205], v216 offset:20648
    ds_read_b64_tr_b16 v[206:207], v216 offset:21160
    v_mfma_f32_16x16x32_bf16 v[56:59], v[208:211], a[200:203], v[56:59]
    s_add_u32 s48, s48, 262144
    s_cmp_eq_u32 s48, 4718592
    s_cselect_b32 s48, 0, s48
    v_mfma_f32_16x16x32_bf16 v[60:63], v[208:211], a[204:207], v[60:63]
    ds_read_b128 a[220:223], v245 offset:2048
    v_mfma_f32_16x16x32_bf16 v[64:67], v[208:211], a[208:211], v[64:67]
    v_mfma_f32_16x16x32_bf16 v[68:71], v[208:211], a[212:215], v[68:71]
    s_waitcnt lgkmcnt(6)
    v_mfma_f32_16x16x32_bf16 v[72:75], v[212:215], a[192:195], v[72:75]
    ds_read_b64_tr_b16 v[208:209], v217 offset:20640
    ds_read_b64_tr_b16 v[210:211], v217 offset:21152
    v_mfma_f32_16x16x32_bf16 v[76:79], v[212:215], a[196:199], v[76:79]
    ds_read_b128 a[224:227], v245 offset:4096
    v_mfma_f32_16x16x32_bf16 v[80:83], v[212:215], a[200:203], v[80:83]
    v_mfma_f32_16x16x32_bf16 v[84:87], v[212:215], a[204:207], v[84:87]
    v_mfma_f32_16x16x32_bf16 v[88:91], v[212:215], a[208:211], v[88:91]
    v_mfma_f32_16x16x32_bf16 v[92:95], v[212:215], a[212:215], v[92:95]
    s_waitcnt lgkmcnt(7)
    v_mfma_f32_16x16x32_bf16 v[96:99], v[200:203], a[192:195], v[96:99]
    s_add_u32 m0, s28, 16512
    s_add_u32 s73, s48, 0
    v_mfma_f32_16x16x32_bf16 v[100:103], v[200:203], a[196:199], v[100:103]
    buffer_load_dwordx4 v220, s[12:15], s73 offen lds
    v_mfma_f32_16x16x32_bf16 v[104:107], v[200:203], a[200:203], v[104:107]
    buffer_load_dwordx4 v221, s[12:15], s73 offen offset:1032 lds
    v_mfma_f32_16x16x32_bf16 v[108:111], v[200:203], a[204:207], v[108:111]
    ds_read_b64_tr_b16 v[212:213], v217 offset:20648
    ds_read_b64_tr_b16 v[214:215], v217 offset:21160
    v_mfma_f32_16x16x32_bf16 v[112:115], v[200:203], a[208:211], v[112:115]
    buffer_load_dwordx4 v222, s[12:15], s73 offen offset:2064 lds
    v_mfma_f32_16x16x32_bf16 v[116:119], v[200:203], a[212:215], v[116:119]
    s_waitcnt vmcnt(26)
    s_waitcnt lgkmcnt(6)
    v_mfma_f32_16x16x32_bf16 v[120:123], v[204:207], a[192:195], v[120:123]
    buffer_load_dwordx4 v223, s[12:15], s73 offen offset:3096 lds
    v_mfma_f32_16x16x32_bf16 v[124:127], v[204:207], a[196:199], v[124:127]
    ds_read_b128 a[228:231], v245 offset:6144
    ds_read_b128 a[232:235], v245 offset:8192
    v_mfma_f32_16x16x32_bf16 v[128:131], v[204:207], a[200:203], v[128:131]
    ds_read_b64_tr_b16 v[200:201], v216 offset:24768
    ds_read_b64_tr_b16 v[202:203], v216 offset:25280
    v_mfma_f32_16x16x32_bf16 v[132:135], v[204:207], a[204:207], v[132:135]
    v_mfma_f32_16x16x32_bf16 v[136:139], v[204:207], a[208:211], v[136:139]
    ds_read_b128 a[236:239], v245 offset:10240
    v_mfma_f32_16x16x32_bf16 v[140:143], v[204:207], a[212:215], v[140:143]
    s_waitcnt lgkmcnt(8)
    v_mfma_f32_16x16x32_bf16 v[144:147], v[208:211], a[192:195], v[144:147]
    ds_read_b64_tr_b16 v[204:205], v216 offset:24776
    ds_read_b64_tr_b16 v[206:207], v216 offset:25288
    v_mfma_f32_16x16x32_bf16 v[148:151], v[208:211], a[196:199], v[148:151]
    v_mfma_f32_16x16x32_bf16 v[152:155], v[208:211], a[200:203], v[152:155]
    v_mfma_f32_16x16x32_bf16 v[156:159], v[208:211], a[204:207], v[156:159]
    v_mfma_f32_16x16x32_bf16 v[160:163], v[208:211], a[208:211], v[160:163]
    v_mfma_f32_16x16x32_bf16 v[164:167], v[208:211], a[212:215], v[164:167]
    s_waitcnt lgkmcnt(7)
    v_mfma_f32_16x16x32_bf16 v[168:171], v[212:215], a[192:195], v[168:171]
    s_add_u32 m0, s28, 20640
    s_add_u32 s73, s48, 128
    v_mfma_f32_16x16x32_bf16 v[172:175], v[212:215], a[196:199], v[172:175]
    buffer_load_dwordx4 v220, s[12:15], s73 offen lds
    v_mfma_f32_16x16x32_bf16 v[176:179], v[212:215], a[200:203], v[176:179]
    buffer_load_dwordx4 v221, s[12:15], s73 offen offset:1032 lds
    v_mfma_f32_16x16x32_bf16 v[180:183], v[212:215], a[204:207], v[180:183]
    ds_read_b64_tr_b16 v[208:209], v217 offset:24768
    ds_read_b64_tr_b16 v[210:211], v217 offset:25280
    v_mfma_f32_16x16x32_bf16 v[184:187], v[212:215], a[208:211], v[184:187]
    buffer_load_dwordx4 v222, s[12:15], s73 offen offset:2064 lds
    v_mfma_f32_16x16x32_bf16 v[188:191], v[212:215], a[212:215], v[188:191]
    s_waitcnt lgkmcnt(5)
    v_mfma_f32_16x16x32_bf16 v[0:3], v[200:203], a[216:219], v[0:3]
    buffer_load_dwordx4 v223, s[12:15], s73 offen offset:3096 lds
    v_mfma_f32_16x16x32_bf16 v[4:7], v[200:203], a[220:223], v[4:7]
    ds_read_b64_tr_b16 v[212:213], v217 offset:24776
    ds_read_b64_tr_b16 v[214:215], v217 offset:25288
    v_mfma_f32_16x16x32_bf16 v[8:11], v[200:203], a[224:227], v[8:11]
    s_add_u32 s48, s48, 262144
    s_cmp_eq_u32 s48, 4718592
    s_cselect_b32 s48, 0, s48
    v_mfma_f32_16x16x32_bf16 v[12:15], v[200:203], a[228:231], v[12:15]
    v_mfma_f32_16x16x32_bf16 v[16:19], v[200:203], a[232:235], v[16:19]
    s_waitcnt lgkmcnt(6)
    v_mfma_f32_16x16x32_bf16 v[20:23], v[200:203], a[236:239], v[20:23]
    s_waitcnt vmcnt(27)
    s_waitcnt lgkmcnt(4)
    v_mfma_f32_16x16x32_bf16 v[24:27], v[204:207], a[216:219], v[24:27]
    s_waitcnt vmcnt(20)
    s_barrier
    v_mfma_f32_16x16x32_bf16 v[28:31], v[204:207], a[220:223], v[28:31]
    ds_read_b64_tr_b16 v[200:201], v216 offset:28896
    ds_read_b64_tr_b16 v[202:203], v216 offset:29408
    v_mfma_f32_16x16x32_bf16 v[32:35], v[204:207], a[224:227], v[32:35]
    v_mfma_f32_16x16x32_bf16 v[36:39], v[204:207], a[228:231], v[36:39]
    s_add_u32 m0, s72, 0
    s_add_u32 s73, s49, 0
    v_mfma_f32_16x16x32_bf16 v[40:43], v[204:207], a[232:235], v[40:43]
    buffer_load_dwordx4 v224, s[16:19], s73 offen lds
    v_mfma_f32_16x16x32_bf16 v[44:47], v[204:207], a[236:239], v[44:47]
    ds_read_b128 a[192:195], v244 offset:12288
    s_waitcnt lgkmcnt(5)
    v_mfma_f32_16x16x32_bf16 v[48:51], v[208:211], a[216:219], v[48:51]
    s_add_u32 m0, s72, 4096
    s_add_u32 s73, s49, 36864
    v_mfma_f32_16x16x32_bf16 v[52:55], v[208:211], a[220:223], v[52:55]
    buffer_load_dwordx4 v224, s[16:19], s73 offen lds
    v_mfma_f32_16x16x32_bf16 v[56:59], v[208:211], a[224:227], v[56:59]
    ds_read_b64_tr_b16 v[204:205], v216 offset:28904
    ds_read_b64_tr_b16 v[206:207], v216 offset:29416
    v_mfma_f32_16x16x32_bf16 v[60:63], v[208:211], a[228:231], v[60:63]
    s_add_u32 m0, s72, 8192
    s_add_u32 s73, s49, 73728
    v_mfma_f32_16x16x32_bf16 v[64:67], v[208:211], a[232:235], v[64:67]
    buffer_load_dwordx4 v224, s[16:19], s73 offen lds
    v_mfma_f32_16x16x32_bf16 v[68:71], v[208:211], a[236:239], v[68:71]
    ds_read_b128 a[196:199], v244 offset:14336
    s_waitcnt lgkmcnt(6)
    v_mfma_f32_16x16x32_bf16 v[72:75], v[212:215], a[216:219], v[72:75]
    s_add_u32 s49, s49, 128
    s_cmp_eq_u32 s49, 1152
    s_cselect_b32 s49, 0, s49
    v_mfma_f32_16x16x32_bf16 v[76:79], v[212:215], a[220:223], v[76:79]
    s_add_u32 m0, s28, 24768
    s_add_u32 s73, s48, 0
    v_mfma_f32_16x16x32_bf16 v[80:83], v[212:215], a[224:227], v[80:83]
    buffer_load_dwordx4 v220, s[12:15], s73 offen lds
    v_mfma_f32_16x16x32_bf16 v[84:87], v[212:215], a[228:231], v[84:87]
    ds_read_b64_tr_b16 v[208:209], v217 offset:28896
    ds_read_b64_tr_b16 v[210:211], v217 offset:29408
    v_mfma_f32_16x16x32_bf16 v[88:91], v[212:215], a[232:235], v[88:91]
    ds_read_b128 a[200:203], v244 offset:16384
    v_mfma_f32_16x16x32_bf16 v[92:95], v[212:215], a[236:239], v[92:95]
    s_waitcnt lgkmcnt(7)
    v_mfma_f32_16x16x32_bf16 v[96:99], v[200:203], a[216:219], v[96:99]
    buffer_load_dwordx4 v221, s[12:15], s73 offen offset:1032 lds
    v_mfma_f32_16x16x32_bf16 v[100:103], v[200:203], a[220:223], v[100:103]
    ds_read_b64_tr_b16 v[212:213], v217 offset:28904
    ds_read_b64_tr_b16 v[214:215], v217 offset:29416
    v_mfma_f32_16x16x32_bf16 v[104:107], v[200:203], a[224:227], v[104:107]
    ds_read_b128 a[204:207], v244 offset:18432
    v_mfma_f32_16x16x32_bf16 v[108:111], v[200:203], a[228:231], v[108:111]
    v_mfma_f32_16x16x32_bf16 v[112:115], v[200:203], a[232:235], v[112:115]
    v_mfma_f32_16x16x32_bf16 v[116:119], v[200:203], a[236:239], v[116:119]
    s_waitcnt lgkmcnt(7)
    v_mfma_f32_16x16x32_bf16 v[120:123], v[204:207], a[216:219], v[120:123]
    buffer_load_dwordx4 v222, s[12:15], s73 offen offset:2064 lds
    v_mfma_f32_16x16x32_bf16 v[124:127], v[204:207], a[220:223], v[124:127]
    ds_read_b64_tr_b16 v[200:201], v216 offset:0
    ds_read_b64_tr_b16 v[202:203], v216 offset:512
    v_mfma_f32_16x16x32_bf16 v[128:131], v[204:207], a[224:227], v[128:131]
    ds_read_b128 a[208:211], v244 offset:20480
    v_mfma_f32_16x16x32_bf16 v[132:135], v[204:207], a[228:231], v[132:135]
    v_mfma_f32_16x16x32_bf16 v[136:139], v[204:207], a[232:235], v[136:139]
    ds_read_b128 a[212:215], v244 offset:22528
    v_mfma_f32_16x16x32_bf16 v[140:143], v[204:207], a[236:239], v[140:143]
    s_waitcnt lgkmcnt(8)
    v_mfma_f32_16x16x32_bf16 v[144:147], v[208:211], a[216:219], v[144:147]
    buffer_load_dwordx4 v223, s[12:15], s73 offen offset:3096 lds
    v_mfma_f32_16x16x32_bf16 v[148:151], v[208:211], a[220:223], v[148:151]
    ds_read_b64_tr_b16 v[204:205], v216 offset:8
    ds_read_b64_tr_b16 v[206:207], v216 offset:520
    v_mfma_f32_16x16x32_bf16 v[152:155], v[208:211], a[224:227], v[152:155]
    v_mfma_f32_16x16x32_bf16 v[156:159], v[208:211], a[228:231], v[156:159]
    v_mfma_f32_16x16x32_bf16 v[160:163], v[208:211], a[232:235], v[160:163]
    v_mfma_f32_16x16x32_bf16 v[164:167], v[208:211], a[236:239], v[164:167]
    s_waitcnt lgkmcnt(7)
    v_mfma_f32_16x16x32_bf16 v[168:171], v[212:215], a[216:219], v[168:171]
    s_add_u32 m0, s28, 28896
    s_add_u32 s73, s48, 128
    v_mfma_f32_16x16x32_bf16 v[172:175], v[212:215], a[220:223], v[172:175]
    buffer_load_dwordx4 v220, s[12:15], s73 offen lds
    v_mfma_f32_16x16x32_bf16 v[176:179], v[212:215], a[224:227], v[176:179]
    ds_read_b64_tr_b16 v[208:209], v217 offset:0
    ds_read_b64_tr_b16 v[210:211], v217 offset:512
    v_mfma_f32_16x16x32_bf16 v[180:183], v[212:215], a[228:231], v[180:183]
    v_mfma_f32_16x16x32_bf16 v[184:187], v[212:215], a[232:235], v[184:187]
    v_mfma_f32_16x16x32_bf16 v[188:191], v[212:215], a[236:239], v[188:191]
    s_waitcnt lgkmcnt(6)
    v_mfma_f32_16x16x32_bf16 v[0:3], v[200:203], a[192:195], v[0:3]
    buffer_load_dwordx4 v221, s[12:15], s73 offen offset:1032 lds
    v_mfma_f32_16x16x32_bf16 v[4:7], v[200:203], a[196:199], v[4:7]
    ds_read_b64_tr_b16 v[212:213], v217 offset:8
    ds_read_b64_tr_b16 v[214:215], v217 offset:520
    v_mfma_f32_16x16x32_bf16 v[8:11], v[200:203], a[200:203], v[8:11]
    v_mfma_f32_16x16x32_bf16 v[12:15], v[200:203], a[204:207], v[12:15]
    s_waitcnt lgkmcnt(7)
    v_mfma_f32_16x16x32_bf16 v[16:19], v[200:203], a[208:211], v[16:19]
    s_waitcnt lgkmcnt(6)
    v_mfma_f32_16x16x32_bf16 v[20:23], v[200:203], a[212:215], v[20:23]
    s_waitcnt vmcnt(25)
    s_waitcnt lgkmcnt(4)
    v_mfma_f32_16x16x32_bf16 v[24:27], v[204:207], a[192:195], v[24:27]
    buffer_load_dwordx4 v222, s[12:15], s73 offen offset:2064 lds
    v_mfma_f32_16x16x32_bf16 v[28:31], v[204:207], a[196:199], v[28:31]
    ds_read_b64_tr_b16 v[200:201], v216 offset:4128
    ds_read_b64_tr_b16 v[202:203], v216 offset:4640
    v_mfma_f32_16x16x32_bf16 v[32:35], v[204:207], a[200:203], v[32:35]
    v_mfma_f32_16x16x32_bf16 v[36:39], v[204:207], a[204:207], v[36:39]
    ds_read_b128 a[216:219], v245 offset:12288
    v_mfma_f32_16x16x32_bf16 v[40:43], v[204:207], a[208:211], v[40:43]
    v_mfma_f32_16x16x32_bf16 v[44:47], v[204:207], a[212:215], v[44:47]
    s_waitcnt lgkmcnt(5)
    v_mfma_f32_16x16x32_bf16 v[48:51], v[208:211], a[192:195], v[48:51]
    buffer_load_dwordx4 v223, s[12:15], s73 offen offset:3096 lds
    v_mfma_f32_16x16x32_bf16 v[52:55], v[208:211], a[196:199], v[52:55]
    ds_read_b64_tr_b16 v[204:205], v216 offset:4136
    ds_read_b64_tr_b16 v[206:207], v216 offset:4648
    v_mfma_f32_16x16x32_bf16 v[56:59], v[208:211], a[200:203], v[56:59]
    ds_read_b128 a[220:223], v245 offset:14336
    v_mfma_f32_16x16x32_bf16 v[60:63], v[208:211], a[204:207], v[60:63]
    v_mfma_f32_16x16x32_bf16 v[64:67], v[208:211], a[208:211], v[64:67]
    v_mfma_f32_16x16x32_bf16 v[68:71], v[208:211], a[212:215], v[68:71]
    s_waitcnt lgkmcnt(6)
    v_mfma_f32_16x16x32_bf16 v[72:75], v[212:215], a[192:195], v[72:75]
    s_add_u32 s48, s48, 262144
    s_cmp_eq_u32 s48, 4718592
    s_cselect_b32 s48, 0, s48
    v_mfma_f32_16x16x32_bf16 v[76:79], v[212:215], a[196:199], v[76:79]
    s_add_u32 m0, s28, 0
    s_add_u32 s73, s48, 0
    v_mfma_f32_16x16x32_bf16 v[80:83], v[212:215], a[200:203], v[80:83]
    buffer_load_dwordx4 v220, s[12:15], s73 offen lds
    v_mfma_f32_16x16x32_bf16 v[84:87], v[212:215], a[204:207], v[84:87]
    ds_read_b64_tr_b16 v[208:209], v217 offset:4128
    ds_read_b64_tr_b16 v[210:211], v217 offset:4640
    v_mfma_f32_16x16x32_bf16 v[88:91], v[212:215], a[208:211], v[88:91]
    ds_read_b128 a[224:227], v245 offset:16384
    v_mfma_f32_16x16x32_bf16 v[92:95], v[212:215], a[212:215], v[92:95]
    s_waitcnt lgkmcnt(7)
    v_mfma_f32_16x16x32_bf16 v[96:99], v[200:203], a[192:195], v[96:99]
    buffer_load_dwordx4 v221, s[12:15], s73 offen offset:1032 lds
    v_mfma_f32_16x16x32_bf16 v[100:103], v[200:203], a[196:199], v[100:103]
    ds_read_b64_tr_b16 v[212:213], v217 offset:4136
    ds_read_b64_tr_b16 v[214:215], v217 offset:4648
    v_mfma_f32_16x16x32_bf16 v[104:107], v[200:203], a[200:203], v[104:107]
    ds_read_b128 a[228:231], v245 offset:18432
    v_mfma_f32_16x16x32_bf16 v[108:111], v[200:203], a[204:207], v[108:111]
    v_mfma_f32_16x16x32_bf16 v[112:115], v[200:203], a[208:211], v[112:115]
    v_mfma_f32_16x16x32_bf16 v[116:119], v[200:203], a[212:215], v[116:119]
    s_waitcnt vmcnt(25)
    s_waitcnt lgkmcnt(7)
    v_mfma_f32_16x16x32_bf16 v[120:123], v[204:207], a[192:195], v[120:123]
    buffer_load_dwordx4 v222, s[12:15], s73 offen offset:2064 lds
    v_mfma_f32_16x16x32_bf16 v[124:127], v[204:207], a[196:199], v[124:127]
    ds_read_b64_tr_b16 v[200:201], v216 offset:8256
    ds_read_b64_tr_b16 v[202:203], v216 offset:8768
    v_mfma_f32_16x16x32_bf16 v[128:131], v[204:207], a[200:203], v[128:131]
    ds_read_b128 a[232:235], v245 offset:20480
    v_mfma_f32_16x16x32_bf16 v[132:135], v[204:207], a[204:207], v[132:135]
    v_mfma_f32_16x16x32_bf16 v[136:139], v[204:207], a[208:211], v[136:139]
    ds_read_b128 a[236:239], v245 offset:22528
    v_mfma_f32_16x16x32_bf16 v[140:143], v[204:207], a[212:215], v[140:143]
    s_waitcnt lgkmcnt(8)
    v_mfma_f32_16x16x32_bf16 v[144:147], v[208:211], a[192:195], v[144:147]
    buffer_load_dwordx4 v223, s[12:15], s73 offen offset:3096 lds
    v_mfma_f32_16x16x32_bf16 v[148:151], v[208:211], a[196:199], v[148:151]
    ds_read_b64_tr_b16 v[204:205], v216 offset:8264
    ds_read_b64_tr_b16 v[206:207], v216 offset:8776
    v_mfma_f32_16x16x32_bf16 v[152:155], v[208:211], a[200:203], v[152:155]
    v_mfma_f32_16x16x32_bf16 v[156:159], v[208:211], a[204:207], v[156:159]
    v_mfma_f32_16x16x32_bf16 v[160:163], v[208:211], a[208:211], v[160:163]
    v_mfma_f32_16x16x32_bf16 v[164:167], v[208:211], a[212:215], v[164:167]
    s_waitcnt lgkmcnt(7)
    v_mfma_f32_16x16x32_bf16 v[168:171], v[212:215], a[192:195], v[168:171]
    s_add_u32 m0, s28, 4128
    s_add_u32 s73, s48, 128
    v_mfma_f32_16x16x32_bf16 v[172:175], v[212:215], a[196:199], v[172:175]
    buffer_load_dwordx4 v220, s[12:15], s73 offen lds
    v_mfma_f32_16x16x32_bf16 v[176:179], v[212:215], a[200:203], v[176:179]
    buffer_load_dwordx4 v221, s[12:15], s73 offen offset:1032 lds
    v_mfma_f32_16x16x32_bf16 v[180:183], v[212:215], a[204:207], v[180:183]
    ds_read_b64_tr_b16 v[208:209], v217 offset:8256
    ds_read_b64_tr_b16 v[210:211], v217 offset:8768
    v_mfma_f32_16x16x32_bf16 v[184:187], v[212:215], a[208:211], v[184:187]
    buffer_load_dwordx4 v222, s[12:15], s73 offen offset:2064 lds
    v_mfma_f32_16x16x32_bf16 v[188:191], v[212:215], a[212:215], v[188:191]
    s_waitcnt lgkmcnt(6)
    v_mfma_f32_16x16x32_bf16 v[0:3], v[200:203], a[216:219], v[0:3]
    buffer_load_dwordx4 v223, s[12:15], s73 offen offset:3096 lds
    v_mfma_f32_16x16x32_bf16 v[4:7], v[200:203], a[220:223], v[4:7]
    ds_read_b64_tr_b16 v[212:213], v217 offset:8264
    ds_read_b64_tr_b16 v[214:215], v217 offset:8776
    v_mfma_f32_16x16x32_bf16 v[8:11], v[200:203], a[224:227], v[8:11]
    s_add_u32 s48, s48, 262144
    s_cmp_eq_u32 s48, 4718592
    s_cselect_b32 s48, 0, s48
    v_mfma_f32_16x16x32_bf16 v[12:15], v[200:203], a[228:231], v[12:15]
    s_waitcnt lgkmcnt(7)
    v_mfma_f32_16x16x32_bf16 v[16:19], v[200:203], a[232:235], v[16:19]
    s_waitcnt lgkmcnt(6)
    v_mfma_f32_16x16x32_bf16 v[20:23], v[200:203], a[236:239], v[20:23]
    s_waitcnt vmcnt(27)
    s_waitcnt lgkmcnt(4)
    v_mfma_f32_16x16x32_bf16 v[24:27], v[204:207], a[216:219], v[24:27]
    s_waitcnt vmcnt(16)
    s_barrier
    v_mfma_f32_16x16x32_bf16 v[28:31], v[204:207], a[220:223], v[28:31]
    ds_read_b64_tr_b16 v[200:201], v216 offset:12384
    ds_read_b64_tr_b16 v[202:203], v216 offset:12896
    v_mfma_f32_16x16x32_bf16 v[32:35], v[204:207], a[224:227], v[32:35]
    v_mfma_f32_16x16x32_bf16 v[36:39], v[204:207], a[228:231], v[36:39]
    s_add_u32 m0, s72, 12288
    s_add_u32 s73, s49, 0
    v_mfma_f32_16x16x32_bf16 v[40:43], v[204:207], a[232:235], v[40:43]
    buffer_load_dwordx4 v224, s[16:19], s73 offen lds
    v_mfma_f32_16x16x32_bf16 v[44:47], v[204:207], a[236:239], v[44:47]
    ds_read_b128 a[192:195], v244 offset:0
    s_waitcnt lgkmcnt(5)
    v_mfma_f32_16x16x32_bf16 v[48:51], v[208:211], a[216:219], v[48:51]
    s_add_u32 m0, s72, 16384
    s_add_u32 s73, s49, 36864
    v_mfma_f32_16x16x32_bf16 v[52:55], v[208:211], a[220:223], v[52:55]
    buffer_load_dwordx4 v224, s[16:19], s73 offen lds
    v_mfma_f32_16x16x32_bf16 v[56:59], v[208:211], a[224:227], v[56:59]
    ds_read_b64_tr_b16 v[204:205], v216 offset:12392
    ds_read_b64_tr_b16 v[206:207], v216 offset:12904
    v_mfma_f32_16x16x32_bf16 v[60:63], v[208:211], a[228:231], v[60:63]
    s_add_u32 m0, s72, 20480
    s_add_u32 s73, s49, 73728
    v_mfma_f32_16x16x32_bf16 v[64:67], v[208:211], a[232:235], v[64:67]
    buffer_load_dwordx4 v224, s[16:19], s73 offen lds
    v_mfma_f32_16x16x32_bf16 v[68:71], v[208:211], a[236:239], v[68:71]
    ds_read_b128 a[196:199], v244 offset:2048
    s_waitcnt lgkmcnt(6)
    v_mfma_f32_16x16x32_bf16 v[72:75], v[212:215], a[216:219], v[72:75]
    s_add_u32 s49, s49, 128
    s_cmp_eq_u32 s49, 1152
    s_cselect_b32 s49, 0, s49
    v_mfma_f32_16x16x32_bf16 v[76:79], v[212:215], a[220:223], v[76:79]
    s_add_u32 m0, s28, 8256
    s_add_u32 s73, s48, 0
    v_mfma_f32_16x16x32_bf16 v[80:83], v[212:215], a[224:227], v[80:83]
    buffer_load_dwordx4 v220, s[12:15], s73 offen lds
    v_mfma_f32_16x16x32_bf16 v[84:87], v[212:215], a[228:231], v[84:87]
    ds_read_b64_tr_b16 v[208:209], v217 offset:12384
    ds_read_b64_tr_b16 v[210:211], v217 offset:12896
    v_mfma_f32_16x16x32_bf16 v[88:91], v[212:215], a[232:235], v[88:91]
    ds_read_b128 a[200:203], v244 offset:4096
    v_mfma_f32_16x16x32_bf16 v[92:95], v[212:215], a[236:239], v[92:95]
    s_waitcnt lgkmcnt(7)
    v_mfma_f32_16x16x32_bf16 v[96:99], v[200:203], a[216:219], v[96:99]
    buffer_load_dwordx4 v221, s[12:15], s73 offen offset:1032 lds
    v_mfma_f32_16x16x32_bf16 v[100:103], v[200:203], a[220:223], v[100:103]
    ds_read_b64_tr_b16 v[212:213], v217 offset:12392
    ds_read_b64_tr_b16 v[214:215], v217 offset:12904
    v_mfma_f32_16x16x32_bf16 v[104:107], v[200:203], a[224:227], v[104:107]
    ds_read_b128 a[204:207], v244 offset:6144
    v_mfma_f32_16x16x32_bf16 v[108:111], v[200:203], a[228:231], v[108:111]
    v_mfma_f32_16x16x32_bf16 v[112:115], v[200:203], a[232:235], v[112:115]
    v_mfma_f32_16x16x32_bf16 v[116:119], v[200:203], a[236:239], v[116:119]
    s_waitcnt lgkmcnt(7)
    v_mfma_f32_16x16x32_bf16 v[120:123], v[204:207], a[216:219], v[120:123]
    buffer_load_dwordx4 v222, s[12:15], s73 offen offset:2064 lds
    v_mfma_f32_16x16x32_bf16 v[124:127], v[204:207], a[220:223], v[124:127]
    ds_read_b64_tr_b16 v[200:201], v216 offset:16512
    ds_read_b64_tr_b16 v[202:203], v216 offset:17024
    v_mfma_f32_16x16x32_bf16 v[128:131], v[204:207], a[224:227], v[128:131]
    ds_read_b128 a[208:211], v244 offset:8192
    v_mfma_f32_16x16x32_bf16 v[132:135], v[204:207], a[228:231], v[132:135]
    v_mfma_f32_16x16x32_bf16 v[136:139], v[204:207], a[232:235], v[136:139]
    ds_read_b128 a[212:215], v244 offset:10240
    v_mfma_f32_16x16x32_bf16 v[140:143], v[204:207], a[236:239], v[140:143]
    s_waitcnt lgkmcnt(8)
    v_mfma_f32_16x16x32_bf16 v[144:147], v[208:211], a[216:219], v[144:147]
    buffer_load_dwordx4 v223, s[12:15], s73 offen offset:3096 lds
    v_mfma_f32_16x16x32_bf16 v[148:151], v[208:211], a[220:223], v[148:151]
    ds_read_b64_tr_b16 v[204:205], v216 offset:16520
    ds_read_b64_tr_b16 v[206:207], v216 offset:17032
    v_mfma_f32_16x16x32_bf16 v[152:155], v[208:211], a[224:227], v[152:155]
    v_mfma_f32_16x16x32_bf16 v[156:159], v[208:211], a[228:231], v[156:159]
    v_mfma_f32_16x16x32_bf16 v[160:163], v[208:211], a[232:235], v[160:163]
    v_mfma_f32_16x16x32_bf16 v[164:167], v[208:211], a[236:239], v[164:167]
    s_waitcnt lgkmcnt(7)
    v_mfma_f32_16x16x32_bf16 v[168:171], v[212:215], a[216:219], v[168:171]
    s_add_u32 m0, s28, 12384
    s_add_u32 s73, s48, 128
    v_mfma_f32_16x16x32_bf16 v[172:175], v[212:215], a[220:223], v[172:175]
    buffer_load_dwordx4 v220, s[12:15], s73 offen lds
    v_mfma_f32_16x16x32_bf16 v[176:179], v[212:215], a[224:227], v[176:179]
    ds_read_b64_tr_b16 v[208:209], v217 offset:16512
    ds_read_b64_tr_b16 v[210:211], v217 offset:17024
    v_mfma_f32_16x16x32_bf16 v[180:183], v[212:215], a[228:231], v[180:183]
    v_mfma_f32_16x16x32_bf16 v[184:187], v[212:215], a[232:235], v[184:187]
    v_mfma_f32_16x16x32_bf16 v[188:191], v[212:215], a[236:239], v[188:191]
    s_waitcnt lgkmcnt(6)
    v_mfma_f32_16x16x32_bf16 v[0:3], v[200:203], a[192:195], v[0:3]
    buffer_load_dwordx4 v221, s[12:15], s73 offen offset:1032 lds
    v_mfma_f32_16x16x32_bf16 v[4:7], v[200:203], a[196:199], v[4:7]
    ds_read_b64_tr_b16 v[212:213], v217 offset:16520
    ds_read_b64_tr_b16 v[214:215], v217 offset:17032
    v_mfma_f32_16x16x32_bf16 v[8:11], v[200:203], a[200:203], v[8:11]
    v_mfma_f32_16x16x32_bf16 v[12:15], v[200:203], a[204:207], v[12:15]
    s_waitcnt lgkmcnt(7)
    v_mfma_f32_16x16x32_bf16 v[16:19], v[200:203], a[208:211], v[16:19]
    s_waitcnt lgkmcnt(6)
    v_mfma_f32_16x16x32_bf16 v[20:23], v[200:203], a[212:215], v[20:23]
    s_waitcnt lgkmcnt(4)
    v_mfma_f32_16x16x32_bf16 v[24:27], v[204:207], a[192:195], v[24:27]
    buffer_load_dwordx4 v222, s[12:15], s73 offen offset:2064 lds
    v_mfma_f32_16x16x32_bf16 v[28:31], v[204:207], a[196:199], v[28:31]
    ds_read_b64_tr_b16 v[200:201], v216 offset:20640
    ds_read_b64_tr_b16 v[202:203], v216 offset:21152
    v_mfma_f32_16x16x32_bf16 v[32:35], v[204:207], a[200:203], v[32:35]
    v_mfma_f32_16x16x32_bf16 v[36:39], v[204:207], a[204:207], v[36:39]
    ds_read_b128 a[216:219], v245 offset:0
    v_mfma_f32_16x16x32_bf16 v[40:43], v[204:207], a[208:211], v[40:43]
    v_mfma_f32_16x16x32_bf16 v[44:47], v[204:207], a[212:215], v[44:47]
    s_waitcnt lgkmcnt(5)
    v_mfma_f32_16x16x32_bf16 v[48:51], v[208:211], a[192:195], v[48:51]
    buffer_load_dwordx4 v223, s[12:15], s73 offen offset:3096 lds
    v_mfma_f32_16x16x32_bf16 v[52:55], v[208:211], a[196:199], v[52:55]
    ds_read_b64_tr_b16 v[204:205], v216 offset:20648
    ds_read_b64_tr_b16 v[206:207], v216 offset:21160
    v_mfma_f32_16x16x32_bf16 v[56:59], v[208:211], a[200:203], v[56:59]
    ds_read_b128 a[220:223], v245 offset:2048
    v_mfma_f32_16x16x32_bf16 v[60:63], v[208:211], a[204:207], v[60:63]
    v_mfma_f32_16x16x32_bf16 v[64:67], v[208:211], a[208:211], v[64:67]
    v_mfma_f32_16x16x32_bf16 v[68:71], v[208:211], a[212:215], v[68:71]
    s_waitcnt lgkmcnt(6)
    v_mfma_f32_16x16x32_bf16 v[72:75], v[212:215], a[192:195], v[72:75]
    s_add_u32 s48, s48, 262144
    s_cmp_eq_u32 s48, 4718592
    s_cselect_b32 s48, 0, s48
    v_mfma_f32_16x16x32_bf16 v[76:79], v[212:215], a[196:199], v[76:79]
    s_add_u32 m0, s28, 16512
    s_add_u32 s73, s48, 0
    v_mfma_f32_16x16x32_bf16 v[80:83], v[212:215], a[200:203], v[80:83]
    buffer_load_dwordx4 v220, s[12:15], s73 offen lds
    v_mfma_f32_16x16x32_bf16 v[84:87], v[212:215], a[204:207], v[84:87]
    ds_read_b64_tr_b16 v[208:209], v217 offset:20640
    ds_read_b64_tr_b16 v[210:211], v217 offset:21152
    v_mfma_f32_16x16x32_bf16 v[88:91], v[212:215], a[208:211], v[88:91]
    ds_read_b128 a[224:227], v245 offset:4096
    v_mfma_f32_16x16x32_bf16 v[92:95], v[212:215], a[212:215], v[92:95]
    s_waitcnt lgkmcnt(7)
    v_mfma_f32_16x16x32_bf16 v[96:99], v[200:203], a[192:195], v[96:99]
    buffer_load_dwordx4 v221, s[12:15], s73 offen offset:1032 lds
    v_mfma_f32_16x16x32_bf16 v[100:103], v[200:203], a[196:199], v[100:103]
    ds_read_b64_tr_b16 v[212:213], v217 offset:20648
    ds_read_b64_tr_b16 v[214:215], v217 offset:21160
    v_mfma_f32_16x16x32_bf16 v[104:107], v[200:203], a[200:203], v[104:107]
    ds_read_b128 a[228:231], v245 offset:6144
    v_mfma_f32_16x16x32_bf16 v[108:111], v[200:203], a[204:207], v[108:111]
    v_mfma_f32_16x16x32_bf16 v[112:115], v[200:203], a[208:211], v[112:115]
    v_mfma_f32_16x16x32_bf16 v[116:119], v[200:203], a[212:215], v[116:119]
    s_waitcnt vmcnt(25)
    s_waitcnt lgkmcnt(7)
    v_mfma_f32_16x16x32_bf16 v[120:123], v[204:207], a[192:195], v[120:123]
    buffer_load_dwordx4 v222, s[12:15], s73 offen offset:2064 lds
    v_mfma_f32_16x16x32_bf16 v[124:127], v[204:207], a[196:199], v[124:127]
    ds_read_b64_tr_b16 v[200:201], v216 offset:24768
    ds_read_b64_tr_b16 v[202:203], v216 offset:25280
    v_mfma_f32_16x16x32_bf16 v[128:131], v[204:207], a[200:203], v[128:131]
    ds_read_b128 a[232:235], v245 offset:8192
    v_mfma_f32_16x16x32_bf16 v[132:135], v[204:207], a[204:207], v[132:135]
    v_mfma_f32_16x16x32_bf16 v[136:139], v[204:207], a[208:211], v[136:139]
    ds_read_b128 a[236:239], v245 offset:10240
    v_mfma_f32_16x16x32_bf16 v[140:143], v[204:207], a[212:215], v[140:143]
    s_waitcnt lgkmcnt(8)
    v_mfma_f32_16x16x32_bf16 v[144:147], v[208:211], a[192:195], v[144:147]
    buffer_load_dwordx4 v223, s[12:15], s73 offen offset:3096 lds
    v_mfma_f32_16x16x32_bf16 v[148:151], v[208:211], a[196:199], v[148:151]
    ds_read_b64_tr_b16 v[204:205], v216 offset:24776
    ds_read_b64_tr_b16 v[206:207], v216 offset:25288
    v_mfma_f32_16x16x32_bf16 v[152:155], v[208:211], a[200:203], v[152:155]
    v_mfma_f32_16x16x32_bf16 v[156:159], v[208:211], a[204:207], v[156:159]
    v_mfma_f32_16x16x32_bf16 v[160:163], v[208:211], a[208:211], v[160:163]
    v_mfma_f32_16x16x32_bf16 v[164:167], v[208:211], a[212:215], v[164:167]
    s_waitcnt lgkmcnt(7)
    v_mfma_f32_16x16x32_bf16 v[168:171], v[212:215], a[192:195], v[168:171]
    s_add_u32 m0, s28, 20640
    s_add_u32 s73, s48, 128
    v_mfma_f32_16x16x32_bf16 v[172:175], v[212:215], a[196:199], v[172:175]
    buffer_load_dwordx4 v220, s[12:15], s73 offen lds
    v_mfma_f32_16x16x32_bf16 v[176:179], v[212:215], a[200:203], v[176:179]
    buffer_load_dwordx4 v221, s[12:15], s73 offen offset:1032 lds
    v_mfma_f32_16x16x32_bf16 v[180:183], v[212:215], a[204:207], v[180:183]
    ds_read_b64_tr_b16 v[208:209], v217 offset:24768
    ds_read_b64_tr_b16 v[210:211], v217 offset:25280
    v_mfma_f32_16x16x32_bf16 v[184:187], v[212:215], a[208:211], v[184:187]
    buffer_load_dwordx4 v222, s[12:15], s73 offen offset:2064 lds
    v_mfma_f32_16x16x32_bf16 v[188:191], v[212:215], a[212:215], v[188:191]
    s_waitcnt lgkmcnt(6)
    v_mfma_f32_16x16x32_bf16 v[0:3], v[200:203], a[216:219], v[0:3]
    buffer_load_dwordx4 v223, s[12:15], s73 offen offset:3096 lds
    v_mfma_f32_16x16x32_bf16 v[4:7], v[200:203], a[220:223], v[4:7]
    ds_read_b64_tr_b16 v[212:213], v217 offset:24776
    ds_read_b64_tr_b16 v[214:215], v217 offset:25288
    v_mfma_f32_16x16x32_bf16 v[8:11], v[200:203], a[224:227], v[8:11]
    s_add_u32 s48, s48, 262144
    s_cmp_eq_u32 s48, 4718592
    s_cselect_b32 s48, 0, s48
    v_mfma_f32_16x16x32_bf16 v[12:15], v[200:203], a[228:231], v[12:15]
    s_waitcnt lgkmcnt(7)
    v_mfma_f32_16x16x32_bf16 v[16:19], v[200:203], a[232:235], v[16:19]
    s_waitcnt lgkmcnt(6)
    v_mfma_f32_16x16x32_bf16 v[20:23], v[200:203], a[236:239], v[20:23]
    s_waitcnt vmcnt(27)
    s_waitcnt lgkmcnt(4)
    v_mfma_f32_16x16x32_bf16 v[24:27], v[204:207], a[216:219], v[24:27]
    s_waitcnt vmcnt(16)
    s_barrier
    v_mfma_f32_16x16x32_bf16 v[28:31], v[204:207], a[220:223], v[28:31]
    ds_read_b64_tr_b16 v[200:201], v216 offset:28896
    ds_read_b64_tr_b16 v[202:203], v216 offset:29408
    v_mfma_f32_16x16x32_bf16 v[32:35], v[204:207], a[224:227], v[32:35]
    v_mfma_f32_16x16x32_bf16 v[36:39], v[204:207], a[228:231], v[36:39]
    s_add_u32 m0, s72, 0
    s_add_u32 s73, s49, 0
    v_mfma_f32_16x16x32_bf16 v[40:43], v[204:207], a[232:235], v[40:43]
    buffer_load_dwordx4 v224, s[16:19], s73 offen lds
    v_mfma_f32_16x16x32_bf16 v[44:47], v[204:207], a[236:239], v[44:47]
    ds_read_b128 a[192:195], v244 offset:12288
    s_waitcnt lgkmcnt(5)
    v_mfma_f32_16x16x32_bf16 v[48:51], v[208:211], a[216:219], v[48:51]
    s_add_u32 m0, s72, 4096
    s_add_u32 s73, s49, 36864
    v_mfma_f32_16x16x32_bf16 v[52:55], v[208:211], a[220:223], v[52:55]
    buffer_load_dwordx4 v224, s[16:19], s73 offen lds
    v_mfma_f32_16x16x32_bf16 v[56:59], v[208:211], a[224:227], v[56:59]
    ds_read_b64_tr_b16 v[204:205], v216 offset:28904
    ds_read_b64_tr_b16 v[206:207], v216 offset:29416
    v_mfma_f32_16x16x32_bf16 v[60:63], v[208:211], a[228:231], v[60:63]
    s_add_u32 m0, s72, 8192
    s_add_u32 s73, s49, 73728
    v_mfma_f32_16x16x32_bf16 v[64:67], v[208:211], a[232:235], v[64:67]
    buffer_load_dwordx4 v224, s[16:19], s73 offen lds
    v_mfma_f32_16x16x32_bf16 v[68:71], v[208:211], a[236:239], v[68:71]
    ds_read_b128 a[196:199], v244 offset:14336
    s_waitcnt lgkmcnt(6)
    v_mfma_f32_16x16x32_bf16 v[72:75], v[212:215], a[216:219], v[72:75]
    s_add_u32 s49, s49, 128
    s_cmp_eq_u32 s49, 1152
    s_cselect_b32 s49, 0, s49
    v_mfma_f32_16x16x32_bf16 v[76:79], v[212:215], a[220:223], v[76:79]
    s_add_u32 m0, s28, 24768
    s_add_u32 s73, s48, 0
    v_mfma_f32_16x16x32_bf16 v[80:83], v[212:215], a[224:227], v[80:83]
    buffer_load_dwordx4 v220, s[12:15], s73 offen lds
    v_mfma_f32_16x16x32_bf16 v[84:87], v[212:215], a[228:231], v[84:87]
    ds_read_b64_tr_b16 v[208:209], v217 offset:28896
    ds_read_b64_tr_b16 v[210:211], v217 offset:29408
    v_mfma_f32_16x16x32_bf16 v[88:91], v[212:215], a[232:235], v[88:91]
    ds_read_b128 a[200:203], v244 offset:16384
    v_mfma_f32_16x16x32_bf16 v[92:95], v[212:215], a[236:239], v[92:95]
    s_waitcnt lgkmcnt(7)
    v_mfma_f32_16x16x32_bf16 v[96:99], v[200:203], a[216:219], v[96:99]
    buffer_load_dwordx4 v221, s[12:15], s73 offen offset:1032 lds
    v_mfma_f32_16x16x32_bf16 v[100:103], v[200:203], a[220:223], v[100:103]
    ds_read_b64_tr_b16 v[212:213], v217 offset:28904
    ds_read_b64_tr_b16 v[214:215], v217 offset:29416
    v_mfma_f32_16x16x32_bf16 v[104:107], v[200:203], a[224:227], v[104:107]
    ds_read_b128 a[204:207], v244 offset:18432
    v_mfma_f32_16x16x32_bf16 v[108:111], v[200:203], a[228:231], v[108:111]
    v_mfma_f32_16x16x32_bf16 v[112:115], v[200:203], a[232:235], v[112:115]
    v_mfma_f32_16x16x32_bf16 v[116:119], v[200:203], a[236:239], v[116:119]
    s_waitcnt lgkmcnt(7)
    v_mfma_f32_16x16x32_bf16 v[120:123], v[204:207], a[216:219], v[120:123]
    buffer_load_dwordx4 v222, s[12:15], s73 offen offset:2064 lds
    v_mfma_f32_16x16x32_bf16 v[124:127], v[204:207], a[220:223], v[124:127]
    ds_read_b64_tr_b16 v[200:201], v216 offset:0
    ds_read_b64_tr_b16 v[202:203], v216 offset:512
    v_mfma_f32_16x16x32_bf16 v[128:131], v[204:207], a[224:227], v[128:131]
    ds_read_b128 a[208:211], v244 offset:20480
    v_mfma_f32_16x16x32_bf16 v[132:135], v[204:207], a[228:231], v[132:135]
    v_mfma_f32_16x16x32_bf16 v[136:139], v[204:207], a[232:235], v[136:139]
    ds_read_b128 a[212:215], v244 offset:22528
    v_mfma_f32_16x16x32_bf16 v[140:143], v[204:207], a[236:239], v[140:143]
    s_waitcnt lgkmcnt(8)
    v_mfma_f32_16x16x32_bf16 v[144:147], v[208:211], a[216:219], v[144:147]
    buffer_load_dwordx4 v223, s[12:15], s73 offen offset:3096 lds
    v_mfma_f32_16x16x32_bf16 v[148:151], v[208:211], a[220:223], v[148:151]
    ds_read_b64_tr_b16 v[204:205], v216 offset:8
    ds_read_b64_tr_b16 v[206:207], v216 offset:520
    v_mfma_f32_16x16x32_bf16 v[152:155], v[208:211], a[224:227], v[152:155]
    v_mfma_f32_16x16x32_bf16 v[156:159], v[208:211], a[228:231], v[156:159]
    v_mfma_f32_16x16x32_bf16 v[160:163], v[208:211], a[232:235], v[160:163]
    v_mfma_f32_16x16x32_bf16 v[164:167], v[208:211], a[236:239], v[164:167]
    s_waitcnt lgkmcnt(7)
    v_mfma_f32_16x16x32_bf16 v[168:171], v[212:215], a[216:219], v[168:171]
    s_add_u32 m0, s28, 28896
    s_add_u32 s73, s48, 128
    v_mfma_f32_16x16x32_bf16 v[172:175], v[212:215], a[220:223], v[172:175]
    buffer_load_dwordx4 v220, s[12:15], s73 offen lds
    v_mfma_f32_16x16x32_bf16 v[176:179], v[212:215], a[224:227], v[176:179]
    ds_read_b64_tr_b16 v[208:209], v217 offset:0
    ds_read_b64_tr_b16 v[210:211], v217 offset:512
    v_mfma_f32_16x16x32_bf16 v[180:183], v[212:215], a[228:231], v[180:183]
    v_mfma_f32_16x16x32_bf16 v[184:187], v[212:215], a[232:235], v[184:187]
    v_mfma_f32_16x16x32_bf16 v[188:191], v[212:215], a[236:239], v[188:191]
    s_waitcnt lgkmcnt(6)
    v_mfma_f32_16x16x32_bf16 v[0:3], v[200:203], a[192:195], v[0:3]
    buffer_load_dwordx4 v221, s[12:15], s73 offen offset:1032 lds
    v_mfma_f32_16x16x32_bf16 v[4:7], v[200:203], a[196:199], v[4:7]
    ds_read_b64_tr_b16 v[212:213], v217 offset:8
    ds_read_b64_tr_b16 v[214:215], v217 offset:520
    v_mfma_f32_16x16x32_bf16 v[8:11], v[200:203], a[200:203], v[8:11]
    v_mfma_f32_16x16x32_bf16 v[12:15], v[200:203], a[204:207], v[12:15]
    s_waitcnt lgkmcnt(7)
    v_mfma_f32_16x16x32_bf16 v[16:19], v[200:203], a[208:211], v[16:19]
    s_waitcnt lgkmcnt(6)
    v_mfma_f32_16x16x32_bf16 v[20:23], v[200:203], a[212:215], v[20:23]
    s_waitcnt lgkmcnt(4)
    v_mfma_f32_16x16x32_bf16 v[24:27], v[204:207], a[192:195], v[24:27]
    buffer_load_dwordx4 v222, s[12:15], s73 offen offset:2064 lds
    v_mfma_f32_16x16x32_bf16 v[28:31], v[204:207], a[196:199], v[28:31]
    ds_read_b64_tr_b16 v[200:201], v216 offset:4128
    ds_read_b64_tr_b16 v[202:203], v216 offset:4640
    v_mfma_f32_16x16x32_bf16 v[32:35], v[204:207], a[200:203], v[32:35]
    v_mfma_f32_16x16x32_bf16 v[36:39], v[204:207], a[204:207], v[36:39]
    ds_read_b128 a[216:219], v245 offset:12288
    v_mfma_f32_16x16x32_bf16 v[40:43], v[204:207], a[208:211], v[40:43]
    v_mfma_f32_16x16x32_bf16 v[44:47], v[204:207], a[212:215], v[44:47]
    s_waitcnt lgkmcnt(5)
    v_mfma_f32_16x16x32_bf16 v[48:51], v[208:211], a[192:195], v[48:51]
    buffer_load_dwordx4 v223, s[12:15], s73 offen offset:3096 lds
    v_mfma_f32_16x16x32_bf16 v[52:55], v[208:211], a[196:199], v[52:55]
    ds_read_b64_tr_b16 v[204:205], v216 offset:4136
    ds_read_b64_tr_b16 v[206:207], v216 offset:4648
    v_mfma_f32_16x16x32_bf16 v[56:59], v[208:211], a[200:203], v[56:59]
    ds_read_b128 a[220:223], v245 offset:14336
    v_mfma_f32_16x16x32_bf16 v[60:63], v[208:211], a[204:207], v[60:63]
    v_mfma_f32_16x16x32_bf16 v[64:67], v[208:211], a[208:211], v[64:67]
    v_mfma_f32_16x16x32_bf16 v[68:71], v[208:211], a[212:215], v[68:71]
    s_waitcnt lgkmcnt(6)
    v_mfma_f32_16x16x32_bf16 v[72:75], v[212:215], a[192:195], v[72:75]
    s_add_u32 s48, s48, 262144
    s_cmp_eq_u32 s48, 4718592
    s_cselect_b32 s48, 0, s48
    v_mfma_f32_16x16x32_bf16 v[76:79], v[212:215], a[196:199], v[76:79]
    s_add_u32 m0, s28, 0
    s_add_u32 s73, s48, 0
    v_mfma_f32_16x16x32_bf16 v[80:83], v[212:215], a[200:203], v[80:83]
    buffer_load_dwordx4 v220, s[12:15], s73 offen lds
    v_mfma_f32_16x16x32_bf16 v[84:87], v[212:215], a[204:207], v[84:87]
    ds_read_b64_tr_b16 v[208:209], v217 offset:4128
    ds_read_b64_tr_b16 v[210:211], v217 offset:4640
    v_mfma_f32_16x16x32_bf16 v[88:91], v[212:215], a[208:211], v[88:91]
    ds_read_b128 a[224:227], v245 offset:16384
    v_mfma_f32_16x16x32_bf16 v[92:95], v[212:215], a[212:215], v[92:95]
    s_waitcnt lgkmcnt(7)
    v_mfma_f32_16x16x32_bf16 v[96:99], v[200:203], a[192:195], v[96:99]
    buffer_load_dwordx4 v221, s[12:15], s73 offen offset:1032 lds
    v_mfma_f32_16x16x32_bf16 v[100:103], v[200:203], a[196:199], v[100:103]
    ds_read_b64_tr_b16 v[212:213], v217 offset:4136
    ds_read_b64_tr_b16 v[214:215], v217 offset:4648
    v_mfma_f32_16x16x32_bf16 v[104:107], v[200:203], a[200:203], v[104:107]
    ds_read_b128 a[228:231], v245 offset:18432
    v_mfma_f32_16x16x32_bf16 v[108:111], v[200:203], a[204:207], v[108:111]
    v_mfma_f32_16x16x32_bf16 v[112:115], v[200:203], a[208:211], v[112:115]
    v_mfma_f32_16x16x32_bf16 v[116:119], v[200:203], a[212:215], v[116:119]
    s_waitcnt vmcnt(25)
    s_waitcnt lgkmcnt(7)
    v_mfma_f32_16x16x32_bf16 v[120:123], v[204:207], a[192:195], v[120:123]
    buffer_load_dwordx4 v222, s[12:15], s73 offen offset:2064 lds
    v_mfma_f32_16x16x32_bf16 v[124:127], v[204:207], a[196:199], v[124:127]
    ds_read_b64_tr_b16 v[200:201], v216 offset:8256
    ds_read_b64_tr_b16 v[202:203], v216 offset:8768
    v_mfma_f32_16x16x32_bf16 v[128:131], v[204:207], a[200:203], v[128:131]
    ds_read_b128 a[232:235], v245 offset:20480
    v_mfma_f32_16x16x32_bf16 v[132:135], v[204:207], a[204:207], v[132:135]
    v_mfma_f32_16x16x32_bf16 v[136:139], v[204:207], a[208:211], v[136:139]
    ds_read_b128 a[236:239], v245 offset:22528
    v_mfma_f32_16x16x32_bf16 v[140:143], v[204:207], a[212:215], v[140:143]
    s_waitcnt lgkmcnt(8)
    v_mfma_f32_16x16x32_bf16 v[144:147], v[208:211], a[192:195], v[144:147]
    buffer_load_dwordx4 v223, s[12:15], s73 offen offset:3096 lds
    v_mfma_f32_16x16x32_bf16 v[148:151], v[208:211], a[196:199], v[148:151]
    ds_read_b64_tr_b16 v[204:205], v216 offset:8264
    ds_read_b64_tr_b16 v[206:207], v216 offset:8776
    v_mfma_f32_16x16x32_bf16 v[152:155], v[208:211], a[200:203], v[152:155]
    v_mfma_f32_16x16x32_bf16 v[156:159], v[208:211], a[204:207], v[156:159]
    v_mfma_f32_16x16x32_bf16 v[160:163], v[208:211], a[208:211], v[160:163]
    v_mfma_f32_16x16x32_bf16 v[164:167], v[208:211], a[212:215], v[164:167]
    s_waitcnt lgkmcnt(7)
    v_mfma_f32_16x16x32_bf16 v[168:171], v[212:215], a[192:195], v[168:171]
    s_add_u32 m0, s28, 4128
    s_add_u32 s73, s48, 128
    v_mfma_f32_16x16x32_bf16 v[172:175], v[212:215], a[196:199], v[172:175]
    buffer_load_dwordx4 v220, s[12:15], s73 offen lds
    v_mfma_f32_16x16x32_bf16 v[176:179], v[212:215], a[200:203], v[176:179]
    buffer_load_dwordx4 v221, s[12:15], s73 offen offset:1032 lds
    v_mfma_f32_16x16x32_bf16 v[180:183], v[212:215], a[204:207], v[180:183]
    ds_read_b64_tr_b16 v[208:209], v217 offset:8256
    ds_read_b64_tr_b16 v[210:211], v217 offset:8768
    v_mfma_f32_16x16x32_bf16 v[184:187], v[212:215], a[208:211], v[184:187]
    buffer_load_dwordx4 v222, s[12:15], s73 offen offset:2064 lds
    v_mfma_f32_16x16x32_bf16 v[188:191], v[212:215], a[212:215], v[188:191]
    s_waitcnt lgkmcnt(6)
    v_mfma_f32_16x16x32_bf16 v[0:3], v[200:203], a[216:219], v[0:3]
    buffer_load_dwordx4 v223, s[12:15], s73 offen offset:3096 lds
    v_mfma_f32_16x16x32_bf16 v[4:7], v[200:203], a[220:223], v[4:7]
    ds_read_b64_tr_b16 v[212:213], v217 offset:8264
    ds_read_b64_tr_b16 v[214:215], v217 offset:8776
    v_mfma_f32_16x16x32_bf16 v[8:11], v[200:203], a[224:227], v[8:11]
    s_add_u32 s48, s48, 262144
    s_cmp_eq_u32 s48, 4718592
    s_cselect_b32 s48, 0, s48
    v_mfma_f32_16x16x32_bf16 v[12:15], v[200:203], a[228:231], v[12:15]
    s_waitcnt lgkmcnt(7)
    v_mfma_f32_16x16x32_bf16 v[16:19], v[200:203], a[232:235], v[16:19]
    s_waitcnt lgkmcnt(6)
    v_mfma_f32_16x16x32_bf16 v[20:23], v[200:203], a[236:239], v[20:23]
    s_waitcnt vmcnt(27)
    s_waitcnt lgkmcnt(4)
    v_mfma_f32_16x16x32_bf16 v[24:27], v[204:207], a[216:219], v[24:27]
    s_waitcnt vmcnt(16)
    s_barrier
    v_mfma_f32_16x16x32_bf16 v[28:31], v[204:207], a[220:223], v[28:31]
    ds_read_b64_tr_b16 v[200:201], v216 offset:12384
    ds_read_b64_tr_b16 v[202:203], v216 offset:12896
    v_mfma_f32_16x16x32_bf16 v[32:35], v[204:207], a[224:227], v[32:35]
    v_mfma_f32_16x16x32_bf16 v[36:39], v[204:207], a[228:231], v[36:39]
    s_add_u32 m0, s72, 12288
    s_add_u32 s73, s49, 0
    v_mfma_f32_16x16x32_bf16 v[40:43], v[204:207], a[232:235], v[40:43]
    buffer_load_dwordx4 v224, s[16:19], s73 offen lds
    v_mfma_f32_16x16x32_bf16 v[44:47], v[204:207], a[236:239], v[44:47]
    ds_read_b128 a[192:195], v244 offset:0
    s_waitcnt lgkmcnt(5)
    v_mfma_f32_16x16x32_bf16 v[48:51], v[208:211], a[216:219], v[48:51]
    s_add_u32 m0, s72, 16384
    s_add_u32 s73, s49, 36864
    v_mfma_f32_16x16x32_bf16 v[52:55], v[208:211], a[220:223], v[52:55]
    buffer_load_dwordx4 v224, s[16:19], s73 offen lds
    v_mfma_f32_16x16x32_bf16 v[56:59], v[208:211], a[224:227], v[56:59]
    ds_read_b64_tr_b16 v[204:205], v216 offset:12392
    ds_read_b64_tr_b16 v[206:207], v216 offset:12904
    v_mfma_f32_16x16x32_bf16 v[60:63], v[208:211], a[228:231], v[60:63]
    s_add_u32 m0, s72, 20480
    s_add_u32 s73, s49, 73728
    v_mfma_f32_16x16x32_bf16 v[64:67], v[208:211], a[232:235], v[64:67]
    buffer_load_dwordx4 v224, s[16:19], s73 offen lds
    v_mfma_f32_16x16x32_bf16 v[68:71], v[208:211], a[236:239], v[68:71]
    ds_read_b128 a[196:199], v244 offset:2048
    s_waitcnt lgkmcnt(6)
    v_mfma_f32_16x16x32_bf16 v[72:75], v[212:215], a[216:219], v[72:75]
    s_add_u32 s49, s49, 128
    s_cmp_eq_u32 s49, 1152
    s_cselect_b32 s49, 0, s49
    v_mfma_f32_16x16x32_bf16 v[76:79], v[212:215], a[220:223], v[76:79]
    s_add_u32 m0, s28, 8256
    s_add_u32 s73, s48, 0
    v_mfma_f32_16x16x32_bf16 v[80:83], v[212:215], a[224:227], v[80:83]
    buffer_load_dwordx4 v220, s[12:15], s73 offen lds
    v_mfma_f32_16x16x32_bf16 v[84:87], v[212:215], a[228:231], v[84:87]
    ds_read_b64_tr_b16 v[208:209], v217 offset:12384
    ds_read_b64_tr_b16 v[210:211], v217 offset:12896
    v_mfma_f32_16x16x32_bf16 v[88:91], v[212:215], a[232:235], v[88:91]
    ds_read_b128 a[200:203], v244 offset:4096
    v_mfma_f32_16x16x32_bf16 v[92:95], v[212:215], a[236:239], v[92:95]
    s_waitcnt lgkmcnt(7)
    v_mfma_f32_16x16x32_bf16 v[96:99], v[200:203], a[216:219], v[96:99]
    buffer_load_dwordx4 v221, s[12:15], s73 offen offset:1032 lds
    v_mfma_f32_16x16x32_bf16 v[100:103], v[200:203], a[220:223], v[100:103]
    ds_read_b64_tr_b16 v[212:213], v217 offset:12392
    ds_read_b64_tr_b16 v[214:215], v217 offset:12904
    v_mfma_f32_16x16x32_bf16 v[104:107], v[200:203], a[224:227], v[104:107]
    ds_read_b128 a[204:207], v244 offset:6144
    v_mfma_f32_16x16x32_bf16 v[108:111], v[200:203], a[228:231], v[108:111]
    v_mfma_f32_16x16x32_bf16 v[112:115], v[200:203], a[232:235], v[112:115]
    v_mfma_f32_16x16x32_bf16 v[116:119], v[200:203], a[236:239], v[116:119]
    s_waitcnt lgkmcnt(7)
    v_mfma_f32_16x16x32_bf16 v[120:123], v[204:207], a[216:219], v[120:123]
    buffer_load_dwordx4 v222, s[12:15], s73 offen offset:2064 lds
    v_mfma_f32_16x16x32_bf16 v[124:127], v[204:207], a[220:223], v[124:127]
    ds_read_b64_tr_b16 v[200:201], v216 offset:16512
    ds_read_b64_tr_b16 v[202:203], v216 offset:17024
    v_mfma_f32_16x16x32_bf16 v[128:131], v[204:207], a[224:227], v[128:131]
    ds_read_b128 a[208:211], v244 offset:8192
    v_mfma_f32_16x16x32_bf16 v[132:135], v[204:207], a[228:231], v[132:135]
    v_mfma_f32_16x16x32_bf16 v[136:139], v[204:207], a[232:235], v[136:139]
    ds_read_b128 a[212:215], v244 offset:10240
    v_mfma_f32_16x16x32_bf16 v[140:143], v[204:207], a[236:239], v[140:143]
    s_waitcnt lgkmcnt(8)
    v_mfma_f32_16x16x32_bf16 v[144:147], v[208:211], a[216:219], v[144:147]
    buffer_load_dwordx4 v223, s[12:15], s73 offen offset:3096 lds
    v_mfma_f32_16x16x32_bf16 v[148:151], v[208:211], a[220:223], v[148:151]
    ds_read_b64_tr_b16 v[204:205], v216 offset:16520
    ds_read_b64_tr_b16 v[206:207], v216 offset:17032
    v_mfma_f32_16x16x32_bf16 v[152:155], v[208:211], a[224:227], v[152:155]
    v_mfma_f32_16x16x32_bf16 v[156:159], v[208:211], a[228:231], v[156:159]
    v_mfma_f32_16x16x32_bf16 v[160:163], v[208:211], a[232:235], v[160:163]
    v_mfma_f32_16x16x32_bf16 v[164:167], v[208:211], a[236:239], v[164:167]
    s_waitcnt lgkmcnt(7)
    v_mfma_f32_16x16x32_bf16 v[168:171], v[212:215], a[216:219], v[168:171]
    s_add_u32 m0, s28, 12384
    s_add_u32 s73, s48, 128
    v_mfma_f32_16x16x32_bf16 v[172:175], v[212:215], a[220:223], v[172:175]
    buffer_load_dwordx4 v220, s[12:15], s73 offen lds
    v_mfma_f32_16x16x32_bf16 v[176:179], v[212:215], a[224:227], v[176:179]
    ds_read_b64_tr_b16 v[208:209], v217 offset:16512
    ds_read_b64_tr_b16 v[210:211], v217 offset:17024
    v_mfma_f32_16x16x32_bf16 v[180:183], v[212:215], a[228:231], v[180:183]
    v_mfma_f32_16x16x32_bf16 v[184:187], v[212:215], a[232:235], v[184:187]
    v_mfma_f32_16x16x32_bf16 v[188:191], v[212:215], a[236:239], v[188:191]
    s_waitcnt lgkmcnt(6)
    v_mfma_f32_16x16x32_bf16 v[0:3], v[200:203], a[192:195], v[0:3]
    buffer_load_dwordx4 v221, s[12:15], s73 offen offset:1032 lds
    v_mfma_f32_16x16x32_bf16 v[4:7], v[200:203], a[196:199], v[4:7]
    ds_read_b64_tr_b16 v[212:213], v217 offset:16520
    ds_read_b64_tr_b16 v[214:215], v217 offset:17032
    v_mfma_f32_16x16x32_bf16 v[8:11], v[200:203], a[200:203], v[8:11]
    v_mfma_f32_16x16x32_bf16 v[12:15], v[200:203], a[204:207], v[12:15]
    s_waitcnt lgkmcnt(7)
    v_mfma_f32_16x16x32_bf16 v[16:19], v[200:203], a[208:211], v[16:19]
    s_waitcnt lgkmcnt(6)
    v_mfma_f32_16x16x32_bf16 v[20:23], v[200:203], a[212:215], v[20:23]
    s_waitcnt lgkmcnt(4)
    v_mfma_f32_16x16x32_bf16 v[24:27], v[204:207], a[192:195], v[24:27]
    buffer_load_dwordx4 v222, s[12:15], s73 offen offset:2064 lds
    v_mfma_f32_16x16x32_bf16 v[28:31], v[204:207], a[196:199], v[28:31]
    ds_read_b64_tr_b16 v[200:201], v216 offset:20640
    ds_read_b64_tr_b16 v[202:203], v216 offset:21152
    v_mfma_f32_16x16x32_bf16 v[32:35], v[204:207], a[200:203], v[32:35]
    v_mfma_f32_16x16x32_bf16 v[36:39], v[204:207], a[204:207], v[36:39]
    ds_read_b128 a[216:219], v245 offset:0
    v_mfma_f32_16x16x32_bf16 v[40:43], v[204:207], a[208:211], v[40:43]
    v_mfma_f32_16x16x32_bf16 v[44:47], v[204:207], a[212:215], v[44:47]
    s_waitcnt lgkmcnt(5)
    v_mfma_f32_16x16x32_bf16 v[48:51], v[208:211], a[192:195], v[48:51]
    buffer_load_dwordx4 v223, s[12:15], s73 offen offset:3096 lds
    v_mfma_f32_16x16x32_bf16 v[52:55], v[208:211], a[196:199], v[52:55]
    ds_read_b64_tr_b16 v[204:205], v216 offset:20648
    ds_read_b64_tr_b16 v[206:207], v216 offset:21160
    v_mfma_f32_16x16x32_bf16 v[56:59], v[208:211], a[200:203], v[56:59]
    ds_read_b128 a[220:223], v245 offset:2048
    v_mfma_f32_16x16x32_bf16 v[60:63], v[208:211], a[204:207], v[60:63]
    v_mfma_f32_16x16x32_bf16 v[64:67], v[208:211], a[208:211], v[64:67]
    v_mfma_f32_16x16x32_bf16 v[68:71], v[208:211], a[212:215], v[68:71]
    s_waitcnt lgkmcnt(6)
    v_mfma_f32_16x16x32_bf16 v[72:75], v[212:215], a[192:195], v[72:75]
    s_add_u32 s48, s48, 262144
    s_cmp_eq_u32 s48, 4718592
    s_cselect_b32 s48, 0, s48
    v_mfma_f32_16x16x32_bf16 v[76:79], v[212:215], a[196:199], v[76:79]
    s_add_u32 m0, s28, 16512
    s_add_u32 s73, s48, 0
    v_mfma_f32_16x16x32_bf16 v[80:83], v[212:215], a[200:203], v[80:83]
    buffer_load_dwordx4 v220, s[12:15], s73 offen lds
    v_mfma_f32_16x16x32_bf16 v[84:87], v[212:215], a[204:207], v[84:87]
    ds_read_b64_tr_b16 v[208:209], v217 offset:20640
    ds_read_b64_tr_b16 v[210:211], v217 offset:21152
    v_mfma_f32_16x16x32_bf16 v[88:91], v[212:215], a[208:211], v[88:91]
    ds_read_b128 a[224:227], v245 offset:4096
    v_mfma_f32_16x16x32_bf16 v[92:95], v[212:215], a[212:215], v[92:95]
    s_waitcnt lgkmcnt(7)
    v_mfma_f32_16x16x32_bf16 v[96:99], v[200:203], a[192:195], v[96:99]
    buffer_load_dwordx4 v221, s[12:15], s73 offen offset:1032 lds
    v_mfma_f32_16x16x32_bf16 v[100:103], v[200:203], a[196:199], v[100:103]
    ds_read_b64_tr_b16 v[212:213], v217 offset:20648
    ds_read_b64_tr_b16 v[214:215], v217 offset:21160
    v_mfma_f32_16x16x32_bf16 v[104:107], v[200:203], a[200:203], v[104:107]
    ds_read_b128 a[228:231], v245 offset:6144
    v_mfma_f32_16x16x32_bf16 v[108:111], v[200:203], a[204:207], v[108:111]
    v_mfma_f32_16x16x32_bf16 v[112:115], v[200:203], a[208:211], v[112:115]
    v_mfma_f32_16x16x32_bf16 v[116:119], v[200:203], a[212:215], v[116:119]
    s_waitcnt vmcnt(25)
    s_waitcnt lgkmcnt(7)
    v_mfma_f32_16x16x32_bf16 v[120:123], v[204:207], a[192:195], v[120:123]
    buffer_load_dwordx4 v222, s[12:15], s73 offen offset:2064 lds
    v_mfma_f32_16x16x32_bf16 v[124:127], v[204:207], a[196:199], v[124:127]
    ds_read_b64_tr_b16 v[200:201], v216 offset:24768
    ds_read_b64_tr_b16 v[202:203], v216 offset:25280
    v_mfma_f32_16x16x32_bf16 v[128:131], v[204:207], a[200:203], v[128:131]
    ds_read_b128 a[232:235], v245 offset:8192
    v_mfma_f32_16x16x32_bf16 v[132:135], v[204:207], a[204:207], v[132:135]
    v_mfma_f32_16x16x32_bf16 v[136:139], v[204:207], a[208:211], v[136:139]
    ds_read_b128 a[236:239], v245 offset:10240
    v_mfma_f32_16x16x32_bf16 v[140:143], v[204:207], a[212:215], v[140:143]
    s_waitcnt lgkmcnt(8)
    v_mfma_f32_16x16x32_bf16 v[144:147], v[208:211], a[192:195], v[144:147]
    buffer_load_dwordx4 v223, s[12:15], s73 offen offset:3096 lds
    v_mfma_f32_16x16x32_bf16 v[148:151], v[208:211], a[196:199], v[148:151]
    ds_read_b64_tr_b16 v[204:205], v216 offset:24776
    ds_read_b64_tr_b16 v[206:207], v216 offset:25288
    v_mfma_f32_16x16x32_bf16 v[152:155], v[208:211], a[200:203], v[152:155]
    v_mfma_f32_16x16x32_bf16 v[156:159], v[208:211], a[204:207], v[156:159]
    v_mfma_f32_16x16x32_bf16 v[160:163], v[208:211], a[208:211], v[160:163]
    v_mfma_f32_16x16x32_bf16 v[164:167], v[208:211], a[212:215], v[164:167]
    s_waitcnt lgkmcnt(7)
    v_mfma_f32_16x16x32_bf16 v[168:171], v[212:215], a[192:195], v[168:171]
    s_add_u32 m0, s28, 20640
    s_add_u32 s73, s48, 128
    v_mfma_f32_16x16x32_bf16 v[172:175], v[212:215], a[196:199], v[172:175]
    buffer_load_dwordx4 v220, s[12:15], s73 offen lds
    v_mfma_f32_16x16x32_bf16 v[176:179], v[212:215], a[200:203], v[176:179]
    buffer_load_dwordx4 v221, s[12:15], s73 offen offset:1032 lds
    v_mfma_f32_16x16x32_bf16 v[180:183], v[212:215], a[204:207], v[180:183]
    ds_read_b64_tr_b16 v[208:209], v217 offset:24768
    ds_read_b64_tr_b16 v[210:211], v217 offset:25280
    v_mfma_f32_16x16x32_bf16 v[184:187], v[212:215], a[208:211], v[184:187]
    buffer_load_dwordx4 v222, s[12:15], s73 offen offset:2064 lds
    v_mfma_f32_16x16x32_bf16 v[188:191], v[212:215], a[212:215], v[188:191]
    s_waitcnt lgkmcnt(6)
    v_mfma_f32_16x16x32_bf16 v[0:3], v[200:203], a[216:219], v[0:3]
    buffer_load_dwordx4 v223, s[12:15], s73 offen offset:3096 lds
    v_mfma_f32_16x16x32_bf16 v[4:7], v[200:203], a[220:223], v[4:7]
    ds_read_b64_tr_b16 v[212:213], v217 offset:24776
    ds_read_b64_tr_b16 v[214:215], v217 offset:25288
    v_mfma_f32_16x16x32_bf16 v[8:11], v[200:203], a[224:227], v[8:11]
    s_add_u32 s48, s48, 262144
    s_cmp_eq_u32 s48, 4718592
    s_cselect_b32 s48, 0, s48
    v_mfma_f32_16x16x32_bf16 v[12:15], v[200:203], a[228:231], v[12:15]
    s_waitcnt lgkmcnt(7)
    v_mfma_f32_16x16x32_bf16 v[16:19], v[200:203], a[232:235], v[16:19]
    buffer_load_dwordx4 a[0:3], v197, s[8:11], s29 offen nt
    s_waitcnt lgkmcnt(6)
    v_mfma_f32_16x16x32_bf16 v[20:23], v[200:203], a[236:239], v[20:23]
    s_waitcnt vmcnt(28)
    s_waitcnt lgkmcnt(4)
    v_mfma_f32_16x16x32_bf16 v[24:27], v[204:207], a[216:219], v[24:27]
    s_waitcnt vmcnt(17)
    s_barrier
    v_mfma_f32_16x16x32_bf16 v[28:31], v[204:207], a[220:223], v[28:31]
    ds_read_b64_tr_b16 v[200:201], v216 offset:28896
    ds_read_b64_tr_b16 v[202:203], v216 offset:29408
    v_mfma_f32_16x16x32_bf16 v[32:35], v[204:207], a[224:227], v[32:35]
    v_mfma_f32_16x16x32_bf16 v[36:39], v[204:207], a[228:231], v[36:39]
    s_add_u32 m0, s72, 0
    s_add_u32 s73, s49, 0
    v_mfma_f32_16x16x32_bf16 v[40:43], v[204:207], a[232:235], v[40:43]
    buffer_load_dwordx4 v224, s[16:19], s73 offen lds
    v_mfma_f32_16x16x32_bf16 v[44:47], v[204:207], a[236:239], v[44:47]
    ds_read_b128 a[192:195], v244 offset:12288
    s_waitcnt lgkmcnt(5)
    v_mfma_f32_16x16x32_bf16 v[48:51], v[208:211], a[216:219], v[48:51]
    s_add_u32 m0, s72, 4096
    s_add_u32 s73, s49, 36864
    v_mfma_f32_16x16x32_bf16 v[52:55], v[208:211], a[220:223], v[52:55]
    buffer_load_dwordx4 v224, s[16:19], s73 offen lds
    v_mfma_f32_16x16x32_bf16 v[56:59], v[208:211], a[224:227], v[56:59]
    ds_read_b64_tr_b16 v[204:205], v216 offset:28904
    ds_read_b64_tr_b16 v[206:207], v216 offset:29416
    v_mfma_f32_16x16x32_bf16 v[60:63], v[208:211], a[228:231], v[60:63]
    s_add_u32 m0, s72, 8192
    s_add_u32 s73, s49, 73728
    v_mfma_f32_16x16x32_bf16 v[64:67], v[208:211], a[232:235], v[64:67]
    buffer_load_dwordx4 a[4:7], v197, s[8:11], s29 offen offset:1024 nt
    v_mfma_f32_16x16x32_bf16 v[68:71], v[208:211], a[236:239], v[68:71]
    buffer_load_dwordx4 v224, s[16:19], s73 offen lds
    s_waitcnt lgkmcnt(5)
    v_mfma_f32_16x16x32_bf16 v[72:75], v[212:215], a[216:219], v[72:75]
    s_add_u32 s49, s49, 128
    s_cmp_eq_u32 s49, 1152
    s_cselect_b32 s49, 0, s49
    v_mfma_f32_16x16x32_bf16 v[76:79], v[212:215], a[220:223], v[76:79]
    s_add_u32 m0, s28, 24768
    s_add_u32 s73, s48, 0
    v_mfma_f32_16x16x32_bf16 v[80:83], v[212:215], a[224:227], v[80:83]
    buffer_load_dwordx4 v220, s[12:15], s73 offen lds
    v_mfma_f32_16x16x32_bf16 v[84:87], v[212:215], a[228:231], v[84:87]
    ds_read_b64_tr_b16 v[208:209], v217 offset:28896
    ds_read_b64_tr_b16 v[210:211], v217 offset:29408
    v_mfma_f32_16x16x32_bf16 v[88:91], v[212:215], a[232:235], v[88:91]
    ds_read_b128 a[196:199], v244 offset:14336
    ds_read_b128 a[200:203], v244 offset:16384
    v_mfma_f32_16x16x32_bf16 v[92:95], v[212:215], a[236:239], v[92:95]
    s_waitcnt lgkmcnt(7)
    v_mfma_f32_16x16x32_bf16 v[96:99], v[200:203], a[216:219], v[96:99]
    buffer_load_dwordx4 v221, s[12:15], s73 offen offset:1032 lds
    v_mfma_f32_16x16x32_bf16 v[100:103], v[200:203], a[220:223], v[100:103]
    ds_read_b64_tr_b16 v[212:213], v217 offset:28904
    ds_read_b64_tr_b16 v[214:215], v217 offset:29416
    v_mfma_f32_16x16x32_bf16 v[104:107], v[200:203], a[224:227], v[104:107]
    ds_read_b128 a[204:207], v244 offset:18432
    v_mfma_f32_16x16x32_bf16 v[108:111], v[200:203], a[228:231], v[108:111]
    v_mfma_f32_16x16x32_bf16 v[112:115], v[200:203], a[232:235], v[112:115]
    buffer_load_dwordx4 a[8:11], v197, s[8:11], s29 offen offset:2048 nt
    v_mfma_f32_16x16x32_bf16 v[116:119], v[200:203], a[236:239], v[116:119]
    s_waitcnt lgkmcnt(7)
    v_mfma_f32_16x16x32_bf16 v[120:123], v[204:207], a[216:219], v[120:123]
    buffer_load_dwordx4 v222, s[12:15], s73 offen offset:2064 lds
    v_mfma_f32_16x16x32_bf16 v[124:127], v[204:207], a[220:223], v[124:127]
    ds_read_b64_tr_b16 v[200:201], v216 offset:0
    ds_read_b64_tr_b16 v[202:203], v216 offset:512
    v_mfma_f32_16x16x32_bf16 v[128:131], v[204:207], a[224:227], v[128:131]
    ds_read_b128 a[208:211], v244 offset:20480
    v_mfma_f32_16x16x32_bf16 v[132:135], v[204:207], a[228:231], v[132:135]
    v_mfma_f32_16x16x32_bf16 v[136:139], v[204:207], a[232:235], v[136:139]
    ds_read_b128 a[212:215], v244 offset:22528
    v_mfma_f32_16x16x32_bf16 v[140:143], v[204:207], a[236:239], v[140:143]
    s_waitcnt lgkmcnt(9)
    v_mfma_f32_16x16x32_bf16 v[144:147], v[208:211], a[216:219], v[144:147]
    buffer_load_dwordx4 v223, s[12:15], s73 offen offset:3096 lds
    v_mfma_f32_16x16x32_bf16 v[148:151], v[208:211], a[220:223], v[148:151]
    ds_read_b64_tr_b16 v[204:205], v216 offset:8
    ds_read_b64_tr_b16 v[206:207], v216 offset:520
    v_mfma_f32_16x16x32_bf16 v[152:155], v[208:211], a[224:227], v[152:155]
    v_mfma_f32_16x16x32_bf16 v[156:159], v[208:211], a[228:231], v[156:159]
    v_mfma_f32_16x16x32_bf16 v[160:163], v[208:211], a[232:235], v[160:163]
    buffer_load_dwordx4 a[12:15], v197, s[8:11], s29 offen offset:3072 nt
    v_mfma_f32_16x16x32_bf16 v[164:167], v[208:211], a[236:239], v[164:167]
    s_waitcnt lgkmcnt(7)
    v_mfma_f32_16x16x32_bf16 v[168:171], v[212:215], a[216:219], v[168:171]
    s_add_u32 m0, s28, 28896
    s_add_u32 s73, s48, 128
    v_mfma_f32_16x16x32_bf16 v[172:175], v[212:215], a[220:223], v[172:175]
    buffer_load_dwordx4 v220, s[12:15], s73 offen lds
    v_mfma_f32_16x16x32_bf16 v[176:179], v[212:215], a[224:227], v[176:179]
    ds_read_b64_tr_b16 v[208:209], v217 offset:0
    ds_read_b64_tr_b16 v[210:211], v217 offset:512
    v_mfma_f32_16x16x32_bf16 v[180:183], v[212:215], a[228:231], v[180:183]
    v_mfma_f32_16x16x32_bf16 v[184:187], v[212:215], a[232:235], v[184:187]
    v_mfma_f32_16x16x32_bf16 v[188:191], v[212:215], a[236:239], v[188:191]
    s_waitcnt lgkmcnt(6)
    v_mfma_f32_16x16x32_bf16 v[0:3], v[200:203], a[192:195], v[0:3]
    buffer_load_dwordx4 v221, s[12:15], s73 offen offset:1032 lds
    v_mfma_f32_16x16x32_bf16 v[4:7], v[200:203], a[196:199], v[4:7]
    ds_read_b64_tr_b16 v[212:213], v217 offset:8
    ds_read_b64_tr_b16 v[214:215], v217 offset:520
    v_mfma_f32_16x16x32_bf16 v[8:11], v[200:203], a[200:203], v[8:11]
    v_mfma_f32_16x16x32_bf16 v[12:15], v[200:203], a[204:207], v[12:15]
    s_waitcnt lgkmcnt(7)
    v_mfma_f32_16x16x32_bf16 v[16:19], v[200:203], a[208:211], v[16:19]
    buffer_load_dwordx4 a[16:19], v197, s[8:11], s30 offen nt
    s_waitcnt lgkmcnt(6)
    v_mfma_f32_16x16x32_bf16 v[20:23], v[200:203], a[212:215], v[20:23]
    s_waitcnt lgkmcnt(4)
    v_mfma_f32_16x16x32_bf16 v[24:27], v[204:207], a[192:195], v[24:27]
    buffer_load_dwordx4 v222, s[12:15], s73 offen offset:2064 lds
    v_mfma_f32_16x16x32_bf16 v[28:31], v[204:207], a[196:199], v[28:31]
    ds_read_b64_tr_b16 v[200:201], v216 offset:4128
    ds_read_b64_tr_b16 v[202:203], v216 offset:4640
    v_mfma_f32_16x16x32_bf16 v[32:35], v[204:207], a[200:203], v[32:35]
    v_mfma_f32_16x16x32_bf16 v[36:39], v[204:207], a[204:207], v[36:39]
    ds_read_b128 a[216:219], v245 offset:12288
    v_mfma_f32_16x16x32_bf16 v[40:43], v[204:207], a[208:211], v[40:43]
    v_mfma_f32_16x16x32_bf16 v[44:47], v[204:207], a[212:215], v[44:47]
    s_waitcnt lgkmcnt(5)
    v_mfma_f32_16x16x32_bf16 v[48:51], v[208:211], a[192:195], v[48:51]
    buffer_load_dwordx4 v223, s[12:15], s73 offen offset:3096 lds
    v_mfma_f32_16x16x32_bf16 v[52:55], v[208:211], a[196:199], v[52:55]
    ds_read_b64_tr_b16 v[204:205], v216 offset:4136
    ds_read_b64_tr_b16 v[206:207], v216 offset:4648
    v_mfma_f32_16x16x32_bf16 v[56:59], v[208:211], a[200:203], v[56:59]
    ds_read_b128 a[220:223], v245 offset:14336
    v_mfma_f32_16x16x32_bf16 v[60:63], v[208:211], a[204:207], v[60:63]
    v_mfma_f32_16x16x32_bf16 v[64:67], v[208:211], a[208:211], v[64:67]
    buffer_load_dwordx4 a[20:23], v197, s[8:11], s30 offen offset:1024 nt
    v_mfma_f32_16x16x32_bf16 v[68:71], v[208:211], a[212:215], v[68:71]
    s_waitcnt lgkmcnt(6)
    v_mfma_f32_16x16x32_bf16 v[72:75], v[212:215], a[192:195], v[72:75]
    s_add_u32 s48, s48, 262144
    s_cmp_eq_u32 s48, 4718592
    s_cselect_b32 s48, 0, s48
    v_mfma_f32_16x16x32_bf16 v[76:79], v[212:215], a[196:199], v[76:79]
    ds_read_b64_tr_b16 v[208:209], v217 offset:4128
    ds_read_b64_tr_b16 v[210:211], v217 offset:4640
    v_mfma_f32_16x16x32_bf16 v[80:83], v[212:215], a[200:203], v[80:83]
    ds_read_b128 a[224:227], v245 offset:16384
    v_mfma_f32_16x16x32_bf16 v[84:87], v[212:215], a[204:207], v[84:87]
    v_mfma_f32_16x16x32_bf16 v[88:91], v[212:215], a[208:211], v[88:91]
    v_mfma_f32_16x16x32_bf16 v[92:95], v[212:215], a[212:215], v[92:95]
    s_waitcnt lgkmcnt(7)
    v_mfma_f32_16x16x32_bf16 v[96:99], v[200:203], a[192:195], v[96:99]
    ds_read_b64_tr_b16 v[212:213], v217 offset:4136
    ds_read_b64_tr_b16 v[214:215], v217 offset:4648
    v_mfma_f32_16x16x32_bf16 v[100:103], v[200:203], a[196:199], v[100:103]
    ds_read_b128 a[228:231], v245 offset:18432
    v_mfma_f32_16x16x32_bf16 v[104:107], v[200:203], a[200:203], v[104:107]
    v_mfma_f32_16x16x32_bf16 v[108:111], v[200:203], a[204:207], v[108:111]
    v_mfma_f32_16x16x32_bf16 v[112:115], v[200:203], a[208:211], v[112:115]
    buffer_load_dwordx4 a[24:27], v197, s[8:11], s30 offen offset:2048 nt
    v_mfma_f32_16x16x32_bf16 v[116:119], v[200:203], a[212:215], v[116:119]
    s_waitcnt vmcnt(30)
    s_waitcnt lgkmcnt(7)
    v_mfma_f32_16x16x32_bf16 v[120:123], v[204:207], a[192:195], v[120:123]
    ds_read_b64_tr_b16 v[200:201], v216 offset:8256
    ds_read_b64_tr_b16 v[202:203], v216 offset:8768
    v_mfma_f32_16x16x32_bf16 v[124:127], v[204:207], a[196:199], v[124:127]
    ds_read_b128 a[232:235], v245 offset:20480
    v_mfma_f32_16x16x32_bf16 v[128:131], v[204:207], a[200:203], v[128:131]
    v_mfma_f32_16x16x32_bf16 v[132:135], v[204:207], a[204:207], v[132:135]
    v_mfma_f32_16x16x32_bf16 v[136:139], v[204:207], a[208:211], v[136:139]
    ds_read_b128 a[236:239], v245 offset:22528
    v_mfma_f32_16x16x32_bf16 v[140:143], v[204:207], a[212:215], v[140:143]
    s_waitcnt lgkmcnt(8)
    v_mfma_f32_16x16x32_bf16 v[144:147], v[208:211], a[192:195], v[144:147]
    ds_read_b64_tr_b16 v[204:205], v216 offset:8264
    ds_read_b64_tr_b16 v[206:207], v216 offset:8776
    v_mfma_f32_16x16x32_bf16 v[148:151], v[208:211], a[196:199], v[148:151]
    v_mfma_f32_16x16x32_bf16 v[152:155], v[208:211], a[200:203], v[152:155]
    v_mfma_f32_16x16x32_bf16 v[156:159], v[208:211], a[204:207], v[156:159]
    v_mfma_f32_16x16x32_bf16 v[160:163], v[208:211], a[208:211], v[160:163]
    buffer_load_dwordx4 a[28:31], v197, s[8:11], s30 offen offset:3072 nt
    v_mfma_f32_16x16x32_bf16 v[164:167], v[208:211], a[212:215], v[164:167]
    s_waitcnt lgkmcnt(7)
    v_mfma_f32_16x16x32_bf16 v[168:171], v[212:215], a[192:195], v[168:171]
    s_add_u32 s29, s29, 8192
    s_and_b32 s29, s29, 0x3ffff
    v_mfma_f32_16x16x32_bf16 v[172:175], v[212:215], a[196:199], v[172:175]
    s_add_u32 s30, s29, 4096
    v_mfma_f32_16x16x32_bf16 v[176:179], v[212:215], a[200:203], v[176:179]
    ds_read_b64_tr_b16 v[208:209], v217 offset:8256
    ds_read_b64_tr_b16 v[210:211], v217 offset:8768
    v_mfma_f32_16x16x32_bf16 v[180:183], v[212:215], a[204:207], v[180:183]
    v_mfma_f32_16x16x32_bf16 v[184:187], v[212:215], a[208:211], v[184:187]
    v_mfma_f32_16x16x32_bf16 v[188:191], v[212:215], a[212:215], v[188:191]
    s_waitcnt lgkmcnt(6)
    v_mfma_f32_16x16x32_bf16 v[0:3], v[200:203], a[216:219], v[0:3]
    ds_read_b64_tr_b16 v[212:213], v217 offset:8264
    ds_read_b64_tr_b16 v[214:215], v217 offset:8776
    v_mfma_f32_16x16x32_bf16 v[4:7], v[200:203], a[220:223], v[4:7]
    v_mfma_f32_16x16x32_bf16 v[8:11], v[200:203], a[224:227], v[8:11]
    v_mfma_f32_16x16x32_bf16 v[12:15], v[200:203], a[228:231], v[12:15]
    s_waitcnt lgkmcnt(7)
    v_mfma_f32_16x16x32_bf16 v[16:19], v[200:203], a[232:235], v[16:19]
    buffer_load_dwordx4 a[32:35], v197, s[8:11], s29 offen nt
    s_waitcnt lgkmcnt(6)
    v_mfma_f32_16x16x32_bf16 v[20:23], v[200:203], a[236:239], v[20:23]
    s_waitcnt vmcnt(28)
    s_waitcnt lgkmcnt(4)
    v_mfma_f32_16x16x32_bf16 v[24:27], v[204:207], a[216:219], v[24:27]
    s_waitcnt vmcnt(15)
    s_barrier
    v_mfma_f32_16x16x32_bf16 v[28:31], v[204:207], a[220:223], v[28:31]
    ds_read_b64_tr_b16 v[200:201], v216 offset:12384
    ds_read_b64_tr_b16 v[202:203], v216 offset:12896
    v_mfma_f32_16x16x32_bf16 v[32:35], v[204:207], a[224:227], v[32:35]
    v_mfma_f32_16x16x32_bf16 v[36:39], v[204:207], a[228:231], v[36:39]
    ds_read_b128 a[192:195], v244 offset:0
    v_mfma_f32_16x16x32_bf16 v[40:43], v[204:207], a[232:235], v[40:43]
    v_mfma_f32_16x16x32_bf16 v[44:47], v[204:207], a[236:239], v[44:47]
    s_waitcnt lgkmcnt(5)
    v_mfma_f32_16x16x32_bf16 v[48:51], v[208:211], a[216:219], v[48:51]
    ds_read_b64_tr_b16 v[204:205], v216 offset:12392
    ds_read_b64_tr_b16 v[206:207], v216 offset:12904
    v_mfma_f32_16x16x32_bf16 v[52:55], v[208:211], a[220:223], v[52:55]
    v_mfma_f32_16x16x32_bf16 v[56:59], v[208:211], a[224:227], v[56:59]
    ds_read_b128 a[196:199], v244 offset:2048
    v_mfma_f32_16x16x32_bf16 v[60:63], v[208:211], a[228:231], v[60:63]
    v_mfma_f32_16x16x32_bf16 v[64:67], v[208:211], a[232:235], v[64:67]
    buffer_load_dwordx4 a[36:39], v197, s[8:11], s29 offen offset:1024 nt
    v_mfma_f32_16x16x32_bf16 v[68:71], v[208:211], a[236:239], v[68:71]
    s_waitcnt lgkmcnt(6)
    v_mfma_f32_16x16x32_bf16 v[72:75], v[212:215], a[216:219], v[72:75]
    ds_read_b64_tr_b16 v[208:209], v217 offset:12384
    ds_read_b64_tr_b16 v[210:211], v217 offset:12896
    v_mfma_f32_16x16x32_bf16 v[76:79], v[212:215], a[220:223], v[76:79]
    ds_read_b128 a[200:203], v244 offset:4096
    v_mfma_f32_16x16x32_bf16 v[80:83], v[212:215], a[224:227], v[80:83]
    v_mfma_f32_16x16x32_bf16 v[84:87], v[212:215], a[228:231], v[84:87]
    v_mfma_f32_16x16x32_bf16 v[88:91], v[212:215], a[232:235], v[88:91]
    v_mfma_f32_16x16x32_bf16 v[92:95], v[212:215], a[236:239], v[92:95]
    s_waitcnt lgkmcnt(7)
    v_mfma_f32_16x16x32_bf16 v[96:99], v[200:203], a[216:219], v[96:99]
    ds_read_b64_tr_b16 v[212:213], v217 offset:12392
    ds_read_b64_tr_b16 v[214:215], v217 offset:12904
    v_mfma_f32_16x16x32_bf16 v[100:103], v[200:203], a[220:223], v[100:103]
    ds_read_b128 a[204:207], v244 offset:6144
    v_mfma_f32_16x16x32_bf16 v[104:107], v[200:203], a[224:227], v[104:107]
    v_mfma_f32_16x16x32_bf16 v[108:111], v[200:203], a[228:231], v[108:111]
    v_mfma_f32_16x16x32_bf16 v[112:115], v[200:203], a[232:235], v[112:115]
    buffer_load_dwordx4 a[40:43], v197, s[8:11], s29 offen offset:2048 nt
    v_mfma_f32_16x16x32_bf16 v[116:119], v[200:203], a[236:239], v[116:119]
    s_waitcnt lgkmcnt(7)
    v_mfma_f32_16x16x32_bf16 v[120:123], v[204:207], a[216:219], v[120:123]
    ds_read_b64_tr_b16 v[200:201], v216 offset:16512
    ds_read_b64_tr_b16 v[202:203], v216 offset:17024
    v_mfma_f32_16x16x32_bf16 v[124:127], v[204:207], a[220:223], v[124:127]
    ds_read_b128 a[208:211], v244 offset:8192
    v_mfma_f32_16x16x32_bf16 v[128:131], v[204:207], a[224:227], v[128:131]
    v_mfma_f32_16x16x32_bf16 v[132:135], v[204:207], a[228:231], v[132:135]
    v_mfma_f32_16x16x32_bf16 v[136:139], v[204:207], a[232:235], v[136:139]
    ds_read_b128 a[212:215], v244 offset:10240
    v_mfma_f32_16x16x32_bf16 v[140:143], v[204:207], a[236:239], v[140:143]
    s_waitcnt lgkmcnt(8)
    v_mfma_f32_16x16x32_bf16 v[144:147], v[208:211], a[216:219], v[144:147]
    ds_read_b64_tr_b16 v[204:205], v216 offset:16520
    ds_read_b64_tr_b16 v[206:207], v216 offset:17032
    v_mfma_f32_16x16x32_bf16 v[148:151], v[208:211], a[220:223], v[148:151]
    v_mfma_f32_16x16x32_bf16 v[152:155], v[208:211], a[224:227], v[152:155]
    v_mfma_f32_16x16x32_bf16 v[156:159], v[208:211], a[228:231], v[156:159]
    v_mfma_f32_16x16x32_bf16 v[160:163], v[208:211], a[232:235], v[160:163]
    buffer_load_dwordx4 a[44:47], v197, s[8:11], s29 offen offset:3072 nt
    v_mfma_f32_16x16x32_bf16 v[164:167], v[208:211], a[236:239], v[164:167]
    s_waitcnt lgkmcnt(7)
    v_mfma_f32_16x16x32_bf16 v[168:171], v[212:215], a[216:219], v[168:171]
    ds_read_b64_tr_b16 v[208:209], v217 offset:16512
    ds_read_b64_tr_b16 v[210:211], v217 offset:17024
    v_mfma_f32_16x16x32_bf16 v[172:175], v[212:215], a[220:223], v[172:175]
    v_mfma_f32_16x16x32_bf16 v[176:179], v[212:215], a[224:227], v[176:179]
    v_mfma_f32_16x16x32_bf16 v[180:183], v[212:215], a[228:231], v[180:183]
    v_mfma_f32_16x16x32_bf16 v[184:187], v[212:215], a[232:235], v[184:187]
    v_mfma_f32_16x16x32_bf16 v[188:191], v[212:215], a[236:239], v[188:191]
    s_waitcnt lgkmcnt(6)
    v_mfma_f32_16x16x32_bf16 v[0:3], v[200:203], a[192:195], v[0:3]
    ds_read_b64_tr_b16 v[212:213], v217 offset:16520
    ds_read_b64_tr_b16 v[214:215], v217 offset:17032
    v_mfma_f32_16x16x32_bf16 v[4:7], v[200:203], a[196:199], v[4:7]
    v_mfma_f32_16x16x32_bf16 v[8:11], v[200:203], a[200:203], v[8:11]
    v_mfma_f32_16x16x32_bf16 v[12:15], v[200:203], a[204:207], v[12:15]
    s_waitcnt lgkmcnt(7)
    v_mfma_f32_16x16x32_bf16 v[16:19], v[200:203], a[208:211], v[16:19]
    buffer_load_dwordx4 a[48:51], v197, s[8:11], s30 offen nt
    s_waitcnt lgkmcnt(6)
    v_mfma_f32_16x16x32_bf16 v[20:23], v[200:203], a[212:215], v[20:23]
    s_waitcnt lgkmcnt(4)
    v_mfma_f32_16x16x32_bf16 v[24:27], v[204:207], a[192:195], v[24:27]
    ds_read_b64_tr_b16 v[200:201], v216 offset:20640
    ds_read_b64_tr_b16 v[202:203], v216 offset:21152
    v_mfma_f32_16x16x32_bf16 v[28:31], v[204:207], a[196:199], v[28:31]
    v_mfma_f32_16x16x32_bf16 v[32:35], v[204:207], a[200:203], v[32:35]
    v_mfma_f32_16x16x32_bf16 v[36:39], v[204:207], a[204:207], v[36:39]
    ds_read_b128 a[216:219], v245 offset:0
    v_mfma_f32_16x16x32_bf16 v[40:43], v[204:207], a[208:211], v[40:43]
    v_mfma_f32_16x16x32_bf16 v[44:47], v[204:207], a[212:215], v[44:47]
    s_waitcnt lgkmcnt(5)
    v_mfma_f32_16x16x32_bf16 v[48:51], v[208:211], a[192:195], v[48:51]
    ds_read_b64_tr_b16 v[204:205], v216 offset:20648
    ds_read_b64_tr_b16 v[206:207], v216 offset:21160
    v_mfma_f32_16x16x32_bf16 v[52:55], v[208:211], a[196:199], v[52:55]
    v_mfma_f32_16x16x32_bf16 v[56:59], v[208:211], a[200:203], v[56:59]
    ds_read_b128 a[220:223], v245 offset:2048
    v_mfma_f32_16x16x32_bf16 v[60:63], v[208:211], a[204:207], v[60:63]
    v_mfma_f32_16x16x32_bf16 v[64:67], v[208:211], a[208:211], v[64:67]
    buffer_load_dwordx4 a[52:55], v197, s[8:11], s30 offen offset:1024 nt
    v_mfma_f32_16x16x32_bf16 v[68:71], v[208:211], a[212:215], v[68:71]
    s_waitcnt lgkmcnt(6)
    v_mfma_f32_16x16x32_bf16 v[72:75], v[212:215], a[192:195], v[72:75]
    ds_read_b64_tr_b16 v[208:209], v217 offset:20640
    ds_read_b64_tr_b16 v[210:211], v217 offset:21152
    v_mfma_f32_16x16x32_bf16 v[76:79], v[212:215], a[196:199], v[76:79]
    ds_read_b128 a[224:227], v245 offset:4096
    v_mfma_f32_16x16x32_bf16 v[80:83], v[212:215], a[200:203], v[80:83]
    v_mfma_f32_16x16x32_bf16 v[84:87], v[212:215], a[204:207], v[84:87]
    v_mfma_f32_16x16x32_bf16 v[88:91], v[212:215], a[208:211], v[88:91]
    v_mfma_f32_16x16x32_bf16 v[92:95], v[212:215], a[212:215], v[92:95]
    s_waitcnt lgkmcnt(7)
    v_mfma_f32_16x16x32_bf16 v[96:99], v[200:203], a[192:195], v[96:99]
    ds_read_b64_tr_b16 v[212:213], v217 offset:20648
    ds_read_b64_tr_b16 v[214:215], v217 offset:21160
    v_mfma_f32_16x16x32_bf16 v[100:103], v[200:203], a[196:199], v[100:103]
    ds_read_b128 a[228:231], v245 offset:6144
    v_mfma_f32_16x16x32_bf16 v[104:107], v[200:203], a[200:203], v[104:107]
    v_mfma_f32_16x16x32_bf16 v[108:111], v[200:203], a[204:207], v[108:111]
    v_mfma_f32_16x16x32_bf16 v[112:115], v[200:203], a[208:211], v[112:115]
    buffer_load_dwordx4 a[56:59], v197, s[8:11], s30 offen offset:2048 nt
    v_mfma_f32_16x16x32_bf16 v[116:119], v[200:203], a[212:215], v[116:119]
    s_waitcnt vmcnt(16)
    s_waitcnt lgkmcnt(7)
    v_mfma_f32_16x16x32_bf16 v[120:123], v[204:207], a[192:195], v[120:123]
    ds_read_b64_tr_b16 v[200:201], v216 offset:24768
    ds_read_b64_tr_b16 v[202:203], v216 offset:25280
    v_mfma_f32_16x16x32_bf16 v[124:127], v[204:207], a[196:199], v[124:127]
    ds_read_b128 a[232:235], v245 offset:8192
    v_mfma_f32_16x16x32_bf16 v[128:131], v[204:207], a[200:203], v[128:131]
    v_mfma_f32_16x16x32_bf16 v[132:135], v[204:207], a[204:207], v[132:135]
    v_mfma_f32_16x16x32_bf16 v[136:139], v[204:207], a[208:211], v[136:139]
    ds_read_b128 a[236:239], v245 offset:10240
    v_mfma_f32_16x16x32_bf16 v[140:143], v[204:207], a[212:215], v[140:143]
    s_waitcnt lgkmcnt(8)
    v_mfma_f32_16x16x32_bf16 v[144:147], v[208:211], a[192:195], v[144:147]
    ds_read_b64_tr_b16 v[204:205], v216 offset:24776
    ds_read_b64_tr_b16 v[206:207], v216 offset:25288
    v_mfma_f32_16x16x32_bf16 v[148:151], v[208:211], a[196:199], v[148:151]
    v_mfma_f32_16x16x32_bf16 v[152:155], v[208:211], a[200:203], v[152:155]
    v_mfma_f32_16x16x32_bf16 v[156:159], v[208:211], a[204:207], v[156:159]
    v_mfma_f32_16x16x32_bf16 v[160:163], v[208:211], a[208:211], v[160:163]
    buffer_load_dwordx4 a[60:63], v197, s[8:11], s30 offen offset:3072 nt
    v_mfma_f32_16x16x32_bf16 v[164:167], v[208:211], a[212:215], v[164:167]
    s_waitcnt lgkmcnt(7)
    v_mfma_f32_16x16x32_bf16 v[168:171], v[212:215], a[192:195], v[168:171]
    s_add_u32 s29, s29, 8192
    s_and_b32 s29, s29, 0x3ffff
    v_mfma_f32_16x16x32_bf16 v[172:175], v[212:215], a[196:199], v[172:175]
    s_add_u32 s30, s29, 4096
    v_mfma_f32_16x16x32_bf16 v[176:179], v[212:215], a[200:203], v[176:179]
    ds_read_b64_tr_b16 v[208:209], v217 offset:24768
    ds_read_b64_tr_b16 v[210:211], v217 offset:25280
    v_mfma_f32_16x16x32_bf16 v[180:183], v[212:215], a[204:207], v[180:183]
    v_mfma_f32_16x16x32_bf16 v[184:187], v[212:215], a[208:211], v[184:187]
    v_mfma_f32_16x16x32_bf16 v[188:191], v[212:215], a[212:215], v[188:191]
    s_waitcnt lgkmcnt(6)
    v_mfma_f32_16x16x32_bf16 v[0:3], v[200:203], a[216:219], v[0:3]
    ds_read_b64_tr_b16 v[212:213], v217 offset:24776
    ds_read_b64_tr_b16 v[214:215], v217 offset:25288
    v_mfma_f32_16x16x32_bf16 v[4:7], v[200:203], a[220:223], v[4:7]
    v_mfma_f32_16x16x32_bf16 v[8:11], v[200:203], a[224:227], v[8:11]
    v_mfma_f32_16x16x32_bf16 v[12:15], v[200:203], a[228:231], v[12:15]
    s_waitcnt lgkmcnt(7)
    v_mfma_f32_16x16x32_bf16 v[16:19], v[200:203], a[232:235], v[16:19]
    s_waitcnt lgkmcnt(6)
    v_mfma_f32_16x16x32_bf16 v[20:23], v[200:203], a[236:239], v[20:23]
    s_waitcnt vmcnt(11)
    s_waitcnt lgkmcnt(4)
    v_mfma_f32_16x16x32_bf16 v[24:27], v[204:207], a[216:219], v[24:27]
    ds_read_b64_tr_b16 v[200:201], v216 offset:28896
    ds_read_b64_tr_b16 v[202:203], v216 offset:29408
    v_mfma_f32_16x16x32_bf16 v[28:31], v[204:207], a[220:223], v[28:31]
    v_mfma_f32_16x16x32_bf16 v[32:35], v[204:207], a[224:227], v[32:35]
    v_mfma_f32_16x16x32_bf16 v[36:39], v[204:207], a[228:231], v[36:39]
    v_mfma_f32_16x16x32_bf16 v[40:43], v[204:207], a[232:235], v[40:43]
    v_mfma_f32_16x16x32_bf16 v[44:47], v[204:207], a[236:239], v[44:47]
    s_waitcnt lgkmcnt(4)
    v_mfma_f32_16x16x32_bf16 v[48:51], v[208:211], a[216:219], v[48:51]
    ds_read_b64_tr_b16 v[204:205], v216 offset:28904
    ds_read_b64_tr_b16 v[206:207], v216 offset:29416
    v_mfma_f32_16x16x32_bf16 v[52:55], v[208:211], a[220:223], v[52:55]
    v_mfma_f32_16x16x32_bf16 v[56:59], v[208:211], a[224:227], v[56:59]
    v_mfma_f32_16x16x32_bf16 v[60:63], v[208:211], a[228:231], v[60:63]
    v_mfma_f32_16x16x32_bf16 v[64:67], v[208:211], a[232:235], v[64:67]
    v_mfma_f32_16x16x32_bf16 v[68:71], v[208:211], a[236:239], v[68:71]
    s_waitcnt lgkmcnt(4)
    v_mfma_f32_16x16x32_bf16 v[72:75], v[212:215], a[216:219], v[72:75]
    ds_write_b128 v199, a[0:3] offset:0
    v_mfma_f32_16x16x32_bf16 v[76:79], v[212:215], a[220:223], v[76:79]
    ds_read_b64_tr_b16 v[208:209], v217 offset:28896
    ds_read_b64_tr_b16 v[210:211], v217 offset:29408
    v_mfma_f32_16x16x32_bf16 v[80:83], v[212:215], a[224:227], v[80:83]
    v_mfma_f32_16x16x32_bf16 v[84:87], v[212:215], a[228:231], v[84:87]
    ds_write_b128 v199, a[4:7] offset:1088
    v_mfma_f32_16x16x32_bf16 v[88:91], v[212:215], a[232:235], v[88:91]
    v_mfma_f32_16x16x32_bf16 v[92:95], v[212:215], a[236:239], v[92:95]
    s_waitcnt lgkmcnt(6)
    v_mfma_f32_16x16x32_bf16 v[96:99], v[200:203], a[216:219], v[96:99]
    v_mfma_f32_16x16x32_bf16 v[100:103], v[200:203], a[220:223], v[100:103]
    ds_write_b128 v199, a[8:11] offset:2176
    v_mfma_f32_16x16x32_bf16 v[104:107], v[200:203], a[224:227], v[104:107]
    ds_read_b64_tr_b16 v[212:213], v217 offset:28904
    ds_read_b64_tr_b16 v[214:215], v217 offset:29416
    v_mfma_f32_16x16x32_bf16 v[108:111], v[200:203], a[228:231], v[108:111]
    v_mfma_f32_16x16x32_bf16 v[112:115], v[200:203], a[232:235], v[112:115]
    v_mfma_f32_16x16x32_bf16 v[116:119], v[200:203], a[236:239], v[116:119]
    s_waitcnt lgkmcnt(7)
    v_mfma_f32_16x16x32_bf16 v[120:123], v[204:207], a[216:219], v[120:123]
    ds_write_b128 v199, a[12:15] offset:3264
    v_mfma_f32_16x16x32_bf16 v[124:127], v[204:207], a[220:223], v[124:127]
    v_mfma_f32_16x16x32_bf16 v[128:131], v[204:207], a[224:227], v[128:131]
    v_mfma_f32_16x16x32_bf16 v[132:135], v[204:207], a[228:231], v[132:135]
    ds_write_b128 v199, a[16:19] offset:4352
    v_mfma_f32_16x16x32_bf16 v[136:139], v[204:207], a[232:235], v[136:139]
    v_mfma_f32_16x16x32_bf16 v[140:143], v[204:207], a[236:239], v[140:143]
    s_waitcnt lgkmcnt(6)
    v_mfma_f32_16x16x32_bf16 v[144:147], v[208:211], a[216:219], v[144:147]
    s_waitcnt vmcnt(10)
    v_mfma_f32_16x16x32_bf16 v[148:151], v[208:211], a[220:223], v[148:151]
    ds_write_b128 v199, a[20:23] offset:5440
    v_mfma_f32_16x16x32_bf16 v[152:155], v[208:211], a[224:227], v[152:155]
    v_mfma_f32_16x16x32_bf16 v[156:159], v[208:211], a[228:231], v[156:159]
    v_mfma_f32_16x16x32_bf16 v[160:163], v[208:211], a[232:235], v[160:163]
    s_waitcnt vmcnt(9)
    v_mfma_f32_16x16x32_bf16 v[164:167], v[208:211], a[236:239], v[164:167]
    s_waitcnt lgkmcnt(3)
    v_mfma_f32_16x16x32_bf16 v[168:171], v[212:215], a[216:219], v[168:171]
    ds_write_b128 v199, a[24:27] offset:6528
    v_mfma_f32_16x16x32_bf16 v[172:175], v[212:215], a[220:223], v[172:175]
    v_mfma_f32_16x16x32_bf16 v[176:179], v[212:215], a[224:227], v[176:179]
    s_waitcnt vmcnt(8)
    v_mfma_f32_16x16x32_bf16 v[180:183], v[212:215], a[228:231], v[180:183]
    ds_write_b128 v199, a[28:31] offset:7616
    v_mfma_f32_16x16x32_bf16 v[184:187], v[212:215], a[232:235], v[184:187]
    v_mfma_f32_16x16x32_bf16 v[188:191], v[212:215], a[236:239], v[188:191]
    v_pk_mul_f32 v[16:17], v[16:17], s[74:75]
    v_pk_mul_f32 v[18:19], v[18:19], s[74:75]
    v_pk_mul_f32 v[40:41], v[40:41], s[74:75]
    v_pk_mul_f32 v[42:43], v[42:43], s[74:75]
    s_add_u32 m0, s28, 17408
    v_pk_mul_f32 v[64:65], v[64:65], s[74:75]
    v_pk_mul_f32 v[66:67], v[66:67], s[74:75]
    v_pk_mul_f32 v[88:89], v[88:89], s[74:75]
    v_pk_mul_f32 v[90:91], v[90:91], s[74:75]
    v_pk_mul_f32 v[112:113], v[112:113], s[74:75]
    v_pk_mul_f32 v[114:115], v[114:115], s[74:75]
    v_pk_mul_f32 v[136:137], v[136:137], s[74:75]
    v_pk_mul_f32 v[138:139], v[138:139], s[74:75]
    v_pk_mul_f32 v[160:161], v[160:161], s[74:75]
    v_pk_mul_f32 v[162:163], v[162:163], s[74:75]
    v_pk_mul_f32 v[184:185], v[184:185], s[74:75]
    v_pk_mul_f32 v[186:187], v[186:187], s[74:75]
    v_cvt_pk_bf16_f32 v200, v16, v17
    v_cvt_pk_bf16_f32 v201, v18, v19
    v_cvt_pk_bf16_f32 v202, v40, v41
    v_cvt_pk_bf16_f32 v203, v42, v43
    v_cvt_pk_bf16_f32 v204, v64, v65
    v_cvt_pk_bf16_f32 v205, v66, v67
    v_cvt_pk_bf16_f32 v206, v88, v89
    v_cvt_pk_bf16_f32 v207, v90, v91
    v_cvt_pk_bf16_f32 v208, v112, v113
    v_cvt_pk_bf16_f32 v209, v114, v115
    v_cvt_pk_bf16_f32 v210, v136, v137
    v_cvt_pk_bf16_f32 v211, v138, v139
    buffer_load_dwordx4 v197, s[8:11], s29 offen nt lds
    s_add_u32 m0, s28, 17472
    s_waitcnt vmcnt(8)
    ds_write_b128 v199, a[32:35] offset:8704
    v_cvt_pk_bf16_f32 v212, v160, v161
    v_cvt_pk_bf16_f32 v213, v162, v163
    v_cvt_pk_bf16_f32 v214, v184, v185
    v_cvt_pk_bf16_f32 v215, v186, v187
    v_pk_mul_f32 v[20:21], v[20:21], s[74:75]
    v_pk_mul_f32 v[22:23], v[22:23], s[74:75]
    v_pk_mul_f32 v[44:45], v[44:45], s[74:75]
    v_pk_mul_f32 v[46:47], v[46:47], s[74:75]
    v_pk_mul_f32 v[68:69], v[68:69], s[74:75]
    v_pk_mul_f32 v[70:71], v[70:71], s[74:75]
    v_pk_mul_f32 v[92:93], v[92:93], s[74:75]
    v_pk_mul_f32 v[94:95], v[94:95], s[74:75]
    v_pk_mul_f32 v[116:117], v[116:117], s[74:75]
    v_pk_mul_f32 v[118:119], v[118:119], s[74:75]
    v_pk_mul_f32 v[140:141], v[140:141], s[74:75]
    v_pk_mul_f32 v[142:143], v[142:143], s[74:75]
    v_pk_mul_f32 v[164:165], v[164:165], s[74:75]
    v_pk_mul_f32 v[166:167], v[166:167], s[74:75]
    v_pk_mul_f32 v[188:189], v[188:189], s[74:75]
    v_pk_mul_f32 v[190:191], v[190:191], s[74:75]
    v_cvt_pk_bf16_f32 v216, v20, v21
    v_cvt_pk_bf16_f32 v217, v22, v23
    buffer_load_dwordx4 v197, s[8:11], s29 offen offset:1024 nt lds
    s_add_u32 m0, s28, 17536
    v_cvt_pk_bf16_f32 v218, v44, v45
    v_cvt_pk_bf16_f32 v219, v46, v47
    v_cvt_pk_bf16_f32 v220, v68, v69
    v_cvt_pk_bf16_f32 v221, v70, v71
    s_waitcnt vmcnt(8)
    ds_write_b128 v199, a[36:39] offset:9792
    v_cvt_pk_bf16_f32 v222, v92, v93
    v_cvt_pk_bf16_f32 v223, v94, v95
    v_cvt_pk_bf16_f32 v224, v116, v117
    v_cvt_pk_bf16_f32 v225, v118, v119
    v_cvt_pk_bf16_f32 v226, v140, v141
    v_cvt_pk_bf16_f32 v227, v142, v143
    v_cvt_pk_bf16_f32 v228, v164, v165
    v_cvt_pk_bf16_f32 v229, v166, v167
    v_cvt_pk_bf16_f32 v230, v188, v189
    v_cvt_pk_bf16_f32 v231, v190, v191
    v_pk_mul_f32 v[0:1], v[0:1], s[74:75]
    v_pk_mul_f32 v[2:3], v[2:3], s[74:75]
    v_pk_mul_f32 v[24:25], v[24:25], s[74:75]
    v_pk_mul_f32 v[26:27], v[26:27], s[74:75]
    v_pk_mul_f32 v[48:49], v[48:49], s[74:75]
    v_pk_mul_f32 v[50:51], v[50:51], s[74:75]
    v_pk_mul_f32 v[72:73], v[72:73], s[74:75]
    v_pk_mul_f32 v[74:75], v[74:75], s[74:75]
    buffer_load_dwordx4 v197, s[8:11], s29 offen offset:2048 nt lds
    s_add_u32 m0, s28, 17600
    v_pk_mul_f32 v[96:97], v[96:97], s[74:75]
    v_pk_mul_f32 v[98:99], v[98:99], s[74:75]
    v_pk_mul_f32 v[120:121], v[120:121], s[74:75]
    v_pk_mul_f32 v[122:123], v[122:123], s[74:75]
    v_pk_mul_f32 v[144:145], v[144:145], s[74:75]
    v_pk_mul_f32 v[146:147], v[146:147], s[74:75]
    v_pk_mul_f32 v[168:169], v[168:169], s[74:75]
    v_pk_mul_f32 v[170:171], v[170:171], s[74:75]
    s_waitcnt vmcnt(8)
    ds_write_b128 v199, a[40:43] offset:10880
    v_cvt_pk_bf16_f32 v0, v0, v1
    v_cvt_pk_bf16_f32 v1, v2, v3
    v_cvt_pk_bf16_f32 v24, v24, v25
    v_cvt_pk_bf16_f32 v25, v26, v27
    v_cvt_pk_bf16_f32 v48, v48, v49
    v_cvt_pk_bf16_f32 v49, v50, v51
    v_cvt_pk_bf16_f32 v72, v72, v73
    v_cvt_pk_bf16_f32 v73, v74, v75
    v_cvt_pk_bf16_f32 v96, v96, v97
    v_cvt_pk_bf16_f32 v97, v98, v99
    v_cvt_pk_bf16_f32 v120, v120, v121
    v_cvt_pk_bf16_f32 v121, v122, v123
    v_cvt_pk_bf16_f32 v144, v144, v145
    v_cvt_pk_bf16_f32 v145, v146, v147
    buffer_load_dwordx4 v197, s[8:11], s29 offen offset:3072 nt lds
    s_add_u32 m0, s28, 21760
    v_cvt_pk_bf16_f32 v168, v168, v169
    v_cvt_pk_bf16_f32 v169, v170, v171
    v_accvgpr_write_b32 a192, v0
    v_accvgpr_write_b32 a193, v1
    v_accvgpr_write_b32 a194, v24
    v_accvgpr_write_b32 a195, v25
    v_accvgpr_write_b32 a196, v48
    v_accvgpr_write_b32 a197, v49
    v_accvgpr_write_b32 a198, v72
    v_accvgpr_write_b32 a199, v73
    v_accvgpr_write_b32 a200, v96
    v_accvgpr_write_b32 a201, v97
    v_accvgpr_write_b32 a202, v120
    v_accvgpr_write_b32 a203, v121
    v_accvgpr_write_b32 a204, v144
    v_accvgpr_write_b32 a205, v145
    s_waitcnt vmcnt(8)
    ds_write_b128 v199, a[44:47] offset:11968
    v_accvgpr_write_b32 a206, v168
    v_accvgpr_write_b32 a207, v169
    v_pk_mul_f32 v[4:5], v[4:5], s[74:75]
    v_pk_mul_f32 v[6:7], v[6:7], s[74:75]
    v_pk_mul_f32 v[28:29], v[28:29], s[74:75]
    v_pk_mul_f32 v[30:31], v[30:31], s[74:75]
    buffer_load_dwordx4 v197, s[8:11], s30 offen nt lds
    s_add_u32 m0, s28, 21824
    v_pk_mul_f32 v[52:53], v[52:53], s[74:75]
    v_pk_mul_f32 v[54:55], v[54:55], s[74:75]
    v_pk_mul_f32 v[76:77], v[76:77], s[74:75]
    v_pk_mul_f32 v[78:79], v[78:79], s[74:75]
    v_pk_mul_f32 v[100:101], v[100:101], s[74:75]
    v_pk_mul_f32 v[102:103], v[102:103], s[74:75]
    v_pk_mul_f32 v[124:125], v[124:125], s[74:75]
    v_pk_mul_f32 v[126:127], v[126:127], s[74:75]
    v_pk_mul_f32 v[148:149], v[148:149], s[74:75]
    v_pk_mul_f32 v[150:151], v[150:151], s[74:75]
    v_pk_mul_f32 v[172:173], v[172:173], s[74:75]
    v_pk_mul_f32 v[174:175], v[174:175], s[74:75]
    v_cvt_pk_bf16_f32 v4, v4, v5
    v_cvt_pk_bf16_f32 v5, v6, v7
    v_cvt_pk_bf16_f32 v28, v28, v29
    v_cvt_pk_bf16_f32 v29, v30, v31
    v_cvt_pk_bf16_f32 v52, v52, v53
    v_cvt_pk_bf16_f32 v53, v54, v55
    v_cvt_pk_bf16_f32 v76, v76, v77
    v_cvt_pk_bf16_f32 v77, v78, v79
    v_cvt_pk_bf16_f32 v100, v100, v101
    s_waitcnt vmcnt(8)
    ds_write_b128 v199, a[48:51] offset:13056
    v_cvt_pk_bf16_f32 v101, v102, v103
    buffer_load_dwordx4 v197, s[8:11], s30 offen offset:1024 nt lds
    s_add_u32 m0, s28, 21888
    v_cvt_pk_bf16_f32 v124, v124, v125
    v_cvt_pk_bf16_f32 v125, v126, v127
    v_cvt_pk_bf16_f32 v148, v148, v149
    v_cvt_pk_bf16_f32 v149, v150, v151
    v_cvt_pk_bf16_f32 v172, v172, v173
    v_cvt_pk_bf16_f32 v173, v174, v175
    v_accvgpr_write_b32 a208, v4
    v_accvgpr_write_b32 a209, v5
    v_accvgpr_write_b32 a210, v28
    v_accvgpr_write_b32 a211, v29
    v_accvgpr_write_b32 a212, v52
    v_accvgpr_write_b32 a213, v53
    v_accvgpr_write_b32 a214, v76
    v_accvgpr_write_b32 a215, v77
    v_accvgpr_write_b32 a216, v100
    v_accvgpr_write_b32 a217, v101
    v_accvgpr_write_b32 a218, v124
    v_accvgpr_write_b32 a219, v125
    v_accvgpr_write_b32 a220, v148
    v_accvgpr_write_b32 a221, v149
    v_accvgpr_write_b32 a222, v172
    v_accvgpr_write_b32 a223, v173
    v_pk_mul_f32 v[8:9], v[8:9], s[74:75]
    v_pk_mul_f32 v[10:11], v[10:11], s[74:75]
    buffer_load_dwordx4 v197, s[8:11], s30 offen offset:2048 nt lds
    s_add_u32 m0, s28, 21952
    v_pk_mul_f32 v[32:33], v[32:33], s[74:75]
    v_pk_mul_f32 v[34:35], v[34:35], s[74:75]
    s_waitcnt vmcnt(9)
    ds_write_b128 v199, a[52:55] offset:14144
    v_pk_mul_f32 v[56:57], v[56:57], s[74:75]
    v_pk_mul_f32 v[58:59], v[58:59], s[74:75]
    v_pk_mul_f32 v[80:81], v[80:81], s[74:75]
    v_pk_mul_f32 v[82:83], v[82:83], s[74:75]
    v_pk_mul_f32 v[104:105], v[104:105], s[74:75]
    v_pk_mul_f32 v[106:107], v[106:107], s[74:75]
    v_pk_mul_f32 v[128:129], v[128:129], s[74:75]
    v_pk_mul_f32 v[130:131], v[130:131], s[74:75]
    v_pk_mul_f32 v[152:153], v[152:153], s[74:75]
    v_pk_mul_f32 v[154:155], v[154:155], s[74:75]
    v_pk_mul_f32 v[176:177], v[176:177], s[74:75]
    v_pk_mul_f32 v[178:179], v[178:179], s[74:75]
    v_cvt_pk_bf16_f32 v8, v8, v9
    v_cvt_pk_bf16_f32 v9, v10, v11
    v_cvt_pk_bf16_f32 v32, v32, v33
    v_cvt_pk_bf16_f32 v33, v34, v35
    v_cvt_pk_bf16_f32 v56, v56, v57
    v_cvt_pk_bf16_f32 v57, v58, v59
    v_cvt_pk_bf16_f32 v80, v80, v81
    v_cvt_pk_bf16_f32 v81, v82, v83
    buffer_load_dwordx4 v197, s[8:11], s30 offen offset:3072 nt lds
    v_cvt_pk_bf16_f32 v104, v104, v105
    v_cvt_pk_bf16_f32 v105, v106, v107
    v_cvt_pk_bf16_f32 v128, v128, v129
    v_cvt_pk_bf16_f32 v129, v130, v131
    v_cvt_pk_bf16_f32 v152, v152, v153
    v_cvt_pk_bf16_f32 v153, v154, v155
    v_cvt_pk_bf16_f32 v176, v176, v177
    s_waitcnt vmcnt(9)
    ds_write_b128 v199, a[56:59] offset:15232
    v_cvt_pk_bf16_f32 v177, v178, v179
    v_accvgpr_write_b32 a224, v8
    v_accvgpr_write_b32 a225, v9
    v_accvgpr_write_b32 a226, v32
    v_accvgpr_write_b32 a227, v33
    v_accvgpr_write_b32 a228, v56
    v_accvgpr_write_b32 a229, v57
    v_accvgpr_write_b32 a230, v80
    v_accvgpr_write_b32 a231, v81
    v_accvgpr_write_b32 a232, v104
    v_accvgpr_write_b32 a233, v105
    v_accvgpr_write_b32 a234, v128
    v_accvgpr_write_b32 a235, v129
    v_accvgpr_write_b32 a236, v152
    v_accvgpr_write_b32 a237, v153
    s_add_u32 s29, s29, 8192
    s_and_b32 s29, s29, 0x3ffff
    s_add_u32 s30, s29, 4096
    v_accvgpr_write_b32 a238, v176
    v_accvgpr_write_b32 a239, v177
    v_pk_mul_f32 v[12:13], v[12:13], s[74:75]
    v_pk_mul_f32 v[14:15], v[14:15], s[74:75]
    v_pk_mul_f32 v[36:37], v[36:37], s[74:75]
    v_pk_mul_f32 v[38:39], v[38:39], s[74:75]
    v_pk_mul_f32 v[60:61], v[60:61], s[74:75]
    v_pk_mul_f32 v[62:63], v[62:63], s[74:75]
    v_pk_mul_f32 v[84:85], v[84:85], s[74:75]
    v_pk_mul_f32 v[86:87], v[86:87], s[74:75]
    v_pk_mul_f32 v[108:109], v[108:109], s[74:75]
    v_pk_mul_f32 v[110:111], v[110:111], s[74:75]
    v_pk_mul_f32 v[132:133], v[132:133], s[74:75]
    v_pk_mul_f32 v[134:135], v[134:135], s[74:75]
    v_pk_mul_f32 v[156:157], v[156:157], s[74:75]
    v_pk_mul_f32 v[158:159], v[158:159], s[74:75]
    v_pk_mul_f32 v[180:181], v[180:181], s[74:75]
    v_pk_mul_f32 v[182:183], v[182:183], s[74:75]
    v_cvt_pk_bf16_f32 v12, v12, v13
    v_cvt_pk_bf16_f32 v13, v14, v15
    s_waitcnt vmcnt(8)
    ds_write_b128 v199, a[60:63] offset:16320
    v_cvt_pk_bf16_f32 v36, v36, v37
    v_cvt_pk_bf16_f32 v37, v38, v39
    v_cvt_pk_bf16_f32 v60, v60, v61
    v_cvt_pk_bf16_f32 v61, v62, v63
    v_cvt_pk_bf16_f32 v84, v84, v85
    v_cvt_pk_bf16_f32 v85, v86, v87
    v_cvt_pk_bf16_f32 v108, v108, v109
    v_cvt_pk_bf16_f32 v109, v110, v111
    v_cvt_pk_bf16_f32 v132, v132, v133
    v_cvt_pk_bf16_f32 v133, v134, v135
    v_cvt_pk_bf16_f32 v156, v156, v157
    v_cvt_pk_bf16_f32 v157, v158, v159
    v_cvt_pk_bf16_f32 v180, v180, v181
    v_cvt_pk_bf16_f32 v181, v182, v183
    v_accvgpr_write_b32 a240, v12
    v_accvgpr_write_b32 a241, v13
    v_accvgpr_write_b32 a242, v36
    v_accvgpr_write_b32 a243, v37
    v_accvgpr_write_b32 a244, v60
    v_accvgpr_write_b32 a245, v61
    v_accvgpr_write_b32 a246, v84
    v_accvgpr_write_b32 a247, v85
    v_accvgpr_write_b32 a248, v108
    v_accvgpr_write_b32 a249, v109
    v_accvgpr_write_b32 a250, v132
    v_accvgpr_write_b32 a251, v133
    v_accvgpr_write_b32 a252, v156
    v_accvgpr_write_b32 a253, v157
    v_accvgpr_write_b32 a254, v180
    v_accvgpr_write_b32 a255, v181
    s_waitcnt lgkmcnt(0)
    s_barrier
    s_mov_b32 s32, 7
    ds_read_b128 v[168:171], v192 offset:0
    ds_read_b128 v[172:175], v192 offset:64
    s_waitcnt lgkmcnt(1)
    v_mfma_f32_16x16x32_bf16 v[0:3], v[168:171], a[192:195], 0
    ds_read_b128 v[176:179], v192 offset:128
    ds_read_b128 v[180:183], v192 offset:192
    v_mfma_f32_16x16x32_bf16 v[4:7], v[168:171], a[208:211], 0
    s_lshl_b32 s10, s84, 18
    v_and_b32 v184, 15, v198
    v_cmp_eq_u32 vcc, 0, v184
    v_mov_b32 v185, 0x3f803f80
    s_nop 0
    v_cndmask_b32 v184, 0, v185, vcc
    v_mfma_f32_16x16x32_bf16 v[8:11], v[168:171], a[224:227], 0
    s_add_u32 m0, s28, 26112
    v_mfma_f32_16x16x32_bf16 v[12:15], v[168:171], a[240:243], 0
    v_mov_b32 v185, v184
    v_mov_b32 v186, v184
    v_mov_b32 v187, v184
    v_mfma_f32_16x16x32_bf16 v[16:19], v[168:171], v[200:203], 0
    buffer_load_dwordx4 v197, s[8:11], s29 offen nt lds
    s_add_u32 m0, s28, 26176
    v_mfma_f32_16x16x32_bf16 v[20:23], v[168:171], v[216:219], 0
    s_waitcnt lgkmcnt(2)
    v_mfma_f32_16x16x32_bf16 v[0:3], v[172:175], a[196:199], v[0:3]
    buffer_load_dwordx4 v197, s[8:11], s29 offen offset:1024 nt lds
    s_add_u32 m0, s28, 26240
    ds_read_b128 v[168:171], v192 offset:4352
    v_mfma_f32_16x16x32_bf16 v[4:7], v[172:175], a[212:215], v[4:7]
    v_mfma_f32_16x16x32_bf16 v[8:11], v[172:175], a[228:231], v[8:11]
    buffer_load_dwordx4 v197, s[8:11], s29 offen offset:2048 nt lds
    s_add_u32 m0, s28, 26304
    v_mfma_f32_16x16x32_bf16 v[12:15], v[172:175], a[244:247], v[12:15]
    v_mfma_f32_16x16x32_bf16 v[16:19], v[172:175], v[204:207], v[16:19]
    buffer_load_dwordx4 v197, s[8:11], s29 offen offset:3072 nt lds
    s_add_u32 m0, s28, 30464
    v_mfma_f32_16x16x32_bf16 v[20:23], v[172:175], v[220:223], v[20:23]
    s_waitcnt lgkmcnt(2)
    v_mfma_f32_16x16x32_bf16 v[0:3], v[176:179], a[200:203], v[0:3]
    buffer_load_dwordx4 v197, s[8:11], s30 offen nt lds
    s_add_u32 m0, s28, 30528
    ds_read_b128 v[172:175], v192 offset:4416
    v_mfma_f32_16x16x32_bf16 v[4:7], v[176:179], a[216:219], v[4:7]
    v_mfma_f32_16x16x32_bf16 v[8:11], v[176:179], a[232:235], v[8:11]
    buffer_load_dwordx4 v197, s[8:11], s30 offen offset:1024 nt lds
    s_add_u32 m0, s28, 30592
    v_mfma_f32_16x16x32_bf16 v[12:15], v[176:179], a[248:251], v[12:15]
    v_mfma_f32_16x16x32_bf16 v[16:19], v[176:179], v[208:211], v[16:19]
    buffer_load_dwordx4 v197, s[8:11], s30 offen offset:2048 nt lds
    s_add_u32 m0, s28, 30656
    v_mfma_f32_16x16x32_bf16 v[20:23], v[176:179], v[224:227], v[20:23]
    s_waitcnt lgkmcnt(2)
    v_mfma_f32_16x16x32_bf16 v[0:3], v[180:183], a[204:207], v[0:3]
    buffer_load_dwordx4 v197, s[8:11], s30 offen offset:3072 nt lds
    ds_read_b128 v[176:179], v192 offset:4480
    v_mfma_f32_16x16x32_bf16 v[4:7], v[180:183], a[220:223], v[4:7]
    v_mfma_f32_16x16x32_bf16 v[8:11], v[180:183], a[236:239], v[8:11]
    s_mov_b32 s10, 262144
    s_lshl_b32 s87, s84, 13
    s_add_u32 s29, s29, s87
    s_and_b32 s29, s29, 0x3ffff
    s_add_u32 s30, s29, 4096
    v_mfma_f32_16x16x32_bf16 v[12:15], v[180:183], a[252:255], v[12:15]
    v_mfma_f32_16x16x32_bf16 v[16:19], v[180:183], v[212:215], v[16:19]
    v_mfma_f32_16x16x32_bf16 v[20:23], v[180:183], v[228:231], v[20:23]
    v_max3_f32 v48, v0, v1, v2
    v_max3_f32 v50, v4, v5, v6
    v_max3_f32 v52, v8, v9, v10
    s_nop 2
    v_max3_f32 v54, v12, v13, v14
    v_max3_f32 v56, v16, v17, v18
    v_max3_f32 v58, v20, v21, v22
    v_max_f32 v48, v48, v3
    v_max_f32 v50, v50, v7
    v_max_f32 v52, v52, v11
    v_max_f32 v54, v54, v15
    v_max_f32 v56, v56, v19
    v_max_f32 v58, v58, v23
    v_mov_b32 v49, v48
    v_mov_b32 v51, v50
    v_mov_b32 v53, v52
    v_mov_b32 v55, v54
    v_mov_b32 v57, v56
    v_mov_b32 v59, v58
    v_permlane32_swap_b32 v48, v49
    v_permlane32_swap_b32 v50, v51
    v_permlane32_swap_b32 v52, v53
    v_permlane32_swap_b32 v54, v55
    v_permlane32_swap_b32 v56, v57
    v_permlane32_swap_b32 v58, v59
    v_max_f32 v48, v48, v49
    v_max_f32 v50, v50, v51
    v_max_f32 v52, v52, v53
    v_max_f32 v54, v54, v55
    v_max_f32 v56, v56, v57
    v_max_f32 v58, v58, v59
    v_mov_b32 v49, v48
    v_mov_b32 v51, v50
    v_mov_b32 v53, v52
    v_mov_b32 v55, v54
    v_mov_b32 v57, v56
    v_mov_b32 v59, v58
    v_permlane16_swap_b32 v48, v49
    v_permlane16_swap_b32 v50, v51
    v_permlane16_swap_b32 v52, v53
    v_permlane16_swap_b32 v54, v55
    v_permlane16_swap_b32 v56, v57
    v_permlane16_swap_b32 v58, v59
    v_max_f32 v48, v48, v49
    v_max_f32 v50, v50, v51
    v_max_f32 v52, v52, v53
    v_max_f32 v54, v54, v55
    v_max_f32 v56, v56, v57
    v_max_f32 v58, v58, v59
    v_sub_f32 v96, 0, v48
    v_sub_f32 v100, 0, v50
    v_sub_f32 v104, 0, v52
    v_sub_f32 v108, 0, v54
    v_sub_f32 v112, 0, v56
    v_sub_f32 v116, 0, v58
    v_sub_f32 v97, 0, v48
    v_sub_f32 v101, 0, v50
    v_sub_f32 v105, 0, v52
    v_sub_f32 v109, 0, v54
    v_sub_f32 v113, 0, v56
    v_sub_f32 v117, 0, v58
    v_sub_f32 v98, 0, v48
    v_sub_f32 v102, 0, v50
    v_sub_f32 v106, 0, v52
    v_sub_f32 v110, 0, v54
    v_sub_f32 v114, 0, v56
    v_sub_f32 v118, 0, v58
    v_sub_f32 v99, 0, v48
    v_sub_f32 v103, 0, v50
    v_sub_f32 v107, 0, v52
    v_sub_f32 v111, 0, v54
    v_sub_f32 v115, 0, v56
    v_sub_f32 v119, 0, v58
    s_waitcnt lgkmcnt(2)
    v_mfma_f32_16x16x32_bf16 v[24:27], v[168:171], a[192:195], v[96:99]
    v_add_f32 v0, v0, v96
    v_add_f32 v1, v1, v96
    v_add_f32 v2, v2, v96
    v_add_f32 v3, v3, v96
    v_mfma_f32_16x16x32_bf16 v[28:31], v[168:171], a[208:211], v[100:103]
    v_exp_f32 v0, v0
    v_exp_f32 v1, v1
    v_mfma_f32_16x16x32_bf16 v[32:35], v[168:171], a[224:227], v[104:107]
    v_exp_f32 v2, v2
    v_mfma_f32_16x16x32_bf16 v[36:39], v[168:171], a[240:243], v[108:111]
    v_exp_f32 v3, v3
    v_mfma_f32_16x16x32_bf16 v[40:43], v[168:171], v[200:203], v[112:115]
    v_add_f32 v4, v4, v100
    v_add_f32 v5, v5, v100
    v_add_f32 v6, v6, v100
    v_add_f32 v7, v7, v100
    v_mfma_f32_16x16x32_bf16 v[44:47], v[168:171], v[216:219], v[116:119]
    v_exp_f32 v4, v4
    v_exp_f32 v5, v5
    s_waitcnt lgkmcnt(1)
    v_mfma_f32_16x16x32_bf16 v[24:27], v[172:175], a[196:199], v[24:27]
    v_exp_f32 v6, v6
    v_mfma_f32_16x16x32_bf16 v[28:31], v[172:175], a[212:215], v[28:31]
    v_exp_f32 v7, v7
    v_mfma_f32_16x16x32_bf16 v[32:35], v[172:175], a[228:231], v[32:35]
    ds_read_b128 v[180:183], v192 offset:4544
    v_add_f32 v8, v8, v104
    v_add_f32 v9, v9, v104
    v_add_f32 v10, v10, v104
    v_add_f32 v11, v11, v104
    v_mfma_f32_16x16x32_bf16 v[36:39], v[172:175], a[244:247], v[36:39]
    v_exp_f32 v8, v8
    v_exp_f32 v9, v9
    v_mfma_f32_16x16x32_bf16 v[40:43], v[172:175], v[204:207], v[40:43]
    v_exp_f32 v10, v10
    v_mfma_f32_16x16x32_bf16 v[44:47], v[172:175], v[220:223], v[44:47]
    v_exp_f32 v11, v11
    s_waitcnt lgkmcnt(1)
    v_mfma_f32_16x16x32_bf16 v[24:27], v[176:179], a[200:203], v[24:27]
    v_add_f32 v12, v12, v108
    v_add_f32 v13, v13, v108
    v_add_f32 v14, v14, v108
    v_add_f32 v15, v15, v108
    v_mfma_f32_16x16x32_bf16 v[28:31], v[176:179], a[216:219], v[28:31]
    v_exp_f32 v12, v12
    v_exp_f32 v13, v13
    v_mfma_f32_16x16x32_bf16 v[32:35], v[176:179], a[232:235], v[32:35]
    ds_read_b128 v[168:171], v192 offset:8704
    v_exp_f32 v14, v14
    v_mfma_f32_16x16x32_bf16 v[36:39], v[176:179], a[248:251], v[36:39]
    v_exp_f32 v15, v15
    v_mfma_f32_16x16x32_bf16 v[40:43], v[176:179], v[208:211], v[40:43]
    v_add_f32 v16, v16, v112
    v_add_f32 v17, v17, v112
    v_add_f32 v18, v18, v112
    v_add_f32 v19, v19, v112
    v_mfma_f32_16x16x32_bf16 v[44:47], v[176:179], v[224:227], v[44:47]
    v_exp_f32 v16, v16
    v_exp_f32 v17, v17
    s_waitcnt lgkmcnt(1)
    v_mfma_f32_16x16x32_bf16 v[24:27], v[180:183], a[204:207], v[24:27]
    v_exp_f32 v18, v18
    v_mfma_f32_16x16x32_bf16 v[28:31], v[180:183], a[220:223], v[28:31]
    v_exp_f32 v19, v19
    v_mfma_f32_16x16x32_bf16 v[32:35], v[180:183], a[236:239], v[32:35]
    ds_read_b128 v[172:175], v192 offset:8768
    v_add_f32 v20, v20, v116
    v_add_f32 v21, v21, v116
    v_add_f32 v22, v22, v116
    v_add_f32 v23, v23, v116
    v_mfma_f32_16x16x32_bf16 v[36:39], v[180:183], a[252:255], v[36:39]
    v_exp_f32 v20, v20
    v_exp_f32 v21, v21
    v_mfma_f32_16x16x32_bf16 v[40:43], v[180:183], v[212:215], v[40:43]
    v_exp_f32 v22, v22
    v_mfma_f32_16x16x32_bf16 v[44:47], v[180:183], v[228:231], v[44:47]
    v_exp_f32 v23, v23
    v_exp_f32 v24, v24
    v_exp_f32 v25, v25
    v_exp_f32 v26, v26
    v_exp_f32 v27, v27
    v_exp_f32 v28, v28
    v_exp_f32 v29, v29
    s_waitcnt lgkmcnt(0)
    s_barrier
    v_mfma_f32_16x16x32_bf16 v[48:51], v[168:171], a[192:195], v[96:99]
    s_add_u32 m0, s40, 0
    ds_read_b128 v[176:179], v192 offset:8832
    v_cvt_pk_bf16_f32 v144, v0, v1
    v_mfma_f32_16x16x32_bf16 v[52:55], v[168:171], a[208:211], v[100:103]
    v_cvt_pk_bf16_f32 v145, v2, v3
    v_cvt_pk_bf16_f32 v146, v24, v25
    v_cvt_pk_bf16_f32 v147, v26, v27
    v_mfma_f32_16x16x32_bf16 v[56:59], v[168:171], a[224:227], v[104:107]
    s_waitcnt vmcnt(3)
    buffer_load_dwordx4 v197, s[8:11], s29 offen nt lds
    v_mfma_f32_16x16x32_bf16 v[60:63], v[168:171], a[240:243], v[108:111]
    ds_read_b128 v[180:183], v192 offset:8896
    s_add_u32 m0, s40, 64
    v_exp_f32 v30, v30
    v_mfma_f32_16x16x32_bf16 v[64:67], v[168:171], v[200:203], v[112:115]
    v_exp_f32 v31, v31
    v_mfma_f32_16x16x32_bf16 v[68:71], v[168:171], v[216:219], v[116:119]
    v_cvt_pk_bf16_f32 v148, v4, v5
    v_cvt_pk_bf16_f32 v149, v6, v7
    v_cvt_pk_bf16_f32 v150, v28, v29
    v_mfma_f32_16x16x32_bf16 v[48:51], v[172:175], a[196:199], v[48:51]
    v_cvt_pk_bf16_f32 v151, v30, v31
    v_exp_f32 v32, v32
    v_mfma_f32_16x16x32_bf16 v[52:55], v[172:175], a[212:215], v[52:55]
    v_exp_f32 v33, v33
    v_exp_f32 v34, v34
    v_mfma_f32_16x16x32_bf16 v[56:59], v[172:175], a[228:231], v[56:59]
    v_exp_f32 v35, v35
    v_mfma_f32_16x16x32_bf16 v[60:63], v[172:175], a[244:247], v[60:63]
    ds_read_b128 v[168:171], v192 offset:13056
    v_cvt_pk_bf16_f32 v152, v8, v9
    v_cvt_pk_bf16_f32 v153, v10, v11
    v_mfma_f32_16x16x32_bf16 v[64:67], v[172:175], v[204:207], v[64:67]
    v_cvt_pk_bf16_f32 v154, v32, v33
    v_cvt_pk_bf16_f32 v155, v34, v35
    v_exp_f32 v36, v36
    v_mfma_f32_16x16x32_bf16 v[68:71], v[172:175], v[220:223], v[68:71]
    v_exp_f32 v37, v37
    s_waitcnt lgkmcnt(2)
    v_mfma_f32_16x16x32_bf16 v[48:51], v[176:179], a[200:203], v[48:51]
    v_exp_f32 v38, v38
    v_exp_f32 v39, v39
    v_mfma_f32_16x16x32_bf16 v[52:55], v[176:179], a[216:219], v[52:55]
    s_waitcnt vmcnt(4)
    buffer_load_dwordx4 v197, s[8:11], s29 offen offset:1024 nt lds
    v_mfma_f32_16x16x32_bf16 v[56:59], v[176:179], a[232:235], v[56:59]
    s_add_u32 m0, s40, 128
    v_cvt_pk_bf16_f32 v156, v12, v13
    v_mfma_f32_16x16x32_bf16 v[60:63], v[176:179], a[248:251], v[60:63]
    ds_read_b128 v[172:175], v192 offset:13120
    v_cvt_pk_bf16_f32 v157, v14, v15
    v_cvt_pk_bf16_f32 v158, v36, v37
    v_mfma_f32_16x16x32_bf16 v[64:67], v[176:179], v[208:211], v[64:67]
    v_cvt_pk_bf16_f32 v159, v38, v39
    v_exp_f32 v40, v40
    v_mfma_f32_16x16x32_bf16 v[68:71], v[176:179], v[224:227], v[68:71]
    v_exp_f32 v41, v41
    v_cvt_pk_bf16_f32 v160, v16, v17
    s_waitcnt lgkmcnt(2)
    v_mfma_f32_16x16x32_bf16 v[48:51], v[180:183], a[204:207], v[48:51]
    v_exp_f32 v42, v42
    v_exp_f32 v43, v43
    v_mfma_f32_16x16x32_bf16 v[52:55], v[180:183], a[220:223], v[52:55]
    v_cvt_pk_bf16_f32 v161, v18, v19
    v_cvt_pk_bf16_f32 v162, v40, v41
    v_mfma_f32_16x16x32_bf16 v[56:59], v[180:183], a[236:239], v[56:59]
    v_cvt_pk_bf16_f32 v163, v42, v43
    v_exp_f32 v44, v44
    v_mfma_f32_16x16x32_bf16 v[60:63], v[180:183], a[252:255], v[60:63]
    ds_read_b128 v[176:179], v192 offset:13184
    v_exp_f32 v45, v45
    v_mfma_f32_16x16x32_bf16 v[64:67], v[180:183], v[212:215], v[64:67]
    v_exp_f32 v46, v46
    v_exp_f32 v47, v47
    v_mfma_f32_16x16x32_bf16 v[68:71], v[180:183], v[228:231], v[68:71]
    v_cvt_pk_bf16_f32 v164, v20, v21
    v_cvt_pk_bf16_f32 v165, v22, v23
    s_waitcnt lgkmcnt(2)
    v_mfma_f32_16x16x32_bf16 v[72:75], v[168:171], a[192:195], v[96:99]
    s_waitcnt vmcnt(4)
    buffer_load_dwordx4 v197, s[8:11], s29 offen offset:2048 nt lds
    v_mfma_f32_16x16x32_bf16 v[76:79], v[168:171], a[208:211], v[100:103]
    s_add_u32 m0, s40, 192
    v_cvt_pk_bf16_f32 v166, v44, v45
    v_cvt_pk_bf16_f32 v167, v46, v47
    v_mfma_f32_16x16x32_bf16 v[80:83], v[168:171], a[224:227], v[104:107]
    v_lshrrev_b32 v188, 3, v198
    v_and_b32 v189, 7, v198
    v_and_b32 v190, 6, v188
    v_xor_b32 v189, v189, v190
    v_mfma_f32_16x16x32_bf16 v[84:87], v[168:171], a[240:243], v[108:111]
    ds_read_b128 v[180:183], v192 offset:13248
    s_lshl_b32 s34, s3, 3
    v_add_u32 v188, s34, v188
    v_mfma_f32_16x16x32_bf16 v[88:91], v[168:171], v[200:203], v[112:115]
    v_mul_u32_u24 v188, 1152, v188
    v_lshl_add_u32 v240, v189, 4, v188
    v_mfma_f32_16x16x32_bf16 v[92:95], v[168:171], v[216:219], v[116:119]
    v_bfe_u32 v188, v198, 2, 3
    v_lshrrev_b32 v189, 1, v188
    s_waitcnt lgkmcnt(2)
    v_mfma_f32_16x16x32_bf16 v[72:75], v[172:175], a[196:199], v[72:75]
    v_xor_b32 v189, s3, v189
    v_lshlrev_b32 v189, 5, v189
    v_lshl_add_u32 v188, v188, 7, v189
    v_and_b32 v189, 3, v198
    v_mfma_f32_16x16x32_bf16 v[76:79], v[172:175], a[212:215], v[76:79]
    v_lshl_add_u32 v188, v189, 3, v188
    v_lshrrev_b32 v189, 5, v198
    v_lshl_add_u32 v241, v189, 10, v188
    v_mfma_f32_16x16x32_bf16 v[80:83], v[172:175], a[228:231], v[80:83]
    v_add_u32 v242, 65536, v241
    v_lshlrev_b32 v243, 4, v198
    s_mul_hi_u32 s34, s44, 715827883
    s_add_u32 s34, s34, 65536
    v_mfma_f32_16x16x32_bf16 v[84:87], v[172:175], a[244:247], v[84:87]
    ds_read_b64_tr_b16 v[168:169], v193 offset:0
    ds_read_b64_tr_b16 v[170:171], v193 offset:4352
    v_mfma_f32_16x16x32_bf16 v[88:91], v[172:175], v[204:207], v[88:91]
    v_add_u32 v234, s34, v243
    s_mul_hi_u32 s34, s45, 715827883
    s_add_u32 s34, s34, 65536
    v_mfma_f32_16x16x32_bf16 v[92:95], v[172:175], v[220:223], v[92:95]
    s_waitcnt vmcnt(3)
    buffer_load_dwordx4 v197, s[8:11], s29 offen offset:3072 nt lds
    s_waitcnt lgkmcnt(3)
    v_mfma_f32_16x16x32_bf16 v[72:75], v[176:179], a[200:203], v[72:75]
    s_add_u32 m0, s40, 4352
    v_add_u32 v235, s34, v243
    s_mul_hi_u32 s34, s46, 715827883
    s_add_u32 s34, s34, 65536
    v_mfma_f32_16x16x32_bf16 v[76:79], v[176:179], a[216:219], v[76:79]
    v_add_u32 v236, s34, v243
    s_mul_hi_u32 s34, s47, 715827883
    s_add_u32 s34, s34, 65536
    v_mfma_f32_16x16x32_bf16 v[80:83], v[176:179], a[232:235], v[80:83]
    v_add_u32 v237, s34, v243
    s_mul_i32 s34, s3, 24576
    s_add_u32 s34, s34, 65536
    v_mfma_f32_16x16x32_bf16 v[84:87], v[176:179], a[248:251], v[84:87]
    v_add_u32 v238, s34, v243
    v_mov_b32 v190, 2147483632
    v_cmp_eq_u32 vcc, 0, v198
    v_mfma_f32_16x16x32_bf16 v[88:91], v[176:179], v[208:211], v[88:91]
    ds_read_b64_tr_b16 v[172:173], v194 offset:0
    ds_read_b64_tr_b16 v[174:175], v194 offset:4352
    v_mfma_f32_16x16x32_bf16 v[92:95], v[176:179], v[224:227], v[92:95]
    s_cmp_eq_u32 s3, 0
    s_cselect_b32 s34, 1, 0
    v_cndmask_b32 v246, v190, v198, vcc
    s_waitcnt lgkmcnt(4)
    v_mfma_f32_16x16x32_bf16 v[72:75], v[180:183], a[204:207], v[72:75]
    v_cmp_gt_u32 vcc, s34, v198
    v_lshlrev_b32 v188, 7, v198
    s_nop 0
    v_cndmask_b32 v199, v190, v198, vcc
    v_mfma_f32_16x16x32_bf16 v[76:79], v[180:183], a[220:223], v[76:79]
    v_cmp_gt_u32 vcc, 36, v198
    s_nop 1
    v_cndmask_b32 v239, v190, v188, vcc
    v_mfma_f32_16x16x32_bf16 v[80:83], v[180:183], a[236:239], v[80:83]
    v_subrev_u32 v188, 7, v198
    v_sub_u32 v189, s5, v188
    v_mfma_f32_16x16x32_bf16 v[84:87], v[180:183], a[252:255], v[84:87]
    v_and_b32 v189, 7, v189
    v_lshlrev_b32 v189, 12, v189
    v_mfma_f32_16x16x32_bf16 v[88:91], v[180:183], v[212:215], v[88:91]
    s_waitcnt vmcnt(4)
    buffer_load_dwordx4 v197, s[8:11], s30 offen nt lds
    v_mfma_f32_16x16x32_bf16 v[92:95], v[180:183], v[228:231], v[92:95]
    ds_read_b64_tr_b16 v[176:177], v193 offset:64
    ds_read_b64_tr_b16 v[178:179], v193 offset:4416
    s_add_u32 m0, s40, 4416
    s_waitcnt lgkmcnt(4)
    v_mfma_f32_16x16x32_bf16 a[0:3], v[168:171], v[144:147], 0
    v_lshl_add_u32 v189, v188, 7, v189
    v_cmp_gt_u32 vcc, 15, v198
    v_lshlrev_b32 v188, 12, v198
    s_nop 0
    v_cndmask_b32 v189, 0, v189, vcc
    v_mfma_f32_16x16x32_bf16 a[4:7], v[168:171], v[148:151], 0
    v_exp_f32 v48, v48
    v_mfma_f32_16x16x32_bf16 a[8:11], v[168:171], v[152:155], 0
    v_cmp_gt_u32 vcc, 8, v198
    s_nop 1
    v_cndmask_b32 v247, v189, v188, vcc
    v_mfma_f32_16x16x32_bf16 a[12:15], v[168:171], v[156:159], 0
    v_exp_f32 v49, v49
    v_mfma_f32_16x16x32_bf16 a[16:19], v[168:171], v[160:163], 0
    v_and_b32 v188, 15, v198
    v_mul_u32_u24 v188, 2304, v188
    v_mfma_f32_16x16x32_bf16 a[20:23], v[168:171], v[164:167], 0
    v_lshrrev_b32 v189, 4, v198
    v_lshl_add_u32 v245, v189, 3, v188
    v_exp_f32 v50, v50
    v_mfma_f32_16x16x32_bf16 v[120:123], v[184:187], v[144:147], 0
    ds_read_b64_tr_b16 v[180:181], v194 offset:64
    ds_read_b64_tr_b16 v[182:183], v194 offset:4416
    s_waitcnt lgkmcnt(4)
    v_mfma_f32_16x16x32_bf16 a[24:27], v[172:175], v[144:147], 0
    v_bfe_u32 v188, v198, 2, 2
    v_cmp_eq_u32 vcc, v188, v189
    v_and_b32 v188, 1, v198
    v_lshlrev_b32 v188, 4, v188
    v_mfma_f32_16x16x32_bf16 a[28:31], v[172:175], v[148:151], 0
    v_lshlrev_b32_e64 v188, v188, 1
    v_mul_u32_u24 v188, 0x3f80, v188
    v_mfma_f32_16x16x32_bf16 a[32:35], v[172:175], v[152:155], 0
    s_waitcnt vmcnt(4)
    buffer_load_dwordx4 v197, s[8:11], s30 offen offset:1024 nt lds
    v_mfma_f32_16x16x32_bf16 a[36:39], v[172:175], v[156:159], 0
    s_add_u32 m0, s40, 4480
    v_cndmask_b32 v188, 0, v188, vcc
    v_and_b32 v189, 2, v198
    v_cmp_eq_u32 vcc, 0, v189
    v_mfma_f32_16x16x32_bf16 a[40:43], v[172:175], v[160:163], 0
    v_mov_b32 v248, 0
    v_mov_b32 v249, 0
    v_mfma_f32_16x16x32_bf16 a[44:47], v[172:175], v[164:167], 0
    v_cndmask_b32 v250, 0, v188, vcc
    v_sub_u32 v251, v188, v250
    v_exp_f32 v51, v51
    v_mfma_f32_16x16x32_bf16 v[124:127], v[184:187], v[148:151], 0
    ds_read_b64_tr_b16 v[168:169], v195 offset:0
    ds_read_b64_tr_b16 v[170:171], v195 offset:4352
    s_waitcnt lgkmcnt(4)
    v_mfma_f32_16x16x32_bf16 a[48:51], v[176:179], v[144:147], 0
    v_mov_b32 v252, 0
    v_mov_b32 v253, 0
    s_lshl_b32 s85, s3, 10
    v_mfma_f32_16x16x32_bf16 a[52:55], v[176:179], v[148:151], 0
    v_exp_f32 v52, v52
    v_exp_f32 v53, v53
    v_mfma_f32_16x16x32_bf16 a[56:59], v[176:179], v[152:155], 0
    v_exp_f32 v54, v54
    v_mfma_f32_16x16x32_bf16 a[60:63], v[176:179], v[156:159], 0
    v_exp_f32 v55, v55
    v_exp_f32 v56, v56
    v_mfma_f32_16x16x32_bf16 a[64:67], v[176:179], v[160:163], 0
    v_exp_f32 v57, v57
    v_mfma_f32_16x16x32_bf16 a[68:71], v[176:179], v[164:167], 0
    v_exp_f32 v58, v58
    v_exp_f32 v59, v59
    v_mfma_f32_16x16x32_bf16 v[128:131], v[184:187], v[152:155], 0
    ds_read_b64_tr_b16 v[172:173], v196 offset:0
    ds_read_b64_tr_b16 v[174:175], v196 offset:4352
    s_waitcnt lgkmcnt(4)
    v_mfma_f32_16x16x32_bf16 a[72:75], v[180:183], v[144:147], 0
    s_waitcnt vmcnt(3)
    buffer_load_dwordx4 v197, s[8:11], s30 offen offset:2048 nt lds
    v_mfma_f32_16x16x32_bf16 a[76:79], v[180:183], v[148:151], 0
    s_add_u32 m0, s40, 4544
    v_exp_f32 v60, v60
    v_mfma_f32_16x16x32_bf16 a[80:83], v[180:183], v[152:155], 0
    v_exp_f32 v61, v61
    v_exp_f32 v62, v62
    v_mfma_f32_16x16x32_bf16 a[84:87], v[180:183], v[156:159], 0
    v_exp_f32 v63, v63
    v_mfma_f32_16x16x32_bf16 a[88:91], v[180:183], v[160:163], 0
    v_exp_f32 v64, v64
    v_exp_f32 v65, v65
    v_mfma_f32_16x16x32_bf16 a[92:95], v[180:183], v[164:167], 0
    v_exp_f32 v66, v66
    v_mfma_f32_16x16x32_bf16 v[132:135], v[184:187], v[156:159], 0
    ds_read_b64_tr_b16 v[176:177], v195 offset:64
    ds_read_b64_tr_b16 v[178:179], v195 offset:4416
    s_waitcnt lgkmcnt(4)
    v_mfma_f32_16x16x32_bf16 a[96:99], v[168:171], v[144:147], 0
    v_exp_f32 v67, v67
    v_exp_f32 v68, v68
    v_mfma_f32_16x16x32_bf16 a[100:103], v[168:171], v[148:151], 0
    v_exp_f32 v69, v69
    v_exp_f32 v70, v70
    v_mfma_f32_16x16x32_bf16 a[104:107], v[168:171], v[152:155], 0
    v_exp_f32 v71, v71
    v_mfma_f32_16x16x32_bf16 a[108:111], v[168:171], v[156:159], 0
    s_waitcnt vmcnt(4)
    buffer_load_dwordx4 v197, s[8:11], s30 offen offset:3072 nt lds
    v_mfma_f32_16x16x32_bf16 a[112:115], v[168:171], v[160:163], 0
    v_exp_f32 v72, v72
    v_exp_f32 v73, v73
    v_mfma_f32_16x16x32_bf16 a[116:119], v[168:171], v[164:167], 0
    ds_read_b64_tr_b16 v[180:181], v196 offset:64
    ds_read_b64_tr_b16 v[182:183], v196 offset:4416
    v_mfma_f32_16x16x32_bf16 v[136:139], v[184:187], v[160:163], 0
    v_exp_f32 v74, v74
    s_waitcnt lgkmcnt(4)
    v_mfma_f32_16x16x32_bf16 a[120:123], v[172:175], v[144:147], 0
    v_exp_f32 v75, v75
    v_exp_f32 v76, v76
    v_mfma_f32_16x16x32_bf16 a[124:127], v[172:175], v[148:151], 0
    v_exp_f32 v77, v77
    v_mfma_f32_16x16x32_bf16 a[128:131], v[172:175], v[152:155], 0
    s_waitcnt vmcnt(8)
    s_barrier
    v_mfma_f32_16x16x32_bf16 a[132:135], v[172:175], v[156:159], 0
    v_mfma_f32_16x16x32_bf16 a[136:139], v[172:175], v[160:163], 0
    ds_read_b128 v[168:171], v192 offset:17408
    v_mfma_f32_16x16x32_bf16 a[140:143], v[172:175], v[164:167], 0
    s_add_u32 s29, s29, 8192
    s_and_b32 s29, s29, 0x3ffff
    s_add_u32 s30, s29, 4096
    v_mfma_f32_16x16x32_bf16 v[140:143], v[184:187], v[164:167], 0
    s_waitcnt lgkmcnt(3)
    v_mfma_f32_16x16x32_bf16 a[144:147], v[176:179], v[144:147], 0
    v_mfma_f32_16x16x32_bf16 a[148:151], v[176:179], v[148:151], 0
    v_mfma_f32_16x16x32_bf16 a[152:155], v[176:179], v[152:155], 0
    v_mfma_f32_16x16x32_bf16 a[156:159], v[176:179], v[156:159], 0
    ds_read_b128 v[172:175], v192 offset:17472
    v_mfma_f32_16x16x32_bf16 a[160:163], v[176:179], v[160:163], 0
    v_mfma_f32_16x16x32_bf16 a[164:167], v[176:179], v[164:167], 0
    s_waitcnt lgkmcnt(2)
    v_mfma_f32_16x16x32_bf16 a[168:171], v[180:183], v[144:147], 0
    s_waitcnt vmcnt(8)
    s_barrier
    v_mfma_f32_16x16x32_bf16 a[172:175], v[180:183], v[148:151], 0
    v_mfma_f32_16x16x32_bf16 a[176:179], v[180:183], v[152:155], 0
    v_mfma_f32_16x16x32_bf16 a[180:183], v[180:183], v[156:159], 0
    v_mfma_f32_16x16x32_bf16 a[184:187], v[180:183], v[160:163], 0
    v_mfma_f32_16x16x32_bf16 a[188:191], v[180:183], v[164:167], 0
.p2align 3
L_loopf0:
    s_waitcnt lgkmcnt(1)
    v_mfma_f32_16x16x32_bf16 v[0:3], v[168:171], a[192:195], v[96:99]
    s_add_u32 m0, s41, 0
    ds_read_b128 v[176:179], v192 offset:17536
    v_mfma_f32_16x16x32_bf16 v[4:7], v[168:171], a[208:211], v[100:103]
    v_cvt_pk_bf16_f32 v144, v48, v49
    v_cvt_pk_bf16_f32 v145, v50, v51
    v_mfma_f32_16x16x32_bf16 v[8:11], v[168:171], a[224:227], v[104:107]
    s_waitcnt vmcnt(3)
    v_cvt_pk_bf16_f32 v146, v72, v73
    v_mfma_f32_16x16x32_bf16 v[12:15], v[168:171], a[240:243], v[108:111]
    ds_read_b128 v[180:183], v192 offset:17600
    v_cvt_pk_bf16_f32 v147, v74, v75
    v_mfma_f32_16x16x32_bf16 v[16:19], v[168:171], v[200:203], v[112:115]
    buffer_load_dwordx4 v197, s[8:11], s29 offen nt lds
    v_mfma_f32_16x16x32_bf16 v[20:23], v[168:171], v[216:219], v[116:119]
    s_add_u32 m0, s41, 64
    s_waitcnt lgkmcnt(2)
    v_mfma_f32_16x16x32_bf16 v[0:3], v[172:175], a[196:199], v[0:3]
    v_exp_f32 v78, v78
    v_mfma_f32_16x16x32_bf16 v[4:7], v[172:175], a[212:215], v[4:7]
    v_exp_f32 v79, v79
    v_mfma_f32_16x16x32_bf16 v[8:11], v[172:175], a[228:231], v[8:11]
    v_cvt_pk_bf16_f32 v148, v52, v53
    v_cvt_pk_bf16_f32 v149, v54, v55
    v_mfma_f32_16x16x32_bf16 v[12:15], v[172:175], a[244:247], v[12:15]
    ds_read_b128 v[168:171], v192 offset:21760
    v_cvt_pk_bf16_f32 v150, v76, v77
    v_mfma_f32_16x16x32_bf16 v[16:19], v[172:175], v[204:207], v[16:19]
    v_cvt_pk_bf16_f32 v151, v78, v79
    v_cvt_pk_bf16_f32 v152, v56, v57
    v_mfma_f32_16x16x32_bf16 v[20:23], v[172:175], v[220:223], v[20:23]
    v_cvt_pk_bf16_f32 v153, v58, v59
    s_waitcnt lgkmcnt(2)
    v_mfma_f32_16x16x32_bf16 v[0:3], v[176:179], a[200:203], v[0:3]
    v_exp_f32 v80, v80
    v_mfma_f32_16x16x32_bf16 v[4:7], v[176:179], a[216:219], v[4:7]
    s_waitcnt vmcnt(4)
    v_mfma_f32_16x16x32_bf16 v[8:11], v[176:179], a[232:235], v[8:11]
    buffer_load_dwordx4 v197, s[8:11], s29 offen offset:1024 nt lds
    v_mfma_f32_16x16x32_bf16 v[12:15], v[176:179], a[248:251], v[12:15]
    ds_read_b128 v[172:175], v192 offset:21824
    s_add_u32 m0, s41, 128
    v_mfma_f32_16x16x32_bf16 v[16:19], v[176:179], v[208:211], v[16:19]
    v_exp_f32 v81, v81
    v_mfma_f32_16x16x32_bf16 v[20:23], v[176:179], v[224:227], v[20:23]
    v_cvt_pk_bf16_f32 v154, v80, v81
    s_waitcnt lgkmcnt(2)
    v_mfma_f32_16x16x32_bf16 v[0:3], v[180:183], a[204:207], v[0:3]
    v_exp_f32 v82, v82
    v_mfma_f32_16x16x32_bf16 v[4:7], v[180:183], a[220:223], v[4:7]
    v_exp_f32 v83, v83
    v_mfma_f32_16x16x32_bf16 v[8:11], v[180:183], a[236:239], v[8:11]
    v_cvt_pk_bf16_f32 v155, v82, v83
    v_cvt_pk_bf16_f32 v156, v60, v61
    v_mfma_f32_16x16x32_bf16 v[12:15], v[180:183], a[252:255], v[12:15]
    ds_read_b128 v[176:179], v192 offset:21888
    v_cvt_pk_bf16_f32 v157, v62, v63
    v_mfma_f32_16x16x32_bf16 v[16:19], v[180:183], v[212:215], v[16:19]
    v_exp_f32 v84, v84
    v_mfma_f32_16x16x32_bf16 v[20:23], v[180:183], v[228:231], v[20:23]
    s_waitcnt lgkmcnt(2)
    v_mfma_f32_16x16x32_bf16 v[24:27], v[168:171], a[192:195], v[96:99]
    s_waitcnt vmcnt(4)
    v_mfma_f32_16x16x32_bf16 v[28:31], v[168:171], a[208:211], v[100:103]
    buffer_load_dwordx4 v197, s[8:11], s29 offen offset:2048 nt lds
    v_mfma_f32_16x16x32_bf16 v[32:35], v[168:171], a[224:227], v[104:107]
    s_add_u32 m0, s41, 192
    v_mfma_f32_16x16x32_bf16 v[36:39], v[168:171], a[240:243], v[108:111]
    ds_read_b128 v[180:183], v192 offset:21952
    v_mfma_f32_16x16x32_bf16 v[40:43], v[168:171], v[200:203], v[112:115]
    v_exp_f32 v85, v85
    v_mfma_f32_16x16x32_bf16 v[44:47], v[168:171], v[216:219], v[116:119]
    v_cvt_pk_bf16_f32 v158, v84, v85
    s_waitcnt lgkmcnt(2)
    v_mfma_f32_16x16x32_bf16 v[24:27], v[172:175], a[196:199], v[24:27]
    v_exp_f32 v86, v86
    v_mfma_f32_16x16x32_bf16 v[28:31], v[172:175], a[212:215], v[28:31]
    v_exp_f32 v87, v87
    v_mfma_f32_16x16x32_bf16 v[32:35], v[172:175], a[228:231], v[32:35]
    v_cvt_pk_bf16_f32 v159, v86, v87
    v_cvt_pk_bf16_f32 v160, v64, v65
    v_mfma_f32_16x16x32_bf16 v[36:39], v[172:175], a[244:247], v[36:39]
    ds_read_b64_tr_b16 v[168:169], v193 offset:8704
    ds_read_b64_tr_b16 v[170:171], v193 offset:13056
    v_mfma_f32_16x16x32_bf16 v[40:43], v[172:175], v[204:207], v[40:43]
    v_exp_f32 v88, v88
    v_mfma_f32_16x16x32_bf16 v[44:47], v[172:175], v[220:223], v[44:47]
    s_waitcnt vmcnt(3)
    s_waitcnt lgkmcnt(3)
    v_mfma_f32_16x16x32_bf16 v[24:27], v[176:179], a[200:203], v[24:27]
    buffer_load_dwordx4 v197, s[8:11], s29 offen offset:3072 nt lds
    v_mfma_f32_16x16x32_bf16 v[28:31], v[176:179], a[216:219], v[28:31]
    s_add_u32 m0, s41, 4352
    v_cvt_pk_bf16_f32 v161, v66, v67
    v_mfma_f32_16x16x32_bf16 v[32:35], v[176:179], a[232:235], v[32:35]
    v_exp_f32 v89, v89
    v_mfma_f32_16x16x32_bf16 v[36:39], v[176:179], a[248:251], v[36:39]
    v_exp_f32 v90, v90
    v_mfma_f32_16x16x32_bf16 v[40:43], v[176:179], v[208:211], v[40:43]
    ds_read_b64_tr_b16 v[172:173], v194 offset:8704
    ds_read_b64_tr_b16 v[174:175], v194 offset:13056
    v_mfma_f32_16x16x32_bf16 v[44:47], v[176:179], v[224:227], v[44:47]
    v_cvt_pk_bf16_f32 v162, v88, v89
    s_waitcnt lgkmcnt(4)
    v_mfma_f32_16x16x32_bf16 v[24:27], v[180:183], a[204:207], v[24:27]
    v_exp_f32 v91, v91
    v_mfma_f32_16x16x32_bf16 v[28:31], v[180:183], a[220:223], v[28:31]
    v_cvt_pk_bf16_f32 v163, v90, v91
    v_cvt_pk_bf16_f32 v164, v68, v69
    v_mfma_f32_16x16x32_bf16 v[32:35], v[180:183], a[236:239], v[32:35]
    v_exp_f32 v92, v92
    v_mfma_f32_16x16x32_bf16 v[36:39], v[180:183], a[252:255], v[36:39]
    v_exp_f32 v93, v93
    v_mfma_f32_16x16x32_bf16 v[40:43], v[180:183], v[212:215], v[40:43]
    v_exp_f32 v94, v94
    v_mfma_f32_16x16x32_bf16 v[44:47], v[180:183], v[228:231], v[44:47]
    v_cvt_pk_bf16_f32 v165, v70, v71
    s_waitcnt lgkmcnt(2)
    v_mfma_f32_16x16x32_bf16 a[0:3], v[168:171], v[144:147], a[0:3]
    v_exp_f32 v95, v95
    v_mfma_f32_16x16x32_bf16 a[4:7], v[168:171], v[148:151], a[4:7]
    v_cvt_pk_bf16_f32 v166, v92, v93
    v_cvt_pk_bf16_f32 v167, v94, v95
    v_mfma_f32_16x16x32_bf16 a[8:11], v[168:171], v[152:155], a[8:11]
    ds_read_b64_tr_b16 v[176:177], v193 offset:8768
    ds_read_b64_tr_b16 v[178:179], v193 offset:13120
    v_mfma_f32_16x16x32_bf16 a[12:15], v[168:171], v[156:159], a[12:15]
    s_waitcnt vmcnt(4)
    v_mfma_f32_16x16x32_bf16 a[16:19], v[168:171], v[160:163], a[16:19]
    buffer_load_dwordx4 v197, s[8:11], s30 offen nt lds
    v_mfma_f32_16x16x32_bf16 a[20:23], v[168:171], v[164:167], a[20:23]
    s_add_u32 m0, s41, 4416
    v_mfma_f32_16x16x32_bf16 v[120:123], v[184:187], v[144:147], v[120:123]
    s_waitcnt lgkmcnt(2)
    v_mfma_f32_16x16x32_bf16 a[24:27], v[172:175], v[144:147], a[24:27]
    ds_read_b64_tr_b16 v[180:181], v194 offset:8768
    ds_read_b64_tr_b16 v[182:183], v194 offset:13120
    v_mfma_f32_16x16x32_bf16 a[28:31], v[172:175], v[148:151], a[28:31]
    v_exp_f32 v0, v0
    v_mfma_f32_16x16x32_bf16 a[32:35], v[172:175], v[152:155], a[32:35]
    s_waitcnt vmcnt(4)
    v_mfma_f32_16x16x32_bf16 a[36:39], v[172:175], v[156:159], a[36:39]
    buffer_load_dwordx4 v197, s[8:11], s30 offen offset:1024 nt lds
    v_mfma_f32_16x16x32_bf16 a[40:43], v[172:175], v[160:163], a[40:43]
    s_add_u32 m0, s41, 4480
    v_mfma_f32_16x16x32_bf16 a[44:47], v[172:175], v[164:167], a[44:47]
    v_exp_f32 v1, v1
    v_mfma_f32_16x16x32_bf16 v[124:127], v[184:187], v[148:151], v[124:127]
    s_waitcnt lgkmcnt(2)
    v_mfma_f32_16x16x32_bf16 a[48:51], v[176:179], v[144:147], a[48:51]
    ds_read_b64_tr_b16 v[168:169], v195 offset:8704
    ds_read_b64_tr_b16 v[170:171], v195 offset:13056
    v_mfma_f32_16x16x32_bf16 a[52:55], v[176:179], v[148:151], a[52:55]
    v_exp_f32 v2, v2
    v_mfma_f32_16x16x32_bf16 a[56:59], v[176:179], v[152:155], a[56:59]
    v_exp_f32 v3, v3
    v_mfma_f32_16x16x32_bf16 a[60:63], v[176:179], v[156:159], a[60:63]
    v_exp_f32 v4, v4
    v_mfma_f32_16x16x32_bf16 a[64:67], v[176:179], v[160:163], a[64:67]
    v_exp_f32 v5, v5
    v_mfma_f32_16x16x32_bf16 a[68:71], v[176:179], v[164:167], a[68:71]
    v_exp_f32 v6, v6
    v_mfma_f32_16x16x32_bf16 v[128:131], v[184:187], v[152:155], v[128:131]
    s_waitcnt vmcnt(3)
    s_waitcnt lgkmcnt(2)
    v_mfma_f32_16x16x32_bf16 a[72:75], v[180:183], v[144:147], a[72:75]
    ds_read_b64_tr_b16 v[172:173], v196 offset:8704
    ds_read_b64_tr_b16 v[174:175], v196 offset:13056
    v_mfma_f32_16x16x32_bf16 a[76:79], v[180:183], v[148:151], a[76:79]
    buffer_load_dwordx4 v197, s[8:11], s30 offen offset:2048 nt lds
    v_mfma_f32_16x16x32_bf16 a[80:83], v[180:183], v[152:155], a[80:83]
    s_add_u32 m0, s41, 4544
    v_mfma_f32_16x16x32_bf16 a[84:87], v[180:183], v[156:159], a[84:87]
    v_exp_f32 v7, v7
    v_mfma_f32_16x16x32_bf16 a[88:91], v[180:183], v[160:163], a[88:91]
    v_exp_f32 v8, v8
    v_mfma_f32_16x16x32_bf16 a[92:95], v[180:183], v[164:167], a[92:95]
    v_exp_f32 v9, v9
    v_mfma_f32_16x16x32_bf16 v[132:135], v[184:187], v[156:159], v[132:135]
    s_waitcnt lgkmcnt(2)
    v_mfma_f32_16x16x32_bf16 a[96:99], v[168:171], v[144:147], a[96:99]
    ds_read_b64_tr_b16 v[176:177], v195 offset:8768
    ds_read_b64_tr_b16 v[178:179], v195 offset:13120
    v_mfma_f32_16x16x32_bf16 a[100:103], v[168:171], v[148:151], a[100:103]
    v_exp_f32 v10, v10
    v_mfma_f32_16x16x32_bf16 a[104:107], v[168:171], v[152:155], a[104:107]
    v_exp_f32 v11, v11
    v_mfma_f32_16x16x32_bf16 a[108:111], v[168:171], v[156:159], a[108:111]
    s_waitcnt vmcnt(4)
    v_mfma_f32_16x16x32_bf16 a[112:115], v[168:171], v[160:163], a[112:115]
    buffer_load_dwordx4 v197, s[8:11], s30 offen offset:3072 nt lds
    v_mfma_f32_16x16x32_bf16 a[116:119], v[168:171], v[164:167], a[116:119]
    ds_read_b64_tr_b16 v[180:181], v196 offset:8768
    ds_read_b64_tr_b16 v[182:183], v196 offset:13120
    v_mfma_f32_16x16x32_bf16 v[136:139], v[184:187], v[160:163], v[136:139]
    s_waitcnt lgkmcnt(4)
    v_mfma_f32_16x16x32_bf16 a[120:123], v[172:175], v[144:147], a[120:123]
    v_exp_f32 v12, v12
    v_mfma_f32_16x16x32_bf16 a[124:127], v[172:175], v[148:151], a[124:127]
    v_exp_f32 v13, v13
    v_mfma_f32_16x16x32_bf16 a[128:131], v[172:175], v[152:155], a[128:131]
    v_exp_f32 v14, v14
    v_mfma_f32_16x16x32_bf16 a[132:135], v[172:175], v[156:159], a[132:135]
    v_exp_f32 v15, v15
    v_mfma_f32_16x16x32_bf16 a[136:139], v[172:175], v[160:163], a[136:139]
    ds_read_b128 v[168:171], v192 offset:26112
    v_mfma_f32_16x16x32_bf16 a[140:143], v[172:175], v[164:167], a[140:143]
    s_add_u32 s29, s29, 8192
    s_and_b32 s29, s29, 0x3ffff
    v_mfma_f32_16x16x32_bf16 v[140:143], v[184:187], v[164:167], v[140:143]
    s_add_u32 s30, s29, 4096
    s_waitcnt lgkmcnt(3)
    v_mfma_f32_16x16x32_bf16 a[144:147], v[176:179], v[144:147], a[144:147]
    v_exp_f32 v16, v16
    v_mfma_f32_16x16x32_bf16 a[148:151], v[176:179], v[148:151], a[148:151]
    v_exp_f32 v17, v17
    v_mfma_f32_16x16x32_bf16 a[152:155], v[176:179], v[152:155], a[152:155]
    v_exp_f32 v18, v18
    v_mfma_f32_16x16x32_bf16 a[156:159], v[176:179], v[156:159], a[156:159]
    ds_read_b128 v[172:175], v192 offset:26176
    v_mfma_f32_16x16x32_bf16 a[160:163], v[176:179], v[160:163], a[160:163]
    v_exp_f32 v19, v19
    v_mfma_f32_16x16x32_bf16 a[164:167], v[176:179], v[164:167], a[164:167]
    s_waitcnt lgkmcnt(2)
    v_mfma_f32_16x16x32_bf16 a[168:171], v[180:183], v[144:147], a[168:171]
    s_waitcnt vmcnt(8)
    s_barrier
    v_mfma_f32_16x16x32_bf16 a[172:175], v[180:183], v[148:151], a[172:175]
    v_exp_f32 v20, v20
    v_mfma_f32_16x16x32_bf16 a[176:179], v[180:183], v[152:155], a[176:179]
    v_exp_f32 v21, v21
    v_mfma_f32_16x16x32_bf16 a[180:183], v[180:183], v[156:159], a[180:183]
    v_exp_f32 v22, v22
    v_mfma_f32_16x16x32_bf16 a[184:187], v[180:183], v[160:163], a[184:187]
    v_exp_f32 v23, v23
    v_mfma_f32_16x16x32_bf16 a[188:191], v[180:183], v[164:167], a[188:191]
    v_exp_f32 v24, v24
    v_exp_f32 v25, v25
    v_exp_f32 v26, v26
    v_exp_f32 v27, v27
    v_exp_f32 v28, v28
    v_exp_f32 v29, v29
    s_waitcnt lgkmcnt(1)
    v_mfma_f32_16x16x32_bf16 v[48:51], v[168:171], a[192:195], v[96:99]
    s_add_u32 m0, s42, 0
    ds_read_b128 v[176:179], v192 offset:26240
    v_mfma_f32_16x16x32_bf16 v[52:55], v[168:171], a[208:211], v[100:103]
    v_cvt_pk_bf16_f32 v144, v0, v1
    v_cvt_pk_bf16_f32 v145, v2, v3
    v_mfma_f32_16x16x32_bf16 v[56:59], v[168:171], a[224:227], v[104:107]
    s_waitcnt vmcnt(3)
    v_cvt_pk_bf16_f32 v146, v24, v25
    v_mfma_f32_16x16x32_bf16 v[60:63], v[168:171], a[240:243], v[108:111]
    ds_read_b128 v[180:183], v192 offset:26304
    v_cvt_pk_bf16_f32 v147, v26, v27
    v_mfma_f32_16x16x32_bf16 v[64:67], v[168:171], v[200:203], v[112:115]
    buffer_load_dwordx4 v197, s[8:11], s29 offen nt lds
    v_mfma_f32_16x16x32_bf16 v[68:71], v[168:171], v[216:219], v[116:119]
    s_add_u32 m0, s42, 64
    s_waitcnt lgkmcnt(2)
    v_mfma_f32_16x16x32_bf16 v[48:51], v[172:175], a[196:199], v[48:51]
    v_exp_f32 v30, v30
    v_mfma_f32_16x16x32_bf16 v[52:55], v[172:175], a[212:215], v[52:55]
    v_exp_f32 v31, v31
    v_mfma_f32_16x16x32_bf16 v[56:59], v[172:175], a[228:231], v[56:59]
    v_cvt_pk_bf16_f32 v148, v4, v5
    v_cvt_pk_bf16_f32 v149, v6, v7
    v_mfma_f32_16x16x32_bf16 v[60:63], v[172:175], a[244:247], v[60:63]
    ds_read_b128 v[168:171], v192 offset:30464
    v_cvt_pk_bf16_f32 v150, v28, v29
    v_mfma_f32_16x16x32_bf16 v[64:67], v[172:175], v[204:207], v[64:67]
    v_cvt_pk_bf16_f32 v151, v30, v31
    v_cvt_pk_bf16_f32 v152, v8, v9
    v_mfma_f32_16x16x32_bf16 v[68:71], v[172:175], v[220:223], v[68:71]
    v_cvt_pk_bf16_f32 v153, v10, v11
    s_waitcnt lgkmcnt(2)
    v_mfma_f32_16x16x32_bf16 v[48:51], v[176:179], a[200:203], v[48:51]
    v_exp_f32 v32, v32
    v_mfma_f32_16x16x32_bf16 v[52:55], v[176:179], a[216:219], v[52:55]
    s_waitcnt vmcnt(4)
    v_mfma_f32_16x16x32_bf16 v[56:59], v[176:179], a[232:235], v[56:59]
    buffer_load_dwordx4 v197, s[8:11], s29 offen offset:1024 nt lds
    v_mfma_f32_16x16x32_bf16 v[60:63], v[176:179], a[248:251], v[60:63]
    ds_read_b128 v[172:175], v192 offset:30528
    s_add_u32 m0, s42, 128
    v_mfma_f32_16x16x32_bf16 v[64:67], v[176:179], v[208:211], v[64:67]
    v_exp_f32 v33, v33
    v_mfma_f32_16x16x32_bf16 v[68:71], v[176:179], v[224:227], v[68:71]
    v_cvt_pk_bf16_f32 v154, v32, v33
    s_waitcnt lgkmcnt(2)
    v_mfma_f32_16x16x32_bf16 v[48:51], v[180:183], a[204:207], v[48:51]
    v_exp_f32 v34, v34
    v_mfma_f32_16x16x32_bf16 v[52:55], v[180:183], a[220:223], v[52:55]
    v_exp_f32 v35, v35
    v_mfma_f32_16x16x32_bf16 v[56:59], v[180:183], a[236:239], v[56:59]
    v_cvt_pk_bf16_f32 v155, v34, v35
    v_cvt_pk_bf16_f32 v156, v12, v13
    v_mfma_f32_16x16x32_bf16 v[60:63], v[180:183], a[252:255], v[60:63]
    ds_read_b128 v[176:179], v192 offset:30592
    v_cvt_pk_bf16_f32 v157, v14, v15
    v_mfma_f32_16x16x32_bf16 v[64:67], v[180:183], v[212:215], v[64:67]
    v_exp_f32 v36, v36
    v_mfma_f32_16x16x32_bf16 v[68:71], v[180:183], v[228:231], v[68:71]
    s_waitcnt lgkmcnt(2)
    v_mfma_f32_16x16x32_bf16 v[72:75], v[168:171], a[192:195], v[96:99]
    s_waitcnt vmcnt(4)
    v_mfma_f32_16x16x32_bf16 v[76:79], v[168:171], a[208:211], v[100:103]
    buffer_load_dwordx4 v197, s[8:11], s29 offen offset:2048 nt lds
    v_mfma_f32_16x16x32_bf16 v[80:83], v[168:171], a[224:227], v[104:107]
    s_add_u32 m0, s42, 192
    v_mfma_f32_16x16x32_bf16 v[84:87], v[168:171], a[240:243], v[108:111]
    ds_read_b128 v[180:183], v192 offset:30656
    v_mfma_f32_16x16x32_bf16 v[88:91], v[168:171], v[200:203], v[112:115]
    v_exp_f32 v37, v37
    v_mfma_f32_16x16x32_bf16 v[92:95], v[168:171], v[216:219], v[116:119]
    v_cvt_pk_bf16_f32 v158, v36, v37
    s_waitcnt lgkmcnt(2)
    v_mfma_f32_16x16x32_bf16 v[72:75], v[172:175], a[196:199], v[72:75]
    v_exp_f32 v38, v38
    v_mfma_f32_16x16x32_bf16 v[76:79], v[172:175], a[212:215], v[76:79]
    v_exp_f32 v39, v39
    v_mfma_f32_16x16x32_bf16 v[80:83], v[172:175], a[228:231], v[80:83]
    v_cvt_pk_bf16_f32 v159, v38, v39
    v_cvt_pk_bf16_f32 v160, v16, v17
    v_mfma_f32_16x16x32_bf16 v[84:87], v[172:175], a[244:247], v[84:87]
    ds_read_b64_tr_b16 v[168:169], v193 offset:17408
    ds_read_b64_tr_b16 v[170:171], v193 offset:21760
    v_mfma_f32_16x16x32_bf16 v[88:91], v[172:175], v[204:207], v[88:91]
    v_exp_f32 v40, v40
    v_mfma_f32_16x16x32_bf16 v[92:95], v[172:175], v[220:223], v[92:95]
    s_waitcnt vmcnt(3)
    s_waitcnt lgkmcnt(3)
    v_mfma_f32_16x16x32_bf16 v[72:75], v[176:179], a[200:203], v[72:75]
    buffer_load_dwordx4 v197, s[8:11], s29 offen offset:3072 nt lds
    v_mfma_f32_16x16x32_bf16 v[76:79], v[176:179], a[216:219], v[76:79]
    s_add_u32 m0, s42, 4352
    v_cvt_pk_bf16_f32 v161, v18, v19
    v_mfma_f32_16x16x32_bf16 v[80:83], v[176:179], a[232:235], v[80:83]
    v_exp_f32 v41, v41
    v_mfma_f32_16x16x32_bf16 v[84:87], v[176:179], a[248:251], v[84:87]
    v_exp_f32 v42, v42
    v_mfma_f32_16x16x32_bf16 v[88:91], v[176:179], v[208:211], v[88:91]
    ds_read_b64_tr_b16 v[172:173], v194 offset:17408
    ds_read_b64_tr_b16 v[174:175], v194 offset:21760
    v_mfma_f32_16x16x32_bf16 v[92:95], v[176:179], v[224:227], v[92:95]
    v_cvt_pk_bf16_f32 v162, v40, v41
    s_waitcnt lgkmcnt(4)
    v_mfma_f32_16x16x32_bf16 v[72:75], v[180:183], a[204:207], v[72:75]
    v_exp_f32 v43, v43
    v_mfma_f32_16x16x32_bf16 v[76:79], v[180:183], a[220:223], v[76:79]
    v_cvt_pk_bf16_f32 v163, v42, v43
    v_cvt_pk_bf16_f32 v164, v20, v21
    v_mfma_f32_16x16x32_bf16 v[80:83], v[180:183], a[236:239], v[80:83]
    v_exp_f32 v44, v44
    v_mfma_f32_16x16x32_bf16 v[84:87], v[180:183], a[252:255], v[84:87]
    v_exp_f32 v45, v45
    v_mfma_f32_16x16x32_bf16 v[88:91], v[180:183], v[212:215], v[88:91]
    v_exp_f32 v46, v46
    v_mfma_f32_16x16x32_bf16 v[92:95], v[180:183], v[228:231], v[92:95]
    v_cvt_pk_bf16_f32 v165, v22, v23
    s_waitcnt lgkmcnt(2)
    v_mfma_f32_16x16x32_bf16 a[0:3], v[168:171], v[144:147], a[0:3]
    v_exp_f32 v47, v47
    v_mfma_f32_16x16x32_bf16 a[4:7], v[168:171], v[148:151], a[4:7]
    v_cvt_pk_bf16_f32 v166, v44, v45
    v_cvt_pk_bf16_f32 v167, v46, v47
    v_mfma_f32_16x16x32_bf16 a[8:11], v[168:171], v[152:155], a[8:11]
    ds_read_b64_tr_b16 v[176:177], v193 offset:17472
    ds_read_b64_tr_b16 v[178:179], v193 offset:21824
    v_mfma_f32_16x16x32_bf16 a[12:15], v[168:171], v[156:159], a[12:15]
    s_waitcnt vmcnt(4)
    v_mfma_f32_16x16x32_bf16 a[16:19], v[168:171], v[160:163], a[16:19]
    buffer_load_dwordx4 v197, s[8:11], s30 offen nt lds
    v_mfma_f32_16x16x32_bf16 a[20:23], v[168:171], v[164:167], a[20:23]
    s_add_u32 m0, s42, 4416
    v_mfma_f32_16x16x32_bf16 v[120:123], v[184:187], v[144:147], v[120:123]
    s_waitcnt lgkmcnt(2)
    v_mfma_f32_16x16x32_bf16 a[24:27], v[172:175], v[144:147], a[24:27]
    ds_read_b64_tr_b16 v[180:181], v194 offset:17472
    ds_read_b64_tr_b16 v[182:183], v194 offset:21824
    v_mfma_f32_16x16x32_bf16 a[28:31], v[172:175], v[148:151], a[28:31]
    v_exp_f32 v48, v48
    v_mfma_f32_16x16x32_bf16 a[32:35], v[172:175], v[152:155], a[32:35]
    s_waitcnt vmcnt(4)
    v_mfma_f32_16x16x32_bf16 a[36:39], v[172:175], v[156:159], a[36:39]
    buffer_load_dwordx4 v197, s[8:11], s30 offen offset:1024 nt lds
    v_mfma_f32_16x16x32_bf16 a[40:43], v[172:175], v[160:163], a[40:43]
    s_add_u32 m0, s42, 4480
    v_mfma_f32_16x16x32_bf16 a[44:47], v[172:175], v[164:167], a[44:47]
    v_exp_f32 v49, v49
    v_mfma_f32_16x16x32_bf16 v[124:127], v[184:187], v[148:151], v[124:127]
    s_waitcnt lgkmcnt(2)
    v_mfma_f32_16x16x32_bf16 a[48:51], v[176:179], v[144:147], a[48:51]
    ds_read_b64_tr_b16 v[168:169], v195 offset:17408
    ds_read_b64_tr_b16 v[170:171], v195 offset:21760
    v_mfma_f32_16x16x32_bf16 a[52:55], v[176:179], v[148:151], a[52:55]
    v_exp_f32 v50, v50
    v_mfma_f32_16x16x32_bf16 a[56:59], v[176:179], v[152:155], a[56:59]
    v_exp_f32 v51, v51
    v_mfma_f32_16x16x32_bf16 a[60:63], v[176:179], v[156:159], a[60:63]
    v_exp_f32 v52, v52
    v_mfma_f32_16x16x32_bf16 a[64:67], v[176:179], v[160:163], a[64:67]
    v_exp_f32 v53, v53
    v_mfma_f32_16x16x32_bf16 a[68:71], v[176:179], v[164:167], a[68:71]
    v_exp_f32 v54, v54
    v_mfma_f32_16x16x32_bf16 v[128:131], v[184:187], v[152:155], v[128:131]
    s_waitcnt vmcnt(3)
    s_waitcnt lgkmcnt(2)
    v_mfma_f32_16x16x32_bf16 a[72:75], v[180:183], v[144:147], a[72:75]
    ds_read_b64_tr_b16 v[172:173], v196 offset:17408
    ds_read_b64_tr_b16 v[174:175], v196 offset:21760
    v_mfma_f32_16x16x32_bf16 a[76:79], v[180:183], v[148:151], a[76:79]
    buffer_load_dwordx4 v197, s[8:11], s30 offen offset:2048 nt lds
    v_mfma_f32_16x16x32_bf16 a[80:83], v[180:183], v[152:155], a[80:83]
    s_add_u32 m0, s42, 4544
    v_mfma_f32_16x16x32_bf16 a[84:87], v[180:183], v[156:159], a[84:87]
    v_exp_f32 v55, v55
    v_mfma_f32_16x16x32_bf16 a[88:91], v[180:183], v[160:163], a[88:91]
    v_exp_f32 v56, v56
    v_mfma_f32_16x16x32_bf16 a[92:95], v[180:183], v[164:167], a[92:95]
    v_exp_f32 v57, v57
    v_mfma_f32_16x16x32_bf16 v[132:135], v[184:187], v[156:159], v[132:135]
    s_waitcnt lgkmcnt(2)
    v_mfma_f32_16x16x32_bf16 a[96:99], v[168:171], v[144:147], a[96:99]
    ds_read_b64_tr_b16 v[176:177], v195 offset:17472
    ds_read_b64_tr_b16 v[178:179], v195 offset:21824
    v_mfma_f32_16x16x32_bf16 a[100:103], v[168:171], v[148:151], a[100:103]
    v_exp_f32 v58, v58
    v_mfma_f32_16x16x32_bf16 a[104:107], v[168:171], v[152:155], a[104:107]
    v_exp_f32 v59, v59
    v_mfma_f32_16x16x32_bf16 a[108:111], v[168:171], v[156:159], a[108:111]
    s_waitcnt vmcnt(4)
    v_mfma_f32_16x16x32_bf16 a[112:115], v[168:171], v[160:163], a[112:115]
    buffer_load_dwordx4 v197, s[8:11], s30 offen offset:3072 nt lds
    v_mfma_f32_16x16x32_bf16 a[116:119], v[168:171], v[164:167], a[116:119]
    ds_read_b64_tr_b16 v[180:181], v196 offset:17472
    ds_read_b64_tr_b16 v[182:183], v196 offset:21824
    v_mfma_f32_16x16x32_bf16 v[136:139], v[184:187], v[160:163], v[136:139]
    s_waitcnt lgkmcnt(4)
    v_mfma_f32_16x16x32_bf16 a[120:123], v[172:175], v[144:147], a[120:123]
    v_exp_f32 v60, v60
    v_mfma_f32_16x16x32_bf16 a[124:127], v[172:175], v[148:151], a[124:127]
    v_exp_f32 v61, v61
    v_mfma_f32_16x16x32_bf16 a[128:131], v[172:175], v[152:155], a[128:131]
    v_exp_f32 v62, v62
    v_mfma_f32_16x16x32_bf16 a[132:135], v[172:175], v[156:159], a[132:135]
    v_exp_f32 v63, v63
    v_mfma_f32_16x16x32_bf16 a[136:139], v[172:175], v[160:163], a[136:139]
    ds_read_b128 v[168:171], v192 offset:0
    v_mfma_f32_16x16x32_bf16 a[140:143], v[172:175], v[164:167], a[140:143]
    s_add_u32 s29, s29, 8192
    s_and_b32 s29, s29, 0x3ffff
    v_mfma_f32_16x16x32_bf16 v[140:143], v[184:187], v[164:167], v[140:143]
    s_add_u32 s30, s29, 4096
    s_waitcnt lgkmcnt(3)
    v_mfma_f32_16x16x32_bf16 a[144:147], v[176:179], v[144:147], a[144:147]
    v_exp_f32 v64, v64
    v_mfma_f32_16x16x32_bf16 a[148:151], v[176:179], v[148:151], a[148:151]
    v_exp_f32 v65, v65
    v_mfma_f32_16x16x32_bf16 a[152:155], v[176:179], v[152:155], a[152:155]
    v_exp_f32 v66, v66
    v_mfma_f32_16x16x32_bf16 a[156:159], v[176:179], v[156:159], a[156:159]
    ds_read_b128 v[172:175], v192 offset:64
    v_mfma_f32_16x16x32_bf16 a[160:163], v[176:179], v[160:163], a[160:163]
    v_exp_f32 v67, v67
    v_mfma_f32_16x16x32_bf16 a[164:167], v[176:179], v[164:167], a[164:167]
    s_waitcnt lgkmcnt(2)
    v_mfma_f32_16x16x32_bf16 a[168:171], v[180:183], v[144:147], a[168:171]
    s_waitcnt vmcnt(8)
    s_barrier
    v_mfma_f32_16x16x32_bf16 a[172:175], v[180:183], v[148:151], a[172:175]
    v_exp_f32 v68, v68
    v_mfma_f32_16x16x32_bf16 a[176:179], v[180:183], v[152:155], a[176:179]
    v_exp_f32 v69, v69
    v_mfma_f32_16x16x32_bf16 a[180:183], v[180:183], v[156:159], a[180:183]
    v_exp_f32 v70, v70
    v_mfma_f32_16x16x32_bf16 a[184:187], v[180:183], v[160:163], a[184:187]
    v_exp_f32 v71, v71
    v_mfma_f32_16x16x32_bf16 a[188:191], v[180:183], v[164:167], a[188:191]
    v_exp_f32 v72, v72
    v_exp_f32 v73, v73
    v_exp_f32 v74, v74
    v_exp_f32 v75, v75
    v_exp_f32 v76, v76
    v_exp_f32 v77, v77
    s_waitcnt lgkmcnt(1)
    v_mfma_f32_16x16x32_bf16 v[0:3], v[168:171], a[192:195], v[96:99]
    s_add_u32 m0, s43, 0
    ds_read_b128 v[176:179], v192 offset:128
    v_mfma_f32_16x16x32_bf16 v[4:7], v[168:171], a[208:211], v[100:103]
    v_cvt_pk_bf16_f32 v144, v48, v49
    v_cvt_pk_bf16_f32 v145, v50, v51
    v_mfma_f32_16x16x32_bf16 v[8:11], v[168:171], a[224:227], v[104:107]
    s_waitcnt vmcnt(3)
    v_cvt_pk_bf16_f32 v146, v72, v73
    v_mfma_f32_16x16x32_bf16 v[12:15], v[168:171], a[240:243], v[108:111]
    ds_read_b128 v[180:183], v192 offset:192
    v_cvt_pk_bf16_f32 v147, v74, v75
    v_mfma_f32_16x16x32_bf16 v[16:19], v[168:171], v[200:203], v[112:115]
    buffer_load_dwordx4 v197, s[8:11], s29 offen nt lds
    v_mfma_f32_16x16x32_bf16 v[20:23], v[168:171], v[216:219], v[116:119]
    s_add_u32 m0, s43, 64
    s_waitcnt lgkmcnt(2)
    v_mfma_f32_16x16x32_bf16 v[0:3], v[172:175], a[196:199], v[0:3]
    v_exp_f32 v78, v78
    v_mfma_f32_16x16x32_bf16 v[4:7], v[172:175], a[212:215], v[4:7]
    v_exp_f32 v79, v79
    v_mfma_f32_16x16x32_bf16 v[8:11], v[172:175], a[228:231], v[8:11]
    v_cvt_pk_bf16_f32 v148, v52, v53
    v_cvt_pk_bf16_f32 v149, v54, v55
    v_mfma_f32_16x16x32_bf16 v[12:15], v[172:175], a[244:247], v[12:15]
    ds_read_b128 v[168:171], v192 offset:4352
    v_cvt_pk_bf16_f32 v150, v76, v77
    v_mfma_f32_16x16x32_bf16 v[16:19], v[172:175], v[204:207], v[16:19]
    v_cvt_pk_bf16_f32 v151, v78, v79
    v_cvt_pk_bf16_f32 v152, v56, v57
    v_mfma_f32_16x16x32_bf16 v[20:23], v[172:175], v[220:223], v[20:23]
    v_cvt_pk_bf16_f32 v153, v58, v59
    s_waitcnt lgkmcnt(2)
    v_mfma_f32_16x16x32_bf16 v[0:3], v[176:179], a[200:203], v[0:3]
    v_exp_f32 v80, v80
    v_mfma_f32_16x16x32_bf16 v[4:7], v[176:179], a[216:219], v[4:7]
    s_waitcnt vmcnt(4)
    v_mfma_f32_16x16x32_bf16 v[8:11], v[176:179], a[232:235], v[8:11]
    buffer_load_dwordx4 v197, s[8:11], s29 offen offset:1024 nt lds
    v_mfma_f32_16x16x32_bf16 v[12:15], v[176:179], a[248:251], v[12:15]
    ds_read_b128 v[172:175], v192 offset:4416
    s_add_u32 m0, s43, 128
    v_mfma_f32_16x16x32_bf16 v[16:19], v[176:179], v[208:211], v[16:19]
    v_exp_f32 v81, v81
    v_mfma_f32_16x16x32_bf16 v[20:23], v[176:179], v[224:227], v[20:23]
    v_cvt_pk_bf16_f32 v154, v80, v81
    s_waitcnt lgkmcnt(2)
    v_mfma_f32_16x16x32_bf16 v[0:3], v[180:183], a[204:207], v[0:3]
    v_exp_f32 v82, v82
    v_mfma_f32_16x16x32_bf16 v[4:7], v[180:183], a[220:223], v[4:7]
    v_exp_f32 v83, v83
    v_mfma_f32_16x16x32_bf16 v[8:11], v[180:183], a[236:239], v[8:11]
    v_cvt_pk_bf16_f32 v155, v82, v83
    v_cvt_pk_bf16_f32 v156, v60, v61
    v_mfma_f32_16x16x32_bf16 v[12:15], v[180:183], a[252:255], v[12:15]
    ds_read_b128 v[176:179], v192 offset:4480
    v_cvt_pk_bf16_f32 v157, v62, v63
    v_mfma_f32_16x16x32_bf16 v[16:19], v[180:183], v[212:215], v[16:19]
    v_exp_f32 v84, v84
    v_mfma_f32_16x16x32_bf16 v[20:23], v[180:183], v[228:231], v[20:23]
    s_waitcnt lgkmcnt(2)
    v_mfma_f32_16x16x32_bf16 v[24:27], v[168:171], a[192:195], v[96:99]
    s_waitcnt vmcnt(4)
    v_mfma_f32_16x16x32_bf16 v[28:31], v[168:171], a[208:211], v[100:103]
    buffer_load_dwordx4 v197, s[8:11], s29 offen offset:2048 nt lds
    v_mfma_f32_16x16x32_bf16 v[32:35], v[168:171], a[224:227], v[104:107]
    s_add_u32 m0, s43, 192
    v_mfma_f32_16x16x32_bf16 v[36:39], v[168:171], a[240:243], v[108:111]
    ds_read_b128 v[180:183], v192 offset:4544
    v_mfma_f32_16x16x32_bf16 v[40:43], v[168:171], v[200:203], v[112:115]
    v_exp_f32 v85, v85
    v_mfma_f32_16x16x32_bf16 v[44:47], v[168:171], v[216:219], v[116:119]
    v_cvt_pk_bf16_f32 v158, v84, v85
    s_waitcnt lgkmcnt(2)
    v_mfma_f32_16x16x32_bf16 v[24:27], v[172:175], a[196:199], v[24:27]
    v_exp_f32 v86, v86
    v_mfma_f32_16x16x32_bf16 v[28:31], v[172:175], a[212:215], v[28:31]
    v_exp_f32 v87, v87
    v_mfma_f32_16x16x32_bf16 v[32:35], v[172:175], a[228:231], v[32:35]
    v_cvt_pk_bf16_f32 v159, v86, v87
    v_cvt_pk_bf16_f32 v160, v64, v65
    v_mfma_f32_16x16x32_bf16 v[36:39], v[172:175], a[244:247], v[36:39]
    ds_read_b64_tr_b16 v[168:169], v193 offset:26112
    ds_read_b64_tr_b16 v[170:171], v193 offset:30464
    v_mfma_f32_16x16x32_bf16 v[40:43], v[172:175], v[204:207], v[40:43]
    v_exp_f32 v88, v88
    v_mfma_f32_16x16x32_bf16 v[44:47], v[172:175], v[220:223], v[44:47]
    s_waitcnt vmcnt(3)
    s_waitcnt lgkmcnt(3)
    v_mfma_f32_16x16x32_bf16 v[24:27], v[176:179], a[200:203], v[24:27]
    buffer_load_dwordx4 v197, s[8:11], s29 offen offset:3072 nt lds
    v_mfma_f32_16x16x32_bf16 v[28:31], v[176:179], a[216:219], v[28:31]
    s_add_u32 m0, s43, 4352
    v_cvt_pk_bf16_f32 v161, v66, v67
    v_mfma_f32_16x16x32_bf16 v[32:35], v[176:179], a[232:235], v[32:35]
    v_exp_f32 v89, v89
    v_mfma_f32_16x16x32_bf16 v[36:39], v[176:179], a[248:251], v[36:39]
    v_exp_f32 v90, v90
    v_mfma_f32_16x16x32_bf16 v[40:43], v[176:179], v[208:211], v[40:43]
    ds_read_b64_tr_b16 v[172:173], v194 offset:26112
    ds_read_b64_tr_b16 v[174:175], v194 offset:30464
    v_mfma_f32_16x16x32_bf16 v[44:47], v[176:179], v[224:227], v[44:47]
    v_cvt_pk_bf16_f32 v162, v88, v89
    s_waitcnt lgkmcnt(4)
    v_mfma_f32_16x16x32_bf16 v[24:27], v[180:183], a[204:207], v[24:27]
    v_exp_f32 v91, v91
    v_mfma_f32_16x16x32_bf16 v[28:31], v[180:183], a[220:223], v[28:31]
    v_cvt_pk_bf16_f32 v163, v90, v91
    v_cvt_pk_bf16_f32 v164, v68, v69
    v_mfma_f32_16x16x32_bf16 v[32:35], v[180:183], a[236:239], v[32:35]
    v_exp_f32 v92, v92
    v_mfma_f32_16x16x32_bf16 v[36:39], v[180:183], a[252:255], v[36:39]
    v_exp_f32 v93, v93
    v_mfma_f32_16x16x32_bf16 v[40:43], v[180:183], v[212:215], v[40:43]
    v_exp_f32 v94, v94
    v_mfma_f32_16x16x32_bf16 v[44:47], v[180:183], v[228:231], v[44:47]
    v_cvt_pk_bf16_f32 v165, v70, v71
    s_waitcnt lgkmcnt(2)
    v_mfma_f32_16x16x32_bf16 a[0:3], v[168:171], v[144:147], a[0:3]
    v_exp_f32 v95, v95
    v_mfma_f32_16x16x32_bf16 a[4:7], v[168:171], v[148:151], a[4:7]
    v_cvt_pk_bf16_f32 v166, v92, v93
    v_cvt_pk_bf16_f32 v167, v94, v95
    v_mfma_f32_16x16x32_bf16 a[8:11], v[168:171], v[152:155], a[8:11]
    ds_read_b64_tr_b16 v[176:177], v193 offset:26176
    ds_read_b64_tr_b16 v[178:179], v193 offset:30528
    v_mfma_f32_16x16x32_bf16 a[12:15], v[168:171], v[156:159], a[12:15]
    s_waitcnt vmcnt(4)
    v_mfma_f32_16x16x32_bf16 a[16:19], v[168:171], v[160:163], a[16:19]
    buffer_load_dwordx4 v197, s[8:11], s30 offen nt lds
    v_mfma_f32_16x16x32_bf16 a[20:23], v[168:171], v[164:167], a[20:23]
    s_add_u32 m0, s43, 4416
    v_mfma_f32_16x16x32_bf16 v[120:123], v[184:187], v[144:147], v[120:123]
    s_waitcnt lgkmcnt(2)
    v_mfma_f32_16x16x32_bf16 a[24:27], v[172:175], v[144:147], a[24:27]
    ds_read_b64_tr_b16 v[180:181], v194 offset:26176
    ds_read_b64_tr_b16 v[182:183], v194 offset:30528
    v_mfma_f32_16x16x32_bf16 a[28:31], v[172:175], v[148:151], a[28:31]
    v_exp_f32 v0, v0
    v_mfma_f32_16x16x32_bf16 a[32:35], v[172:175], v[152:155], a[32:35]
    s_waitcnt vmcnt(4)
    v_mfma_f32_16x16x32_bf16 a[36:39], v[172:175], v[156:159], a[36:39]
    buffer_load_dwordx4 v197, s[8:11], s30 offen offset:1024 nt lds
    v_mfma_f32_16x16x32_bf16 a[40:43], v[172:175], v[160:163], a[40:43]
    s_add_u32 m0, s43, 4480
    v_mfma_f32_16x16x32_bf16 a[44:47], v[172:175], v[164:167], a[44:47]
    v_exp_f32 v1, v1
    v_mfma_f32_16x16x32_bf16 v[124:127], v[184:187], v[148:151], v[124:127]
    s_waitcnt lgkmcnt(2)
    v_mfma_f32_16x16x32_bf16 a[48:51], v[176:179], v[144:147], a[48:51]
    ds_read_b64_tr_b16 v[168:169], v195 offset:26112
    ds_read_b64_tr_b16 v[170:171], v195 offset:30464
    v_mfma_f32_16x16x32_bf16 a[52:55], v[176:179], v[148:151], a[52:55]
    v_exp_f32 v2, v2
    v_mfma_f32_16x16x32_bf16 a[56:59], v[176:179], v[152:155], a[56:59]
    v_exp_f32 v3, v3
    v_mfma_f32_16x16x32_bf16 a[60:63], v[176:179], v[156:159], a[60:63]
    v_exp_f32 v4, v4
    v_mfma_f32_16x16x32_bf16 a[64:67], v[176:179], v[160:163], a[64:67]
    v_exp_f32 v5, v5
    v_mfma_f32_16x16x32_bf16 a[68:71], v[176:179], v[164:167], a[68:71]
    v_exp_f32 v6, v6
    v_mfma_f32_16x16x32_bf16 v[128:131], v[184:187], v[152:155], v[128:131]
    s_waitcnt vmcnt(3)
    s_waitcnt lgkmcnt(2)
    v_mfma_f32_16x16x32_bf16 a[72:75], v[180:183], v[144:147], a[72:75]
    ds_read_b64_tr_b16 v[172:173], v196 offset:26112
    ds_read_b64_tr_b16 v[174:175], v196 offset:30464
    v_mfma_f32_16x16x32_bf16 a[76:79], v[180:183], v[148:151], a[76:79]
    buffer_load_dwordx4 v197, s[8:11], s30 offen offset:2048 nt lds
    v_mfma_f32_16x16x32_bf16 a[80:83], v[180:183], v[152:155], a[80:83]
    s_add_u32 m0, s43, 4544
    v_mfma_f32_16x16x32_bf16 a[84:87], v[180:183], v[156:159], a[84:87]
    v_exp_f32 v7, v7
    v_mfma_f32_16x16x32_bf16 a[88:91], v[180:183], v[160:163], a[88:91]
    v_exp_f32 v8, v8
    v_mfma_f32_16x16x32_bf16 a[92:95], v[180:183], v[164:167], a[92:95]
    v_exp_f32 v9, v9
    v_mfma_f32_16x16x32_bf16 v[132:135], v[184:187], v[156:159], v[132:135]
    s_waitcnt lgkmcnt(2)
    v_mfma_f32_16x16x32_bf16 a[96:99], v[168:171], v[144:147], a[96:99]
    ds_read_b64_tr_b16 v[176:177], v195 offset:26176
    ds_read_b64_tr_b16 v[178:179], v195 offset:30528
    v_mfma_f32_16x16x32_bf16 a[100:103], v[168:171], v[148:151], a[100:103]
    v_exp_f32 v10, v10
    v_mfma_f32_16x16x32_bf16 a[104:107], v[168:171], v[152:155], a[104:107]
    v_exp_f32 v11, v11
    v_mfma_f32_16x16x32_bf16 a[108:111], v[168:171], v[156:159], a[108:111]
    s_waitcnt vmcnt(4)
    v_mfma_f32_16x16x32_bf16 a[112:115], v[168:171], v[160:163], a[112:115]
    buffer_load_dwordx4 v197, s[8:11], s30 offen offset:3072 nt lds
    v_mfma_f32_16x16x32_bf16 a[116:119], v[168:171], v[164:167], a[116:119]
    ds_read_b64_tr_b16 v[180:181], v196 offset:26176
    ds_read_b64_tr_b16 v[182:183], v196 offset:30528
    v_mfma_f32_16x16x32_bf16 v[136:139], v[184:187], v[160:163], v[136:139]
    s_waitcnt lgkmcnt(4)
    v_mfma_f32_16x16x32_bf16 a[120:123], v[172:175], v[144:147], a[120:123]
    v_exp_f32 v12, v12
    v_mfma_f32_16x16x32_bf16 a[124:127], v[172:175], v[148:151], a[124:127]
    v_exp_f32 v13, v13
    v_mfma_f32_16x16x32_bf16 a[128:131], v[172:175], v[152:155], a[128:131]
    v_exp_f32 v14, v14
    v_mfma_f32_16x16x32_bf16 a[132:135], v[172:175], v[156:159], a[132:135]
    v_exp_f32 v15, v15
    v_mfma_f32_16x16x32_bf16 a[136:139], v[172:175], v[160:163], a[136:139]
    ds_read_b128 v[168:171], v192 offset:8704
    v_mfma_f32_16x16x32_bf16 a[140:143], v[172:175], v[164:167], a[140:143]
    s_add_u32 s29, s29, 8192
    s_and_b32 s29, s29, 0x3ffff
    v_mfma_f32_16x16x32_bf16 v[140:143], v[184:187], v[164:167], v[140:143]
    s_add_u32 s30, s29, 4096
    s_waitcnt lgkmcnt(3)
    v_mfma_f32_16x16x32_bf16 a[144:147], v[176:179], v[144:147], a[144:147]
    v_exp_f32 v16, v16
    v_mfma_f32_16x16x32_bf16 a[148:151], v[176:179], v[148:151], a[148:151]
    v_exp_f32 v17, v17
    v_mfma_f32_16x16x32_bf16 a[152:155], v[176:179], v[152:155], a[152:155]
    v_exp_f32 v18, v18
    v_mfma_f32_16x16x32_bf16 a[156:159], v[176:179], v[156:159], a[156:159]
    ds_read_b128 v[172:175], v192 offset:8768
    v_mfma_f32_16x16x32_bf16 a[160:163], v[176:179], v[160:163], a[160:163]
    v_exp_f32 v19, v19
    v_mfma_f32_16x16x32_bf16 a[164:167], v[176:179], v[164:167], a[164:167]
    s_waitcnt lgkmcnt(2)
    v_mfma_f32_16x16x32_bf16 a[168:171], v[180:183], v[144:147], a[168:171]
    s_waitcnt vmcnt(8)
    s_barrier
    v_mfma_f32_16x16x32_bf16 a[172:175], v[180:183], v[148:151], a[172:175]
    v_exp_f32 v20, v20
    v_mfma_f32_16x16x32_bf16 a[176:179], v[180:183], v[152:155], a[176:179]
    v_exp_f32 v21, v21
    v_mfma_f32_16x16x32_bf16 a[180:183], v[180:183], v[156:159], a[180:183]
    v_exp_f32 v22, v22
    v_mfma_f32_16x16x32_bf16 a[184:187], v[180:183], v[160:163], a[184:187]
    v_exp_f32 v23, v23
    v_mfma_f32_16x16x32_bf16 a[188:191], v[180:183], v[164:167], a[188:191]
    v_exp_f32 v24, v24
    v_exp_f32 v25, v25
    v_exp_f32 v26, v26
    v_exp_f32 v27, v27
    v_exp_f32 v28, v28
    v_exp_f32 v29, v29
    s_waitcnt lgkmcnt(1)
    v_mfma_f32_16x16x32_bf16 v[48:51], v[168:171], a[192:195], v[96:99]
    s_cmp_eq_u32 s32, s84
    s_cselect_b32 s10, 0, s10
    v_mfma_f32_16x16x32_bf16 v[52:55], v[168:171], a[208:211], v[100:103]
    ds_read_b128 v[176:179], v192 offset:8832
    s_add_u32 m0, s40, 0
    v_mfma_f32_16x16x32_bf16 v[56:59], v[168:171], a[224:227], v[104:107]
    s_waitcnt vmcnt(3)
    v_cvt_pk_bf16_f32 v144, v0, v1
    v_mfma_f32_16x16x32_bf16 v[60:63], v[168:171], a[240:243], v[108:111]
    ds_read_b128 v[180:183], v192 offset:8896
    v_cvt_pk_bf16_f32 v145, v2, v3
    v_mfma_f32_16x16x32_bf16 v[64:67], v[168:171], v[200:203], v[112:115]
    buffer_load_dwordx4 v197, s[8:11], s29 offen nt lds
    v_mfma_f32_16x16x32_bf16 v[68:71], v[168:171], v[216:219], v[116:119]
    s_add_u32 m0, s40, 64
    s_waitcnt lgkmcnt(2)
    v_mfma_f32_16x16x32_bf16 v[48:51], v[172:175], a[196:199], v[48:51]
    v_cvt_pk_bf16_f32 v146, v24, v25
    v_cvt_pk_bf16_f32 v147, v26, v27
    v_mfma_f32_16x16x32_bf16 v[52:55], v[172:175], a[212:215], v[52:55]
    v_exp_f32 v30, v30
    v_mfma_f32_16x16x32_bf16 v[56:59], v[172:175], a[228:231], v[56:59]
    v_exp_f32 v31, v31
    v_mfma_f32_16x16x32_bf16 v[60:63], v[172:175], a[244:247], v[60:63]
    ds_read_b128 v[168:171], v192 offset:13056
    v_cvt_pk_bf16_f32 v148, v4, v5
    v_mfma_f32_16x16x32_bf16 v[64:67], v[172:175], v[204:207], v[64:67]
    v_cvt_pk_bf16_f32 v149, v6, v7
    v_cvt_pk_bf16_f32 v150, v28, v29
    v_mfma_f32_16x16x32_bf16 v[68:71], v[172:175], v[220:223], v[68:71]
    v_cvt_pk_bf16_f32 v151, v30, v31
    s_waitcnt lgkmcnt(2)
    v_mfma_f32_16x16x32_bf16 v[48:51], v[176:179], a[200:203], v[48:51]
    v_exp_f32 v32, v32
    v_mfma_f32_16x16x32_bf16 v[52:55], v[176:179], a[216:219], v[52:55]
    s_waitcnt vmcnt(4)
    v_cvt_pk_bf16_f32 v152, v8, v9
    v_mfma_f32_16x16x32_bf16 v[56:59], v[176:179], a[232:235], v[56:59]
    buffer_load_dwordx4 v197, s[8:11], s29 offen offset:1024 nt lds
    v_mfma_f32_16x16x32_bf16 v[60:63], v[176:179], a[248:251], v[60:63]
    ds_read_b128 v[172:175], v192 offset:13120
    s_add_u32 m0, s40, 128
    v_mfma_f32_16x16x32_bf16 v[64:67], v[176:179], v[208:211], v[64:67]
    v_exp_f32 v33, v33
    v_mfma_f32_16x16x32_bf16 v[68:71], v[176:179], v[224:227], v[68:71]
    v_cvt_pk_bf16_f32 v153, v10, v11
    s_waitcnt lgkmcnt(2)
    v_mfma_f32_16x16x32_bf16 v[48:51], v[180:183], a[204:207], v[48:51]
    v_exp_f32 v34, v34
    v_mfma_f32_16x16x32_bf16 v[52:55], v[180:183], a[220:223], v[52:55]
    v_exp_f32 v35, v35
    v_mfma_f32_16x16x32_bf16 v[56:59], v[180:183], a[236:239], v[56:59]
    v_cvt_pk_bf16_f32 v154, v32, v33
    v_cvt_pk_bf16_f32 v155, v34, v35
    v_mfma_f32_16x16x32_bf16 v[60:63], v[180:183], a[252:255], v[60:63]
    ds_read_b128 v[176:179], v192 offset:13184
    v_cvt_pk_bf16_f32 v156, v12, v13
    v_mfma_f32_16x16x32_bf16 v[64:67], v[180:183], v[212:215], v[64:67]
    v_exp_f32 v36, v36
    v_mfma_f32_16x16x32_bf16 v[68:71], v[180:183], v[228:231], v[68:71]
    v_cvt_pk_bf16_f32 v157, v14, v15
    s_waitcnt lgkmcnt(2)
    v_mfma_f32_16x16x32_bf16 v[72:75], v[168:171], a[192:195], v[96:99]
    s_waitcnt vmcnt(4)
    v_mfma_f32_16x16x32_bf16 v[76:79], v[168:171], a[208:211], v[100:103]
    buffer_load_dwordx4 v197, s[8:11], s29 offen offset:2048 nt lds
    v_mfma_f32_16x16x32_bf16 v[80:83], v[168:171], a[224:227], v[104:107]
    s_add_u32 m0, s40, 192
    v_mfma_f32_16x16x32_bf16 v[84:87], v[168:171], a[240:243], v[108:111]
    ds_read_b128 v[180:183], v192 offset:13248
    v_mfma_f32_16x16x32_bf16 v[88:91], v[168:171], v[200:203], v[112:115]
    v_exp_f32 v37, v37
    v_mfma_f32_16x16x32_bf16 v[92:95], v[168:171], v[216:219], v[116:119]
    v_cvt_pk_bf16_f32 v158, v36, v37
    s_waitcnt lgkmcnt(2)
    v_mfma_f32_16x16x32_bf16 v[72:75], v[172:175], a[196:199], v[72:75]
    v_exp_f32 v38, v38
    v_mfma_f32_16x16x32_bf16 v[76:79], v[172:175], a[212:215], v[76:79]
    v_exp_f32 v39, v39
    v_mfma_f32_16x16x32_bf16 v[80:83], v[172:175], a[228:231], v[80:83]
    v_cvt_pk_bf16_f32 v159, v38, v39
    v_cvt_pk_bf16_f32 v160, v16, v17
    v_mfma_f32_16x16x32_bf16 v[84:87], v[172:175], a[244:247], v[84:87]
    ds_read_b64_tr_b16 v[168:169], v193 offset:0
    ds_read_b64_tr_b16 v[170:171], v193 offset:4352
    v_mfma_f32_16x16x32_bf16 v[88:91], v[172:175], v[204:207], v[88:91]
    v_exp_f32 v40, v40
    v_mfma_f32_16x16x32_bf16 v[92:95], v[172:175], v[220:223], v[92:95]
    s_waitcnt vmcnt(3)
    s_waitcnt lgkmcnt(3)
    v_mfma_f32_16x16x32_bf16 v[72:75], v[176:179], a[200:203], v[72:75]
    buffer_load_dwordx4 v197, s[8:11], s29 offen offset:3072 nt lds
    v_mfma_f32_16x16x32_bf16 v[76:79], v[176:179], a[216:219], v[76:79]
    s_add_u32 m0, s40, 4352
    v_cvt_pk_bf16_f32 v161, v18, v19
    v_mfma_f32_16x16x32_bf16 v[80:83], v[176:179], a[232:235], v[80:83]
    v_exp_f32 v41, v41
    v_mfma_f32_16x16x32_bf16 v[84:87], v[176:179], a[248:251], v[84:87]
    v_exp_f32 v42, v42
    v_mfma_f32_16x16x32_bf16 v[88:91], v[176:179], v[208:211], v[88:91]
    ds_read_b64_tr_b16 v[172:173], v194 offset:0
    ds_read_b64_tr_b16 v[174:175], v194 offset:4352
    v_mfma_f32_16x16x32_bf16 v[92:95], v[176:179], v[224:227], v[92:95]
    v_cvt_pk_bf16_f32 v162, v40, v41
    s_waitcnt lgkmcnt(4)
    v_mfma_f32_16x16x32_bf16 v[72:75], v[180:183], a[204:207], v[72:75]
    v_exp_f32 v43, v43
    v_mfma_f32_16x16x32_bf16 v[76:79], v[180:183], a[220:223], v[76:79]
    v_cvt_pk_bf16_f32 v163, v42, v43
    v_cvt_pk_bf16_f32 v164, v20, v21
    v_mfma_f32_16x16x32_bf16 v[80:83], v[180:183], a[236:239], v[80:83]
    v_exp_f32 v44, v44
    v_mfma_f32_16x16x32_bf16 v[84:87], v[180:183], a[252:255], v[84:87]
    v_exp_f32 v45, v45
    v_mfma_f32_16x16x32_bf16 v[88:91], v[180:183], v[212:215], v[88:91]
    v_exp_f32 v46, v46
    v_mfma_f32_16x16x32_bf16 v[92:95], v[180:183], v[228:231], v[92:95]
    v_cvt_pk_bf16_f32 v165, v22, v23
    s_waitcnt lgkmcnt(2)
    v_mfma_f32_16x16x32_bf16 a[0:3], v[168:171], v[144:147], a[0:3]
    v_exp_f32 v47, v47
    v_mfma_f32_16x16x32_bf16 a[4:7], v[168:171], v[148:151], a[4:7]
    v_cvt_pk_bf16_f32 v166, v44, v45
    v_cvt_pk_bf16_f32 v167, v46, v47
    v_mfma_f32_16x16x32_bf16 a[8:11], v[168:171], v[152:155], a[8:11]
    ds_read_b64_tr_b16 v[176:177], v193 offset:64
    ds_read_b64_tr_b16 v[178:179], v193 offset:4416
    v_mfma_f32_16x16x32_bf16 a[12:15], v[168:171], v[156:159], a[12:15]
    s_waitcnt vmcnt(4)
    v_mfma_f32_16x16x32_bf16 a[16:19], v[168:171], v[160:163], a[16:19]
    buffer_load_dwordx4 v197, s[8:11], s30 offen nt lds
    v_mfma_f32_16x16x32_bf16 a[20:23], v[168:171], v[164:167], a[20:23]
    s_add_u32 m0, s40, 4416
    v_mfma_f32_16x16x32_bf16 v[120:123], v[184:187], v[144:147], v[120:123]
    s_waitcnt lgkmcnt(2)
    v_mfma_f32_16x16x32_bf16 a[24:27], v[172:175], v[144:147], a[24:27]
    ds_read_b64_tr_b16 v[180:181], v194 offset:64
    ds_read_b64_tr_b16 v[182:183], v194 offset:4416
    v_mfma_f32_16x16x32_bf16 a[28:31], v[172:175], v[148:151], a[28:31]
    v_exp_f32 v48, v48
    v_mfma_f32_16x16x32_bf16 a[32:35], v[172:175], v[152:155], a[32:35]
    s_waitcnt vmcnt(4)
    v_mfma_f32_16x16x32_bf16 a[36:39], v[172:175], v[156:159], a[36:39]
    buffer_load_dwordx4 v197, s[8:11], s30 offen offset:1024 nt lds
    v_mfma_f32_16x16x32_bf16 a[40:43], v[172:175], v[160:163], a[40:43]
    s_add_u32 m0, s40, 4480
    v_mfma_f32_16x16x32_bf16 a[44:47], v[172:175], v[164:167], a[44:47]
    v_exp_f32 v49, v49
    v_mfma_f32_16x16x32_bf16 v[124:127], v[184:187], v[148:151], v[124:127]
    s_waitcnt lgkmcnt(2)
    v_mfma_f32_16x16x32_bf16 a[48:51], v[176:179], v[144:147], a[48:51]
    ds_read_b64_tr_b16 v[168:169], v195 offset:0
    ds_read_b64_tr_b16 v[170:171], v195 offset:4352
    v_mfma_f32_16x16x32_bf16 a[52:55], v[176:179], v[148:151], a[52:55]
    v_exp_f32 v50, v50
    v_mfma_f32_16x16x32_bf16 a[56:59], v[176:179], v[152:155], a[56:59]
    v_exp_f32 v51, v51
    v_mfma_f32_16x16x32_bf16 a[60:63], v[176:179], v[156:159], a[60:63]
    v_exp_f32 v52, v52
    v_mfma_f32_16x16x32_bf16 a[64:67], v[176:179], v[160:163], a[64:67]
    v_exp_f32 v53, v53
    v_mfma_f32_16x16x32_bf16 a[68:71], v[176:179], v[164:167], a[68:71]
    v_exp_f32 v54, v54
    v_mfma_f32_16x16x32_bf16 v[128:131], v[184:187], v[152:155], v[128:131]
    s_waitcnt vmcnt(3)
    s_waitcnt lgkmcnt(2)
    v_mfma_f32_16x16x32_bf16 a[72:75], v[180:183], v[144:147], a[72:75]
    ds_read_b64_tr_b16 v[172:173], v196 offset:0
    ds_read_b64_tr_b16 v[174:175], v196 offset:4352
    v_mfma_f32_16x16x32_bf16 a[76:79], v[180:183], v[148:151], a[76:79]
    buffer_load_dwordx4 v197, s[8:11], s30 offen offset:2048 nt lds
    v_mfma_f32_16x16x32_bf16 a[80:83], v[180:183], v[152:155], a[80:83]
    s_add_u32 m0, s40, 4544
    v_mfma_f32_16x16x32_bf16 a[84:87], v[180:183], v[156:159], a[84:87]
    v_exp_f32 v55, v55
    v_mfma_f32_16x16x32_bf16 a[88:91], v[180:183], v[160:163], a[88:91]
    v_exp_f32 v56, v56
    v_mfma_f32_16x16x32_bf16 a[92:95], v[180:183], v[164:167], a[92:95]
    v_exp_f32 v57, v57
    v_mfma_f32_16x16x32_bf16 v[132:135], v[184:187], v[156:159], v[132:135]
    s_waitcnt lgkmcnt(2)
    v_mfma_f32_16x16x32_bf16 a[96:99], v[168:171], v[144:147], a[96:99]
    ds_read_b64_tr_b16 v[176:177], v195 offset:64
    ds_read_b64_tr_b16 v[178:179], v195 offset:4416
    v_mfma_f32_16x16x32_bf16 a[100:103], v[168:171], v[148:151], a[100:103]
    v_exp_f32 v58, v58
    v_mfma_f32_16x16x32_bf16 a[104:107], v[168:171], v[152:155], a[104:107]
    v_exp_f32 v59, v59
    v_mfma_f32_16x16x32_bf16 a[108:111], v[168:171], v[156:159], a[108:111]
    s_waitcnt vmcnt(4)
    v_mfma_f32_16x16x32_bf16 a[112:115], v[168:171], v[160:163], a[112:115]
    buffer_load_dwordx4 v197, s[8:11], s30 offen offset:3072 nt lds
    v_mfma_f32_16x16x32_bf16 a[116:119], v[168:171], v[164:167], a[116:119]
    ds_read_b64_tr_b16 v[180:181], v196 offset:64
    ds_read_b64_tr_b16 v[182:183], v196 offset:4416
    v_mfma_f32_16x16x32_bf16 v[136:139], v[184:187], v[160:163], v[136:139]
    s_waitcnt lgkmcnt(4)
    v_mfma_f32_16x16x32_bf16 a[120:123], v[172:175], v[144:147], a[120:123]
    v_exp_f32 v60, v60
    v_mfma_f32_16x16x32_bf16 a[124:127], v[172:175], v[148:151], a[124:127]
    v_exp_f32 v61, v61
    v_mfma_f32_16x16x32_bf16 a[128:131], v[172:175], v[152:155], a[128:131]
    v_exp_f32 v62, v62
    v_mfma_f32_16x16x32_bf16 a[132:135], v[172:175], v[156:159], a[132:135]
    v_exp_f32 v63, v63
    v_mfma_f32_16x16x32_bf16 a[136:139], v[172:175], v[160:163], a[136:139]
    ds_read_b128 v[168:171], v192 offset:17408
    v_mfma_f32_16x16x32_bf16 a[140:143], v[172:175], v[164:167], a[140:143]
    s_add_u32 s29, s29, 8192
    s_and_b32 s29, s29, 0x3ffff
    v_mfma_f32_16x16x32_bf16 v[140:143], v[184:187], v[164:167], v[140:143]
    s_add_u32 s30, s29, 4096
    s_waitcnt lgkmcnt(3)
    v_mfma_f32_16x16x32_bf16 a[144:147], v[176:179], v[144:147], a[144:147]
    v_exp_f32 v64, v64
    v_mfma_f32_16x16x32_bf16 a[148:151], v[176:179], v[148:151], a[148:151]
    v_exp_f32 v65, v65
    v_mfma_f32_16x16x32_bf16 a[152:155], v[176:179], v[152:155], a[152:155]
    v_exp_f32 v66, v66
    v_mfma_f32_16x16x32_bf16 a[156:159], v[176:179], v[156:159], a[156:159]
    ds_read_b128 v[172:175], v192 offset:17472
    v_mfma_f32_16x16x32_bf16 a[160:163], v[176:179], v[160:163], a[160:163]
    v_exp_f32 v67, v67
    v_mfma_f32_16x16x32_bf16 a[164:167], v[176:179], v[164:167], a[164:167]
    s_waitcnt lgkmcnt(2)
    v_mfma_f32_16x16x32_bf16 a[168:171], v[180:183], v[144:147], a[168:171]
    s_waitcnt vmcnt(8)
    s_barrier
    v_mfma_f32_16x16x32_bf16 a[172:175], v[180:183], v[148:151], a[172:175]
    v_exp_f32 v68, v68
    v_mfma_f32_16x16x32_bf16 a[176:179], v[180:183], v[152:155], a[176:179]
    v_exp_f32 v69, v69
    v_mfma_f32_16x16x32_bf16 a[180:183], v[180:183], v[156:159], a[180:183]
    v_exp_f32 v70, v70
    v_mfma_f32_16x16x32_bf16 a[184:187], v[180:183], v[160:163], a[184:187]
    v_exp_f32 v71, v71
    v_mfma_f32_16x16x32_bf16 a[188:191], v[180:183], v[164:167], a[188:191]
    v_exp_f32 v72, v72
    v_exp_f32 v73, v73
    v_exp_f32 v74, v74
    v_exp_f32 v75, v75
    v_exp_f32 v76, v76
    v_exp_f32 v77, v77
    s_sub_u32 s32, s32, 1
    s_cmp_lg_u32 s32, 3
    s_cbranch_scc1 L_loopf0
.p2align 3
L_loopf1:
    s_waitcnt lgkmcnt(1)
    v_mfma_f32_16x16x32_bf16 v[0:3], v[168:171], a[192:195], v[96:99]
    s_add_u32 m0, s41, 0
    ds_read_b128 v[176:179], v192 offset:17536
    v_mfma_f32_16x16x32_bf16 v[4:7], v[168:171], a[208:211], v[100:103]
    v_cvt_pk_bf16_f32 v144, v48, v49
    v_cvt_pk_bf16_f32 v145, v50, v51
    v_mfma_f32_16x16x32_bf16 v[8:11], v[168:171], a[224:227], v[104:107]
    s_waitcnt vmcnt(4)
    v_cvt_pk_bf16_f32 v146, v72, v73
    v_mfma_f32_16x16x32_bf16 v[12:15], v[168:171], a[240:243], v[108:111]
    ds_read_b128 v[180:183], v192 offset:17600
    v_cvt_pk_bf16_f32 v147, v74, v75
    v_mfma_f32_16x16x32_bf16 v[16:19], v[168:171], v[200:203], v[112:115]
    buffer_load_dwordx4 v197, s[8:11], s29 offen nt lds
    v_mfma_f32_16x16x32_bf16 v[20:23], v[168:171], v[216:219], v[116:119]
    s_add_u32 m0, s41, 64
    s_waitcnt lgkmcnt(2)
    v_mfma_f32_16x16x32_bf16 v[0:3], v[172:175], a[196:199], v[0:3]
    v_exp_f32 v78, v78
    v_mfma_f32_16x16x32_bf16 v[4:7], v[172:175], a[212:215], v[4:7]
    v_exp_f32 v79, v79
    v_mfma_f32_16x16x32_bf16 v[8:11], v[172:175], a[228:231], v[8:11]
    v_cvt_pk_bf16_f32 v148, v52, v53
    v_cvt_pk_bf16_f32 v149, v54, v55
    v_mfma_f32_16x16x32_bf16 v[12:15], v[172:175], a[244:247], v[12:15]
    ds_read_b128 v[168:171], v192 offset:21760
    v_cvt_pk_bf16_f32 v150, v76, v77
    v_mfma_f32_16x16x32_bf16 v[16:19], v[172:175], v[204:207], v[16:19]
    v_cvt_pk_bf16_f32 v151, v78, v79
    v_cvt_pk_bf16_f32 v152, v56, v57
    v_mfma_f32_16x16x32_bf16 v[20:23], v[172:175], v[220:223], v[20:23]
    v_cvt_pk_bf16_f32 v153, v58, v59
    s_waitcnt lgkmcnt(2)
    v_mfma_f32_16x16x32_bf16 v[0:3], v[176:179], a[200:203], v[0:3]
    v_exp_f32 v80, v80
    v_mfma_f32_16x16x32_bf16 v[4:7], v[176:179], a[216:219], v[4:7]
    s_waitcnt vmcnt(4)
    v_mfma_f32_16x16x32_bf16 v[8:11], v[176:179], a[232:235], v[8:11]
    buffer_load_dwordx4 v197, s[8:11], s29 offen offset:1024 nt lds
    v_mfma_f32_16x16x32_bf16 v[12:15], v[176:179], a[248:251], v[12:15]
    ds_read_b128 v[172:175], v192 offset:21824
    s_add_u32 m0, s41, 128
    v_mfma_f32_16x16x32_bf16 v[16:19], v[176:179], v[208:211], v[16:19]
    v_exp_f32 v81, v81
    v_mfma_f32_16x16x32_bf16 v[20:23], v[176:179], v[224:227], v[20:23]
    v_cvt_pk_bf16_f32 v154, v80, v81
    s_waitcnt lgkmcnt(2)
    v_mfma_f32_16x16x32_bf16 v[0:3], v[180:183], a[204:207], v[0:3]
    v_exp_f32 v82, v82
    v_mfma_f32_16x16x32_bf16 v[4:7], v[180:183], a[220:223], v[4:7]
    v_exp_f32 v83, v83
    v_mfma_f32_16x16x32_bf16 v[8:11], v[180:183], a[236:239], v[8:11]
    v_cvt_pk_bf16_f32 v155, v82, v83
    v_cvt_pk_bf16_f32 v156, v60, v61
    v_mfma_f32_16x16x32_bf16 v[12:15], v[180:183], a[252:255], v[12:15]
    ds_read_b128 v[176:179], v192 offset:21888
    v_cvt_pk_bf16_f32 v157, v62, v63
    v_mfma_f32_16x16x32_bf16 v[16:19], v[180:183], v[212:215], v[16:19]
    v_exp_f32 v84, v84
    v_mfma_f32_16x16x32_bf16 v[20:23], v[180:183], v[228:231], v[20:23]
    s_waitcnt lgkmcnt(2)
    v_mfma_f32_16x16x32_bf16 v[24:27], v[168:171], a[192:195], v[96:99]
    s_waitcnt vmcnt(4)
    v_mfma_f32_16x16x32_bf16 v[28:31], v[168:171], a[208:211], v[100:103]
    buffer_load_dwordx4 v197, s[8:11], s29 offen offset:2048 nt lds
    v_mfma_f32_16x16x32_bf16 v[32:35], v[168:171], a[224:227], v[104:107]
    s_add_u32 m0, s41, 192
    v_mfma_f32_16x16x32_bf16 v[36:39], v[168:171], a[240:243], v[108:111]
    ds_read_b128 v[180:183], v192 offset:21952
    v_mfma_f32_16x16x32_bf16 v[40:43], v[168:171], v[200:203], v[112:115]
    v_exp_f32 v85, v85
    v_mfma_f32_16x16x32_bf16 v[44:47], v[168:171], v[216:219], v[116:119]
    v_cvt_pk_bf16_f32 v158, v84, v85
    s_waitcnt lgkmcnt(2)
    v_mfma_f32_16x16x32_bf16 v[24:27], v[172:175], a[196:199], v[24:27]
    v_exp_f32 v86, v86
    v_mfma_f32_16x16x32_bf16 v[28:31], v[172:175], a[212:215], v[28:31]
    v_exp_f32 v87, v87
    v_mfma_f32_16x16x32_bf16 v[32:35], v[172:175], a[228:231], v[32:35]
    v_cvt_pk_bf16_f32 v159, v86, v87
    v_cvt_pk_bf16_f32 v160, v64, v65
    v_mfma_f32_16x16x32_bf16 v[36:39], v[172:175], a[244:247], v[36:39]
    ds_read_b64_tr_b16 v[168:169], v193 offset:8704
    ds_read_b64_tr_b16 v[170:171], v193 offset:13056
    v_mfma_f32_16x16x32_bf16 v[40:43], v[172:175], v[204:207], v[40:43]
    v_exp_f32 v88, v88
    v_mfma_f32_16x16x32_bf16 v[44:47], v[172:175], v[220:223], v[44:47]
    s_waitcnt vmcnt(4)
    s_waitcnt lgkmcnt(3)
    v_mfma_f32_16x16x32_bf16 v[24:27], v[176:179], a[200:203], v[24:27]
    buffer_load_dwordx4 v197, s[8:11], s29 offen offset:3072 nt lds
    v_mfma_f32_16x16x32_bf16 v[28:31], v[176:179], a[216:219], v[28:31]
    s_add_u32 m0, s41, 4352
    v_cvt_pk_bf16_f32 v161, v66, v67
    v_mfma_f32_16x16x32_bf16 v[32:35], v[176:179], a[232:235], v[32:35]
    v_exp_f32 v89, v89
    v_mfma_f32_16x16x32_bf16 v[36:39], v[176:179], a[248:251], v[36:39]
    v_exp_f32 v90, v90
    v_mfma_f32_16x16x32_bf16 v[40:43], v[176:179], v[208:211], v[40:43]
    ds_read_b64_tr_b16 v[172:173], v194 offset:8704
    ds_read_b64_tr_b16 v[174:175], v194 offset:13056
    v_mfma_f32_16x16x32_bf16 v[44:47], v[176:179], v[224:227], v[44:47]
    v_cvt_pk_bf16_f32 v162, v88, v89
    s_waitcnt lgkmcnt(4)
    v_mfma_f32_16x16x32_bf16 v[24:27], v[180:183], a[204:207], v[24:27]
    v_exp_f32 v91, v91
    v_mfma_f32_16x16x32_bf16 v[28:31], v[180:183], a[220:223], v[28:31]
    v_cvt_pk_bf16_f32 v163, v90, v91
    v_cvt_pk_bf16_f32 v164, v68, v69
    v_mfma_f32_16x16x32_bf16 v[32:35], v[180:183], a[236:239], v[32:35]
    v_exp_f32 v92, v92
    v_mfma_f32_16x16x32_bf16 v[36:39], v[180:183], a[252:255], v[36:39]
    v_exp_f32 v93, v93
    v_mfma_f32_16x16x32_bf16 v[40:43], v[180:183], v[212:215], v[40:43]
    v_exp_f32 v94, v94
    v_mfma_f32_16x16x32_bf16 v[44:47], v[180:183], v[228:231], v[44:47]
    v_cvt_pk_bf16_f32 v165, v70, v71
    s_waitcnt lgkmcnt(2)
    v_mfma_f32_16x16x32_bf16 a[0:3], v[168:171], v[144:147], a[0:3]
    v_exp_f32 v95, v95
    v_mfma_f32_16x16x32_bf16 a[4:7], v[168:171], v[148:151], a[4:7]
    v_cvt_pk_bf16_f32 v166, v92, v93
    v_cvt_pk_bf16_f32 v167, v94, v95
    v_mfma_f32_16x16x32_bf16 a[8:11], v[168:171], v[152:155], a[8:11]
    ds_read_b64_tr_b16 v[176:177], v193 offset:8768
    ds_read_b64_tr_b16 v[178:179], v193 offset:13120
    v_mfma_f32_16x16x32_bf16 a[12:15], v[168:171], v[156:159], a[12:15]
    s_waitcnt vmcnt(4)
    v_mfma_f32_16x16x32_bf16 a[16:19], v[168:171], v[160:163], a[16:19]
    buffer_load_dwordx4 v197, s[8:11], s30 offen nt lds
    v_mfma_f32_16x16x32_bf16 a[20:23], v[168:171], v[164:167], a[20:23]
    s_add_u32 m0, s41, 4416
    v_mfma_f32_16x16x32_bf16 v[120:123], v[184:187], v[144:147], v[120:123]
    s_waitcnt lgkmcnt(2)
    v_mfma_f32_16x16x32_bf16 a[24:27], v[172:175], v[144:147], a[24:27]
    ds_read_b64_tr_b16 v[180:181], v194 offset:8768
    ds_read_b64_tr_b16 v[182:183], v194 offset:13120
    v_mfma_f32_16x16x32_bf16 a[28:31], v[172:175], v[148:151], a[28:31]
    v_exp_f32 v0, v0
    v_mfma_f32_16x16x32_bf16 a[32:35], v[172:175], v[152:155], a[32:35]
    s_waitcnt vmcnt(4)
    v_mfma_f32_16x16x32_bf16 a[36:39], v[172:175], v[156:159], a[36:39]
    buffer_load_dwordx4 v197, s[8:11], s30 offen offset:1024 nt lds
    v_mfma_f32_16x16x32_bf16 a[40:43], v[172:175], v[160:163], a[40:43]
    s_add_u32 m0, s41, 4480
    v_mfma_f32_16x16x32_bf16 a[44:47], v[172:175], v[164:167], a[44:47]
    v_exp_f32 v1, v1
    v_mfma_f32_16x16x32_bf16 v[124:127], v[184:187], v[148:151], v[124:127]
    s_waitcnt lgkmcnt(2)
    v_mfma_f32_16x16x32_bf16 a[48:51], v[176:179], v[144:147], a[48:51]
    ds_read_b64_tr_b16 v[168:169], v195 offset:8704
    ds_read_b64_tr_b16 v[170:171], v195 offset:13056
    v_mfma_f32_16x16x32_bf16 a[52:55], v[176:179], v[148:151], a[52:55]
    v_exp_f32 v2, v2
    v_mfma_f32_16x16x32_bf16 a[56:59], v[176:179], v[152:155], a[56:59]
    v_exp_f32 v3, v3
    v_mfma_f32_16x16x32_bf16 a[60:63], v[176:179], v[156:159], a[60:63]
    v_exp_f32 v4, v4
    v_mfma_f32_16x16x32_bf16 a[64:67], v[176:179], v[160:163], a[64:67]
    v_exp_f32 v5, v5
    v_mfma_f32_16x16x32_bf16 a[68:71], v[176:179], v[164:167], a[68:71]
    v_exp_f32 v6, v6
    v_mfma_f32_16x16x32_bf16 v[128:131], v[184:187], v[152:155], v[128:131]
    s_waitcnt vmcnt(4)
    s_waitcnt lgkmcnt(2)
    v_mfma_f32_16x16x32_bf16 a[72:75], v[180:183], v[144:147], a[72:75]
    ds_read_b64_tr_b16 v[172:173], v196 offset:8704
    ds_read_b64_tr_b16 v[174:175], v196 offset:13056
    v_mfma_f32_16x16x32_bf16 a[76:79], v[180:183], v[148:151], a[76:79]
    buffer_load_dwordx4 v197, s[8:11], s30 offen offset:2048 nt lds
    v_mfma_f32_16x16x32_bf16 a[80:83], v[180:183], v[152:155], a[80:83]
    s_add_u32 m0, s41, 4544
    v_mfma_f32_16x16x32_bf16 a[84:87], v[180:183], v[156:159], a[84:87]
    v_exp_f32 v7, v7
    v_mfma_f32_16x16x32_bf16 a[88:91], v[180:183], v[160:163], a[88:91]
    v_exp_f32 v8, v8
    v_mfma_f32_16x16x32_bf16 a[92:95], v[180:183], v[164:167], a[92:95]
    v_exp_f32 v9, v9
    v_mfma_f32_16x16x32_bf16 v[132:135], v[184:187], v[156:159], v[132:135]
    s_waitcnt lgkmcnt(2)
    v_mfma_f32_16x16x32_bf16 a[96:99], v[168:171], v[144:147], a[96:99]
    ds_read_b64_tr_b16 v[176:177], v195 offset:8768
    ds_read_b64_tr_b16 v[178:179], v195 offset:13120
    v_mfma_f32_16x16x32_bf16 a[100:103], v[168:171], v[148:151], a[100:103]
    v_exp_f32 v10, v10
    v_mfma_f32_16x16x32_bf16 a[104:107], v[168:171], v[152:155], a[104:107]
    v_exp_f32 v11, v11
    v_mfma_f32_16x16x32_bf16 a[108:111], v[168:171], v[156:159], a[108:111]
    s_waitcnt vmcnt(4)
    v_mfma_f32_16x16x32_bf16 a[112:115], v[168:171], v[160:163], a[112:115]
    buffer_load_dwordx4 v197, s[8:11], s30 offen offset:3072 nt lds
    v_mfma_f32_16x16x32_bf16 a[116:119], v[168:171], v[164:167], a[116:119]
    ds_read_b64_tr_b16 v[180:181], v196 offset:8768
    ds_read_b64_tr_b16 v[182:183], v196 offset:13120
    v_mfma_f32_16x16x32_bf16 v[136:139], v[184:187], v[160:163], v[136:139]
    s_waitcnt lgkmcnt(4)
    v_mfma_f32_16x16x32_bf16 a[120:123], v[172:175], v[144:147], a[120:123]
    v_exp_f32 v12, v12
    v_mfma_f32_16x16x32_bf16 a[124:127], v[172:175], v[148:151], a[124:127]
    v_exp_f32 v13, v13
    v_mfma_f32_16x16x32_bf16 a[128:131], v[172:175], v[152:155], a[128:131]
    v_exp_f32 v14, v14
    v_mfma_f32_16x16x32_bf16 a[132:135], v[172:175], v[156:159], a[132:135]
    v_exp_f32 v15, v15
    v_mfma_f32_16x16x32_bf16 a[136:139], v[172:175], v[160:163], a[136:139]
    ds_read_b128 v[168:171], v192 offset:26112
    v_mfma_f32_16x16x32_bf16 a[140:143], v[172:175], v[164:167], a[140:143]
    s_add_u32 s29, s29, 8192
    s_and_b32 s29, s29, 0x3ffff
    v_mfma_f32_16x16x32_bf16 v[140:143], v[184:187], v[164:167], v[140:143]
    s_add_u32 s30, s29, 4096
    s_waitcnt lgkmcnt(3)
    v_mfma_f32_16x16x32_bf16 a[144:147], v[176:179], v[144:147], a[144:147]
    v_exp_f32 v16, v16
    v_mfma_f32_16x16x32_bf16 a[148:151], v[176:179], v[148:151], a[148:151]
    v_exp_f32 v17, v17
    v_mfma_f32_16x16x32_bf16 a[152:155], v[176:179], v[152:155], a[152:155]
    v_exp_f32 v18, v18
    v_mfma_f32_16x16x32_bf16 a[156:159], v[176:179], v[156:159], a[156:159]
    ds_read_b128 v[172:175], v192 offset:26176
    v_mfma_f32_16x16x32_bf16 a[160:163], v[176:179], v[160:163], a[160:163]
    v_exp_f32 v19, v19
    v_mfma_f32_16x16x32_bf16 a[164:167], v[176:179], v[164:167], a[164:167]
    s_waitcnt lgkmcnt(2)
    v_mfma_f32_16x16x32_bf16 a[168:171], v[180:183], v[144:147], a[168:171]
    s_waitcnt vmcnt(8)
    s_barrier
    v_mfma_f32_16x16x32_bf16 a[172:175], v[180:183], v[148:151], a[172:175]
    v_exp_f32 v20, v20
    v_mfma_f32_16x16x32_bf16 a[176:179], v[180:183], v[152:155], a[176:179]
    v_exp_f32 v21, v21
    v_mfma_f32_16x16x32_bf16 a[180:183], v[180:183], v[156:159], a[180:183]
    v_exp_f32 v22, v22
    v_mfma_f32_16x16x32_bf16 a[184:187], v[180:183], v[160:163], a[184:187]
    v_exp_f32 v23, v23
    v_mfma_f32_16x16x32_bf16 a[188:191], v[180:183], v[164:167], a[188:191]
    v_exp_f32 v24, v24
    v_exp_f32 v25, v25
    v_exp_f32 v26, v26
    v_exp_f32 v27, v27
    v_exp_f32 v28, v28
    v_exp_f32 v29, v29
    s_waitcnt lgkmcnt(1)
    v_mfma_f32_16x16x32_bf16 v[48:51], v[168:171], a[192:195], v[96:99]
    s_add_u32 m0, s42, 0
    ds_read_b128 v[176:179], v192 offset:26240
    v_mfma_f32_16x16x32_bf16 v[52:55], v[168:171], a[208:211], v[100:103]
    v_cvt_pk_bf16_f32 v144, v0, v1
    v_cvt_pk_bf16_f32 v145, v2, v3
    v_mfma_f32_16x16x32_bf16 v[56:59], v[168:171], a[224:227], v[104:107]
    s_waitcnt vmcnt(4)
    v_cvt_pk_bf16_f32 v146, v24, v25
    v_mfma_f32_16x16x32_bf16 v[60:63], v[168:171], a[240:243], v[108:111]
    ds_read_b128 v[180:183], v192 offset:26304
    v_cvt_pk_bf16_f32 v147, v26, v27
    v_mfma_f32_16x16x32_bf16 v[64:67], v[168:171], v[200:203], v[112:115]
    buffer_load_dwordx4 v197, s[8:11], s29 offen nt lds
    v_mfma_f32_16x16x32_bf16 v[68:71], v[168:171], v[216:219], v[116:119]
    s_add_u32 m0, s42, 64
    s_waitcnt lgkmcnt(2)
    v_mfma_f32_16x16x32_bf16 v[48:51], v[172:175], a[196:199], v[48:51]
    v_exp_f32 v30, v30
    v_mfma_f32_16x16x32_bf16 v[52:55], v[172:175], a[212:215], v[52:55]
    v_exp_f32 v31, v31
    v_mfma_f32_16x16x32_bf16 v[56:59], v[172:175], a[228:231], v[56:59]
    v_cvt_pk_bf16_f32 v148, v4, v5
    v_cvt_pk_bf16_f32 v149, v6, v7
    v_mfma_f32_16x16x32_bf16 v[60:63], v[172:175], a[244:247], v[60:63]
    ds_read_b128 v[168:171], v192 offset:30464
    v_cvt_pk_bf16_f32 v150, v28, v29
    v_mfma_f32_16x16x32_bf16 v[64:67], v[172:175], v[204:207], v[64:67]
    v_cvt_pk_bf16_f32 v151, v30, v31
    v_cvt_pk_bf16_f32 v152, v8, v9
    v_mfma_f32_16x16x32_bf16 v[68:71], v[172:175], v[220:223], v[68:71]
    v_cvt_pk_bf16_f32 v153, v10, v11
    s_waitcnt lgkmcnt(2)
    v_mfma_f32_16x16x32_bf16 v[48:51], v[176:179], a[200:203], v[48:51]
    v_exp_f32 v32, v32
    v_mfma_f32_16x16x32_bf16 v[52:55], v[176:179], a[216:219], v[52:55]
    s_waitcnt vmcnt(4)
    v_mfma_f32_16x16x32_bf16 v[56:59], v[176:179], a[232:235], v[56:59]
    buffer_load_dwordx4 v197, s[8:11], s29 offen offset:1024 nt lds
    v_mfma_f32_16x16x32_bf16 v[60:63], v[176:179], a[248:251], v[60:63]
    ds_read_b128 v[172:175], v192 offset:30528
    s_add_u32 m0, s42, 128
    v_mfma_f32_16x16x32_bf16 v[64:67], v[176:179], v[208:211], v[64:67]
    v_exp_f32 v33, v33
    v_mfma_f32_16x16x32_bf16 v[68:71], v[176:179], v[224:227], v[68:71]
    v_cvt_pk_bf16_f32 v154, v32, v33
    s_waitcnt lgkmcnt(2)
    v_mfma_f32_16x16x32_bf16 v[48:51], v[180:183], a[204:207], v[48:51]
    v_exp_f32 v34, v34
    v_mfma_f32_16x16x32_bf16 v[52:55], v[180:183], a[220:223], v[52:55]
    v_exp_f32 v35, v35
    v_mfma_f32_16x16x32_bf16 v[56:59], v[180:183], a[236:239], v[56:59]
    v_cvt_pk_bf16_f32 v155, v34, v35
    v_cvt_pk_bf16_f32 v156, v12, v13
    v_mfma_f32_16x16x32_bf16 v[60:63], v[180:183], a[252:255], v[60:63]
    ds_read_b128 v[176:179], v192 offset:30592
    v_cvt_pk_bf16_f32 v157, v14, v15
    v_mfma_f32_16x16x32_bf16 v[64:67], v[180:183], v[212:215], v[64:67]
    v_exp_f32 v36, v36
    v_mfma_f32_16x16x32_bf16 v[68:71], v[180:183], v[228:231], v[68:71]
    s_waitcnt lgkmcnt(2)
    v_mfma_f32_16x16x32_bf16 v[72:75], v[168:171], a[192:195], v[96:99]
    s_waitcnt vmcnt(4)
    v_mfma_f32_16x16x32_bf16 v[76:79], v[168:171], a[208:211], v[100:103]
    buffer_load_dwordx4 v197, s[8:11], s29 offen offset:2048 nt lds
    v_mfma_f32_16x16x32_bf16 v[80:83], v[168:171], a[224:227], v[104:107]
    s_add_u32 m0, s42, 192
    v_mfma_f32_16x16x32_bf16 v[84:87], v[168:171], a[240:243], v[108:111]
    ds_read_b128 v[180:183], v192 offset:30656
    v_mfma_f32_16x16x32_bf16 v[88:91], v[168:171], v[200:203], v[112:115]
    v_exp_f32 v37, v37
    v_mfma_f32_16x16x32_bf16 v[92:95], v[168:171], v[216:219], v[116:119]
    v_cvt_pk_bf16_f32 v158, v36, v37
    s_waitcnt lgkmcnt(2)
    v_mfma_f32_16x16x32_bf16 v[72:75], v[172:175], a[196:199], v[72:75]
    v_exp_f32 v38, v38
    v_mfma_f32_16x16x32_bf16 v[76:79], v[172:175], a[212:215], v[76:79]
    v_exp_f32 v39, v39
    v_mfma_f32_16x16x32_bf16 v[80:83], v[172:175], a[228:231], v[80:83]
    v_cvt_pk_bf16_f32 v159, v38, v39
    v_cvt_pk_bf16_f32 v160, v16, v17
    v_mfma_f32_16x16x32_bf16 v[84:87], v[172:175], a[244:247], v[84:87]
    ds_read_b64_tr_b16 v[168:169], v193 offset:17408
    ds_read_b64_tr_b16 v[170:171], v193 offset:21760
    v_mfma_f32_16x16x32_bf16 v[88:91], v[172:175], v[204:207], v[88:91]
    v_exp_f32 v40, v40
    v_mfma_f32_16x16x32_bf16 v[92:95], v[172:175], v[220:223], v[92:95]
    s_waitcnt vmcnt(4)
    s_waitcnt lgkmcnt(3)
    v_mfma_f32_16x16x32_bf16 v[72:75], v[176:179], a[200:203], v[72:75]
    buffer_load_dwordx4 v197, s[8:11], s29 offen offset:3072 nt lds
    v_mfma_f32_16x16x32_bf16 v[76:79], v[176:179], a[216:219], v[76:79]
    s_add_u32 m0, s42, 4352
    v_cvt_pk_bf16_f32 v161, v18, v19
    v_mfma_f32_16x16x32_bf16 v[80:83], v[176:179], a[232:235], v[80:83]
    v_exp_f32 v41, v41
    v_mfma_f32_16x16x32_bf16 v[84:87], v[176:179], a[248:251], v[84:87]
    v_exp_f32 v42, v42
    v_mfma_f32_16x16x32_bf16 v[88:91], v[176:179], v[208:211], v[88:91]
    ds_read_b64_tr_b16 v[172:173], v194 offset:17408
    ds_read_b64_tr_b16 v[174:175], v194 offset:21760
    v_mfma_f32_16x16x32_bf16 v[92:95], v[176:179], v[224:227], v[92:95]
    v_cvt_pk_bf16_f32 v162, v40, v41
    s_waitcnt lgkmcnt(4)
    v_mfma_f32_16x16x32_bf16 v[72:75], v[180:183], a[204:207], v[72:75]
    v_exp_f32 v43, v43
    v_mfma_f32_16x16x32_bf16 v[76:79], v[180:183], a[220:223], v[76:79]
    v_cvt_pk_bf16_f32 v163, v42, v43
    v_cvt_pk_bf16_f32 v164, v20, v21
    v_mfma_f32_16x16x32_bf16 v[80:83], v[180:183], a[236:239], v[80:83]
    v_exp_f32 v44, v44
    v_mfma_f32_16x16x32_bf16 v[84:87], v[180:183], a[252:255], v[84:87]
    v_exp_f32 v45, v45
    v_mfma_f32_16x16x32_bf16 v[88:91], v[180:183], v[212:215], v[88:91]
    v_exp_f32 v46, v46
    v_mfma_f32_16x16x32_bf16 v[92:95], v[180:183], v[228:231], v[92:95]
    v_cvt_pk_bf16_f32 v165, v22, v23
    s_waitcnt lgkmcnt(2)
    v_mfma_f32_16x16x32_bf16 a[0:3], v[168:171], v[144:147], a[0:3]
    v_exp_f32 v47, v47
    v_mfma_f32_16x16x32_bf16 a[4:7], v[168:171], v[148:151], a[4:7]
    v_cvt_pk_bf16_f32 v166, v44, v45
    v_cvt_pk_bf16_f32 v167, v46, v47
    v_mfma_f32_16x16x32_bf16 a[8:11], v[168:171], v[152:155], a[8:11]
    ds_read_b64_tr_b16 v[176:177], v193 offset:17472
    ds_read_b64_tr_b16 v[178:179], v193 offset:21824
    v_mfma_f32_16x16x32_bf16 a[12:15], v[168:171], v[156:159], a[12:15]
    s_waitcnt vmcnt(4)
    v_mfma_f32_16x16x32_bf16 a[16:19], v[168:171], v[160:163], a[16:19]
    buffer_load_dwordx4 v197, s[8:11], s30 offen nt lds
    v_mfma_f32_16x16x32_bf16 a[20:23], v[168:171], v[164:167], a[20:23]
    s_add_u32 m0, s42, 4416
    v_mfma_f32_16x16x32_bf16 v[120:123], v[184:187], v[144:147], v[120:123]
    s_waitcnt lgkmcnt(2)
    v_mfma_f32_16x16x32_bf16 a[24:27], v[172:175], v[144:147], a[24:27]
    ds_read_b64_tr_b16 v[180:181], v194 offset:17472
    ds_read_b64_tr_b16 v[182:183], v194 offset:21824
    v_mfma_f32_16x16x32_bf16 a[28:31], v[172:175], v[148:151], a[28:31]
    v_exp_f32 v48, v48
    v_mfma_f32_16x16x32_bf16 a[32:35], v[172:175], v[152:155], a[32:35]
    s_waitcnt vmcnt(4)
    v_mfma_f32_16x16x32_bf16 a[36:39], v[172:175], v[156:159], a[36:39]
    buffer_load_dwordx4 v197, s[8:11], s30 offen offset:1024 nt lds
    v_mfma_f32_16x16x32_bf16 a[40:43], v[172:175], v[160:163], a[40:43]
    s_add_u32 m0, s42, 4480
    v_mfma_f32_16x16x32_bf16 a[44:47], v[172:175], v[164:167], a[44:47]
    v_exp_f32 v49, v49
    v_mfma_f32_16x16x32_bf16 v[124:127], v[184:187], v[148:151], v[124:127]
    s_waitcnt lgkmcnt(2)
    v_mfma_f32_16x16x32_bf16 a[48:51], v[176:179], v[144:147], a[48:51]
    ds_read_b64_tr_b16 v[168:169], v195 offset:17408
    ds_read_b64_tr_b16 v[170:171], v195 offset:21760
    v_mfma_f32_16x16x32_bf16 a[52:55], v[176:179], v[148:151], a[52:55]
    v_exp_f32 v50, v50
    v_mfma_f32_16x16x32_bf16 a[56:59], v[176:179], v[152:155], a[56:59]
    v_exp_f32 v51, v51
    v_mfma_f32_16x16x32_bf16 a[60:63], v[176:179], v[156:159], a[60:63]
    v_exp_f32 v52, v52
    v_mfma_f32_16x16x32_bf16 a[64:67], v[176:179], v[160:163], a[64:67]
    v_exp_f32 v53, v53
    v_mfma_f32_16x16x32_bf16 a[68:71], v[176:179], v[164:167], a[68:71]
    v_exp_f32 v54, v54
    v_mfma_f32_16x16x32_bf16 v[128:131], v[184:187], v[152:155], v[128:131]
    s_waitcnt vmcnt(4)
    s_waitcnt lgkmcnt(2)
    v_mfma_f32_16x16x32_bf16 a[72:75], v[180:183], v[144:147], a[72:75]
    ds_read_b64_tr_b16 v[172:173], v196 offset:17408
    ds_read_b64_tr_b16 v[174:175], v196 offset:21760
    v_mfma_f32_16x16x32_bf16 a[76:79], v[180:183], v[148:151], a[76:79]
    buffer_load_dwordx4 v197, s[8:11], s30 offen offset:2048 nt lds
    v_mfma_f32_16x16x32_bf16 a[80:83], v[180:183], v[152:155], a[80:83]
    s_add_u32 m0, s42, 4544
    v_mfma_f32_16x16x32_bf16 a[84:87], v[180:183], v[156:159], a[84:87]
    v_exp_f32 v55, v55
    v_mfma_f32_16x16x32_bf16 a[88:91], v[180:183], v[160:163], a[88:91]
    v_exp_f32 v56, v56
    v_mfma_f32_16x16x32_bf16 a[92:95], v[180:183], v[164:167], a[92:95]
    v_exp_f32 v57, v57
    v_mfma_f32_16x16x32_bf16 v[132:135], v[184:187], v[156:159], v[132:135]
    s_waitcnt lgkmcnt(2)
    v_mfma_f32_16x16x32_bf16 a[96:99], v[168:171], v[144:147], a[96:99]
    ds_read_b64_tr_b16 v[176:177], v195 offset:17472
    ds_read_b64_tr_b16 v[178:179], v195 offset:21824
    v_mfma_f32_16x16x32_bf16 a[100:103], v[168:171], v[148:151], a[100:103]
    v_exp_f32 v58, v58
    v_mfma_f32_16x16x32_bf16 a[104:107], v[168:171], v[152:155], a[104:107]
    v_exp_f32 v59, v59
    v_mfma_f32_16x16x32_bf16 a[108:111], v[168:171], v[156:159], a[108:111]
    s_waitcnt vmcnt(4)
    v_mfma_f32_16x16x32_bf16 a[112:115], v[168:171], v[160:163], a[112:115]
    buffer_load_dwordx4 v197, s[8:11], s30 offen offset:3072 nt lds
    v_mfma_f32_16x16x32_bf16 a[116:119], v[168:171], v[164:167], a[116:119]
    ds_read_b64_tr_b16 v[180:181], v196 offset:17472
    ds_read_b64_tr_b16 v[182:183], v196 offset:21824
    v_mfma_f32_16x16x32_bf16 v[136:139], v[184:187], v[160:163], v[136:139]
    s_waitcnt lgkmcnt(4)
    v_mfma_f32_16x16x32_bf16 a[120:123], v[172:175], v[144:147], a[120:123]
    v_exp_f32 v60, v60
    v_mfma_f32_16x16x32_bf16 a[124:127], v[172:175], v[148:151], a[124:127]
    v_exp_f32 v61, v61
    v_mfma_f32_16x16x32_bf16 a[128:131], v[172:175], v[152:155], a[128:131]
    v_exp_f32 v62, v62
    v_mfma_f32_16x16x32_bf16 a[132:135], v[172:175], v[156:159], a[132:135]
    v_exp_f32 v63, v63
    v_mfma_f32_16x16x32_bf16 a[136:139], v[172:175], v[160:163], a[136:139]
    ds_read_b128 v[168:171], v192 offset:0
    v_mfma_f32_16x16x32_bf16 a[140:143], v[172:175], v[164:167], a[140:143]
    s_add_u32 s29, s29, 8192
    s_and_b32 s29, s29, 0x3ffff
    v_mfma_f32_16x16x32_bf16 v[140:143], v[184:187], v[164:167], v[140:143]
    s_add_u32 s30, s29, 4096
    s_waitcnt lgkmcnt(3)
    v_mfma_f32_16x16x32_bf16 a[144:147], v[176:179], v[144:147], a[144:147]
    v_exp_f32 v64, v64
    v_mfma_f32_16x16x32_bf16 a[148:151], v[176:179], v[148:151], a[148:151]
    v_exp_f32 v65, v65
    v_mfma_f32_16x16x32_bf16 a[152:155], v[176:179], v[152:155], a[152:155]
    v_exp_f32 v66, v66
    v_mfma_f32_16x16x32_bf16 a[156:159], v[176:179], v[156:159], a[156:159]
    ds_read_b128 v[172:175], v192 offset:64
    v_mfma_f32_16x16x32_bf16 a[160:163], v[176:179], v[160:163], a[160:163]
    v_exp_f32 v67, v67
    v_mfma_f32_16x16x32_bf16 a[164:167], v[176:179], v[164:167], a[164:167]
    s_waitcnt lgkmcnt(2)
    v_mfma_f32_16x16x32_bf16 a[168:171], v[180:183], v[144:147], a[168:171]
    s_waitcnt vmcnt(8)
    s_barrier
    v_mfma_f32_16x16x32_bf16 a[172:175], v[180:183], v[148:151], a[172:175]
    v_exp_f32 v68, v68
    v_mfma_f32_16x16x32_bf16 a[176:179], v[180:183], v[152:155], a[176:179]
    v_exp_f32 v69, v69
    v_mfma_f32_16x16x32_bf16 a[180:183], v[180:183], v[156:159], a[180:183]
    v_exp_f32 v70, v70
    v_mfma_f32_16x16x32_bf16 a[184:187], v[180:183], v[160:163], a[184:187]
    v_exp_f32 v71, v71
    v_mfma_f32_16x16x32_bf16 a[188:191], v[180:183], v[164:167], a[188:191]
    v_exp_f32 v72, v72
    v_exp_f32 v73, v73
    v_exp_f32 v74, v74
    v_exp_f32 v75, v75
    v_exp_f32 v76, v76
    v_exp_f32 v77, v77
    s_waitcnt lgkmcnt(1)
    v_mfma_f32_16x16x32_bf16 v[0:3], v[168:171], a[192:195], v[96:99]
    s_add_u32 m0, s43, 0
    ds_read_b128 v[176:179], v192 offset:128
    v_mfma_f32_16x16x32_bf16 v[4:7], v[168:171], a[208:211], v[100:103]
    v_cvt_pk_bf16_f32 v144, v48, v49
    v_cvt_pk_bf16_f32 v145, v50, v51
    v_mfma_f32_16x16x32_bf16 v[8:11], v[168:171], a[224:227], v[104:107]
    s_waitcnt vmcnt(4)
    v_cvt_pk_bf16_f32 v146, v72, v73
    v_mfma_f32_16x16x32_bf16 v[12:15], v[168:171], a[240:243], v[108:111]
    ds_read_b128 v[180:183], v192 offset:192
    v_cvt_pk_bf16_f32 v147, v74, v75
    v_mfma_f32_16x16x32_bf16 v[16:19], v[168:171], v[200:203], v[112:115]
    buffer_load_dwordx4 v197, s[8:11], s29 offen nt lds
    v_mfma_f32_16x16x32_bf16 v[20:23], v[168:171], v[216:219], v[116:119]
    s_add_u32 m0, s43, 64
    s_waitcnt lgkmcnt(2)
    v_mfma_f32_16x16x32_bf16 v[0:3], v[172:175], a[196:199], v[0:3]
    v_exp_f32 v78, v78
    v_mfma_f32_16x16x32_bf16 v[4:7], v[172:175], a[212:215], v[4:7]
    v_exp_f32 v79, v79
    v_mfma_f32_16x16x32_bf16 v[8:11], v[172:175], a[228:231], v[8:11]
    v_cvt_pk_bf16_f32 v148, v52, v53
    v_cvt_pk_bf16_f32 v149, v54, v55
    v_mfma_f32_16x16x32_bf16 v[12:15], v[172:175], a[244:247], v[12:15]
    ds_read_b128 v[168:171], v192 offset:4352
    v_cvt_pk_bf16_f32 v150, v76, v77
    v_mfma_f32_16x16x32_bf16 v[16:19], v[172:175], v[204:207], v[16:19]
    v_cvt_pk_bf16_f32 v151, v78, v79
    v_cvt_pk_bf16_f32 v152, v56, v57
    v_mfma_f32_16x16x32_bf16 v[20:23], v[172:175], v[220:223], v[20:23]
    v_cvt_pk_bf16_f32 v153, v58, v59
    s_waitcnt lgkmcnt(2)
    v_mfma_f32_16x16x32_bf16 v[0:3], v[176:179], a[200:203], v[0:3]
    v_exp_f32 v80, v80
    v_mfma_f32_16x16x32_bf16 v[4:7], v[176:179], a[216:219], v[4:7]
    s_waitcnt vmcnt(4)
    v_mfma_f32_16x16x32_bf16 v[8:11], v[176:179], a[232:235], v[8:11]
    buffer_load_dwordx4 v197, s[8:11], s29 offen offset:1024 nt lds
    v_mfma_f32_16x16x32_bf16 v[12:15], v[176:179], a[248:251], v[12:15]
    ds_read_b128 v[172:175], v192 offset:4416
    s_add_u32 m0, s43, 128
    v_mfma_f32_16x16x32_bf16 v[16:19], v[176:179], v[208:211], v[16:19]
    v_exp_f32 v81, v81
    v_mfma_f32_16x16x32_bf16 v[20:23], v[176:179], v[224:227], v[20:23]
    v_cvt_pk_bf16_f32 v154, v80, v81
    s_waitcnt lgkmcnt(2)
    v_mfma_f32_16x16x32_bf16 v[0:3], v[180:183], a[204:207], v[0:3]
    v_exp_f32 v82, v82
    v_mfma_f32_16x16x32_bf16 v[4:7], v[180:183], a[220:223], v[4:7]
    v_exp_f32 v83, v83
    v_mfma_f32_16x16x32_bf16 v[8:11], v[180:183], a[236:239], v[8:11]
    v_cvt_pk_bf16_f32 v155, v82, v83
    v_cvt_pk_bf16_f32 v156, v60, v61
    v_mfma_f32_16x16x32_bf16 v[12:15], v[180:183], a[252:255], v[12:15]
    ds_read_b128 v[176:179], v192 offset:4480
    v_cvt_pk_bf16_f32 v157, v62, v63
    v_mfma_f32_16x16x32_bf16 v[16:19], v[180:183], v[212:215], v[16:19]
    v_exp_f32 v84, v84
    v_mfma_f32_16x16x32_bf16 v[20:23], v[180:183], v[228:231], v[20:23]
    s_waitcnt lgkmcnt(2)
    v_mfma_f32_16x16x32_bf16 v[24:27], v[168:171], a[192:195], v[96:99]
    s_waitcnt vmcnt(4)
    v_mfma_f32_16x16x32_bf16 v[28:31], v[168:171], a[208:211], v[100:103]
    buffer_load_dwordx4 v197, s[8:11], s29 offen offset:2048 nt lds
    v_mfma_f32_16x16x32_bf16 v[32:35], v[168:171], a[224:227], v[104:107]
    s_add_u32 m0, s43, 192
    v_mfma_f32_16x16x32_bf16 v[36:39], v[168:171], a[240:243], v[108:111]
    ds_read_b128 v[180:183], v192 offset:4544
    v_mfma_f32_16x16x32_bf16 v[40:43], v[168:171], v[200:203], v[112:115]
    v_exp_f32 v85, v85
    v_mfma_f32_16x16x32_bf16 v[44:47], v[168:171], v[216:219], v[116:119]
    v_cvt_pk_bf16_f32 v158, v84, v85
    s_waitcnt lgkmcnt(2)
    v_mfma_f32_16x16x32_bf16 v[24:27], v[172:175], a[196:199], v[24:27]
    v_exp_f32 v86, v86
    v_mfma_f32_16x16x32_bf16 v[28:31], v[172:175], a[212:215], v[28:31]
    v_exp_f32 v87, v87
    v_mfma_f32_16x16x32_bf16 v[32:35], v[172:175], a[228:231], v[32:35]
    v_cvt_pk_bf16_f32 v159, v86, v87
    v_cvt_pk_bf16_f32 v160, v64, v65
    v_mfma_f32_16x16x32_bf16 v[36:39], v[172:175], a[244:247], v[36:39]
    ds_read_b64_tr_b16 v[168:169], v193 offset:26112
    ds_read_b64_tr_b16 v[170:171], v193 offset:30464
    v_mfma_f32_16x16x32_bf16 v[40:43], v[172:175], v[204:207], v[40:43]
    v_exp_f32 v88, v88
    v_mfma_f32_16x16x32_bf16 v[44:47], v[172:175], v[220:223], v[44:47]
    s_waitcnt vmcnt(4)
    s_waitcnt lgkmcnt(3)
    v_mfma_f32_16x16x32_bf16 v[24:27], v[176:179], a[200:203], v[24:27]
    buffer_load_dwordx4 v197, s[8:11], s29 offen offset:3072 nt lds
    v_mfma_f32_16x16x32_bf16 v[28:31], v[176:179], a[216:219], v[28:31]
    s_add_u32 m0, s43, 4352
    v_cvt_pk_bf16_f32 v161, v66, v67
    v_mfma_f32_16x16x32_bf16 v[32:35], v[176:179], a[232:235], v[32:35]
    v_exp_f32 v89, v89
    v_mfma_f32_16x16x32_bf16 v[36:39], v[176:179], a[248:251], v[36:39]
    v_exp_f32 v90, v90
    v_mfma_f32_16x16x32_bf16 v[40:43], v[176:179], v[208:211], v[40:43]
    ds_read_b64_tr_b16 v[172:173], v194 offset:26112
    ds_read_b64_tr_b16 v[174:175], v194 offset:30464
    v_mfma_f32_16x16x32_bf16 v[44:47], v[176:179], v[224:227], v[44:47]
    v_cvt_pk_bf16_f32 v162, v88, v89
    s_waitcnt lgkmcnt(4)
    v_mfma_f32_16x16x32_bf16 v[24:27], v[180:183], a[204:207], v[24:27]
    v_exp_f32 v91, v91
    v_mfma_f32_16x16x32_bf16 v[28:31], v[180:183], a[220:223], v[28:31]
    v_cvt_pk_bf16_f32 v163, v90, v91
    v_cvt_pk_bf16_f32 v164, v68, v69
    v_mfma_f32_16x16x32_bf16 v[32:35], v[180:183], a[236:239], v[32:35]
    v_exp_f32 v92, v92
    v_mfma_f32_16x16x32_bf16 v[36:39], v[180:183], a[252:255], v[36:39]
    v_exp_f32 v93, v93
    v_mfma_f32_16x16x32_bf16 v[40:43], v[180:183], v[212:215], v[40:43]
    v_exp_f32 v94, v94
    v_mfma_f32_16x16x32_bf16 v[44:47], v[180:183], v[228:231], v[44:47]
    v_cvt_pk_bf16_f32 v165, v70, v71
    s_waitcnt lgkmcnt(2)
    v_mfma_f32_16x16x32_bf16 a[0:3], v[168:171], v[144:147], a[0:3]
    v_exp_f32 v95, v95
    v_mfma_f32_16x16x32_bf16 a[4:7], v[168:171], v[148:151], a[4:7]
    v_cvt_pk_bf16_f32 v166, v92, v93
    v_cvt_pk_bf16_f32 v167, v94, v95
    v_mfma_f32_16x16x32_bf16 a[8:11], v[168:171], v[152:155], a[8:11]
    ds_read_b64_tr_b16 v[176:177], v193 offset:26176
    ds_read_b64_tr_b16 v[178:179], v193 offset:30528
    v_mfma_f32_16x16x32_bf16 a[12:15], v[168:171], v[156:159], a[12:15]
    s_waitcnt vmcnt(4)
    v_mfma_f32_16x16x32_bf16 a[16:19], v[168:171], v[160:163], a[16:19]
    buffer_load_dwordx4 v197, s[8:11], s30 offen nt lds
    v_mfma_f32_16x16x32_bf16 a[20:23], v[168:171], v[164:167], a[20:23]
    s_add_u32 m0, s43, 4416
    v_mfma_f32_16x16x32_bf16 v[120:123], v[184:187], v[144:147], v[120:123]
    s_waitcnt lgkmcnt(2)
    v_mfma_f32_16x16x32_bf16 a[24:27], v[172:175], v[144:147], a[24:27]
    ds_read_b64_tr_b16 v[180:181], v194 offset:26176
    ds_read_b64_tr_b16 v[182:183], v194 offset:30528
    v_mfma_f32_16x16x32_bf16 a[28:31], v[172:175], v[148:151], a[28:31]
    v_exp_f32 v0, v0
    v_mfma_f32_16x16x32_bf16 a[32:35], v[172:175], v[152:155], a[32:35]
    s_waitcnt vmcnt(4)
    v_mfma_f32_16x16x32_bf16 a[36:39], v[172:175], v[156:159], a[36:39]
    buffer_load_dwordx4 v197, s[8:11], s30 offen offset:1024 nt lds
    v_mfma_f32_16x16x32_bf16 a[40:43], v[172:175], v[160:163], a[40:43]
    s_add_u32 m0, s43, 4480
    v_mfma_f32_16x16x32_bf16 a[44:47], v[172:175], v[164:167], a[44:47]
    v_exp_f32 v1, v1
    v_mfma_f32_16x16x32_bf16 v[124:127], v[184:187], v[148:151], v[124:127]
    s_waitcnt lgkmcnt(2)
    v_mfma_f32_16x16x32_bf16 a[48:51], v[176:179], v[144:147], a[48:51]
    ds_read_b64_tr_b16 v[168:169], v195 offset:26112
    ds_read_b64_tr_b16 v[170:171], v195 offset:30464
    v_mfma_f32_16x16x32_bf16 a[52:55], v[176:179], v[148:151], a[52:55]
    v_exp_f32 v2, v2
    v_mfma_f32_16x16x32_bf16 a[56:59], v[176:179], v[152:155], a[56:59]
    v_exp_f32 v3, v3
    v_mfma_f32_16x16x32_bf16 a[60:63], v[176:179], v[156:159], a[60:63]
    v_exp_f32 v4, v4
    v_mfma_f32_16x16x32_bf16 a[64:67], v[176:179], v[160:163], a[64:67]
    v_exp_f32 v5, v5
    v_mfma_f32_16x16x32_bf16 a[68:71], v[176:179], v[164:167], a[68:71]
    v_exp_f32 v6, v6
    v_mfma_f32_16x16x32_bf16 v[128:131], v[184:187], v[152:155], v[128:131]
    s_waitcnt vmcnt(4)
    s_waitcnt lgkmcnt(2)
    v_mfma_f32_16x16x32_bf16 a[72:75], v[180:183], v[144:147], a[72:75]
    ds_read_b64_tr_b16 v[172:173], v196 offset:26112
    ds_read_b64_tr_b16 v[174:175], v196 offset:30464
    v_mfma_f32_16x16x32_bf16 a[76:79], v[180:183], v[148:151], a[76:79]
    buffer_load_dwordx4 v197, s[8:11], s30 offen offset:2048 nt lds
    v_mfma_f32_16x16x32_bf16 a[80:83], v[180:183], v[152:155], a[80:83]
    s_add_u32 m0, s43, 4544
    v_mfma_f32_16x16x32_bf16 a[84:87], v[180:183], v[156:159], a[84:87]
    v_exp_f32 v7, v7
    v_mfma_f32_16x16x32_bf16 a[88:91], v[180:183], v[160:163], a[88:91]
    v_exp_f32 v8, v8
    v_mfma_f32_16x16x32_bf16 a[92:95], v[180:183], v[164:167], a[92:95]
    v_exp_f32 v9, v9
    v_mfma_f32_16x16x32_bf16 v[132:135], v[184:187], v[156:159], v[132:135]
    s_waitcnt lgkmcnt(2)
    v_mfma_f32_16x16x32_bf16 a[96:99], v[168:171], v[144:147], a[96:99]
    ds_read_b64_tr_b16 v[176:177], v195 offset:26176
    ds_read_b64_tr_b16 v[178:179], v195 offset:30528
    v_mfma_f32_16x16x32_bf16 a[100:103], v[168:171], v[148:151], a[100:103]
    v_exp_f32 v10, v10
    v_mfma_f32_16x16x32_bf16 a[104:107], v[168:171], v[152:155], a[104:107]
    v_exp_f32 v11, v11
    v_mfma_f32_16x16x32_bf16 a[108:111], v[168:171], v[156:159], a[108:111]
    s_waitcnt vmcnt(4)
    v_mfma_f32_16x16x32_bf16 a[112:115], v[168:171], v[160:163], a[112:115]
    buffer_load_dwordx4 v197, s[8:11], s30 offen offset:3072 nt lds
    v_mfma_f32_16x16x32_bf16 a[116:119], v[168:171], v[164:167], a[116:119]
    ds_read_b64_tr_b16 v[180:181], v196 offset:26176
    ds_read_b64_tr_b16 v[182:183], v196 offset:30528
    v_mfma_f32_16x16x32_bf16 v[136:139], v[184:187], v[160:163], v[136:139]
    s_waitcnt lgkmcnt(4)
    v_mfma_f32_16x16x32_bf16 a[120:123], v[172:175], v[144:147], a[120:123]
    v_exp_f32 v12, v12
    v_mfma_f32_16x16x32_bf16 a[124:127], v[172:175], v[148:151], a[124:127]
    v_exp_f32 v13, v13
    v_mfma_f32_16x16x32_bf16 a[128:131], v[172:175], v[152:155], a[128:131]
    v_exp_f32 v14, v14
    v_mfma_f32_16x16x32_bf16 a[132:135], v[172:175], v[156:159], a[132:135]
    v_exp_f32 v15, v15
    v_mfma_f32_16x16x32_bf16 a[136:139], v[172:175], v[160:163], a[136:139]
    ds_read_b128 v[168:171], v192 offset:8704
    v_mfma_f32_16x16x32_bf16 a[140:143], v[172:175], v[164:167], a[140:143]
    s_add_u32 s29, s29, 8192
    s_and_b32 s29, s29, 0x3ffff
    v_mfma_f32_16x16x32_bf16 v[140:143], v[184:187], v[164:167], v[140:143]
    s_add_u32 s30, s29, 4096
    s_waitcnt lgkmcnt(3)
    v_mfma_f32_16x16x32_bf16 a[144:147], v[176:179], v[144:147], a[144:147]
    v_exp_f32 v16, v16
    v_mfma_f32_16x16x32_bf16 a[148:151], v[176:179], v[148:151], a[148:151]
    v_exp_f32 v17, v17
    v_mfma_f32_16x16x32_bf16 a[152:155], v[176:179], v[152:155], a[152:155]
    v_exp_f32 v18, v18
    v_mfma_f32_16x16x32_bf16 a[156:159], v[176:179], v[156:159], a[156:159]
    ds_read_b128 v[172:175], v192 offset:8768
    v_mfma_f32_16x16x32_bf16 a[160:163], v[176:179], v[160:163], a[160:163]
    v_exp_f32 v19, v19
    v_mfma_f32_16x16x32_bf16 a[164:167], v[176:179], v[164:167], a[164:167]
    s_waitcnt lgkmcnt(2)
    v_mfma_f32_16x16x32_bf16 a[168:171], v[180:183], v[144:147], a[168:171]
    s_waitcnt vmcnt(8)
    s_barrier
    v_mfma_f32_16x16x32_bf16 a[172:175], v[180:183], v[148:151], a[172:175]
    v_exp_f32 v20, v20
    v_mfma_f32_16x16x32_bf16 a[176:179], v[180:183], v[152:155], a[176:179]
    v_exp_f32 v21, v21
    v_mfma_f32_16x16x32_bf16 a[180:183], v[180:183], v[156:159], a[180:183]
    v_exp_f32 v22, v22
    v_mfma_f32_16x16x32_bf16 a[184:187], v[180:183], v[160:163], a[184:187]
    v_exp_f32 v23, v23
    v_mfma_f32_16x16x32_bf16 a[188:191], v[180:183], v[164:167], a[188:191]
    v_exp_f32 v24, v24
    v_exp_f32 v25, v25
    v_exp_f32 v26, v26
    v_exp_f32 v27, v27
    v_exp_f32 v28, v28
    v_exp_f32 v29, v29
    s_waitcnt lgkmcnt(1)
    v_mfma_f32_16x16x32_bf16 v[48:51], v[168:171], a[192:195], v[96:99]
    s_cmp_eq_u32 s32, s84
    s_cselect_b32 s10, 0, s10
    v_mfma_f32_16x16x32_bf16 v[52:55], v[168:171], a[208:211], v[100:103]
    ds_read_b128 v[176:179], v192 offset:8832
    s_add_u32 m0, s40, 0
    v_mfma_f32_16x16x32_bf16 v[56:59], v[168:171], a[224:227], v[104:107]
    s_waitcnt vmcnt(4)
    v_cvt_pk_bf16_f32 v144, v0, v1
    v_mfma_f32_16x16x32_bf16 v[60:63], v[168:171], a[240:243], v[108:111]
    ds_read_b128 v[180:183], v192 offset:8896
    v_cvt_pk_bf16_f32 v145, v2, v3
    v_mfma_f32_16x16x32_bf16 v[64:67], v[168:171], v[200:203], v[112:115]
    buffer_load_dwordx4 v197, s[8:11], s29 offen nt lds
    v_mfma_f32_16x16x32_bf16 v[68:71], v[168:171], v[216:219], v[116:119]
    s_add_u32 m0, s40, 64
    s_waitcnt lgkmcnt(2)
    v_mfma_f32_16x16x32_bf16 v[48:51], v[172:175], a[196:199], v[48:51]
    v_cvt_pk_bf16_f32 v146, v24, v25
    v_cvt_pk_bf16_f32 v147, v26, v27
    v_mfma_f32_16x16x32_bf16 v[52:55], v[172:175], a[212:215], v[52:55]
    v_exp_f32 v30, v30
    v_mfma_f32_16x16x32_bf16 v[56:59], v[172:175], a[228:231], v[56:59]
    v_exp_f32 v31, v31
    v_mfma_f32_16x16x32_bf16 v[60:63], v[172:175], a[244:247], v[60:63]
    ds_read_b128 v[168:171], v192 offset:13056
    v_cvt_pk_bf16_f32 v148, v4, v5
    v_mfma_f32_16x16x32_bf16 v[64:67], v[172:175], v[204:207], v[64:67]
    v_cvt_pk_bf16_f32 v149, v6, v7
    v_cvt_pk_bf16_f32 v150, v28, v29
    v_mfma_f32_16x16x32_bf16 v[68:71], v[172:175], v[220:223], v[68:71]
    v_cvt_pk_bf16_f32 v151, v30, v31
    s_waitcnt lgkmcnt(2)
    v_mfma_f32_16x16x32_bf16 v[48:51], v[176:179], a[200:203], v[48:51]
    v_exp_f32 v32, v32
    v_mfma_f32_16x16x32_bf16 v[52:55], v[176:179], a[216:219], v[52:55]
    s_waitcnt vmcnt(4)
    v_cvt_pk_bf16_f32 v152, v8, v9
    v_mfma_f32_16x16x32_bf16 v[56:59], v[176:179], a[232:235], v[56:59]
    buffer_load_dwordx4 v197, s[8:11], s29 offen offset:1024 nt lds
    v_mfma_f32_16x16x32_bf16 v[60:63], v[176:179], a[248:251], v[60:63]
    ds_read_b128 v[172:175], v192 offset:13120
    s_add_u32 m0, s40, 128
    v_mfma_f32_16x16x32_bf16 v[64:67], v[176:179], v[208:211], v[64:67]
    v_exp_f32 v33, v33
    v_mfma_f32_16x16x32_bf16 v[68:71], v[176:179], v[224:227], v[68:71]
    v_cvt_pk_bf16_f32 v153, v10, v11
    s_waitcnt lgkmcnt(2)
    v_mfma_f32_16x16x32_bf16 v[48:51], v[180:183], a[204:207], v[48:51]
    v_exp_f32 v34, v34
    v_mfma_f32_16x16x32_bf16 v[52:55], v[180:183], a[220:223], v[52:55]
    v_exp_f32 v35, v35
    v_mfma_f32_16x16x32_bf16 v[56:59], v[180:183], a[236:239], v[56:59]
    v_cvt_pk_bf16_f32 v154, v32, v33
    v_cvt_pk_bf16_f32 v155, v34, v35
    v_mfma_f32_16x16x32_bf16 v[60:63], v[180:183], a[252:255], v[60:63]
    ds_read_b128 v[176:179], v192 offset:13184
    v_cvt_pk_bf16_f32 v156, v12, v13
    v_mfma_f32_16x16x32_bf16 v[64:67], v[180:183], v[212:215], v[64:67]
    v_exp_f32 v36, v36
    v_mfma_f32_16x16x32_bf16 v[68:71], v[180:183], v[228:231], v[68:71]
    v_cvt_pk_bf16_f32 v157, v14, v15
    s_waitcnt lgkmcnt(2)
    v_mfma_f32_16x16x32_bf16 v[72:75], v[168:171], a[192:195], v[96:99]
    s_waitcnt vmcnt(4)
    v_mfma_f32_16x16x32_bf16 v[76:79], v[168:171], a[208:211], v[100:103]
    buffer_load_dwordx4 v197, s[8:11], s29 offen offset:2048 nt lds
    v_mfma_f32_16x16x32_bf16 v[80:83], v[168:171], a[224:227], v[104:107]
    s_add_u32 m0, s40, 192
    v_mfma_f32_16x16x32_bf16 v[84:87], v[168:171], a[240:243], v[108:111]
    ds_read_b128 v[180:183], v192 offset:13248
    v_mfma_f32_16x16x32_bf16 v[88:91], v[168:171], v[200:203], v[112:115]
    v_exp_f32 v37, v37
    v_mfma_f32_16x16x32_bf16 v[92:95], v[168:171], v[216:219], v[116:119]
    v_cvt_pk_bf16_f32 v158, v36, v37
    s_waitcnt lgkmcnt(2)
    v_mfma_f32_16x16x32_bf16 v[72:75], v[172:175], a[196:199], v[72:75]
    v_exp_f32 v38, v38
    v_mfma_f32_16x16x32_bf16 v[76:79], v[172:175], a[212:215], v[76:79]
    v_exp_f32 v39, v39
    v_mfma_f32_16x16x32_bf16 v[80:83], v[172:175], a[228:231], v[80:83]
    v_cvt_pk_bf16_f32 v159, v38, v39
    v_cvt_pk_bf16_f32 v160, v16, v17
    v_mfma_f32_16x16x32_bf16 v[84:87], v[172:175], a[244:247], v[84:87]
    ds_read_b64_tr_b16 v[168:169], v193 offset:0
    ds_read_b64_tr_b16 v[170:171], v193 offset:4352
    v_mfma_f32_16x16x32_bf16 v[88:91], v[172:175], v[204:207], v[88:91]
    v_exp_f32 v40, v40
    v_mfma_f32_16x16x32_bf16 v[92:95], v[172:175], v[220:223], v[92:95]
    s_waitcnt vmcnt(4)
    s_waitcnt lgkmcnt(3)
    v_mfma_f32_16x16x32_bf16 v[72:75], v[176:179], a[200:203], v[72:75]
    buffer_load_dwordx4 v197, s[8:11], s29 offen offset:3072 nt lds
    v_mfma_f32_16x16x32_bf16 v[76:79], v[176:179], a[216:219], v[76:79]
    s_add_u32 m0, s40, 4352
    v_cvt_pk_bf16_f32 v161, v18, v19
    v_mfma_f32_16x16x32_bf16 v[80:83], v[176:179], a[232:235], v[80:83]
    v_exp_f32 v41, v41
    v_mfma_f32_16x16x32_bf16 v[84:87], v[176:179], a[248:251], v[84:87]
    v_exp_f32 v42, v42
    v_mfma_f32_16x16x32_bf16 v[88:91], v[176:179], v[208:211], v[88:91]
    ds_read_b64_tr_b16 v[172:173], v194 offset:0
    ds_read_b64_tr_b16 v[174:175], v194 offset:4352
    v_mfma_f32_16x16x32_bf16 v[92:95], v[176:179], v[224:227], v[92:95]
    v_cvt_pk_bf16_f32 v162, v40, v41
    s_waitcnt lgkmcnt(4)
    v_mfma_f32_16x16x32_bf16 v[72:75], v[180:183], a[204:207], v[72:75]
    v_exp_f32 v43, v43
    v_mfma_f32_16x16x32_bf16 v[76:79], v[180:183], a[220:223], v[76:79]
    v_cvt_pk_bf16_f32 v163, v42, v43
    v_cvt_pk_bf16_f32 v164, v20, v21
    v_mfma_f32_16x16x32_bf16 v[80:83], v[180:183], a[236:239], v[80:83]
    v_exp_f32 v44, v44
    v_mfma_f32_16x16x32_bf16 v[84:87], v[180:183], a[252:255], v[84:87]
    v_exp_f32 v45, v45
    v_mfma_f32_16x16x32_bf16 v[88:91], v[180:183], v[212:215], v[88:91]
    v_exp_f32 v46, v46
    v_mfma_f32_16x16x32_bf16 v[92:95], v[180:183], v[228:231], v[92:95]
    v_cvt_pk_bf16_f32 v165, v22, v23
    s_waitcnt lgkmcnt(2)
    v_mfma_f32_16x16x32_bf16 a[0:3], v[168:171], v[144:147], a[0:3]
    v_exp_f32 v47, v47
    v_mfma_f32_16x16x32_bf16 a[4:7], v[168:171], v[148:151], a[4:7]
    v_cvt_pk_bf16_f32 v166, v44, v45
    v_cvt_pk_bf16_f32 v167, v46, v47
    v_mfma_f32_16x16x32_bf16 a[8:11], v[168:171], v[152:155], a[8:11]
    ds_read_b64_tr_b16 v[176:177], v193 offset:64
    ds_read_b64_tr_b16 v[178:179], v193 offset:4416
    v_mfma_f32_16x16x32_bf16 a[12:15], v[168:171], v[156:159], a[12:15]
    s_waitcnt vmcnt(4)
    v_mfma_f32_16x16x32_bf16 a[16:19], v[168:171], v[160:163], a[16:19]
    buffer_load_dwordx4 v197, s[8:11], s30 offen nt lds
    v_mfma_f32_16x16x32_bf16 a[20:23], v[168:171], v[164:167], a[20:23]
    s_add_u32 m0, s40, 4416
    v_mfma_f32_16x16x32_bf16 v[120:123], v[184:187], v[144:147], v[120:123]
    s_waitcnt lgkmcnt(2)
    v_mfma_f32_16x16x32_bf16 a[24:27], v[172:175], v[144:147], a[24:27]
    ds_read_b64_tr_b16 v[180:181], v194 offset:64
    ds_read_b64_tr_b16 v[182:183], v194 offset:4416
    v_mfma_f32_16x16x32_bf16 a[28:31], v[172:175], v[148:151], a[28:31]
    v_exp_f32 v48, v48
    v_mfma_f32_16x16x32_bf16 a[32:35], v[172:175], v[152:155], a[32:35]
    s_waitcnt vmcnt(4)
    v_mfma_f32_16x16x32_bf16 a[36:39], v[172:175], v[156:159], a[36:39]
    buffer_load_dwordx4 v197, s[8:11], s30 offen offset:1024 nt lds
    v_mfma_f32_16x16x32_bf16 a[40:43], v[172:175], v[160:163], a[40:43]
    s_add_u32 m0, s40, 4480
    v_mfma_f32_16x16x32_bf16 a[44:47], v[172:175], v[164:167], a[44:47]
    v_exp_f32 v49, v49
    v_mfma_f32_16x16x32_bf16 v[124:127], v[184:187], v[148:151], v[124:127]
    s_waitcnt lgkmcnt(2)
    v_mfma_f32_16x16x32_bf16 a[48:51], v[176:179], v[144:147], a[48:51]
    ds_read_b64_tr_b16 v[168:169], v195 offset:0
    ds_read_b64_tr_b16 v[170:171], v195 offset:4352
    v_mfma_f32_16x16x32_bf16 a[52:55], v[176:179], v[148:151], a[52:55]
    v_exp_f32 v50, v50
    v_mfma_f32_16x16x32_bf16 a[56:59], v[176:179], v[152:155], a[56:59]
    v_exp_f32 v51, v51
    v_mfma_f32_16x16x32_bf16 a[60:63], v[176:179], v[156:159], a[60:63]
    v_exp_f32 v52, v52
    v_mfma_f32_16x16x32_bf16 a[64:67], v[176:179], v[160:163], a[64:67]
    v_exp_f32 v53, v53
    v_mfma_f32_16x16x32_bf16 a[68:71], v[176:179], v[164:167], a[68:71]
    v_exp_f32 v54, v54
    v_mfma_f32_16x16x32_bf16 v[128:131], v[184:187], v[152:155], v[128:131]
    s_waitcnt vmcnt(4)
    s_waitcnt lgkmcnt(2)
    v_mfma_f32_16x16x32_bf16 a[72:75], v[180:183], v[144:147], a[72:75]
    ds_read_b64_tr_b16 v[172:173], v196 offset:0
    ds_read_b64_tr_b16 v[174:175], v196 offset:4352
    v_mfma_f32_16x16x32_bf16 a[76:79], v[180:183], v[148:151], a[76:79]
    buffer_load_dwordx4 v197, s[8:11], s30 offen offset:2048 nt lds
    v_mfma_f32_16x16x32_bf16 a[80:83], v[180:183], v[152:155], a[80:83]
    s_add_u32 m0, s40, 4544
    v_mfma_f32_16x16x32_bf16 a[84:87], v[180:183], v[156:159], a[84:87]
    v_exp_f32 v55, v55
    v_mfma_f32_16x16x32_bf16 a[88:91], v[180:183], v[160:163], a[88:91]
    v_exp_f32 v56, v56
    v_mfma_f32_16x16x32_bf16 a[92:95], v[180:183], v[164:167], a[92:95]
    v_exp_f32 v57, v57
    v_mfma_f32_16x16x32_bf16 v[132:135], v[184:187], v[156:159], v[132:135]
    s_waitcnt lgkmcnt(2)
    v_mfma_f32_16x16x32_bf16 a[96:99], v[168:171], v[144:147], a[96:99]
    ds_read_b64_tr_b16 v[176:177], v195 offset:64
    ds_read_b64_tr_b16 v[178:179], v195 offset:4416
    v_mfma_f32_16x16x32_bf16 a[100:103], v[168:171], v[148:151], a[100:103]
    v_exp_f32 v58, v58
    v_mfma_f32_16x16x32_bf16 a[104:107], v[168:171], v[152:155], a[104:107]
    v_exp_f32 v59, v59
    v_mfma_f32_16x16x32_bf16 a[108:111], v[168:171], v[156:159], a[108:111]
    s_waitcnt vmcnt(4)
    v_mfma_f32_16x16x32_bf16 a[112:115], v[168:171], v[160:163], a[112:115]
    buffer_load_dwordx4 v197, s[8:11], s30 offen offset:3072 nt lds
    v_mfma_f32_16x16x32_bf16 a[116:119], v[168:171], v[164:167], a[116:119]
    ds_read_b64_tr_b16 v[180:181], v196 offset:64
    ds_read_b64_tr_b16 v[182:183], v196 offset:4416
    v_mfma_f32_16x16x32_bf16 v[136:139], v[184:187], v[160:163], v[136:139]
    s_waitcnt lgkmcnt(4)
    v_mfma_f32_16x16x32_bf16 a[120:123], v[172:175], v[144:147], a[120:123]
    v_exp_f32 v60, v60
    v_mfma_f32_16x16x32_bf16 a[124:127], v[172:175], v[148:151], a[124:127]
    v_exp_f32 v61, v61
    v_mfma_f32_16x16x32_bf16 a[128:131], v[172:175], v[152:155], a[128:131]
    v_exp_f32 v62, v62
    v_mfma_f32_16x16x32_bf16 a[132:135], v[172:175], v[156:159], a[132:135]
    v_exp_f32 v63, v63
    v_mfma_f32_16x16x32_bf16 a[136:139], v[172:175], v[160:163], a[136:139]
    ds_read_b128 v[168:171], v192 offset:17408
    v_mfma_f32_16x16x32_bf16 a[140:143], v[172:175], v[164:167], a[140:143]
    s_add_u32 s29, s29, 8192
    s_and_b32 s29, s29, 0x3ffff
    v_mfma_f32_16x16x32_bf16 v[140:143], v[184:187], v[164:167], v[140:143]
    s_add_u32 s30, s29, 4096
    s_waitcnt lgkmcnt(3)
    v_mfma_f32_16x16x32_bf16 a[144:147], v[176:179], v[144:147], a[144:147]
    v_exp_f32 v64, v64
    v_mfma_f32_16x16x32_bf16 a[148:151], v[176:179], v[148:151], a[148:151]
    v_exp_f32 v65, v65
    v_mfma_f32_16x16x32_bf16 a[152:155], v[176:179], v[152:155], a[152:155]
    v_exp_f32 v66, v66
    v_mfma_f32_16x16x32_bf16 a[156:159], v[176:179], v[156:159], a[156:159]
    ds_read_b128 v[172:175], v192 offset:17472
    v_mfma_f32_16x16x32_bf16 a[160:163], v[176:179], v[160:163], a[160:163]
    v_exp_f32 v67, v67
    v_mfma_f32_16x16x32_bf16 a[164:167], v[176:179], v[164:167], a[164:167]
    s_waitcnt lgkmcnt(2)
    v_mfma_f32_16x16x32_bf16 a[168:171], v[180:183], v[144:147], a[168:171]
    s_waitcnt vmcnt(8)
    s_barrier
    v_mfma_f32_16x16x32_bf16 a[172:175], v[180:183], v[148:151], a[172:175]
    v_exp_f32 v68, v68
    v_mfma_f32_16x16x32_bf16 a[176:179], v[180:183], v[152:155], a[176:179]
    v_exp_f32 v69, v69
    v_mfma_f32_16x16x32_bf16 a[180:183], v[180:183], v[156:159], a[180:183]
    v_exp_f32 v70, v70
    v_mfma_f32_16x16x32_bf16 a[184:187], v[180:183], v[160:163], a[184:187]
    v_exp_f32 v71, v71
    v_mfma_f32_16x16x32_bf16 a[188:191], v[180:183], v[164:167], a[188:191]
    v_exp_f32 v72, v72
    v_exp_f32 v73, v73
    v_exp_f32 v74, v74
    v_exp_f32 v75, v75
    v_exp_f32 v76, v76
    v_exp_f32 v77, v77
    s_sub_u32 s32, s32, 1
    s_cmp_lg_u32 s32, 2
    s_cbranch_scc1 L_loopf1
.p2align 3
L_loopf2:
    s_waitcnt lgkmcnt(1)
    v_mfma_f32_16x16x32_bf16 v[0:3], v[168:171], a[192:195], v[96:99]
    s_add_u32 m0, s41, 0
    ds_read_b128 v[176:179], v192 offset:17536
    v_mfma_f32_16x16x32_bf16 v[4:7], v[168:171], a[208:211], v[100:103]
    v_cvt_pk_bf16_f32 v144, v48, v49
    v_cvt_pk_bf16_f32 v145, v50, v51
    v_mfma_f32_16x16x32_bf16 v[8:11], v[168:171], a[224:227], v[104:107]
    s_waitcnt vmcnt(5)
    v_cvt_pk_bf16_f32 v146, v72, v73
    v_mfma_f32_16x16x32_bf16 v[12:15], v[168:171], a[240:243], v[108:111]
    ds_read_b128 v[180:183], v192 offset:17600
    v_cvt_pk_bf16_f32 v147, v74, v75
    v_mfma_f32_16x16x32_bf16 v[16:19], v[168:171], v[200:203], v[112:115]
    buffer_load_dwordx4 v197, s[8:11], s29 offen nt lds
    v_mfma_f32_16x16x32_bf16 v[20:23], v[168:171], v[216:219], v[116:119]
    s_add_u32 m0, s41, 64
    s_waitcnt lgkmcnt(2)
    v_mfma_f32_16x16x32_bf16 v[0:3], v[172:175], a[196:199], v[0:3]
    v_exp_f32 v78, v78
    v_mfma_f32_16x16x32_bf16 v[4:7], v[172:175], a[212:215], v[4:7]
    v_exp_f32 v79, v79
    v_mfma_f32_16x16x32_bf16 v[8:11], v[172:175], a[228:231], v[8:11]
    v_cvt_pk_bf16_f32 v148, v52, v53
    v_cvt_pk_bf16_f32 v149, v54, v55
    v_mfma_f32_16x16x32_bf16 v[12:15], v[172:175], a[244:247], v[12:15]
    ds_read_b128 v[168:171], v192 offset:21760
    v_cvt_pk_bf16_f32 v150, v76, v77
    v_mfma_f32_16x16x32_bf16 v[16:19], v[172:175], v[204:207], v[16:19]
    v_cvt_pk_bf16_f32 v151, v78, v79
    v_cvt_pk_bf16_f32 v152, v56, v57
    v_mfma_f32_16x16x32_bf16 v[20:23], v[172:175], v[220:223], v[20:23]
    v_cvt_pk_bf16_f32 v153, v58, v59
    s_waitcnt lgkmcnt(2)
    v_mfma_f32_16x16x32_bf16 v[0:3], v[176:179], a[200:203], v[0:3]
    v_exp_f32 v80, v80
    v_mfma_f32_16x16x32_bf16 v[4:7], v[176:179], a[216:219], v[4:7]
    s_waitcnt vmcnt(5)
    v_mfma_f32_16x16x32_bf16 v[8:11], v[176:179], a[232:235], v[8:11]
    buffer_load_dwordx4 v197, s[8:11], s29 offen offset:1024 nt lds
    v_mfma_f32_16x16x32_bf16 v[12:15], v[176:179], a[248:251], v[12:15]
    ds_read_b128 v[172:175], v192 offset:21824
    s_add_u32 m0, s41, 128
    v_mfma_f32_16x16x32_bf16 v[16:19], v[176:179], v[208:211], v[16:19]
    v_exp_f32 v81, v81
    v_mfma_f32_16x16x32_bf16 v[20:23], v[176:179], v[224:227], v[20:23]
    v_cvt_pk_bf16_f32 v154, v80, v81
    s_waitcnt lgkmcnt(2)
    v_mfma_f32_16x16x32_bf16 v[0:3], v[180:183], a[204:207], v[0:3]
    v_exp_f32 v82, v82
    v_mfma_f32_16x16x32_bf16 v[4:7], v[180:183], a[220:223], v[4:7]
    v_exp_f32 v83, v83
    v_mfma_f32_16x16x32_bf16 v[8:11], v[180:183], a[236:239], v[8:11]
    v_cvt_pk_bf16_f32 v155, v82, v83
    v_cvt_pk_bf16_f32 v156, v60, v61
    v_mfma_f32_16x16x32_bf16 v[12:15], v[180:183], a[252:255], v[12:15]
    ds_read_b128 v[176:179], v192 offset:21888
    v_cvt_pk_bf16_f32 v157, v62, v63
    v_mfma_f32_16x16x32_bf16 v[16:19], v[180:183], v[212:215], v[16:19]
    v_exp_f32 v84, v84
    v_mfma_f32_16x16x32_bf16 v[20:23], v[180:183], v[228:231], v[20:23]
    s_waitcnt lgkmcnt(2)
    v_mfma_f32_16x16x32_bf16 v[24:27], v[168:171], a[192:195], v[96:99]
    s_waitcnt vmcnt(5)
    v_mfma_f32_16x16x32_bf16 v[28:31], v[168:171], a[208:211], v[100:103]
    buffer_load_dwordx4 v197, s[8:11], s29 offen offset:2048 nt lds
    v_mfma_f32_16x16x32_bf16 v[32:35], v[168:171], a[224:227], v[104:107]
    s_add_u32 m0, s41, 192
    v_mfma_f32_16x16x32_bf16 v[36:39], v[168:171], a[240:243], v[108:111]
    ds_read_b128 v[180:183], v192 offset:21952
    v_mfma_f32_16x16x32_bf16 v[40:43], v[168:171], v[200:203], v[112:115]
    v_exp_f32 v85, v85
    v_mfma_f32_16x16x32_bf16 v[44:47], v[168:171], v[216:219], v[116:119]
    v_cvt_pk_bf16_f32 v158, v84, v85
    s_waitcnt lgkmcnt(2)
    v_mfma_f32_16x16x32_bf16 v[24:27], v[172:175], a[196:199], v[24:27]
    v_exp_f32 v86, v86
    v_mfma_f32_16x16x32_bf16 v[28:31], v[172:175], a[212:215], v[28:31]
    v_exp_f32 v87, v87
    v_mfma_f32_16x16x32_bf16 v[32:35], v[172:175], a[228:231], v[32:35]
    v_cvt_pk_bf16_f32 v159, v86, v87
    v_cvt_pk_bf16_f32 v160, v64, v65
    v_mfma_f32_16x16x32_bf16 v[36:39], v[172:175], a[244:247], v[36:39]
    ds_read_b64_tr_b16 v[168:169], v193 offset:8704
    ds_read_b64_tr_b16 v[170:171], v193 offset:13056
    v_mfma_f32_16x16x32_bf16 v[40:43], v[172:175], v[204:207], v[40:43]
    v_exp_f32 v88, v88
    v_mfma_f32_16x16x32_bf16 v[44:47], v[172:175], v[220:223], v[44:47]
    s_waitcnt vmcnt(5)
    s_waitcnt lgkmcnt(3)
    v_mfma_f32_16x16x32_bf16 v[24:27], v[176:179], a[200:203], v[24:27]
    buffer_load_dwordx4 v197, s[8:11], s29 offen offset:3072 nt lds
    v_mfma_f32_16x16x32_bf16 v[28:31], v[176:179], a[216:219], v[28:31]
    s_add_u32 m0, s41, 4352
    v_cvt_pk_bf16_f32 v161, v66, v67
    v_mfma_f32_16x16x32_bf16 v[32:35], v[176:179], a[232:235], v[32:35]
    v_exp_f32 v89, v89
    v_mfma_f32_16x16x32_bf16 v[36:39], v[176:179], a[248:251], v[36:39]
    v_exp_f32 v90, v90
    v_mfma_f32_16x16x32_bf16 v[40:43], v[176:179], v[208:211], v[40:43]
    ds_read_b64_tr_b16 v[172:173], v194 offset:8704
    ds_read_b64_tr_b16 v[174:175], v194 offset:13056
    v_mfma_f32_16x16x32_bf16 v[44:47], v[176:179], v[224:227], v[44:47]
    v_cvt_pk_bf16_f32 v162, v88, v89
    s_waitcnt lgkmcnt(4)
    v_mfma_f32_16x16x32_bf16 v[24:27], v[180:183], a[204:207], v[24:27]
    v_exp_f32 v91, v91
    v_mfma_f32_16x16x32_bf16 v[28:31], v[180:183], a[220:223], v[28:31]
    v_cvt_pk_bf16_f32 v163, v90, v91
    v_cvt_pk_bf16_f32 v164, v68, v69
    v_mfma_f32_16x16x32_bf16 v[32:35], v[180:183], a[236:239], v[32:35]
    v_exp_f32 v92, v92
    v_mfma_f32_16x16x32_bf16 v[36:39], v[180:183], a[252:255], v[36:39]
    v_exp_f32 v93, v93
    v_mfma_f32_16x16x32_bf16 v[40:43], v[180:183], v[212:215], v[40:43]
    v_exp_f32 v94, v94
    v_mfma_f32_16x16x32_bf16 v[44:47], v[180:183], v[228:231], v[44:47]
    v_cvt_pk_bf16_f32 v165, v70, v71
    s_waitcnt lgkmcnt(2)
    v_mfma_f32_16x16x32_bf16 a[0:3], v[168:171], v[144:147], a[0:3]
    v_exp_f32 v95, v95
    v_mfma_f32_16x16x32_bf16 a[4:7], v[168:171], v[148:151], a[4:7]
    v_cvt_pk_bf16_f32 v166, v92, v93
    v_cvt_pk_bf16_f32 v167, v94, v95
    v_mfma_f32_16x16x32_bf16 a[8:11], v[168:171], v[152:155], a[8:11]
    ds_read_b64_tr_b16 v[176:177], v193 offset:8768
    ds_read_b64_tr_b16 v[178:179], v193 offset:13120
    v_mfma_f32_16x16x32_bf16 a[12:15], v[168:171], v[156:159], a[12:15]
    s_waitcnt vmcnt(5)
    v_mfma_f32_16x16x32_bf16 a[16:19], v[168:171], v[160:163], a[16:19]
    buffer_load_dwordx4 v197, s[8:11], s30 offen nt lds
    v_mfma_f32_16x16x32_bf16 a[20:23], v[168:171], v[164:167], a[20:23]
    s_add_u32 m0, s41, 4416
    v_mfma_f32_16x16x32_bf16 v[120:123], v[184:187], v[144:147], v[120:123]
    s_waitcnt lgkmcnt(2)
    v_mfma_f32_16x16x32_bf16 a[24:27], v[172:175], v[144:147], a[24:27]
    ds_read_b64_tr_b16 v[180:181], v194 offset:8768
    ds_read_b64_tr_b16 v[182:183], v194 offset:13120
    v_mfma_f32_16x16x32_bf16 a[28:31], v[172:175], v[148:151], a[28:31]
    v_exp_f32 v0, v0
    v_mfma_f32_16x16x32_bf16 a[32:35], v[172:175], v[152:155], a[32:35]
    s_waitcnt vmcnt(5)
    v_mfma_f32_16x16x32_bf16 a[36:39], v[172:175], v[156:159], a[36:39]
    buffer_load_dwordx4 v197, s[8:11], s30 offen offset:1024 nt lds
    v_mfma_f32_16x16x32_bf16 a[40:43], v[172:175], v[160:163], a[40:43]
    s_add_u32 m0, s41, 4480
    v_mfma_f32_16x16x32_bf16 a[44:47], v[172:175], v[164:167], a[44:47]
    v_exp_f32 v1, v1
    v_mfma_f32_16x16x32_bf16 v[124:127], v[184:187], v[148:151], v[124:127]
    s_waitcnt lgkmcnt(2)
    v_mfma_f32_16x16x32_bf16 a[48:51], v[176:179], v[144:147], a[48:51]
    ds_read_b64_tr_b16 v[168:169], v195 offset:8704
    ds_read_b64_tr_b16 v[170:171], v195 offset:13056
    v_mfma_f32_16x16x32_bf16 a[52:55], v[176:179], v[148:151], a[52:55]
    v_exp_f32 v2, v2
    v_mfma_f32_16x16x32_bf16 a[56:59], v[176:179], v[152:155], a[56:59]
    v_exp_f32 v3, v3
    v_mfma_f32_16x16x32_bf16 a[60:63], v[176:179], v[156:159], a[60:63]
    v_exp_f32 v4, v4
    v_mfma_f32_16x16x32_bf16 a[64:67], v[176:179], v[160:163], a[64:67]
    v_exp_f32 v5, v5
    v_mfma_f32_16x16x32_bf16 a[68:71], v[176:179], v[164:167], a[68:71]
    v_exp_f32 v6, v6
    v_mfma_f32_16x16x32_bf16 v[128:131], v[184:187], v[152:155], v[128:131]
    s_waitcnt vmcnt(5)
    s_waitcnt lgkmcnt(2)
    v_mfma_f32_16x16x32_bf16 a[72:75], v[180:183], v[144:147], a[72:75]
    ds_read_b64_tr_b16 v[172:173], v196 offset:8704
    ds_read_b64_tr_b16 v[174:175], v196 offset:13056
    v_mfma_f32_16x16x32_bf16 a[76:79], v[180:183], v[148:151], a[76:79]
    buffer_load_dwordx4 v197, s[8:11], s30 offen offset:2048 nt lds
    v_mfma_f32_16x16x32_bf16 a[80:83], v[180:183], v[152:155], a[80:83]
    s_add_u32 m0, s41, 4544
    v_mfma_f32_16x16x32_bf16 a[84:87], v[180:183], v[156:159], a[84:87]
    v_exp_f32 v7, v7
    v_mfma_f32_16x16x32_bf16 a[88:91], v[180:183], v[160:163], a[88:91]
    v_exp_f32 v8, v8
    v_mfma_f32_16x16x32_bf16 a[92:95], v[180:183], v[164:167], a[92:95]
    v_exp_f32 v9, v9
    v_mfma_f32_16x16x32_bf16 v[132:135], v[184:187], v[156:159], v[132:135]
    s_waitcnt lgkmcnt(2)
    v_mfma_f32_16x16x32_bf16 a[96:99], v[168:171], v[144:147], a[96:99]
    ds_read_b64_tr_b16 v[176:177], v195 offset:8768
    ds_read_b64_tr_b16 v[178:179], v195 offset:13120
    v_mfma_f32_16x16x32_bf16 a[100:103], v[168:171], v[148:151], a[100:103]
    v_exp_f32 v10, v10
    v_mfma_f32_16x16x32_bf16 a[104:107], v[168:171], v[152:155], a[104:107]
    v_exp_f32 v11, v11
    v_mfma_f32_16x16x32_bf16 a[108:111], v[168:171], v[156:159], a[108:111]
    s_waitcnt vmcnt(5)
    v_mfma_f32_16x16x32_bf16 a[112:115], v[168:171], v[160:163], a[112:115]
    buffer_load_dwordx4 v197, s[8:11], s30 offen offset:3072 nt lds
    v_mfma_f32_16x16x32_bf16 a[116:119], v[168:171], v[164:167], a[116:119]
    ds_read_b64_tr_b16 v[180:181], v196 offset:8768
    ds_read_b64_tr_b16 v[182:183], v196 offset:13120
    v_mfma_f32_16x16x32_bf16 v[136:139], v[184:187], v[160:163], v[136:139]
    s_waitcnt lgkmcnt(4)
    v_mfma_f32_16x16x32_bf16 a[120:123], v[172:175], v[144:147], a[120:123]
    v_exp_f32 v12, v12
    v_mfma_f32_16x16x32_bf16 a[124:127], v[172:175], v[148:151], a[124:127]
    v_exp_f32 v13, v13
    v_mfma_f32_16x16x32_bf16 a[128:131], v[172:175], v[152:155], a[128:131]
    v_exp_f32 v14, v14
    v_mfma_f32_16x16x32_bf16 a[132:135], v[172:175], v[156:159], a[132:135]
    v_exp_f32 v15, v15
    v_mfma_f32_16x16x32_bf16 a[136:139], v[172:175], v[160:163], a[136:139]
    ds_read_b128 v[168:171], v192 offset:26112
    v_mfma_f32_16x16x32_bf16 a[140:143], v[172:175], v[164:167], a[140:143]
    s_add_u32 s29, s29, 8192
    s_and_b32 s29, s29, 0x3ffff
    v_mfma_f32_16x16x32_bf16 v[140:143], v[184:187], v[164:167], v[140:143]
    s_add_u32 s30, s29, 4096
    s_waitcnt lgkmcnt(3)
    v_mfma_f32_16x16x32_bf16 a[144:147], v[176:179], v[144:147], a[144:147]
    v_exp_f32 v16, v16
    v_mfma_f32_16x16x32_bf16 a[148:151], v[176:179], v[148:151], a[148:151]
    v_exp_f32 v17, v17
    v_mfma_f32_16x16x32_bf16 a[152:155], v[176:179], v[152:155], a[152:155]
    v_exp_f32 v18, v18
    v_mfma_f32_16x16x32_bf16 a[156:159], v[176:179], v[156:159], a[156:159]
    ds_read_b128 v[172:175], v192 offset:26176
    v_mfma_f32_16x16x32_bf16 a[160:163], v[176:179], v[160:163], a[160:163]
    v_exp_f32 v19, v19
    v_mfma_f32_16x16x32_bf16 a[164:167], v[176:179], v[164:167], a[164:167]
    s_waitcnt lgkmcnt(2)
    v_mfma_f32_16x16x32_bf16 a[168:171], v[180:183], v[144:147], a[168:171]
    s_waitcnt vmcnt(8)
    s_barrier
    v_mfma_f32_16x16x32_bf16 a[172:175], v[180:183], v[148:151], a[172:175]
    v_exp_f32 v20, v20
    v_mfma_f32_16x16x32_bf16 a[176:179], v[180:183], v[152:155], a[176:179]
    v_exp_f32 v21, v21
    v_mfma_f32_16x16x32_bf16 a[180:183], v[180:183], v[156:159], a[180:183]
    v_exp_f32 v22, v22
    v_mfma_f32_16x16x32_bf16 a[184:187], v[180:183], v[160:163], a[184:187]
    v_exp_f32 v23, v23
    v_mfma_f32_16x16x32_bf16 a[188:191], v[180:183], v[164:167], a[188:191]
    v_exp_f32 v24, v24
    v_exp_f32 v25, v25
    v_exp_f32 v26, v26
    v_exp_f32 v27, v27
    v_exp_f32 v28, v28
    v_exp_f32 v29, v29
    s_waitcnt lgkmcnt(1)
    v_mfma_f32_16x16x32_bf16 v[48:51], v[168:171], a[192:195], v[96:99]
    s_add_u32 m0, s42, 0
    ds_read_b128 v[176:179], v192 offset:26240
    v_mfma_f32_16x16x32_bf16 v[52:55], v[168:171], a[208:211], v[100:103]
    v_cvt_pk_bf16_f32 v144, v0, v1
    v_cvt_pk_bf16_f32 v145, v2, v3
    v_mfma_f32_16x16x32_bf16 v[56:59], v[168:171], a[224:227], v[104:107]
    s_waitcnt vmcnt(5)
    v_cvt_pk_bf16_f32 v146, v24, v25
    v_mfma_f32_16x16x32_bf16 v[60:63], v[168:171], a[240:243], v[108:111]
    ds_read_b128 v[180:183], v192 offset:26304
    v_cvt_pk_bf16_f32 v147, v26, v27
    v_mfma_f32_16x16x32_bf16 v[64:67], v[168:171], v[200:203], v[112:115]
    buffer_load_dwordx4 v197, s[8:11], s29 offen nt lds
    v_mfma_f32_16x16x32_bf16 v[68:71], v[168:171], v[216:219], v[116:119]
    s_add_u32 m0, s42, 64
    s_waitcnt lgkmcnt(2)
    v_mfma_f32_16x16x32_bf16 v[48:51], v[172:175], a[196:199], v[48:51]
    v_exp_f32 v30, v30
    v_mfma_f32_16x16x32_bf16 v[52:55], v[172:175], a[212:215], v[52:55]
    v_exp_f32 v31, v31
    v_mfma_f32_16x16x32_bf16 v[56:59], v[172:175], a[228:231], v[56:59]
    v_cvt_pk_bf16_f32 v148, v4, v5
    v_cvt_pk_bf16_f32 v149, v6, v7
    v_mfma_f32_16x16x32_bf16 v[60:63], v[172:175], a[244:247], v[60:63]
    ds_read_b128 v[168:171], v192 offset:30464
    v_cvt_pk_bf16_f32 v150, v28, v29
    v_mfma_f32_16x16x32_bf16 v[64:67], v[172:175], v[204:207], v[64:67]
    v_cvt_pk_bf16_f32 v151, v30, v31
    v_cvt_pk_bf16_f32 v152, v8, v9
    v_mfma_f32_16x16x32_bf16 v[68:71], v[172:175], v[220:223], v[68:71]
    v_cvt_pk_bf16_f32 v153, v10, v11
    s_waitcnt lgkmcnt(2)
    v_mfma_f32_16x16x32_bf16 v[48:51], v[176:179], a[200:203], v[48:51]
    v_exp_f32 v32, v32
    v_mfma_f32_16x16x32_bf16 v[52:55], v[176:179], a[216:219], v[52:55]
    s_waitcnt vmcnt(5)
    v_mfma_f32_16x16x32_bf16 v[56:59], v[176:179], a[232:235], v[56:59]
    buffer_load_dwordx4 v197, s[8:11], s29 offen offset:1024 nt lds
    v_mfma_f32_16x16x32_bf16 v[60:63], v[176:179], a[248:251], v[60:63]
    ds_read_b128 v[172:175], v192 offset:30528
    s_add_u32 m0, s42, 128
    v_mfma_f32_16x16x32_bf16 v[64:67], v[176:179], v[208:211], v[64:67]
    v_exp_f32 v33, v33
    v_mfma_f32_16x16x32_bf16 v[68:71], v[176:179], v[224:227], v[68:71]
    v_cvt_pk_bf16_f32 v154, v32, v33
    s_waitcnt lgkmcnt(2)
    v_mfma_f32_16x16x32_bf16 v[48:51], v[180:183], a[204:207], v[48:51]
    v_exp_f32 v34, v34
    v_mfma_f32_16x16x32_bf16 v[52:55], v[180:183], a[220:223], v[52:55]
    v_exp_f32 v35, v35
    v_mfma_f32_16x16x32_bf16 v[56:59], v[180:183], a[236:239], v[56:59]
    v_cvt_pk_bf16_f32 v155, v34, v35
    v_cvt_pk_bf16_f32 v156, v12, v13
    v_mfma_f32_16x16x32_bf16 v[60:63], v[180:183], a[252:255], v[60:63]
    ds_read_b128 v[176:179], v192 offset:30592
    v_cvt_pk_bf16_f32 v157, v14, v15
    v_mfma_f32_16x16x32_bf16 v[64:67], v[180:183], v[212:215], v[64:67]
    v_exp_f32 v36, v36
    v_mfma_f32_16x16x32_bf16 v[68:71], v[180:183], v[228:231], v[68:71]
    s_waitcnt lgkmcnt(2)
    v_mfma_f32_16x16x32_bf16 v[72:75], v[168:171], a[192:195], v[96:99]
    s_waitcnt vmcnt(5)
    v_mfma_f32_16x16x32_bf16 v[76:79], v[168:171], a[208:211], v[100:103]
    buffer_load_dwordx4 v197, s[8:11], s29 offen offset:2048 nt lds
    v_mfma_f32_16x16x32_bf16 v[80:83], v[168:171], a[224:227], v[104:107]
    s_add_u32 m0, s42, 192
    v_mfma_f32_16x16x32_bf16 v[84:87], v[168:171], a[240:243], v[108:111]
    ds_read_b128 v[180:183], v192 offset:30656
    v_mfma_f32_16x16x32_bf16 v[88:91], v[168:171], v[200:203], v[112:115]
    v_exp_f32 v37, v37
    v_mfma_f32_16x16x32_bf16 v[92:95], v[168:171], v[216:219], v[116:119]
    v_cvt_pk_bf16_f32 v158, v36, v37
    s_waitcnt lgkmcnt(2)
    v_mfma_f32_16x16x32_bf16 v[72:75], v[172:175], a[196:199], v[72:75]
    v_exp_f32 v38, v38
    v_mfma_f32_16x16x32_bf16 v[76:79], v[172:175], a[212:215], v[76:79]
    v_exp_f32 v39, v39
    v_mfma_f32_16x16x32_bf16 v[80:83], v[172:175], a[228:231], v[80:83]
    v_cvt_pk_bf16_f32 v159, v38, v39
    v_cvt_pk_bf16_f32 v160, v16, v17
    v_mfma_f32_16x16x32_bf16 v[84:87], v[172:175], a[244:247], v[84:87]
    ds_read_b64_tr_b16 v[168:169], v193 offset:17408
    ds_read_b64_tr_b16 v[170:171], v193 offset:21760
    v_mfma_f32_16x16x32_bf16 v[88:91], v[172:175], v[204:207], v[88:91]
    v_exp_f32 v40, v40
    v_mfma_f32_16x16x32_bf16 v[92:95], v[172:175], v[220:223], v[92:95]
    s_waitcnt vmcnt(5)
    s_waitcnt lgkmcnt(3)
    v_mfma_f32_16x16x32_bf16 v[72:75], v[176:179], a[200:203], v[72:75]
    buffer_load_dwordx4 v197, s[8:11], s29 offen offset:3072 nt lds
    v_mfma_f32_16x16x32_bf16 v[76:79], v[176:179], a[216:219], v[76:79]
    s_add_u32 m0, s42, 4352
    v_cvt_pk_bf16_f32 v161, v18, v19
    v_mfma_f32_16x16x32_bf16 v[80:83], v[176:179], a[232:235], v[80:83]
    v_exp_f32 v41, v41
    v_mfma_f32_16x16x32_bf16 v[84:87], v[176:179], a[248:251], v[84:87]
    v_exp_f32 v42, v42
    v_mfma_f32_16x16x32_bf16 v[88:91], v[176:179], v[208:211], v[88:91]
    ds_read_b64_tr_b16 v[172:173], v194 offset:17408
    ds_read_b64_tr_b16 v[174:175], v194 offset:21760
    v_mfma_f32_16x16x32_bf16 v[92:95], v[176:179], v[224:227], v[92:95]
    v_cvt_pk_bf16_f32 v162, v40, v41
    s_waitcnt lgkmcnt(4)
    v_mfma_f32_16x16x32_bf16 v[72:75], v[180:183], a[204:207], v[72:75]
    v_exp_f32 v43, v43
    v_mfma_f32_16x16x32_bf16 v[76:79], v[180:183], a[220:223], v[76:79]
    v_cvt_pk_bf16_f32 v163, v42, v43
    v_cvt_pk_bf16_f32 v164, v20, v21
    v_mfma_f32_16x16x32_bf16 v[80:83], v[180:183], a[236:239], v[80:83]
    v_exp_f32 v44, v44
    v_mfma_f32_16x16x32_bf16 v[84:87], v[180:183], a[252:255], v[84:87]
    v_exp_f32 v45, v45
    v_mfma_f32_16x16x32_bf16 v[88:91], v[180:183], v[212:215], v[88:91]
    v_exp_f32 v46, v46
    v_mfma_f32_16x16x32_bf16 v[92:95], v[180:183], v[228:231], v[92:95]
    v_cvt_pk_bf16_f32 v165, v22, v23
    s_waitcnt lgkmcnt(2)
    v_mfma_f32_16x16x32_bf16 a[0:3], v[168:171], v[144:147], a[0:3]
    v_exp_f32 v47, v47
    v_mfma_f32_16x16x32_bf16 a[4:7], v[168:171], v[148:151], a[4:7]
    v_cvt_pk_bf16_f32 v166, v44, v45
    v_cvt_pk_bf16_f32 v167, v46, v47
    v_mfma_f32_16x16x32_bf16 a[8:11], v[168:171], v[152:155], a[8:11]
    ds_read_b64_tr_b16 v[176:177], v193 offset:17472
    ds_read_b64_tr_b16 v[178:179], v193 offset:21824
    v_mfma_f32_16x16x32_bf16 a[12:15], v[168:171], v[156:159], a[12:15]
    s_waitcnt vmcnt(5)
    v_mfma_f32_16x16x32_bf16 a[16:19], v[168:171], v[160:163], a[16:19]
    buffer_load_dwordx4 v197, s[8:11], s30 offen nt lds
    v_mfma_f32_16x16x32_bf16 a[20:23], v[168:171], v[164:167], a[20:23]
    s_add_u32 m0, s42, 4416
    v_mfma_f32_16x16x32_bf16 v[120:123], v[184:187], v[144:147], v[120:123]
    s_waitcnt lgkmcnt(2)
    v_mfma_f32_16x16x32_bf16 a[24:27], v[172:175], v[144:147], a[24:27]
    ds_read_b64_tr_b16 v[180:181], v194 offset:17472
    ds_read_b64_tr_b16 v[182:183], v194 offset:21824
    v_mfma_f32_16x16x32_bf16 a[28:31], v[172:175], v[148:151], a[28:31]
    v_exp_f32 v48, v48
    v_mfma_f32_16x16x32_bf16 a[32:35], v[172:175], v[152:155], a[32:35]
    s_waitcnt vmcnt(5)
    v_mfma_f32_16x16x32_bf16 a[36:39], v[172:175], v[156:159], a[36:39]
    buffer_load_dwordx4 v197, s[8:11], s30 offen offset:1024 nt lds
    v_mfma_f32_16x16x32_bf16 a[40:43], v[172:175], v[160:163], a[40:43]
    s_add_u32 m0, s42, 4480
    v_mfma_f32_16x16x32_bf16 a[44:47], v[172:175], v[164:167], a[44:47]
    v_exp_f32 v49, v49
    v_mfma_f32_16x16x32_bf16 v[124:127], v[184:187], v[148:151], v[124:127]
    s_waitcnt lgkmcnt(2)
    v_mfma_f32_16x16x32_bf16 a[48:51], v[176:179], v[144:147], a[48:51]
    ds_read_b64_tr_b16 v[168:169], v195 offset:17408
    ds_read_b64_tr_b16 v[170:171], v195 offset:21760
    v_mfma_f32_16x16x32_bf16 a[52:55], v[176:179], v[148:151], a[52:55]
    v_exp_f32 v50, v50
    v_mfma_f32_16x16x32_bf16 a[56:59], v[176:179], v[152:155], a[56:59]
    v_exp_f32 v51, v51
    v_mfma_f32_16x16x32_bf16 a[60:63], v[176:179], v[156:159], a[60:63]
    v_exp_f32 v52, v52
    v_mfma_f32_16x16x32_bf16 a[64:67], v[176:179], v[160:163], a[64:67]
    v_exp_f32 v53, v53
    v_mfma_f32_16x16x32_bf16 a[68:71], v[176:179], v[164:167], a[68:71]
    v_exp_f32 v54, v54
    v_mfma_f32_16x16x32_bf16 v[128:131], v[184:187], v[152:155], v[128:131]
    s_waitcnt vmcnt(5)
    s_waitcnt lgkmcnt(2)
    v_mfma_f32_16x16x32_bf16 a[72:75], v[180:183], v[144:147], a[72:75]
    ds_read_b64_tr_b16 v[172:173], v196 offset:17408
    ds_read_b64_tr_b16 v[174:175], v196 offset:21760
    v_mfma_f32_16x16x32_bf16 a[76:79], v[180:183], v[148:151], a[76:79]
    buffer_load_dwordx4 v197, s[8:11], s30 offen offset:2048 nt lds
    v_mfma_f32_16x16x32_bf16 a[80:83], v[180:183], v[152:155], a[80:83]
    s_add_u32 m0, s42, 4544
    v_mfma_f32_16x16x32_bf16 a[84:87], v[180:183], v[156:159], a[84:87]
    v_exp_f32 v55, v55
    v_mfma_f32_16x16x32_bf16 a[88:91], v[180:183], v[160:163], a[88:91]
    v_exp_f32 v56, v56
    v_mfma_f32_16x16x32_bf16 a[92:95], v[180:183], v[164:167], a[92:95]
    v_exp_f32 v57, v57
    v_mfma_f32_16x16x32_bf16 v[132:135], v[184:187], v[156:159], v[132:135]
    s_waitcnt lgkmcnt(2)
    v_mfma_f32_16x16x32_bf16 a[96:99], v[168:171], v[144:147], a[96:99]
    ds_read_b64_tr_b16 v[176:177], v195 offset:17472
    ds_read_b64_tr_b16 v[178:179], v195 offset:21824
    v_mfma_f32_16x16x32_bf16 a[100:103], v[168:171], v[148:151], a[100:103]
    v_exp_f32 v58, v58
    v_mfma_f32_16x16x32_bf16 a[104:107], v[168:171], v[152:155], a[104:107]
    v_exp_f32 v59, v59
    v_mfma_f32_16x16x32_bf16 a[108:111], v[168:171], v[156:159], a[108:111]
    s_waitcnt vmcnt(5)
    v_mfma_f32_16x16x32_bf16 a[112:115], v[168:171], v[160:163], a[112:115]
    buffer_load_dwordx4 v197, s[8:11], s30 offen offset:3072 nt lds
    v_mfma_f32_16x16x32_bf16 a[116:119], v[168:171], v[164:167], a[116:119]
    ds_read_b64_tr_b16 v[180:181], v196 offset:17472
    ds_read_b64_tr_b16 v[182:183], v196 offset:21824
    v_mfma_f32_16x16x32_bf16 v[136:139], v[184:187], v[160:163], v[136:139]
    s_waitcnt lgkmcnt(4)
    v_mfma_f32_16x16x32_bf16 a[120:123], v[172:175], v[144:147], a[120:123]
    v_exp_f32 v60, v60
    v_mfma_f32_16x16x32_bf16 a[124:127], v[172:175], v[148:151], a[124:127]
    v_exp_f32 v61, v61
    v_mfma_f32_16x16x32_bf16 a[128:131], v[172:175], v[152:155], a[128:131]
    v_exp_f32 v62, v62
    v_mfma_f32_16x16x32_bf16 a[132:135], v[172:175], v[156:159], a[132:135]
    v_exp_f32 v63, v63
    v_mfma_f32_16x16x32_bf16 a[136:139], v[172:175], v[160:163], a[136:139]
    ds_read_b128 v[168:171], v192 offset:0
    v_mfma_f32_16x16x32_bf16 a[140:143], v[172:175], v[164:167], a[140:143]
    s_add_u32 s29, s29, 8192
    s_and_b32 s29, s29, 0x3ffff
    v_mfma_f32_16x16x32_bf16 v[140:143], v[184:187], v[164:167], v[140:143]
    s_add_u32 s30, s29, 4096
    s_waitcnt lgkmcnt(3)
    v_mfma_f32_16x16x32_bf16 a[144:147], v[176:179], v[144:147], a[144:147]
    v_exp_f32 v64, v64
    v_mfma_f32_16x16x32_bf16 a[148:151], v[176:179], v[148:151], a[148:151]
    v_exp_f32 v65, v65
    v_mfma_f32_16x16x32_bf16 a[152:155], v[176:179], v[152:155], a[152:155]
    v_exp_f32 v66, v66
    v_mfma_f32_16x16x32_bf16 a[156:159], v[176:179], v[156:159], a[156:159]
    ds_read_b128 v[172:175], v192 offset:64
    v_mfma_f32_16x16x32_bf16 a[160:163], v[176:179], v[160:163], a[160:163]
    v_exp_f32 v67, v67
    v_mfma_f32_16x16x32_bf16 a[164:167], v[176:179], v[164:167], a[164:167]
    s_waitcnt lgkmcnt(2)
    v_mfma_f32_16x16x32_bf16 a[168:171], v[180:183], v[144:147], a[168:171]
    s_waitcnt vmcnt(8)
    s_barrier
    v_mfma_f32_16x16x32_bf16 a[172:175], v[180:183], v[148:151], a[172:175]
    v_exp_f32 v68, v68
    v_mfma_f32_16x16x32_bf16 a[176:179], v[180:183], v[152:155], a[176:179]
    v_exp_f32 v69, v69
    v_mfma_f32_16x16x32_bf16 a[180:183], v[180:183], v[156:159], a[180:183]
    v_exp_f32 v70, v70
    v_mfma_f32_16x16x32_bf16 a[184:187], v[180:183], v[160:163], a[184:187]
    v_exp_f32 v71, v71
    v_mfma_f32_16x16x32_bf16 a[188:191], v[180:183], v[164:167], a[188:191]
    v_exp_f32 v72, v72
    v_exp_f32 v73, v73
    v_exp_f32 v74, v74
    v_exp_f32 v75, v75
    v_exp_f32 v76, v76
    v_exp_f32 v77, v77
    s_waitcnt lgkmcnt(1)
    v_mfma_f32_16x16x32_bf16 v[0:3], v[168:171], a[192:195], v[96:99]
    s_add_u32 m0, s43, 0
    ds_read_b128 v[176:179], v192 offset:128
    v_mfma_f32_16x16x32_bf16 v[4:7], v[168:171], a[208:211], v[100:103]
    v_cvt_pk_bf16_f32 v144, v48, v49
    v_cvt_pk_bf16_f32 v145, v50, v51
    v_mfma_f32_16x16x32_bf16 v[8:11], v[168:171], a[224:227], v[104:107]
    s_waitcnt vmcnt(5)
    v_cvt_pk_bf16_f32 v146, v72, v73
    v_mfma_f32_16x16x32_bf16 v[12:15], v[168:171], a[240:243], v[108:111]
    ds_read_b128 v[180:183], v192 offset:192
    v_cvt_pk_bf16_f32 v147, v74, v75
    v_mfma_f32_16x16x32_bf16 v[16:19], v[168:171], v[200:203], v[112:115]
    buffer_load_dwordx4 v197, s[8:11], s29 offen nt lds
    v_mfma_f32_16x16x32_bf16 v[20:23], v[168:171], v[216:219], v[116:119]
    s_add_u32 m0, s43, 64
    s_waitcnt lgkmcnt(2)
    v_mfma_f32_16x16x32_bf16 v[0:3], v[172:175], a[196:199], v[0:3]
    v_exp_f32 v78, v78
    v_mfma_f32_16x16x32_bf16 v[4:7], v[172:175], a[212:215], v[4:7]
    v_exp_f32 v79, v79
    v_mfma_f32_16x16x32_bf16 v[8:11], v[172:175], a[228:231], v[8:11]
    v_cvt_pk_bf16_f32 v148, v52, v53
    v_cvt_pk_bf16_f32 v149, v54, v55
    v_mfma_f32_16x16x32_bf16 v[12:15], v[172:175], a[244:247], v[12:15]
    ds_read_b128 v[168:171], v192 offset:4352
    v_cvt_pk_bf16_f32 v150, v76, v77
    v_mfma_f32_16x16x32_bf16 v[16:19], v[172:175], v[204:207], v[16:19]
    v_cvt_pk_bf16_f32 v151, v78, v79
    v_cvt_pk_bf16_f32 v152, v56, v57
    v_mfma_f32_16x16x32_bf16 v[20:23], v[172:175], v[220:223], v[20:23]
    v_cvt_pk_bf16_f32 v153, v58, v59
    s_waitcnt lgkmcnt(2)
    v_mfma_f32_16x16x32_bf16 v[0:3], v[176:179], a[200:203], v[0:3]
    v_exp_f32 v80, v80
    v_mfma_f32_16x16x32_bf16 v[4:7], v[176:179], a[216:219], v[4:7]
    s_waitcnt vmcnt(5)
    v_mfma_f32_16x16x32_bf16 v[8:11], v[176:179], a[232:235], v[8:11]
    buffer_load_dwordx4 v197, s[8:11], s29 offen offset:1024 nt lds
    v_mfma_f32_16x16x32_bf16 v[12:15], v[176:179], a[248:251], v[12:15]
    ds_read_b128 v[172:175], v192 offset:4416
    s_add_u32 m0, s43, 128
    v_mfma_f32_16x16x32_bf16 v[16:19], v[176:179], v[208:211], v[16:19]
    v_exp_f32 v81, v81
    v_mfma_f32_16x16x32_bf16 v[20:23], v[176:179], v[224:227], v[20:23]
    v_cvt_pk_bf16_f32 v154, v80, v81
    s_waitcnt lgkmcnt(2)
    v_mfma_f32_16x16x32_bf16 v[0:3], v[180:183], a[204:207], v[0:3]
    v_exp_f32 v82, v82
    v_mfma_f32_16x16x32_bf16 v[4:7], v[180:183], a[220:223], v[4:7]
    v_exp_f32 v83, v83
    v_mfma_f32_16x16x32_bf16 v[8:11], v[180:183], a[236:239], v[8:11]
    v_cvt_pk_bf16_f32 v155, v82, v83
    v_cvt_pk_bf16_f32 v156, v60, v61
    v_mfma_f32_16x16x32_bf16 v[12:15], v[180:183], a[252:255], v[12:15]
    ds_read_b128 v[176:179], v192 offset:4480
    v_cvt_pk_bf16_f32 v157, v62, v63
    v_mfma_f32_16x16x32_bf16 v[16:19], v[180:183], v[212:215], v[16:19]
    v_exp_f32 v84, v84
    v_mfma_f32_16x16x32_bf16 v[20:23], v[180:183], v[228:231], v[20:23]
    s_waitcnt lgkmcnt(2)
    v_mfma_f32_16x16x32_bf16 v[24:27], v[168:171], a[192:195], v[96:99]
    s_waitcnt vmcnt(5)
    v_mfma_f32_16x16x32_bf16 v[28:31], v[168:171], a[208:211], v[100:103]
    buffer_load_dwordx4 v197, s[8:11], s29 offen offset:2048 nt lds
    v_mfma_f32_16x16x32_bf16 v[32:35], v[168:171], a[224:227], v[104:107]
    s_add_u32 m0, s43, 192
    v_mfma_f32_16x16x32_bf16 v[36:39], v[168:171], a[240:243], v[108:111]
    ds_read_b128 v[180:183], v192 offset:4544
    v_mfma_f32_16x16x32_bf16 v[40:43], v[168:171], v[200:203], v[112:115]
    v_exp_f32 v85, v85
    v_mfma_f32_16x16x32_bf16 v[44:47], v[168:171], v[216:219], v[116:119]
    v_cvt_pk_bf16_f32 v158, v84, v85
    s_waitcnt lgkmcnt(2)
    v_mfma_f32_16x16x32_bf16 v[24:27], v[172:175], a[196:199], v[24:27]
    v_exp_f32 v86, v86
    v_mfma_f32_16x16x32_bf16 v[28:31], v[172:175], a[212:215], v[28:31]
    v_exp_f32 v87, v87
    v_mfma_f32_16x16x32_bf16 v[32:35], v[172:175], a[228:231], v[32:35]
    v_cvt_pk_bf16_f32 v159, v86, v87
    v_cvt_pk_bf16_f32 v160, v64, v65
    v_mfma_f32_16x16x32_bf16 v[36:39], v[172:175], a[244:247], v[36:39]
    ds_read_b64_tr_b16 v[168:169], v193 offset:26112
    ds_read_b64_tr_b16 v[170:171], v193 offset:30464
    v_mfma_f32_16x16x32_bf16 v[40:43], v[172:175], v[204:207], v[40:43]
    v_exp_f32 v88, v88
    v_mfma_f32_16x16x32_bf16 v[44:47], v[172:175], v[220:223], v[44:47]
    s_waitcnt vmcnt(5)
    s_waitcnt lgkmcnt(3)
    v_mfma_f32_16x16x32_bf16 v[24:27], v[176:179], a[200:203], v[24:27]
    buffer_load_dwordx4 v197, s[8:11], s29 offen offset:3072 nt lds
    v_mfma_f32_16x16x32_bf16 v[28:31], v[176:179], a[216:219], v[28:31]
    s_add_u32 m0, s43, 4352
    v_cvt_pk_bf16_f32 v161, v66, v67
    v_mfma_f32_16x16x32_bf16 v[32:35], v[176:179], a[232:235], v[32:35]
    v_exp_f32 v89, v89
    v_mfma_f32_16x16x32_bf16 v[36:39], v[176:179], a[248:251], v[36:39]
    v_exp_f32 v90, v90
    v_mfma_f32_16x16x32_bf16 v[40:43], v[176:179], v[208:211], v[40:43]
    ds_read_b64_tr_b16 v[172:173], v194 offset:26112
    ds_read_b64_tr_b16 v[174:175], v194 offset:30464
    v_mfma_f32_16x16x32_bf16 v[44:47], v[176:179], v[224:227], v[44:47]
    v_cvt_pk_bf16_f32 v162, v88, v89
    s_waitcnt lgkmcnt(4)
    v_mfma_f32_16x16x32_bf16 v[24:27], v[180:183], a[204:207], v[24:27]
    v_exp_f32 v91, v91
    v_mfma_f32_16x16x32_bf16 v[28:31], v[180:183], a[220:223], v[28:31]
    v_cvt_pk_bf16_f32 v163, v90, v91
    v_cvt_pk_bf16_f32 v164, v68, v69
    v_mfma_f32_16x16x32_bf16 v[32:35], v[180:183], a[236:239], v[32:35]
    v_exp_f32 v92, v92
    v_mfma_f32_16x16x32_bf16 v[36:39], v[180:183], a[252:255], v[36:39]
    v_exp_f32 v93, v93
    v_mfma_f32_16x16x32_bf16 v[40:43], v[180:183], v[212:215], v[40:43]
    v_exp_f32 v94, v94
    v_mfma_f32_16x16x32_bf16 v[44:47], v[180:183], v[228:231], v[44:47]
    v_cvt_pk_bf16_f32 v165, v70, v71
    s_waitcnt lgkmcnt(2)
    v_mfma_f32_16x16x32_bf16 a[0:3], v[168:171], v[144:147], a[0:3]
    v_exp_f32 v95, v95
    v_mfma_f32_16x16x32_bf16 a[4:7], v[168:171], v[148:151], a[4:7]
    v_cvt_pk_bf16_f32 v166, v92, v93
    v_cvt_pk_bf16_f32 v167, v94, v95
    v_mfma_f32_16x16x32_bf16 a[8:11], v[168:171], v[152:155], a[8:11]
    ds_read_b64_tr_b16 v[176:177], v193 offset:26176
    ds_read_b64_tr_b16 v[178:179], v193 offset:30528
    v_mfma_f32_16x16x32_bf16 a[12:15], v[168:171], v[156:159], a[12:15]
    s_waitcnt vmcnt(5)
    v_mfma_f32_16x16x32_bf16 a[16:19], v[168:171], v[160:163], a[16:19]
    buffer_load_dwordx4 v197, s[8:11], s30 offen nt lds
    v_mfma_f32_16x16x32_bf16 a[20:23], v[168:171], v[164:167], a[20:23]
    s_add_u32 m0, s43, 4416
    v_mfma_f32_16x16x32_bf16 v[120:123], v[184:187], v[144:147], v[120:123]
    s_waitcnt lgkmcnt(2)
    v_mfma_f32_16x16x32_bf16 a[24:27], v[172:175], v[144:147], a[24:27]
    ds_read_b64_tr_b16 v[180:181], v194 offset:26176
    ds_read_b64_tr_b16 v[182:183], v194 offset:30528
    v_mfma_f32_16x16x32_bf16 a[28:31], v[172:175], v[148:151], a[28:31]
    v_exp_f32 v0, v0
    v_mfma_f32_16x16x32_bf16 a[32:35], v[172:175], v[152:155], a[32:35]
    s_waitcnt vmcnt(5)
    v_mfma_f32_16x16x32_bf16 a[36:39], v[172:175], v[156:159], a[36:39]
    buffer_load_dwordx4 v197, s[8:11], s30 offen offset:1024 nt lds
    v_mfma_f32_16x16x32_bf16 a[40:43], v[172:175], v[160:163], a[40:43]
    s_add_u32 m0, s43, 4480
    v_mfma_f32_16x16x32_bf16 a[44:47], v[172:175], v[164:167], a[44:47]
    v_exp_f32 v1, v1
    v_mfma_f32_16x16x32_bf16 v[124:127], v[184:187], v[148:151], v[124:127]
    s_waitcnt lgkmcnt(2)
    v_mfma_f32_16x16x32_bf16 a[48:51], v[176:179], v[144:147], a[48:51]
    ds_read_b64_tr_b16 v[168:169], v195 offset:26112
    ds_read_b64_tr_b16 v[170:171], v195 offset:30464
    v_mfma_f32_16x16x32_bf16 a[52:55], v[176:179], v[148:151], a[52:55]
    v_exp_f32 v2, v2
    v_mfma_f32_16x16x32_bf16 a[56:59], v[176:179], v[152:155], a[56:59]
    v_exp_f32 v3, v3
    v_mfma_f32_16x16x32_bf16 a[60:63], v[176:179], v[156:159], a[60:63]
    v_exp_f32 v4, v4
    v_mfma_f32_16x16x32_bf16 a[64:67], v[176:179], v[160:163], a[64:67]
    v_exp_f32 v5, v5
    v_mfma_f32_16x16x32_bf16 a[68:71], v[176:179], v[164:167], a[68:71]
    v_exp_f32 v6, v6
    v_mfma_f32_16x16x32_bf16 v[128:131], v[184:187], v[152:155], v[128:131]
    s_waitcnt vmcnt(5)
    s_waitcnt lgkmcnt(2)
    v_mfma_f32_16x16x32_bf16 a[72:75], v[180:183], v[144:147], a[72:75]
    ds_read_b64_tr_b16 v[172:173], v196 offset:26112
    ds_read_b64_tr_b16 v[174:175], v196 offset:30464
    v_mfma_f32_16x16x32_bf16 a[76:79], v[180:183], v[148:151], a[76:79]
    buffer_load_dwordx4 v197, s[8:11], s30 offen offset:2048 nt lds
    v_mfma_f32_16x16x32_bf16 a[80:83], v[180:183], v[152:155], a[80:83]
    s_add_u32 m0, s43, 4544
    v_mfma_f32_16x16x32_bf16 a[84:87], v[180:183], v[156:159], a[84:87]
    v_exp_f32 v7, v7
    v_mfma_f32_16x16x32_bf16 a[88:91], v[180:183], v[160:163], a[88:91]
    v_exp_f32 v8, v8
    v_mfma_f32_16x16x32_bf16 a[92:95], v[180:183], v[164:167], a[92:95]
    v_exp_f32 v9, v9
    v_mfma_f32_16x16x32_bf16 v[132:135], v[184:187], v[156:159], v[132:135]
    s_waitcnt lgkmcnt(2)
    v_mfma_f32_16x16x32_bf16 a[96:99], v[168:171], v[144:147], a[96:99]
    ds_read_b64_tr_b16 v[176:177], v195 offset:26176
    ds_read_b64_tr_b16 v[178:179], v195 offset:30528
    v_mfma_f32_16x16x32_bf16 a[100:103], v[168:171], v[148:151], a[100:103]
    v_exp_f32 v10, v10
    v_mfma_f32_16x16x32_bf16 a[104:107], v[168:171], v[152:155], a[104:107]
    v_exp_f32 v11, v11
    v_mfma_f32_16x16x32_bf16 a[108:111], v[168:171], v[156:159], a[108:111]
    s_waitcnt vmcnt(5)
    v_mfma_f32_16x16x32_bf16 a[112:115], v[168:171], v[160:163], a[112:115]
    buffer_load_dwordx4 v197, s[8:11], s30 offen offset:3072 nt lds
    v_mfma_f32_16x16x32_bf16 a[116:119], v[168:171], v[164:167], a[116:119]
    ds_read_b64_tr_b16 v[180:181], v196 offset:26176
    ds_read_b64_tr_b16 v[182:183], v196 offset:30528
    v_mfma_f32_16x16x32_bf16 v[136:139], v[184:187], v[160:163], v[136:139]
    s_waitcnt lgkmcnt(4)
    v_mfma_f32_16x16x32_bf16 a[120:123], v[172:175], v[144:147], a[120:123]
    v_exp_f32 v12, v12
    v_mfma_f32_16x16x32_bf16 a[124:127], v[172:175], v[148:151], a[124:127]
    v_exp_f32 v13, v13
    v_mfma_f32_16x16x32_bf16 a[128:131], v[172:175], v[152:155], a[128:131]
    v_exp_f32 v14, v14
    v_mfma_f32_16x16x32_bf16 a[132:135], v[172:175], v[156:159], a[132:135]
    v_exp_f32 v15, v15
    v_mfma_f32_16x16x32_bf16 a[136:139], v[172:175], v[160:163], a[136:139]
    ds_read_b128 v[168:171], v192 offset:8704
    v_mfma_f32_16x16x32_bf16 a[140:143], v[172:175], v[164:167], a[140:143]
    s_add_u32 s29, s29, 8192
    s_and_b32 s29, s29, 0x3ffff
    v_mfma_f32_16x16x32_bf16 v[140:143], v[184:187], v[164:167], v[140:143]
    s_add_u32 s30, s29, 4096
    s_waitcnt lgkmcnt(3)
    v_mfma_f32_16x16x32_bf16 a[144:147], v[176:179], v[144:147], a[144:147]
    v_exp_f32 v16, v16
    v_mfma_f32_16x16x32_bf16 a[148:151], v[176:179], v[148:151], a[148:151]
    v_exp_f32 v17, v17
    v_mfma_f32_16x16x32_bf16 a[152:155], v[176:179], v[152:155], a[152:155]
    v_exp_f32 v18, v18
    v_mfma_f32_16x16x32_bf16 a[156:159], v[176:179], v[156:159], a[156:159]
    ds_read_b128 v[172:175], v192 offset:8768
    v_mfma_f32_16x16x32_bf16 a[160:163], v[176:179], v[160:163], a[160:163]
    v_exp_f32 v19, v19
    v_mfma_f32_16x16x32_bf16 a[164:167], v[176:179], v[164:167], a[164:167]
    s_waitcnt lgkmcnt(2)
    v_mfma_f32_16x16x32_bf16 a[168:171], v[180:183], v[144:147], a[168:171]
    s_waitcnt vmcnt(8)
    s_barrier
    v_mfma_f32_16x16x32_bf16 a[172:175], v[180:183], v[148:151], a[172:175]
    v_exp_f32 v20, v20
    v_mfma_f32_16x16x32_bf16 a[176:179], v[180:183], v[152:155], a[176:179]
    v_exp_f32 v21, v21
    v_mfma_f32_16x16x32_bf16 a[180:183], v[180:183], v[156:159], a[180:183]
    v_exp_f32 v22, v22
    v_mfma_f32_16x16x32_bf16 a[184:187], v[180:183], v[160:163], a[184:187]
    v_exp_f32 v23, v23
    v_mfma_f32_16x16x32_bf16 a[188:191], v[180:183], v[164:167], a[188:191]
    v_exp_f32 v24, v24
    v_exp_f32 v25, v25
    v_exp_f32 v26, v26
    v_exp_f32 v27, v27
    v_exp_f32 v28, v28
    v_exp_f32 v29, v29
    s_waitcnt lgkmcnt(1)
    v_mfma_f32_16x16x32_bf16 v[48:51], v[168:171], a[192:195], v[96:99]
    s_cmp_eq_u32 s32, s84
    s_cselect_b32 s10, 0, s10
    v_mfma_f32_16x16x32_bf16 v[52:55], v[168:171], a[208:211], v[100:103]
    ds_read_b128 v[176:179], v192 offset:8832
    s_add_u32 m0, s40, 0
    v_mfma_f32_16x16x32_bf16 v[56:59], v[168:171], a[224:227], v[104:107]
    s_waitcnt vmcnt(5)
    v_cvt_pk_bf16_f32 v144, v0, v1
    v_mfma_f32_16x16x32_bf16 v[60:63], v[168:171], a[240:243], v[108:111]
    ds_read_b128 v[180:183], v192 offset:8896
    v_cvt_pk_bf16_f32 v145, v2, v3
    v_mfma_f32_16x16x32_bf16 v[64:67], v[168:171], v[200:203], v[112:115]
    buffer_load_dwordx4 v197, s[8:11], s29 offen nt lds
    v_mfma_f32_16x16x32_bf16 v[68:71], v[168:171], v[216:219], v[116:119]
    s_add_u32 m0, s40, 64
    s_waitcnt lgkmcnt(2)
    v_mfma_f32_16x16x32_bf16 v[48:51], v[172:175], a[196:199], v[48:51]
    v_cvt_pk_bf16_f32 v146, v24, v25
    v_cvt_pk_bf16_f32 v147, v26, v27
    v_mfma_f32_16x16x32_bf16 v[52:55], v[172:175], a[212:215], v[52:55]
    v_exp_f32 v30, v30
    v_mfma_f32_16x16x32_bf16 v[56:59], v[172:175], a[228:231], v[56:59]
    v_exp_f32 v31, v31
    v_mfma_f32_16x16x32_bf16 v[60:63], v[172:175], a[244:247], v[60:63]
    ds_read_b128 v[168:171], v192 offset:13056
    v_cvt_pk_bf16_f32 v148, v4, v5
    v_mfma_f32_16x16x32_bf16 v[64:67], v[172:175], v[204:207], v[64:67]
    v_cvt_pk_bf16_f32 v149, v6, v7
    v_cvt_pk_bf16_f32 v150, v28, v29
    v_mfma_f32_16x16x32_bf16 v[68:71], v[172:175], v[220:223], v[68:71]
    v_cvt_pk_bf16_f32 v151, v30, v31
    s_waitcnt lgkmcnt(2)
    v_mfma_f32_16x16x32_bf16 v[48:51], v[176:179], a[200:203], v[48:51]
    v_exp_f32 v32, v32
    v_mfma_f32_16x16x32_bf16 v[52:55], v[176:179], a[216:219], v[52:55]
    s_waitcnt vmcnt(5)
    v_cvt_pk_bf16_f32 v152, v8, v9
    v_mfma_f32_16x16x32_bf16 v[56:59], v[176:179], a[232:235], v[56:59]
    buffer_load_dwordx4 v197, s[8:11], s29 offen offset:1024 nt lds
    v_mfma_f32_16x16x32_bf16 v[60:63], v[176:179], a[248:251], v[60:63]
    ds_read_b128 v[172:175], v192 offset:13120
    s_add_u32 m0, s40, 128
    v_mfma_f32_16x16x32_bf16 v[64:67], v[176:179], v[208:211], v[64:67]
    v_exp_f32 v33, v33
    v_mfma_f32_16x16x32_bf16 v[68:71], v[176:179], v[224:227], v[68:71]
    v_cvt_pk_bf16_f32 v153, v10, v11
    s_waitcnt lgkmcnt(2)
    v_mfma_f32_16x16x32_bf16 v[48:51], v[180:183], a[204:207], v[48:51]
    v_exp_f32 v34, v34
    v_mfma_f32_16x16x32_bf16 v[52:55], v[180:183], a[220:223], v[52:55]
    v_exp_f32 v35, v35
    v_mfma_f32_16x16x32_bf16 v[56:59], v[180:183], a[236:239], v[56:59]
    v_cvt_pk_bf16_f32 v154, v32, v33
    v_cvt_pk_bf16_f32 v155, v34, v35
    v_mfma_f32_16x16x32_bf16 v[60:63], v[180:183], a[252:255], v[60:63]
    ds_read_b128 v[176:179], v192 offset:13184
    v_cvt_pk_bf16_f32 v156, v12, v13
    v_mfma_f32_16x16x32_bf16 v[64:67], v[180:183], v[212:215], v[64:67]
    v_exp_f32 v36, v36
    v_mfma_f32_16x16x32_bf16 v[68:71], v[180:183], v[228:231], v[68:71]
    v_cvt_pk_bf16_f32 v157, v14, v15
    s_waitcnt lgkmcnt(2)
    v_mfma_f32_16x16x32_bf16 v[72:75], v[168:171], a[192:195], v[96:99]
    s_waitcnt vmcnt(5)
    v_mfma_f32_16x16x32_bf16 v[76:79], v[168:171], a[208:211], v[100:103]
    buffer_load_dwordx4 v197, s[8:11], s29 offen offset:2048 nt lds
    v_mfma_f32_16x16x32_bf16 v[80:83], v[168:171], a[224:227], v[104:107]
    s_add_u32 m0, s40, 192
    v_mfma_f32_16x16x32_bf16 v[84:87], v[168:171], a[240:243], v[108:111]
    ds_read_b128 v[180:183], v192 offset:13248
    v_mfma_f32_16x16x32_bf16 v[88:91], v[168:171], v[200:203], v[112:115]
    v_exp_f32 v37, v37
    v_mfma_f32_16x16x32_bf16 v[92:95], v[168:171], v[216:219], v[116:119]
    v_cvt_pk_bf16_f32 v158, v36, v37
    s_waitcnt lgkmcnt(2)
    v_mfma_f32_16x16x32_bf16 v[72:75], v[172:175], a[196:199], v[72:75]
    v_exp_f32 v38, v38
    v_mfma_f32_16x16x32_bf16 v[76:79], v[172:175], a[212:215], v[76:79]
    v_exp_f32 v39, v39
    v_mfma_f32_16x16x32_bf16 v[80:83], v[172:175], a[228:231], v[80:83]
    v_cvt_pk_bf16_f32 v159, v38, v39
    v_cvt_pk_bf16_f32 v160, v16, v17
    v_mfma_f32_16x16x32_bf16 v[84:87], v[172:175], a[244:247], v[84:87]
    ds_read_b64_tr_b16 v[168:169], v193 offset:0
    ds_read_b64_tr_b16 v[170:171], v193 offset:4352
    v_mfma_f32_16x16x32_bf16 v[88:91], v[172:175], v[204:207], v[88:91]
    v_exp_f32 v40, v40
    v_mfma_f32_16x16x32_bf16 v[92:95], v[172:175], v[220:223], v[92:95]
    s_waitcnt vmcnt(5)
    s_waitcnt lgkmcnt(3)
    v_mfma_f32_16x16x32_bf16 v[72:75], v[176:179], a[200:203], v[72:75]
    buffer_load_dwordx4 v197, s[8:11], s29 offen offset:3072 nt lds
    v_mfma_f32_16x16x32_bf16 v[76:79], v[176:179], a[216:219], v[76:79]
    s_add_u32 m0, s40, 4352
    v_cvt_pk_bf16_f32 v161, v18, v19
    v_mfma_f32_16x16x32_bf16 v[80:83], v[176:179], a[232:235], v[80:83]
    v_exp_f32 v41, v41
    v_mfma_f32_16x16x32_bf16 v[84:87], v[176:179], a[248:251], v[84:87]
    v_exp_f32 v42, v42
    v_mfma_f32_16x16x32_bf16 v[88:91], v[176:179], v[208:211], v[88:91]
    ds_read_b64_tr_b16 v[172:173], v194 offset:0
    ds_read_b64_tr_b16 v[174:175], v194 offset:4352
    v_mfma_f32_16x16x32_bf16 v[92:95], v[176:179], v[224:227], v[92:95]
    v_cvt_pk_bf16_f32 v162, v40, v41
    s_waitcnt lgkmcnt(4)
    v_mfma_f32_16x16x32_bf16 v[72:75], v[180:183], a[204:207], v[72:75]
    v_exp_f32 v43, v43
    v_mfma_f32_16x16x32_bf16 v[76:79], v[180:183], a[220:223], v[76:79]
    v_cvt_pk_bf16_f32 v163, v42, v43
    v_cvt_pk_bf16_f32 v164, v20, v21
    v_mfma_f32_16x16x32_bf16 v[80:83], v[180:183], a[236:239], v[80:83]
    v_exp_f32 v44, v44
    v_mfma_f32_16x16x32_bf16 v[84:87], v[180:183], a[252:255], v[84:87]
    v_exp_f32 v45, v45
    v_mfma_f32_16x16x32_bf16 v[88:91], v[180:183], v[212:215], v[88:91]
    v_exp_f32 v46, v46
    v_mfma_f32_16x16x32_bf16 v[92:95], v[180:183], v[228:231], v[92:95]
    v_cvt_pk_bf16_f32 v165, v22, v23
    s_waitcnt lgkmcnt(2)
    v_mfma_f32_16x16x32_bf16 a[0:3], v[168:171], v[144:147], a[0:3]
    v_exp_f32 v47, v47
    v_mfma_f32_16x16x32_bf16 a[4:7], v[168:171], v[148:151], a[4:7]
    v_cvt_pk_bf16_f32 v166, v44, v45
    v_cvt_pk_bf16_f32 v167, v46, v47
    v_mfma_f32_16x16x32_bf16 a[8:11], v[168:171], v[152:155], a[8:11]
    ds_read_b64_tr_b16 v[176:177], v193 offset:64
    ds_read_b64_tr_b16 v[178:179], v193 offset:4416
    v_mfma_f32_16x16x32_bf16 a[12:15], v[168:171], v[156:159], a[12:15]
    s_waitcnt vmcnt(5)
    v_mfma_f32_16x16x32_bf16 a[16:19], v[168:171], v[160:163], a[16:19]
    buffer_load_dwordx4 v197, s[8:11], s30 offen nt lds
    v_mfma_f32_16x16x32_bf16 a[20:23], v[168:171], v[164:167], a[20:23]
    s_add_u32 m0, s40, 4416
    v_mfma_f32_16x16x32_bf16 v[120:123], v[184:187], v[144:147], v[120:123]
    s_waitcnt lgkmcnt(2)
    v_mfma_f32_16x16x32_bf16 a[24:27], v[172:175], v[144:147], a[24:27]
    ds_read_b64_tr_b16 v[180:181], v194 offset:64
    ds_read_b64_tr_b16 v[182:183], v194 offset:4416
    v_mfma_f32_16x16x32_bf16 a[28:31], v[172:175], v[148:151], a[28:31]
    v_exp_f32 v48, v48
    v_mfma_f32_16x16x32_bf16 a[32:35], v[172:175], v[152:155], a[32:35]
    s_waitcnt vmcnt(5)
    v_mfma_f32_16x16x32_bf16 a[36:39], v[172:175], v[156:159], a[36:39]
    buffer_load_dwordx4 v197, s[8:11], s30 offen offset:1024 nt lds
    v_mfma_f32_16x16x32_bf16 a[40:43], v[172:175], v[160:163], a[40:43]
    s_add_u32 m0, s40, 4480
    v_mfma_f32_16x16x32_bf16 a[44:47], v[172:175], v[164:167], a[44:47]
    v_exp_f32 v49, v49
    v_mfma_f32_16x16x32_bf16 v[124:127], v[184:187], v[148:151], v[124:127]
    s_waitcnt lgkmcnt(2)
    v_mfma_f32_16x16x32_bf16 a[48:51], v[176:179], v[144:147], a[48:51]
    ds_read_b64_tr_b16 v[168:169], v195 offset:0
    ds_read_b64_tr_b16 v[170:171], v195 offset:4352
    v_mfma_f32_16x16x32_bf16 a[52:55], v[176:179], v[148:151], a[52:55]
    v_exp_f32 v50, v50
    v_mfma_f32_16x16x32_bf16 a[56:59], v[176:179], v[152:155], a[56:59]
    v_exp_f32 v51, v51
    v_mfma_f32_16x16x32_bf16 a[60:63], v[176:179], v[156:159], a[60:63]
    v_exp_f32 v52, v52
    v_mfma_f32_16x16x32_bf16 a[64:67], v[176:179], v[160:163], a[64:67]
    v_exp_f32 v53, v53
    v_mfma_f32_16x16x32_bf16 a[68:71], v[176:179], v[164:167], a[68:71]
    v_exp_f32 v54, v54
    v_mfma_f32_16x16x32_bf16 v[128:131], v[184:187], v[152:155], v[128:131]
    s_waitcnt vmcnt(5)
    s_waitcnt lgkmcnt(2)
    v_mfma_f32_16x16x32_bf16 a[72:75], v[180:183], v[144:147], a[72:75]
    ds_read_b64_tr_b16 v[172:173], v196 offset:0
    ds_read_b64_tr_b16 v[174:175], v196 offset:4352
    v_mfma_f32_16x16x32_bf16 a[76:79], v[180:183], v[148:151], a[76:79]
    buffer_load_dwordx4 v197, s[8:11], s30 offen offset:2048 nt lds
    v_mfma_f32_16x16x32_bf16 a[80:83], v[180:183], v[152:155], a[80:83]
    s_add_u32 m0, s40, 4544
    v_mfma_f32_16x16x32_bf16 a[84:87], v[180:183], v[156:159], a[84:87]
    v_exp_f32 v55, v55
    v_mfma_f32_16x16x32_bf16 a[88:91], v[180:183], v[160:163], a[88:91]
    v_exp_f32 v56, v56
    v_mfma_f32_16x16x32_bf16 a[92:95], v[180:183], v[164:167], a[92:95]
    v_exp_f32 v57, v57
    v_mfma_f32_16x16x32_bf16 v[132:135], v[184:187], v[156:159], v[132:135]
    s_waitcnt lgkmcnt(2)
    v_mfma_f32_16x16x32_bf16 a[96:99], v[168:171], v[144:147], a[96:99]
    ds_read_b64_tr_b16 v[176:177], v195 offset:64
    ds_read_b64_tr_b16 v[178:179], v195 offset:4416
    v_mfma_f32_16x16x32_bf16 a[100:103], v[168:171], v[148:151], a[100:103]
    v_exp_f32 v58, v58
    v_mfma_f32_16x16x32_bf16 a[104:107], v[168:171], v[152:155], a[104:107]
    v_exp_f32 v59, v59
    v_mfma_f32_16x16x32_bf16 a[108:111], v[168:171], v[156:159], a[108:111]
    s_waitcnt vmcnt(5)
    v_mfma_f32_16x16x32_bf16 a[112:115], v[168:171], v[160:163], a[112:115]
    buffer_load_dwordx4 v197, s[8:11], s30 offen offset:3072 nt lds
    v_mfma_f32_16x16x32_bf16 a[116:119], v[168:171], v[164:167], a[116:119]
    ds_read_b64_tr_b16 v[180:181], v196 offset:64
    ds_read_b64_tr_b16 v[182:183], v196 offset:4416
    v_mfma_f32_16x16x32_bf16 v[136:139], v[184:187], v[160:163], v[136:139]
    s_waitcnt lgkmcnt(4)
    v_mfma_f32_16x16x32_bf16 a[120:123], v[172:175], v[144:147], a[120:123]
    v_exp_f32 v60, v60
    v_mfma_f32_16x16x32_bf16 a[124:127], v[172:175], v[148:151], a[124:127]
    v_exp_f32 v61, v61
    v_mfma_f32_16x16x32_bf16 a[128:131], v[172:175], v[152:155], a[128:131]
    v_exp_f32 v62, v62
    v_mfma_f32_16x16x32_bf16 a[132:135], v[172:175], v[156:159], a[132:135]
    v_exp_f32 v63, v63
    v_mfma_f32_16x16x32_bf16 a[136:139], v[172:175], v[160:163], a[136:139]
    ds_read_b128 v[168:171], v192 offset:17408
    v_mfma_f32_16x16x32_bf16 a[140:143], v[172:175], v[164:167], a[140:143]
    s_add_u32 s29, s29, 8192
    s_and_b32 s29, s29, 0x3ffff
    v_mfma_f32_16x16x32_bf16 v[140:143], v[184:187], v[164:167], v[140:143]
    s_add_u32 s30, s29, 4096
    s_waitcnt lgkmcnt(3)
    v_mfma_f32_16x16x32_bf16 a[144:147], v[176:179], v[144:147], a[144:147]
    v_exp_f32 v64, v64
    v_mfma_f32_16x16x32_bf16 a[148:151], v[176:179], v[148:151], a[148:151]
    v_exp_f32 v65, v65
    v_mfma_f32_16x16x32_bf16 a[152:155], v[176:179], v[152:155], a[152:155]
    v_exp_f32 v66, v66
    v_mfma_f32_16x16x32_bf16 a[156:159], v[176:179], v[156:159], a[156:159]
    ds_read_b128 v[172:175], v192 offset:17472
    v_mfma_f32_16x16x32_bf16 a[160:163], v[176:179], v[160:163], a[160:163]
    v_exp_f32 v67, v67
    v_mfma_f32_16x16x32_bf16 a[164:167], v[176:179], v[164:167], a[164:167]
    s_waitcnt lgkmcnt(2)
    v_mfma_f32_16x16x32_bf16 a[168:171], v[180:183], v[144:147], a[168:171]
    s_waitcnt vmcnt(8)
    s_barrier
    v_mfma_f32_16x16x32_bf16 a[172:175], v[180:183], v[148:151], a[172:175]
    v_exp_f32 v68, v68
    v_mfma_f32_16x16x32_bf16 a[176:179], v[180:183], v[152:155], a[176:179]
    v_exp_f32 v69, v69
    v_mfma_f32_16x16x32_bf16 a[180:183], v[180:183], v[156:159], a[180:183]
    v_exp_f32 v70, v70
    v_mfma_f32_16x16x32_bf16 a[184:187], v[180:183], v[160:163], a[184:187]
    v_exp_f32 v71, v71
    v_mfma_f32_16x16x32_bf16 a[188:191], v[180:183], v[164:167], a[188:191]
    v_exp_f32 v72, v72
    v_exp_f32 v73, v73
    v_exp_f32 v74, v74
    v_exp_f32 v75, v75
    v_exp_f32 v76, v76
    v_exp_f32 v77, v77
    s_sub_u32 s32, s32, 1
    s_cmp_lg_u32 s32, 0
    s_cbranch_scc1 L_loopf2
    s_waitcnt lgkmcnt(1)
    v_mfma_f32_16x16x32_bf16 v[0:3], v[168:171], a[192:195], v[96:99]
    ds_read_b128 v[176:179], v192 offset:17536
    v_cvt_pk_bf16_f32 v144, v48, v49
    v_mfma_f32_16x16x32_bf16 v[4:7], v[168:171], a[208:211], v[100:103]
    v_cvt_pk_bf16_f32 v145, v50, v51
    v_cvt_pk_bf16_f32 v146, v72, v73
    v_mfma_f32_16x16x32_bf16 v[8:11], v[168:171], a[224:227], v[104:107]
    v_mov_b32 v188, 1
    s_lshl_b32 s87, s88, 3
    v_mfma_f32_16x16x32_bf16 v[12:15], v[168:171], a[240:243], v[108:111]
    s_add_u32 s87, s87, s5
    ds_read_b128 v[180:183], v192 offset:17600
    v_mfma_f32_16x16x32_bf16 v[16:19], v[168:171], v[200:203], v[112:115]
    buffer_store_byte v188, v199, s[64:67], s87 offen sc1
    v_mfma_f32_16x16x32_bf16 v[20:23], v[168:171], v[216:219], v[116:119]
    v_cvt_pk_bf16_f32 v147, v74, v75
    s_waitcnt lgkmcnt(2)
    v_mfma_f32_16x16x32_bf16 v[0:3], v[172:175], a[196:199], v[0:3]
    v_exp_f32 v78, v78
    v_mfma_f32_16x16x32_bf16 v[4:7], v[172:175], a[212:215], v[4:7]
    v_exp_f32 v79, v79
    v_mfma_f32_16x16x32_bf16 v[8:11], v[172:175], a[228:231], v[8:11]
    v_cvt_pk_bf16_f32 v148, v52, v53
    v_cvt_pk_bf16_f32 v149, v54, v55
    v_mfma_f32_16x16x32_bf16 v[12:15], v[172:175], a[244:247], v[12:15]
    ds_read_b128 v[168:171], v192 offset:21760
    v_cvt_pk_bf16_f32 v150, v76, v77
    v_mfma_f32_16x16x32_bf16 v[16:19], v[172:175], v[204:207], v[16:19]
    v_cvt_pk_bf16_f32 v151, v78, v79
    v_cvt_pk_bf16_f32 v152, v56, v57
    v_mfma_f32_16x16x32_bf16 v[20:23], v[172:175], v[220:223], v[20:23]
    v_cvt_pk_bf16_f32 v153, v58, v59
    s_waitcnt lgkmcnt(2)
    v_mfma_f32_16x16x32_bf16 v[0:3], v[176:179], a[200:203], v[0:3]
    buffer_load_dword v244, v247, s[60:63], s85 offen sc1
    v_mfma_f32_16x16x32_bf16 v[4:7], v[176:179], a[216:219], v[4:7]
    v_exp_f32 v80, v80
    v_mfma_f32_16x16x32_bf16 v[8:11], v[176:179], a[232:235], v[8:11]
    v_exp_f32 v81, v81
    v_mfma_f32_16x16x32_bf16 v[12:15], v[176:179], a[248:251], v[12:15]
    ds_read_b128 v[172:175], v192 offset:21824
    v_cvt_pk_bf16_f32 v154, v80, v81
    v_mfma_f32_16x16x32_bf16 v[16:19], v[176:179], v[208:211], v[16:19]
    v_exp_f32 v82, v82
    v_mfma_f32_16x16x32_bf16 v[20:23], v[176:179], v[224:227], v[20:23]
    s_waitcnt lgkmcnt(2)
    v_mfma_f32_16x16x32_bf16 v[0:3], v[180:183], a[204:207], v[0:3]
    v_exp_f32 v83, v83
    v_mfma_f32_16x16x32_bf16 v[4:7], v[180:183], a[220:223], v[4:7]
    v_cvt_pk_bf16_f32 v155, v82, v83
    v_cvt_pk_bf16_f32 v156, v60, v61
    v_mfma_f32_16x16x32_bf16 v[8:11], v[180:183], a[236:239], v[8:11]
    v_exp_f32 v84, v84
    v_mfma_f32_16x16x32_bf16 v[12:15], v[180:183], a[252:255], v[12:15]
    ds_read_b128 v[176:179], v192 offset:21888
    v_cvt_pk_bf16_f32 v157, v62, v63
    v_mfma_f32_16x16x32_bf16 v[16:19], v[180:183], v[212:215], v[16:19]
    v_exp_f32 v85, v85
    v_mfma_f32_16x16x32_bf16 v[20:23], v[180:183], v[228:231], v[20:23]
    v_cvt_pk_bf16_f32 v158, v84, v85
    s_waitcnt lgkmcnt(2)
    v_mfma_f32_16x16x32_bf16 v[24:27], v[168:171], a[192:195], v[96:99]
    v_exp_f32 v86, v86
    v_mfma_f32_16x16x32_bf16 v[28:31], v[168:171], a[208:211], v[100:103]
    v_exp_f32 v87, v87
    v_mfma_f32_16x16x32_bf16 v[32:35], v[168:171], a[224:227], v[104:107]
    v_cvt_pk_bf16_f32 v159, v86, v87
    v_cvt_pk_bf16_f32 v160, v64, v65
    v_mfma_f32_16x16x32_bf16 v[36:39], v[168:171], a[240:243], v[108:111]
    ds_read_b128 v[180:183], v192 offset:21952
    v_cvt_pk_bf16_f32 v161, v66, v67
    v_mfma_f32_16x16x32_bf16 v[40:43], v[168:171], v[200:203], v[112:115]
    v_exp_f32 v88, v88
    v_mfma_f32_16x16x32_bf16 v[44:47], v[168:171], v[216:219], v[116:119]
    s_waitcnt lgkmcnt(2)
    v_mfma_f32_16x16x32_bf16 v[24:27], v[172:175], a[196:199], v[24:27]
    v_exp_f32 v89, v89
    v_mfma_f32_16x16x32_bf16 v[28:31], v[172:175], a[212:215], v[28:31]
    v_exp_f32 v90, v90
    v_mfma_f32_16x16x32_bf16 v[32:35], v[172:175], a[228:231], v[32:35]
    v_exp_f32 v91, v91
    v_mfma_f32_16x16x32_bf16 v[36:39], v[172:175], a[244:247], v[36:39]
    ds_read_b64_tr_b16 v[168:169], v193 offset:8704
    ds_read_b64_tr_b16 v[170:171], v193 offset:13056
    v_mfma_f32_16x16x32_bf16 v[40:43], v[172:175], v[204:207], v[40:43]
    v_cvt_pk_bf16_f32 v162, v88, v89
    v_cvt_pk_bf16_f32 v163, v90, v91
    v_mfma_f32_16x16x32_bf16 v[44:47], v[172:175], v[220:223], v[44:47]
    v_cvt_pk_bf16_f32 v164, v68, v69
    s_waitcnt lgkmcnt(3)
    v_mfma_f32_16x16x32_bf16 v[24:27], v[176:179], a[200:203], v[24:27]
    v_exp_f32 v92, v92
    v_mfma_f32_16x16x32_bf16 v[28:31], v[176:179], a[216:219], v[28:31]
    v_exp_f32 v93, v93
    v_mfma_f32_16x16x32_bf16 v[32:35], v[176:179], a[232:235], v[32:35]
    v_exp_f32 v94, v94
    v_mfma_f32_16x16x32_bf16 v[36:39], v[176:179], a[248:251], v[36:39]
    v_exp_f32 v95, v95
    v_mfma_f32_16x16x32_bf16 v[40:43], v[176:179], v[208:211], v[40:43]
    ds_read_b64_tr_b16 v[172:173], v194 offset:8704
    ds_read_b64_tr_b16 v[174:175], v194 offset:13056
    v_mfma_f32_16x16x32_bf16 v[44:47], v[176:179], v[224:227], v[44:47]
    v_cvt_pk_bf16_f32 v165, v70, v71
    s_waitcnt lgkmcnt(4)
    v_mfma_f32_16x16x32_bf16 v[24:27], v[180:183], a[204:207], v[24:27]
    v_cvt_pk_bf16_f32 v166, v92, v93
    v_cvt_pk_bf16_f32 v167, v94, v95
    v_mfma_f32_16x16x32_bf16 v[28:31], v[180:183], a[220:223], v[28:31]
    v_mfma_f32_16x16x32_bf16 v[32:35], v[180:183], a[236:239], v[32:35]
    v_mfma_f32_16x16x32_bf16 v[36:39], v[180:183], a[252:255], v[36:39]
    v_mfma_f32_16x16x32_bf16 v[40:43], v[180:183], v[212:215], v[40:43]
    v_exp_f32 v0, v0
    v_mfma_f32_16x16x32_bf16 v[44:47], v[180:183], v[228:231], v[44:47]
    s_waitcnt lgkmcnt(2)
    v_mfma_f32_16x16x32_bf16 a[0:3], v[168:171], v[144:147], a[0:3]
    ds_read_b64_tr_b16 v[176:177], v193 offset:8768
    ds_read_b64_tr_b16 v[178:179], v193 offset:13120
    v_mfma_f32_16x16x32_bf16 a[4:7], v[168:171], v[148:151], a[4:7]
    v_exp_f32 v1, v1
    v_mfma_f32_16x16x32_bf16 a[8:11], v[168:171], v[152:155], a[8:11]
    v_exp_f32 v2, v2
    v_mfma_f32_16x16x32_bf16 a[12:15], v[168:171], v[156:159], a[12:15]
    v_exp_f32 v3, v3
    v_mfma_f32_16x16x32_bf16 a[16:19], v[168:171], v[160:163], a[16:19]
    v_exp_f32 v4, v4
    v_mfma_f32_16x16x32_bf16 a[20:23], v[168:171], v[164:167], a[20:23]
    v_exp_f32 v5, v5
    v_mfma_f32_16x16x32_bf16 v[120:123], v[184:187], v[144:147], v[120:123]
    s_waitcnt lgkmcnt(2)
    v_mfma_f32_16x16x32_bf16 a[24:27], v[172:175], v[144:147], a[24:27]
    ds_read_b64_tr_b16 v[180:181], v194 offset:8768
    ds_read_b64_tr_b16 v[182:183], v194 offset:13120
    v_mfma_f32_16x16x32_bf16 a[28:31], v[172:175], v[148:151], a[28:31]
    v_exp_f32 v6, v6
    v_mfma_f32_16x16x32_bf16 a[32:35], v[172:175], v[152:155], a[32:35]
    v_exp_f32 v7, v7
    v_mfma_f32_16x16x32_bf16 a[36:39], v[172:175], v[156:159], a[36:39]
    v_exp_f32 v8, v8
    v_mfma_f32_16x16x32_bf16 a[40:43], v[172:175], v[160:163], a[40:43]
    v_exp_f32 v9, v9
    v_mfma_f32_16x16x32_bf16 a[44:47], v[172:175], v[164:167], a[44:47]
    v_exp_f32 v10, v10
    v_mfma_f32_16x16x32_bf16 v[124:127], v[184:187], v[148:151], v[124:127]
    s_waitcnt lgkmcnt(2)
    v_mfma_f32_16x16x32_bf16 a[48:51], v[176:179], v[144:147], a[48:51]
    ds_read_b64_tr_b16 v[168:169], v195 offset:8704
    ds_read_b64_tr_b16 v[170:171], v195 offset:13056
    v_mfma_f32_16x16x32_bf16 a[52:55], v[176:179], v[148:151], a[52:55]
    v_exp_f32 v11, v11
    v_mfma_f32_16x16x32_bf16 a[56:59], v[176:179], v[152:155], a[56:59]
    v_exp_f32 v12, v12
    v_mfma_f32_16x16x32_bf16 a[60:63], v[176:179], v[156:159], a[60:63]
    v_exp_f32 v13, v13
    v_mfma_f32_16x16x32_bf16 a[64:67], v[176:179], v[160:163], a[64:67]
    v_exp_f32 v14, v14
    v_mfma_f32_16x16x32_bf16 a[68:71], v[176:179], v[164:167], a[68:71]
    v_exp_f32 v15, v15
    v_mfma_f32_16x16x32_bf16 v[128:131], v[184:187], v[152:155], v[128:131]
    s_waitcnt lgkmcnt(2)
    v_mfma_f32_16x16x32_bf16 a[72:75], v[180:183], v[144:147], a[72:75]
    ds_read_b64_tr_b16 v[172:173], v196 offset:8704
    ds_read_b64_tr_b16 v[174:175], v196 offset:13056
    v_mfma_f32_16x16x32_bf16 a[76:79], v[180:183], v[148:151], a[76:79]
    v_exp_f32 v16, v16
    v_mfma_f32_16x16x32_bf16 a[80:83], v[180:183], v[152:155], a[80:83]
    v_exp_f32 v17, v17
    v_mfma_f32_16x16x32_bf16 a[84:87], v[180:183], v[156:159], a[84:87]
    v_exp_f32 v18, v18
    v_mfma_f32_16x16x32_bf16 a[88:91], v[180:183], v[160:163], a[88:91]
    v_exp_f32 v19, v19
    v_mfma_f32_16x16x32_bf16 a[92:95], v[180:183], v[164:167], a[92:95]
    v_exp_f32 v20, v20
    v_mfma_f32_16x16x32_bf16 v[132:135], v[184:187], v[156:159], v[132:135]
    s_waitcnt lgkmcnt(2)
    v_mfma_f32_16x16x32_bf16 a[96:99], v[168:171], v[144:147], a[96:99]
    ds_read_b64_tr_b16 v[176:177], v195 offset:8768
    ds_read_b64_tr_b16 v[178:179], v195 offset:13120
    v_mfma_f32_16x16x32_bf16 a[100:103], v[168:171], v[148:151], a[100:103]
    v_exp_f32 v21, v21
    v_mfma_f32_16x16x32_bf16 a[104:107], v[168:171], v[152:155], a[104:107]
    v_exp_f32 v22, v22
    v_mfma_f32_16x16x32_bf16 a[108:111], v[168:171], v[156:159], a[108:111]
    v_exp_f32 v23, v23
    v_mfma_f32_16x16x32_bf16 a[112:115], v[168:171], v[160:163], a[112:115]
    v_exp_f32 v24, v24
    v_mfma_f32_16x16x32_bf16 a[116:119], v[168:171], v[164:167], a[116:119]
    ds_read_b64_tr_b16 v[180:181], v196 offset:8768
    ds_read_b64_tr_b16 v[182:183], v196 offset:13120
    v_mfma_f32_16x16x32_bf16 v[136:139], v[184:187], v[160:163], v[136:139]
    s_waitcnt lgkmcnt(4)
    v_mfma_f32_16x16x32_bf16 a[120:123], v[172:175], v[144:147], a[120:123]
    v_exp_f32 v25, v25
    v_mfma_f32_16x16x32_bf16 a[124:127], v[172:175], v[148:151], a[124:127]
    v_exp_f32 v26, v26
    v_mfma_f32_16x16x32_bf16 a[128:131], v[172:175], v[152:155], a[128:131]
    v_exp_f32 v27, v27
    v_mfma_f32_16x16x32_bf16 a[132:135], v[172:175], v[156:159], a[132:135]
    v_exp_f32 v28, v28
    v_mfma_f32_16x16x32_bf16 a[136:139], v[172:175], v[160:163], a[136:139]
    ds_read_b128 v[168:171], v192 offset:26112
    v_mfma_f32_16x16x32_bf16 a[140:143], v[172:175], v[164:167], a[140:143]
    v_exp_f32 v29, v29
    v_mfma_f32_16x16x32_bf16 v[140:143], v[184:187], v[164:167], v[140:143]
    s_waitcnt lgkmcnt(3)
    v_mfma_f32_16x16x32_bf16 a[144:147], v[176:179], v[144:147], a[144:147]
    v_mfma_f32_16x16x32_bf16 a[148:151], v[176:179], v[148:151], a[148:151]
    v_mfma_f32_16x16x32_bf16 a[152:155], v[176:179], v[152:155], a[152:155]
    v_mfma_f32_16x16x32_bf16 a[156:159], v[176:179], v[156:159], a[156:159]
    ds_read_b128 v[172:175], v192 offset:26176
    v_mfma_f32_16x16x32_bf16 a[160:163], v[176:179], v[160:163], a[160:163]
    v_mfma_f32_16x16x32_bf16 a[164:167], v[176:179], v[164:167], a[164:167]
    s_waitcnt lgkmcnt(2)
    v_mfma_f32_16x16x32_bf16 a[168:171], v[180:183], v[144:147], a[168:171]
    s_waitcnt vmcnt(10)
    s_barrier
    v_mfma_f32_16x16x32_bf16 a[172:175], v[180:183], v[148:151], a[172:175]
    v_mfma_f32_16x16x32_bf16 a[176:179], v[180:183], v[152:155], a[176:179]
    v_mfma_f32_16x16x32_bf16 a[180:183], v[180:183], v[156:159], a[180:183]
    v_mfma_f32_16x16x32_bf16 a[184:187], v[180:183], v[160:163], a[184:187]
    v_mfma_f32_16x16x32_bf16 a[188:191], v[180:183], v[164:167], a[188:191]
    s_waitcnt lgkmcnt(1)
    v_mfma_f32_16x16x32_bf16 v[48:51], v[168:171], a[192:195], v[96:99]
    ds_read_b128 v[176:179], v192 offset:26240
    v_cvt_pk_bf16_f32 v144, v0, v1
    v_mfma_f32_16x16x32_bf16 v[52:55], v[168:171], a[208:211], v[100:103]
    v_cvt_pk_bf16_f32 v145, v2, v3
    v_cvt_pk_bf16_f32 v146, v24, v25
    v_mfma_f32_16x16x32_bf16 v[56:59], v[168:171], a[224:227], v[104:107]
    v_cvt_pk_bf16_f32 v147, v26, v27
    v_cvt_pk_bf16_f32 v148, v4, v5
    v_mfma_f32_16x16x32_bf16 v[60:63], v[168:171], a[240:243], v[108:111]
    ds_read_b128 v[180:183], v192 offset:26304
    v_cvt_pk_bf16_f32 v149, v6, v7
    v_mfma_f32_16x16x32_bf16 v[64:67], v[168:171], v[200:203], v[112:115]
    v_exp_f32 v30, v30
    v_mfma_f32_16x16x32_bf16 v[68:71], v[168:171], v[216:219], v[116:119]
    v_cvt_pk_bf16_f32 v150, v28, v29
    s_waitcnt lgkmcnt(2)
    v_mfma_f32_16x16x32_bf16 v[48:51], v[172:175], a[196:199], v[48:51]
    v_exp_f32 v31, v31
    v_mfma_f32_16x16x32_bf16 v[52:55], v[172:175], a[212:215], v[52:55]
    v_cvt_pk_bf16_f32 v151, v30, v31
    v_cvt_pk_bf16_f32 v152, v8, v9
    v_mfma_f32_16x16x32_bf16 v[56:59], v[172:175], a[228:231], v[56:59]
    s_lshl_b32 s34, s4, 2
    s_add_u32 s34, s34, s3
    v_mfma_f32_16x16x32_bf16 v[60:63], v[172:175], a[244:247], v[60:63]
    s_mul_i32 s34, s34, 9216
    s_add_u32 s34, s34, 0
    v_mfma_f32_16x16x32_bf16 v[64:67], v[172:175], v[204:207], v[64:67]
    ds_read_b128 v[168:171], v192 offset:30464
    v_cvt_pk_bf16_f32 v153, v10, v11
    v_mfma_f32_16x16x32_bf16 v[68:71], v[172:175], v[220:223], v[68:71]
    s_waitcnt lgkmcnt(2)
    v_mfma_f32_16x16x32_bf16 v[48:51], v[176:179], a[200:203], v[48:51]
    buffer_load_dword v244, v239, s[20:23], s34 offen
    v_mfma_f32_16x16x32_bf16 v[52:55], v[176:179], a[216:219], v[52:55]
    s_lshl_b32 s34, s4, 2
    s_add_u32 s34, s34, s3
    v_mfma_f32_16x16x32_bf16 v[56:59], v[176:179], a[232:235], v[56:59]
    s_mul_i32 s34, s34, 9216
    s_add_u32 s34, s34, 4608
    v_mfma_f32_16x16x32_bf16 v[60:63], v[176:179], a[248:251], v[60:63]
    buffer_load_dword v244, v239, s[20:23], s34 offen
    v_mfma_f32_16x16x32_bf16 v[64:67], v[176:179], v[208:211], v[64:67]
    ds_read_b128 v[172:175], v192 offset:30528
    v_mfma_f32_16x16x32_bf16 v[68:71], v[176:179], v[224:227], v[68:71]
    s_waitcnt lgkmcnt(2)
    v_mfma_f32_16x16x32_bf16 v[48:51], v[180:183], a[204:207], v[48:51]
    v_exp_f32 v32, v32
    v_mfma_f32_16x16x32_bf16 v[52:55], v[180:183], a[220:223], v[52:55]
    v_exp_f32 v33, v33
    v_mfma_f32_16x16x32_bf16 v[56:59], v[180:183], a[236:239], v[56:59]
    v_exp_f32 v34, v34
    v_mfma_f32_16x16x32_bf16 v[60:63], v[180:183], a[252:255], v[60:63]
    ds_read_b128 v[176:179], v192 offset:30592
    v_cvt_pk_bf16_f32 v154, v32, v33
    v_mfma_f32_16x16x32_bf16 v[64:67], v[180:183], v[212:215], v[64:67]
    v_exp_f32 v35, v35
    v_mfma_f32_16x16x32_bf16 v[68:71], v[180:183], v[228:231], v[68:71]
    v_cvt_pk_bf16_f32 v155, v34, v35
    s_waitcnt lgkmcnt(2)
    v_mfma_f32_16x16x32_bf16 v[72:75], v[168:171], a[192:195], v[96:99]
    v_exp_f32 v36, v36
    v_mfma_f32_16x16x32_bf16 v[76:79], v[168:171], a[208:211], v[100:103]
    v_exp_f32 v37, v37
    v_mfma_f32_16x16x32_bf16 v[80:83], v[168:171], a[224:227], v[104:107]
    v_exp_f32 v38, v38
    v_mfma_f32_16x16x32_bf16 v[84:87], v[168:171], a[240:243], v[108:111]
    ds_read_b128 v[180:183], v192 offset:30656
    v_cvt_pk_bf16_f32 v156, v12, v13
    v_mfma_f32_16x16x32_bf16 v[88:91], v[168:171], v[200:203], v[112:115]
    v_exp_f32 v39, v39
    v_mfma_f32_16x16x32_bf16 v[92:95], v[168:171], v[216:219], v[116:119]
    v_cvt_pk_bf16_f32 v157, v14, v15
    s_waitcnt lgkmcnt(2)
    v_mfma_f32_16x16x32_bf16 v[72:75], v[172:175], a[196:199], v[72:75]
    v_cvt_pk_bf16_f32 v158, v36, v37
    v_cvt_pk_bf16_f32 v159, v38, v39
    v_mfma_f32_16x16x32_bf16 v[76:79], v[172:175], a[212:215], v[76:79]
    v_exp_f32 v40, v40
    v_mfma_f32_16x16x32_bf16 v[80:83], v[172:175], a[228:231], v[80:83]
    v_exp_f32 v41, v41
    v_mfma_f32_16x16x32_bf16 v[84:87], v[172:175], a[244:247], v[84:87]
    ds_read_b64_tr_b16 v[168:169], v193 offset:17408
    ds_read_b64_tr_b16 v[170:171], v193 offset:21760
    v_mfma_f32_16x16x32_bf16 v[88:91], v[172:175], v[204:207], v[88:91]
    v_exp_f32 v42, v42
    v_mfma_f32_16x16x32_bf16 v[92:95], v[172:175], v[220:223], v[92:95]
    v_cvt_pk_bf16_f32 v160, v16, v17
    s_waitcnt lgkmcnt(3)
    v_mfma_f32_16x16x32_bf16 v[72:75], v[176:179], a[200:203], v[72:75]
    v_exp_f32 v43, v43
    v_mfma_f32_16x16x32_bf16 v[76:79], v[176:179], a[216:219], v[76:79]
    v_cvt_pk_bf16_f32 v161, v18, v19
    v_cvt_pk_bf16_f32 v162, v40, v41
    v_mfma_f32_16x16x32_bf16 v[80:83], v[176:179], a[232:235], v[80:83]
    v_cvt_pk_bf16_f32 v163, v42, v43
    v_cvt_pk_bf16_f32 v164, v20, v21
    v_mfma_f32_16x16x32_bf16 v[84:87], v[176:179], a[248:251], v[84:87]
    v_exp_f32 v44, v44
    v_mfma_f32_16x16x32_bf16 v[88:91], v[176:179], v[208:211], v[88:91]
    ds_read_b64_tr_b16 v[172:173], v194 offset:17408
    ds_read_b64_tr_b16 v[174:175], v194 offset:21760
    v_mfma_f32_16x16x32_bf16 v[92:95], v[176:179], v[224:227], v[92:95]
    v_cvt_pk_bf16_f32 v165, v22, v23
    s_waitcnt lgkmcnt(4)
    v_mfma_f32_16x16x32_bf16 v[72:75], v[180:183], a[204:207], v[72:75]
    v_exp_f32 v45, v45
    v_mfma_f32_16x16x32_bf16 v[76:79], v[180:183], a[220:223], v[76:79]
    v_exp_f32 v46, v46
    v_mfma_f32_16x16x32_bf16 v[80:83], v[180:183], a[236:239], v[80:83]
    v_exp_f32 v47, v47
    v_mfma_f32_16x16x32_bf16 v[84:87], v[180:183], a[252:255], v[84:87]
    v_cvt_pk_bf16_f32 v166, v44, v45
    v_cvt_pk_bf16_f32 v167, v46, v47
    v_mfma_f32_16x16x32_bf16 v[88:91], v[180:183], v[212:215], v[88:91]
    v_exp_f32 v48, v48
    v_mfma_f32_16x16x32_bf16 v[92:95], v[180:183], v[228:231], v[92:95]
    s_waitcnt lgkmcnt(2)
    v_mfma_f32_16x16x32_bf16 a[0:3], v[168:171], v[144:147], a[0:3]
    ds_read_b64_tr_b16 v[176:177], v193 offset:17472
    ds_read_b64_tr_b16 v[178:179], v193 offset:21824
    v_mfma_f32_16x16x32_bf16 a[4:7], v[168:171], v[148:151], a[4:7]
    v_exp_f32 v49, v49
    v_mfma_f32_16x16x32_bf16 a[8:11], v[168:171], v[152:155], a[8:11]
    v_exp_f32 v50, v50
    v_mfma_f32_16x16x32_bf16 a[12:15], v[168:171], v[156:159], a[12:15]
    v_exp_f32 v51, v51
    v_mfma_f32_16x16x32_bf16 a[16:19], v[168:171], v[160:163], a[16:19]
    v_exp_f32 v52, v52
    v_mfma_f32_16x16x32_bf16 a[20:23], v[168:171], v[164:167], a[20:23]
    v_exp_f32 v53, v53
    v_mfma_f32_16x16x32_bf16 v[120:123], v[184:187], v[144:147], v[120:123]
    s_waitcnt lgkmcnt(2)
    v_mfma_f32_16x16x32_bf16 a[24:27], v[172:175], v[144:147], a[24:27]
    ds_read_b64_tr_b16 v[180:181], v194 offset:17472
    ds_read_b64_tr_b16 v[182:183], v194 offset:21824
    v_mfma_f32_16x16x32_bf16 a[28:31], v[172:175], v[148:151], a[28:31]
    v_exp_f32 v54, v54
    v_mfma_f32_16x16x32_bf16 a[32:35], v[172:175], v[152:155], a[32:35]
    v_exp_f32 v55, v55
    v_mfma_f32_16x16x32_bf16 a[36:39], v[172:175], v[156:159], a[36:39]
    v_exp_f32 v56, v56
    v_mfma_f32_16x16x32_bf16 a[40:43], v[172:175], v[160:163], a[40:43]
    v_exp_f32 v57, v57
    v_mfma_f32_16x16x32_bf16 a[44:47], v[172:175], v[164:167], a[44:47]
    v_exp_f32 v58, v58
    v_mfma_f32_16x16x32_bf16 v[124:127], v[184:187], v[148:151], v[124:127]
    s_waitcnt lgkmcnt(2)
    v_mfma_f32_16x16x32_bf16 a[48:51], v[176:179], v[144:147], a[48:51]
    ds_read_b64_tr_b16 v[168:169], v195 offset:17408
    ds_read_b64_tr_b16 v[170:171], v195 offset:21760
    v_mfma_f32_16x16x32_bf16 a[52:55], v[176:179], v[148:151], a[52:55]
    v_exp_f32 v59, v59
    v_mfma_f32_16x16x32_bf16 a[56:59], v[176:179], v[152:155], a[56:59]
    v_exp_f32 v60, v60
    v_mfma_f32_16x16x32_bf16 a[60:63], v[176:179], v[156:159], a[60:63]
    v_exp_f32 v61, v61
    v_mfma_f32_16x16x32_bf16 a[64:67], v[176:179], v[160:163], a[64:67]
    v_exp_f32 v62, v62
    v_mfma_f32_16x16x32_bf16 a[68:71], v[176:179], v[164:167], a[68:71]
    v_exp_f32 v63, v63
    v_mfma_f32_16x16x32_bf16 v[128:131], v[184:187], v[152:155], v[128:131]
    s_waitcnt lgkmcnt(2)
    v_mfma_f32_16x16x32_bf16 a[72:75], v[180:183], v[144:147], a[72:75]
    ds_read_b64_tr_b16 v[172:173], v196 offset:17408
    ds_read_b64_tr_b16 v[174:175], v196 offset:21760
    v_mfma_f32_16x16x32_bf16 a[76:79], v[180:183], v[148:151], a[76:79]
    v_exp_f32 v64, v64
    v_mfma_f32_16x16x32_bf16 a[80:83], v[180:183], v[152:155], a[80:83]
    v_exp_f32 v65, v65
    v_mfma_f32_16x16x32_bf16 a[84:87], v[180:183], v[156:159], a[84:87]
    v_exp_f32 v66, v66
    v_mfma_f32_16x16x32_bf16 a[88:91], v[180:183], v[160:163], a[88:91]
    v_exp_f32 v67, v67
    v_mfma_f32_16x16x32_bf16 a[92:95], v[180:183], v[164:167], a[92:95]
    v_exp_f32 v68, v68
    v_mfma_f32_16x16x32_bf16 v[132:135], v[184:187], v[156:159], v[132:135]
    s_waitcnt lgkmcnt(2)
    v_mfma_f32_16x16x32_bf16 a[96:99], v[168:171], v[144:147], a[96:99]
    ds_read_b64_tr_b16 v[176:177], v195 offset:17472
    ds_read_b64_tr_b16 v[178:179], v195 offset:21824
    v_mfma_f32_16x16x32_bf16 a[100:103], v[168:171], v[148:151], a[100:103]
    v_exp_f32 v69, v69
    v_mfma_f32_16x16x32_bf16 a[104:107], v[168:171], v[152:155], a[104:107]
    v_exp_f32 v70, v70
    v_mfma_f32_16x16x32_bf16 a[108:111], v[168:171], v[156:159], a[108:111]
    v_exp_f32 v71, v71
    v_mfma_f32_16x16x32_bf16 a[112:115], v[168:171], v[160:163], a[112:115]
    v_exp_f32 v72, v72
    v_mfma_f32_16x16x32_bf16 a[116:119], v[168:171], v[164:167], a[116:119]
    ds_read_b64_tr_b16 v[180:181], v196 offset:17472
    ds_read_b64_tr_b16 v[182:183], v196 offset:21824
    v_mfma_f32_16x16x32_bf16 v[136:139], v[184:187], v[160:163], v[136:139]
    s_waitcnt lgkmcnt(4)
    v_mfma_f32_16x16x32_bf16 a[120:123], v[172:175], v[144:147], a[120:123]
    v_exp_f32 v73, v73
    v_mfma_f32_16x16x32_bf16 a[124:127], v[172:175], v[148:151], a[124:127]
    v_exp_f32 v74, v74
    v_mfma_f32_16x16x32_bf16 a[128:131], v[172:175], v[152:155], a[128:131]
    v_exp_f32 v75, v75
    v_mfma_f32_16x16x32_bf16 a[132:135], v[172:175], v[156:159], a[132:135]
    v_exp_f32 v76, v76
    v_mfma_f32_16x16x32_bf16 a[136:139], v[172:175], v[160:163], a[136:139]
    v_exp_f32 v77, v77
    v_mfma_f32_16x16x32_bf16 a[140:143], v[172:175], v[164:167], a[140:143]
    v_exp_f32 v78, v78
    v_mfma_f32_16x16x32_bf16 v[140:143], v[184:187], v[164:167], v[140:143]
    s_waitcnt lgkmcnt(2)
    v_mfma_f32_16x16x32_bf16 a[144:147], v[176:179], v[144:147], a[144:147]
    v_exp_f32 v79, v79
    v_mfma_f32_16x16x32_bf16 a[148:151], v[176:179], v[148:151], a[148:151]
    v_exp_f32 v80, v80
    v_mfma_f32_16x16x32_bf16 a[152:155], v[176:179], v[152:155], a[152:155]
    v_exp_f32 v81, v81
    v_mfma_f32_16x16x32_bf16 a[156:159], v[176:179], v[156:159], a[156:159]
    v_exp_f32 v82, v82
    v_mfma_f32_16x16x32_bf16 a[160:163], v[176:179], v[160:163], a[160:163]
    v_exp_f32 v83, v83
    v_mfma_f32_16x16x32_bf16 a[164:167], v[176:179], v[164:167], a[164:167]
    s_waitcnt lgkmcnt(0)
    v_mfma_f32_16x16x32_bf16 a[168:171], v[180:183], v[144:147], a[168:171]
    s_waitcnt vmcnt(4)
    s_barrier
    v_mfma_f32_16x16x32_bf16 a[172:175], v[180:183], v[148:151], a[172:175]
    v_exp_f32 v84, v84
    v_mfma_f32_16x16x32_bf16 a[176:179], v[180:183], v[152:155], a[176:179]
    v_exp_f32 v85, v85
    v_mfma_f32_16x16x32_bf16 a[180:183], v[180:183], v[156:159], a[180:183]
    v_exp_f32 v86, v86
    v_mfma_f32_16x16x32_bf16 a[184:187], v[180:183], v[160:163], a[184:187]
    v_exp_f32 v87, v87
    v_mfma_f32_16x16x32_bf16 a[188:191], v[180:183], v[164:167], a[188:191]
    v_exp_f32 v88, v88
    v_exp_f32 v89, v89
    v_exp_f32 v90, v90
    v_exp_f32 v91, v91
    v_exp_f32 v92, v92
    v_exp_f32 v93, v93
    v_exp_f32 v94, v94
    v_exp_f32 v95, v95
    ds_read_b64_tr_b16 v[168:169], v193 offset:26112
    ds_read_b64_tr_b16 v[170:171], v193 offset:30464
    ds_read_b64_tr_b16 v[172:173], v194 offset:26112
    ds_read_b64_tr_b16 v[174:175], v194 offset:30464
    v_cvt_pk_bf16_f32 v144, v48, v49
    v_cvt_pk_bf16_f32 v145, v50, v51
    v_cvt_pk_bf16_f32 v146, v72, v73
    v_cvt_pk_bf16_f32 v147, v74, v75
    v_cvt_pk_bf16_f32 v148, v52, v53
    v_cvt_pk_bf16_f32 v149, v54, v55
    v_cvt_pk_bf16_f32 v150, v76, v77
    v_cvt_pk_bf16_f32 v151, v78, v79
    v_cvt_pk_bf16_f32 v152, v56, v57
    v_cvt_pk_bf16_f32 v153, v58, v59
    v_cvt_pk_bf16_f32 v154, v80, v81
    v_cvt_pk_bf16_f32 v155, v82, v83
    s_waitcnt lgkmcnt(2)
    v_mfma_f32_16x16x32_bf16 a[0:3], v[168:171], v[144:147], a[0:3]
    v_cvt_pk_bf16_f32 v156, v60, v61
    v_cvt_pk_bf16_f32 v157, v62, v63
    v_cvt_pk_bf16_f32 v158, v84, v85
    v_cvt_pk_bf16_f32 v159, v86, v87
    v_mfma_f32_16x16x32_bf16 a[4:7], v[168:171], v[148:151], a[4:7]
    v_cvt_pk_bf16_f32 v160, v64, v65
    v_cvt_pk_bf16_f32 v161, v66, v67
    v_cvt_pk_bf16_f32 v162, v88, v89
    v_cvt_pk_bf16_f32 v163, v90, v91
    v_mfma_f32_16x16x32_bf16 a[8:11], v[168:171], v[152:155], a[8:11]
    v_cvt_pk_bf16_f32 v164, v68, v69
    v_cvt_pk_bf16_f32 v165, v70, v71
    v_cvt_pk_bf16_f32 v166, v92, v93
    v_cvt_pk_bf16_f32 v167, v94, v95
    v_mfma_f32_16x16x32_bf16 a[12:15], v[168:171], v[156:159], a[12:15]
    v_mfma_f32_16x16x32_bf16 a[16:19], v[168:171], v[160:163], a[16:19]
    v_mfma_f32_16x16x32_bf16 a[20:23], v[168:171], v[164:167], a[20:23]
    ds_read_b64_tr_b16 v[176:177], v193 offset:26176
    ds_read_b64_tr_b16 v[178:179], v193 offset:30528
    v_mfma_f32_16x16x32_bf16 v[120:123], v[184:187], v[144:147], v[120:123]
    s_add_u32 m0, s80, 0
    s_mov_b32 s81, 1024
    v_mfma_f32_16x16x32_bf16 v[124:127], v[184:187], v[148:151], v[124:127]
    s_add_u32 s73, s44, s81
    buffer_load_dwordx4 v240, s[20:23], s73 offen lds
    v_mfma_f32_16x16x32_bf16 v[128:131], v[184:187], v[152:155], v[128:131]
    s_add_u32 m0, s80, 4096
    s_add_u32 s73, s45, s81
    v_mfma_f32_16x16x32_bf16 v[132:135], v[184:187], v[156:159], v[132:135]
    buffer_load_dwordx4 v240, s[20:23], s73 offen lds
    v_mfma_f32_16x16x32_bf16 v[136:139], v[184:187], v[160:163], v[136:139]
    ds_read_b64_tr_b16 v[180:181], v194 offset:26176
    ds_read_b64_tr_b16 v[182:183], v194 offset:30528
    v_mfma_f32_16x16x32_bf16 v[140:143], v[184:187], v[164:167], v[140:143]
    s_add_u32 m0, s80, 8192
    s_add_u32 s73, s46, s81
    s_waitcnt lgkmcnt(4)
    v_mfma_f32_16x16x32_bf16 a[24:27], v[172:175], v[144:147], a[24:27]
    buffer_load_dwordx4 v240, s[20:23], s73 offen lds
    v_mfma_f32_16x16x32_bf16 a[28:31], v[172:175], v[148:151], a[28:31]
    s_add_u32 m0, s80, 12288
    s_add_u32 s73, s47, s81
    v_mfma_f32_16x16x32_bf16 a[32:35], v[172:175], v[152:155], a[32:35]
    buffer_load_dwordx4 v240, s[20:23], s73 offen lds
    v_mfma_f32_16x16x32_bf16 a[36:39], v[172:175], v[156:159], a[36:39]
    ds_read_b64_tr_b16 v[168:169], v195 offset:26112
    ds_read_b64_tr_b16 v[170:171], v195 offset:30464
    v_mfma_f32_16x16x32_bf16 a[40:43], v[172:175], v[160:163], a[40:43]
    s_add_u32 m0, s80, 16384
    s_add_u32 s81, s81, 36864
    s_add_u32 s73, s44, s81
    v_mfma_f32_16x16x32_bf16 a[44:47], v[172:175], v[164:167], a[44:47]
    buffer_load_dwordx4 v240, s[20:23], s73 offen lds
    v_mov_b32 v121, v120
    s_waitcnt lgkmcnt(4)
    v_mfma_f32_16x16x32_bf16 a[48:51], v[176:179], v[144:147], a[48:51]
    s_add_u32 m0, s80, 20480
    s_add_u32 s73, s45, s81
    v_mfma_f32_16x16x32_bf16 a[52:55], v[176:179], v[148:151], a[52:55]
    buffer_load_dwordx4 v240, s[20:23], s73 offen lds
    v_mfma_f32_16x16x32_bf16 a[56:59], v[176:179], v[152:155], a[56:59]
    ds_read_b64_tr_b16 v[172:173], v196 offset:26112
    ds_read_b64_tr_b16 v[174:175], v196 offset:30464
    v_mfma_f32_16x16x32_bf16 a[60:63], v[176:179], v[156:159], a[60:63]
    s_add_u32 m0, s80, 24576
    s_add_u32 s73, s46, s81
    v_mov_b32 v125, v124
    v_mfma_f32_16x16x32_bf16 a[64:67], v[176:179], v[160:163], a[64:67]
    buffer_load_dwordx4 v240, s[20:23], s73 offen lds
    v_mfma_f32_16x16x32_bf16 a[68:71], v[176:179], v[164:167], a[68:71]
    s_add_u32 m0, s80, 28672
    s_add_u32 s73, s47, s81
    s_waitcnt lgkmcnt(4)
    v_mfma_f32_16x16x32_bf16 a[72:75], v[180:183], v[144:147], a[72:75]
    buffer_load_dwordx4 v240, s[20:23], s73 offen lds
    v_mfma_f32_16x16x32_bf16 a[76:79], v[180:183], v[148:151], a[76:79]
    ds_read_b64_tr_b16 v[176:177], v195 offset:26176
    ds_read_b64_tr_b16 v[178:179], v195 offset:30528
    v_mov_b32 v129, v128
    v_mfma_f32_16x16x32_bf16 a[80:83], v[180:183], v[152:155], a[80:83]
    s_add_u32 m0, s80, 32768
    s_add_u32 s81, s81, 36864
    v_mfma_f32_16x16x32_bf16 a[84:87], v[180:183], v[156:159], a[84:87]
    s_add_u32 s73, s44, s81
    buffer_load_dwordx4 v240, s[20:23], s73 offen lds
    v_mfma_f32_16x16x32_bf16 a[88:91], v[180:183], v[160:163], a[88:91]
    s_add_u32 m0, s80, 36864
    s_add_u32 s73, s45, s81
    v_mfma_f32_16x16x32_bf16 a[92:95], v[180:183], v[164:167], a[92:95]
    buffer_load_dwordx4 v240, s[20:23], s73 offen lds
    s_waitcnt lgkmcnt(4)
    v_mfma_f32_16x16x32_bf16 a[96:99], v[168:171], v[144:147], a[96:99]
    ds_read_b64_tr_b16 v[180:181], v196 offset:26176
    ds_read_b64_tr_b16 v[182:183], v196 offset:30528
    v_mfma_f32_16x16x32_bf16 a[100:103], v[168:171], v[148:151], a[100:103]
    s_add_u32 m0, s80, 40960
    s_add_u32 s73, s46, s81
    v_mfma_f32_16x16x32_bf16 a[104:107], v[168:171], v[152:155], a[104:107]
    buffer_load_dwordx4 v240, s[20:23], s73 offen lds
    v_mfma_f32_16x16x32_bf16 a[108:111], v[168:171], v[156:159], a[108:111]
    s_add_u32 m0, s80, 45056
    s_add_u32 s73, s47, s81
    v_mov_b32 v133, v132
    v_mfma_f32_16x16x32_bf16 a[112:115], v[168:171], v[160:163], a[112:115]
    buffer_load_dwordx4 v240, s[20:23], s73 offen lds
    v_mfma_f32_16x16x32_bf16 a[116:119], v[168:171], v[164:167], a[116:119]
    v_mov_b32 v137, v136
    v_mov_b32 v141, v140
    s_waitcnt lgkmcnt(4)
    v_mfma_f32_16x16x32_bf16 a[120:123], v[172:175], v[144:147], a[120:123]
    v_permlane32_swap_b32 v120, v121
    v_permlane32_swap_b32 v124, v125
    v_mfma_f32_16x16x32_bf16 a[124:127], v[172:175], v[148:151], a[124:127]
    v_permlane32_swap_b32 v128, v129
    v_permlane32_swap_b32 v132, v133
    v_permlane32_swap_b32 v136, v137
    v_mfma_f32_16x16x32_bf16 a[128:131], v[172:175], v[152:155], a[128:131]
    v_permlane32_swap_b32 v140, v141
    v_add_f32 v120, v120, v121
    v_mfma_f32_16x16x32_bf16 a[132:135], v[172:175], v[156:159], a[132:135]
    v_add_f32 v124, v124, v125
    v_add_f32 v128, v128, v129
    v_mfma_f32_16x16x32_bf16 a[136:139], v[172:175], v[160:163], a[136:139]
    v_add_f32 v132, v132, v133
    v_add_f32 v136, v136, v137
    v_mfma_f32_16x16x32_bf16 a[140:143], v[172:175], v[164:167], a[140:143]
    v_add_f32 v140, v140, v141
    v_mov_b32 v121, v120
    v_mov_b32 v125, v124
    s_waitcnt lgkmcnt(2)
    v_mfma_f32_16x16x32_bf16 a[144:147], v[176:179], v[144:147], a[144:147]
    v_mov_b32 v129, v128
    v_mov_b32 v133, v132
    v_mfma_f32_16x16x32_bf16 a[148:151], v[176:179], v[148:151], a[148:151]
    v_mov_b32 v137, v136
    v_mov_b32 v141, v140
    v_mfma_f32_16x16x32_bf16 a[152:155], v[176:179], v[152:155], a[152:155]
    v_permlane16_swap_b32 v120, v121
    v_permlane16_swap_b32 v124, v125
    v_mfma_f32_16x16x32_bf16 a[156:159], v[176:179], v[156:159], a[156:159]
    v_permlane16_swap_b32 v128, v129
    v_permlane16_swap_b32 v132, v133
    v_permlane16_swap_b32 v136, v137
    v_mfma_f32_16x16x32_bf16 a[160:163], v[176:179], v[160:163], a[160:163]
    v_permlane16_swap_b32 v140, v141
    v_add_f32 v120, v120, v121
    v_mfma_f32_16x16x32_bf16 a[164:167], v[176:179], v[164:167], a[164:167]
    v_add_f32 v124, v124, v125
    v_add_f32 v128, v128, v129
    s_waitcnt lgkmcnt(0)
    v_mfma_f32_16x16x32_bf16 a[168:171], v[180:183], v[144:147], a[168:171]
    s_barrier
    v_add_f32 v132, v132, v133
    v_mfma_f32_16x16x32_bf16 a[172:175], v[180:183], v[148:151], a[172:175]
    v_add_f32 v136, v136, v137
    v_add_f32 v140, v140, v141
    v_mfma_f32_16x16x32_bf16 a[176:179], v[180:183], v[152:155], a[176:179]
    v_rcp_f32 v80, v120
    v_mfma_f32_16x16x32_bf16 a[180:183], v[180:183], v[156:159], a[180:183]
    v_rcp_f32 v82, v124
    v_mfma_f32_16x16x32_bf16 a[184:187], v[180:183], v[160:163], a[184:187]
    v_rcp_f32 v84, v128
    v_mfma_f32_16x16x32_bf16 a[188:191], v[180:183], v[164:167], a[188:191]
    v_rcp_f32 v86, v132
    v_rcp_f32 v88, v136
    v_rcp_f32 v90, v140
L_norm:
    v_max3_f32 v188, v120, v124, v128
    v_max3_f32 v188, v188, v132, v136
    v_max_f32 v188, v188, v140
    v_cmp_nge_f32 vcc, s77, v188
    s_nop 1
    s_cmp_lg_u64 vcc, 0
    s_cselect_b32 s34, 1, 0
    s_andn2_b32 s34, s34, s51
    v_mov_b32 v189, s34
    s_lshl_b32 s34, s3, 2
    s_add_u32 s34, s34, 49152
    v_mov_b32 v190, s34
    ds_write_b32 v190, v189
    v_accvgpr_read_b32 v0, a0
    v_accvgpr_read_b32 v1, a1
    v_accvgpr_read_b32 v2, a2
    v_accvgpr_read_b32 v3, a3
    v_accvgpr_read_b32 v4, a24
    v_accvgpr_read_b32 v5, a25
    v_accvgpr_read_b32 v6, a26
    v_accvgpr_read_b32 v7, a27
    v_pk_mul_f32 v[0:1], v[0:1], v[80:81] op_sel_hi:[1,0]
    v_pk_mul_f32 v[2:3], v[2:3], v[80:81] op_sel_hi:[1,0]
    v_pk_mul_f32 v[4:5], v[4:5], v[80:81] op_sel_hi:[1,0]
    v_pk_mul_f32 v[6:7], v[6:7], v[80:81] op_sel_hi:[1,0]
    v_cvt_pk_bf16_f32 v0, v0, v1
    v_cvt_pk_bf16_f32 v1, v2, v3
    v_cvt_pk_bf16_f32 v2, v4, v5
    v_cvt_pk_bf16_f32 v3, v6, v7
    ds_write_b128 v238, v[0:3] offset:0
    v_accvgpr_read_b32 v8, a4
    v_accvgpr_read_b32 v9, a5
    v_accvgpr_read_b32 v10, a6
    v_accvgpr_read_b32 v11, a7
    v_accvgpr_read_b32 v12, a28
    v_accvgpr_read_b32 v13, a29
    v_accvgpr_read_b32 v14, a30
    v_accvgpr_read_b32 v15, a31
    v_pk_mul_f32 v[8:9], v[8:9], v[82:83] op_sel_hi:[1,0]
    v_pk_mul_f32 v[10:11], v[10:11], v[82:83] op_sel_hi:[1,0]
    v_pk_mul_f32 v[12:13], v[12:13], v[82:83] op_sel_hi:[1,0]
    v_pk_mul_f32 v[14:15], v[14:15], v[82:83] op_sel_hi:[1,0]
    v_cvt_pk_bf16_f32 v8, v8, v9
    v_cvt_pk_bf16_f32 v9, v10, v11
    v_cvt_pk_bf16_f32 v10, v12, v13
    v_cvt_pk_bf16_f32 v11, v14, v15
    ds_write_b128 v238, v[8:11] offset:1024
    v_accvgpr_read_b32 v16, a8
    v_accvgpr_read_b32 v17, a9
    v_accvgpr_read_b32 v18, a10
    v_accvgpr_read_b32 v19, a11
    v_accvgpr_read_b32 v20, a32
    v_accvgpr_read_b32 v21, a33
    v_accvgpr_read_b32 v22, a34
    v_accvgpr_read_b32 v23, a35
    v_pk_mul_f32 v[16:17], v[16:17], v[84:85] op_sel_hi:[1,0]
    v_pk_mul_f32 v[18:19], v[18:19], v[84:85] op_sel_hi:[1,0]
    v_pk_mul_f32 v[20:21], v[20:21], v[84:85] op_sel_hi:[1,0]
    v_pk_mul_f32 v[22:23], v[22:23], v[84:85] op_sel_hi:[1,0]
    v_cvt_pk_bf16_f32 v16, v16, v17
    v_cvt_pk_bf16_f32 v17, v18, v19
    v_cvt_pk_bf16_f32 v18, v20, v21
    v_cvt_pk_bf16_f32 v19, v22, v23
    ds_write_b128 v238, v[16:19] offset:2048
    v_accvgpr_read_b32 v24, a12
    v_accvgpr_read_b32 v25, a13
    v_accvgpr_read_b32 v26, a14
    v_accvgpr_read_b32 v27, a15
    v_accvgpr_read_b32 v28, a36
    v_accvgpr_read_b32 v29, a37
    v_accvgpr_read_b32 v30, a38
    v_accvgpr_read_b32 v31, a39
    v_pk_mul_f32 v[24:25], v[24:25], v[86:87] op_sel_hi:[1,0]
    v_pk_mul_f32 v[26:27], v[26:27], v[86:87] op_sel_hi:[1,0]
    v_pk_mul_f32 v[28:29], v[28:29], v[86:87] op_sel_hi:[1,0]
    v_pk_mul_f32 v[30:31], v[30:31], v[86:87] op_sel_hi:[1,0]
    v_cvt_pk_bf16_f32 v24, v24, v25
    v_cvt_pk_bf16_f32 v25, v26, v27
    v_cvt_pk_bf16_f32 v26, v28, v29
    v_cvt_pk_bf16_f32 v27, v30, v31
    ds_write_b128 v238, v[24:27] offset:3072
    v_accvgpr_read_b32 v32, a16
    v_accvgpr_read_b32 v33, a17
    v_accvgpr_read_b32 v34, a18
    v_accvgpr_read_b32 v35, a19
    v_accvgpr_read_b32 v36, a40
    v_accvgpr_read_b32 v37, a41
    v_accvgpr_read_b32 v38, a42
    v_accvgpr_read_b32 v39, a43
    v_pk_mul_f32 v[32:33], v[32:33], v[88:89] op_sel_hi:[1,0]
    v_pk_mul_f32 v[34:35], v[34:35], v[88:89] op_sel_hi:[1,0]
    v_pk_mul_f32 v[36:37], v[36:37], v[88:89] op_sel_hi:[1,0]
    v_pk_mul_f32 v[38:39], v[38:39], v[88:89] op_sel_hi:[1,0]
    v_cvt_pk_bf16_f32 v32, v32, v33
    v_cvt_pk_bf16_f32 v33, v34, v35
    v_cvt_pk_bf16_f32 v34, v36, v37
    v_cvt_pk_bf16_f32 v35, v38, v39
    ds_write_b128 v238, v[32:35] offset:4096
    v_accvgpr_read_b32 v40, a20
    v_accvgpr_read_b32 v41, a21
    v_accvgpr_read_b32 v42, a22
    v_accvgpr_read_b32 v43, a23
    v_accvgpr_read_b32 v44, a44
    v_accvgpr_read_b32 v45, a45
    v_accvgpr_read_b32 v46, a46
    v_accvgpr_read_b32 v47, a47
    v_pk_mul_f32 v[40:41], v[40:41], v[90:91] op_sel_hi:[1,0]
    v_pk_mul_f32 v[42:43], v[42:43], v[90:91] op_sel_hi:[1,0]
    v_pk_mul_f32 v[44:45], v[44:45], v[90:91] op_sel_hi:[1,0]
    v_pk_mul_f32 v[46:47], v[46:47], v[90:91] op_sel_hi:[1,0]
    v_cvt_pk_bf16_f32 v40, v40, v41
    v_cvt_pk_bf16_f32 v41, v42, v43
    v_cvt_pk_bf16_f32 v42, v44, v45
    v_cvt_pk_bf16_f32 v43, v46, v47
    ds_write_b128 v238, v[40:43] offset:5120
    v_accvgpr_read_b32 v0, a48
    v_accvgpr_read_b32 v1, a49
    v_accvgpr_read_b32 v2, a50
    v_accvgpr_read_b32 v3, a51
    v_accvgpr_read_b32 v4, a72
    v_accvgpr_read_b32 v5, a73
    v_accvgpr_read_b32 v6, a74
    v_accvgpr_read_b32 v7, a75
    v_pk_mul_f32 v[0:1], v[0:1], v[80:81] op_sel_hi:[1,0]
    v_pk_mul_f32 v[2:3], v[2:3], v[80:81] op_sel_hi:[1,0]
    v_pk_mul_f32 v[4:5], v[4:5], v[80:81] op_sel_hi:[1,0]
    v_pk_mul_f32 v[6:7], v[6:7], v[80:81] op_sel_hi:[1,0]
    v_cvt_pk_bf16_f32 v0, v0, v1
    v_cvt_pk_bf16_f32 v1, v2, v3
    v_cvt_pk_bf16_f32 v2, v4, v5
    v_cvt_pk_bf16_f32 v3, v6, v7
    ds_write_b128 v238, v[0:3] offset:6144
    v_accvgpr_read_b32 v8, a52
    v_accvgpr_read_b32 v9, a53
    v_accvgpr_read_b32 v10, a54
    v_accvgpr_read_b32 v11, a55
    v_accvgpr_read_b32 v12, a76
    v_accvgpr_read_b32 v13, a77
    v_accvgpr_read_b32 v14, a78
    v_accvgpr_read_b32 v15, a79
    v_pk_mul_f32 v[8:9], v[8:9], v[82:83] op_sel_hi:[1,0]
    v_pk_mul_f32 v[10:11], v[10:11], v[82:83] op_sel_hi:[1,0]
    v_pk_mul_f32 v[12:13], v[12:13], v[82:83] op_sel_hi:[1,0]
    v_pk_mul_f32 v[14:15], v[14:15], v[82:83] op_sel_hi:[1,0]
    v_cvt_pk_bf16_f32 v8, v8, v9
    v_cvt_pk_bf16_f32 v9, v10, v11
    v_cvt_pk_bf16_f32 v10, v12, v13
    v_cvt_pk_bf16_f32 v11, v14, v15
    ds_write_b128 v238, v[8:11] offset:7168
    v_accvgpr_read_b32 v16, a56
    v_accvgpr_read_b32 v17, a57
    v_accvgpr_read_b32 v18, a58
    v_accvgpr_read_b32 v19, a59
    v_accvgpr_read_b32 v20, a80
    v_accvgpr_read_b32 v21, a81
    v_accvgpr_read_b32 v22, a82
    v_accvgpr_read_b32 v23, a83
    v_pk_mul_f32 v[16:17], v[16:17], v[84:85] op_sel_hi:[1,0]
    v_pk_mul_f32 v[18:19], v[18:19], v[84:85] op_sel_hi:[1,0]
    v_pk_mul_f32 v[20:21], v[20:21], v[84:85] op_sel_hi:[1,0]
    v_pk_mul_f32 v[22:23], v[22:23], v[84:85] op_sel_hi:[1,0]
    v_cvt_pk_bf16_f32 v16, v16, v17
    v_cvt_pk_bf16_f32 v17, v18, v19
    v_cvt_pk_bf16_f32 v18, v20, v21
    v_cvt_pk_bf16_f32 v19, v22, v23
    ds_write_b128 v238, v[16:19] offset:8192
    v_accvgpr_read_b32 v24, a60
    v_accvgpr_read_b32 v25, a61
    v_accvgpr_read_b32 v26, a62
    v_accvgpr_read_b32 v27, a63
    v_accvgpr_read_b32 v28, a84
    v_accvgpr_read_b32 v29, a85
    v_accvgpr_read_b32 v30, a86
    v_accvgpr_read_b32 v31, a87
    v_pk_mul_f32 v[24:25], v[24:25], v[86:87] op_sel_hi:[1,0]
    v_pk_mul_f32 v[26:27], v[26:27], v[86:87] op_sel_hi:[1,0]
    v_pk_mul_f32 v[28:29], v[28:29], v[86:87] op_sel_hi:[1,0]
    v_pk_mul_f32 v[30:31], v[30:31], v[86:87] op_sel_hi:[1,0]
    v_cvt_pk_bf16_f32 v24, v24, v25
    v_cvt_pk_bf16_f32 v25, v26, v27
    v_cvt_pk_bf16_f32 v26, v28, v29
    v_cvt_pk_bf16_f32 v27, v30, v31
    ds_write_b128 v238, v[24:27] offset:9216
    v_accvgpr_read_b32 v32, a64
    v_accvgpr_read_b32 v33, a65
    v_accvgpr_read_b32 v34, a66
    v_accvgpr_read_b32 v35, a67
    v_accvgpr_read_b32 v36, a88
    v_accvgpr_read_b32 v37, a89
    v_accvgpr_read_b32 v38, a90
    v_accvgpr_read_b32 v39, a91
    v_pk_mul_f32 v[32:33], v[32:33], v[88:89] op_sel_hi:[1,0]
    v_pk_mul_f32 v[34:35], v[34:35], v[88:89] op_sel_hi:[1,0]
    v_pk_mul_f32 v[36:37], v[36:37], v[88:89] op_sel_hi:[1,0]
    v_pk_mul_f32 v[38:39], v[38:39], v[88:89] op_sel_hi:[1,0]
    v_cvt_pk_bf16_f32 v32, v32, v33
    v_cvt_pk_bf16_f32 v33, v34, v35
    v_cvt_pk_bf16_f32 v34, v36, v37
    v_cvt_pk_bf16_f32 v35, v38, v39
    ds_write_b128 v238, v[32:35] offset:10240
    v_accvgpr_read_b32 v40, a68
    v_accvgpr_read_b32 v41, a69
    v_accvgpr_read_b32 v42, a70
    v_accvgpr_read_b32 v43, a71
    v_accvgpr_read_b32 v44, a92
    v_accvgpr_read_b32 v45, a93
    v_accvgpr_read_b32 v46, a94
    v_accvgpr_read_b32 v47, a95
    v_pk_mul_f32 v[40:41], v[40:41], v[90:91] op_sel_hi:[1,0]
    v_pk_mul_f32 v[42:43], v[42:43], v[90:91] op_sel_hi:[1,0]
    v_pk_mul_f32 v[44:45], v[44:45], v[90:91] op_sel_hi:[1,0]
    v_pk_mul_f32 v[46:47], v[46:47], v[90:91] op_sel_hi:[1,0]
    v_cvt_pk_bf16_f32 v40, v40, v41
    v_cvt_pk_bf16_f32 v41, v42, v43
    v_cvt_pk_bf16_f32 v42, v44, v45
    v_cvt_pk_bf16_f32 v43, v46, v47
    ds_write_b128 v238, v[40:43] offset:11264
    v_accvgpr_read_b32 v0, a96
    v_accvgpr_read_b32 v1, a97
    v_accvgpr_read_b32 v2, a98
    v_accvgpr_read_b32 v3, a99
    v_accvgpr_read_b32 v4, a120
    v_accvgpr_read_b32 v5, a121
    v_accvgpr_read_b32 v6, a122
    v_accvgpr_read_b32 v7, a123
    v_pk_mul_f32 v[0:1], v[0:1], v[80:81] op_sel_hi:[1,0]
    v_pk_mul_f32 v[2:3], v[2:3], v[80:81] op_sel_hi:[1,0]
    v_pk_mul_f32 v[4:5], v[4:5], v[80:81] op_sel_hi:[1,0]
    v_pk_mul_f32 v[6:7], v[6:7], v[80:81] op_sel_hi:[1,0]
    v_cvt_pk_bf16_f32 v0, v0, v1
    v_cvt_pk_bf16_f32 v1, v2, v3
    v_cvt_pk_bf16_f32 v2, v4, v5
    v_cvt_pk_bf16_f32 v3, v6, v7
    ds_write_b128 v238, v[0:3] offset:12288
    v_accvgpr_read_b32 v8, a100
    v_accvgpr_read_b32 v9, a101
    v_accvgpr_read_b32 v10, a102
    v_accvgpr_read_b32 v11, a103
    v_accvgpr_read_b32 v12, a124
    v_accvgpr_read_b32 v13, a125
    v_accvgpr_read_b32 v14, a126
    v_accvgpr_read_b32 v15, a127
    v_pk_mul_f32 v[8:9], v[8:9], v[82:83] op_sel_hi:[1,0]
    v_pk_mul_f32 v[10:11], v[10:11], v[82:83] op_sel_hi:[1,0]
    v_pk_mul_f32 v[12:13], v[12:13], v[82:83] op_sel_hi:[1,0]
    v_pk_mul_f32 v[14:15], v[14:15], v[82:83] op_sel_hi:[1,0]
    v_cvt_pk_bf16_f32 v8, v8, v9
    v_cvt_pk_bf16_f32 v9, v10, v11
    v_cvt_pk_bf16_f32 v10, v12, v13
    v_cvt_pk_bf16_f32 v11, v14, v15
    ds_write_b128 v238, v[8:11] offset:13312
    v_accvgpr_read_b32 v16, a104
    v_accvgpr_read_b32 v17, a105
    v_accvgpr_read_b32 v18, a106
    v_accvgpr_read_b32 v19, a107
    v_accvgpr_read_b32 v20, a128
    v_accvgpr_read_b32 v21, a129
    v_accvgpr_read_b32 v22, a130
    v_accvgpr_read_b32 v23, a131
    v_pk_mul_f32 v[16:17], v[16:17], v[84:85] op_sel_hi:[1,0]
    v_pk_mul_f32 v[18:19], v[18:19], v[84:85] op_sel_hi:[1,0]
    v_pk_mul_f32 v[20:21], v[20:21], v[84:85] op_sel_hi:[1,0]
    v_pk_mul_f32 v[22:23], v[22:23], v[84:85] op_sel_hi:[1,0]
    v_cvt_pk_bf16_f32 v16, v16, v17
    v_cvt_pk_bf16_f32 v17, v18, v19
    v_cvt_pk_bf16_f32 v18, v20, v21
    v_cvt_pk_bf16_f32 v19, v22, v23
    s_waitcnt lgkmcnt(14)
    ds_write_b128 v238, v[16:19] offset:14336
    v_accvgpr_read_b32 v24, a108
    v_accvgpr_read_b32 v25, a109
    v_accvgpr_read_b32 v26, a110
    v_accvgpr_read_b32 v27, a111
    v_accvgpr_read_b32 v28, a132
    v_accvgpr_read_b32 v29, a133
    v_accvgpr_read_b32 v30, a134
    v_accvgpr_read_b32 v31, a135
    v_pk_mul_f32 v[24:25], v[24:25], v[86:87] op_sel_hi:[1,0]
    v_pk_mul_f32 v[26:27], v[26:27], v[86:87] op_sel_hi:[1,0]
    v_pk_mul_f32 v[28:29], v[28:29], v[86:87] op_sel_hi:[1,0]
    v_pk_mul_f32 v[30:31], v[30:31], v[86:87] op_sel_hi:[1,0]
    v_cvt_pk_bf16_f32 v24, v24, v25
    v_cvt_pk_bf16_f32 v25, v26, v27
    v_cvt_pk_bf16_f32 v26, v28, v29
    v_cvt_pk_bf16_f32 v27, v30, v31
    s_waitcnt lgkmcnt(14)
    ds_write_b128 v238, v[24:27] offset:15360
    v_accvgpr_read_b32 v32, a112
    v_accvgpr_read_b32 v33, a113
    v_accvgpr_read_b32 v34, a114
    v_accvgpr_read_b32 v35, a115
    v_accvgpr_read_b32 v36, a136
    v_accvgpr_read_b32 v37, a137
    v_accvgpr_read_b32 v38, a138
    v_accvgpr_read_b32 v39, a139
    v_pk_mul_f32 v[32:33], v[32:33], v[88:89] op_sel_hi:[1,0]
    v_pk_mul_f32 v[34:35], v[34:35], v[88:89] op_sel_hi:[1,0]
    v_pk_mul_f32 v[36:37], v[36:37], v[88:89] op_sel_hi:[1,0]
    v_pk_mul_f32 v[38:39], v[38:39], v[88:89] op_sel_hi:[1,0]
    v_cvt_pk_bf16_f32 v32, v32, v33
    v_cvt_pk_bf16_f32 v33, v34, v35
    v_cvt_pk_bf16_f32 v34, v36, v37
    v_cvt_pk_bf16_f32 v35, v38, v39
    s_waitcnt lgkmcnt(14)
    ds_write_b128 v238, v[32:35] offset:16384
    v_accvgpr_read_b32 v40, a116
    v_accvgpr_read_b32 v41, a117
    v_accvgpr_read_b32 v42, a118
    v_accvgpr_read_b32 v43, a119
    v_accvgpr_read_b32 v44, a140
    v_accvgpr_read_b32 v45, a141
    v_accvgpr_read_b32 v46, a142
    v_accvgpr_read_b32 v47, a143
    v_pk_mul_f32 v[40:41], v[40:41], v[90:91] op_sel_hi:[1,0]
    v_pk_mul_f32 v[42:43], v[42:43], v[90:91] op_sel_hi:[1,0]
    v_pk_mul_f32 v[44:45], v[44:45], v[90:91] op_sel_hi:[1,0]
    v_pk_mul_f32 v[46:47], v[46:47], v[90:91] op_sel_hi:[1,0]
    v_cvt_pk_bf16_f32 v40, v40, v41
    v_cvt_pk_bf16_f32 v41, v42, v43
    v_cvt_pk_bf16_f32 v42, v44, v45
    v_cvt_pk_bf16_f32 v43, v46, v47
    s_waitcnt lgkmcnt(14)
    ds_write_b128 v238, v[40:43] offset:17408
    v_accvgpr_read_b32 v0, a144
    v_accvgpr_read_b32 v1, a145
    v_accvgpr_read_b32 v2, a146
    v_accvgpr_read_b32 v3, a147
    v_accvgpr_read_b32 v4, a168
    v_accvgpr_read_b32 v5, a169
    v_accvgpr_read_b32 v6, a170
    v_accvgpr_read_b32 v7, a171
    v_pk_mul_f32 v[0:1], v[0:1], v[80:81] op_sel_hi:[1,0]
    v_pk_mul_f32 v[2:3], v[2:3], v[80:81] op_sel_hi:[1,0]
    v_pk_mul_f32 v[4:5], v[4:5], v[80:81] op_sel_hi:[1,0]
    v_pk_mul_f32 v[6:7], v[6:7], v[80:81] op_sel_hi:[1,0]
    v_cvt_pk_bf16_f32 v0, v0, v1
    v_cvt_pk_bf16_f32 v1, v2, v3
    v_cvt_pk_bf16_f32 v2, v4, v5
    v_cvt_pk_bf16_f32 v3, v6, v7
    s_waitcnt lgkmcnt(14)
    ds_write_b128 v238, v[0:3] offset:18432
    v_accvgpr_read_b32 v8, a148
    v_accvgpr_read_b32 v9, a149
    v_accvgpr_read_b32 v10, a150
    v_accvgpr_read_b32 v11, a151
    v_accvgpr_read_b32 v12, a172
    v_accvgpr_read_b32 v13, a173
    v_accvgpr_read_b32 v14, a174
    v_accvgpr_read_b32 v15, a175
    v_pk_mul_f32 v[8:9], v[8:9], v[82:83] op_sel_hi:[1,0]
    v_pk_mul_f32 v[10:11], v[10:11], v[82:83] op_sel_hi:[1,0]
    v_pk_mul_f32 v[12:13], v[12:13], v[82:83] op_sel_hi:[1,0]
    v_pk_mul_f32 v[14:15], v[14:15], v[82:83] op_sel_hi:[1,0]
    v_cvt_pk_bf16_f32 v8, v8, v9
    v_cvt_pk_bf16_f32 v9, v10, v11
    v_cvt_pk_bf16_f32 v10, v12, v13
    v_cvt_pk_bf16_f32 v11, v14, v15
    s_waitcnt lgkmcnt(14)
    ds_write_b128 v238, v[8:11] offset:19456
    v_accvgpr_read_b32 v16, a152
    v_accvgpr_read_b32 v17, a153
    v_accvgpr_read_b32 v18, a154
    v_accvgpr_read_b32 v19, a155
    v_accvgpr_read_b32 v20, a176
    v_accvgpr_read_b32 v21, a177
    v_accvgpr_read_b32 v22, a178
    v_accvgpr_read_b32 v23, a179
    v_pk_mul_f32 v[16:17], v[16:17], v[84:85] op_sel_hi:[1,0]
    v_pk_mul_f32 v[18:19], v[18:19], v[84:85] op_sel_hi:[1,0]
    v_pk_mul_f32 v[20:21], v[20:21], v[84:85] op_sel_hi:[1,0]
    v_pk_mul_f32 v[22:23], v[22:23], v[84:85] op_sel_hi:[1,0]
    v_cvt_pk_bf16_f32 v16, v16, v17
    v_cvt_pk_bf16_f32 v17, v18, v19
    v_cvt_pk_bf16_f32 v18, v20, v21
    v_cvt_pk_bf16_f32 v19, v22, v23
    s_waitcnt lgkmcnt(14)
    ds_write_b128 v238, v[16:19] offset:20480
    v_accvgpr_read_b32 v24, a156
    v_accvgpr_read_b32 v25, a157
    v_accvgpr_read_b32 v26, a158
    v_accvgpr_read_b32 v27, a159
    v_accvgpr_read_b32 v28, a180
    v_accvgpr_read_b32 v29, a181
    v_accvgpr_read_b32 v30, a182
    v_accvgpr_read_b32 v31, a183
    v_pk_mul_f32 v[24:25], v[24:25], v[86:87] op_sel_hi:[1,0]
    v_pk_mul_f32 v[26:27], v[26:27], v[86:87] op_sel_hi:[1,0]
    v_pk_mul_f32 v[28:29], v[28:29], v[86:87] op_sel_hi:[1,0]
    v_pk_mul_f32 v[30:31], v[30:31], v[86:87] op_sel_hi:[1,0]
    v_cvt_pk_bf16_f32 v24, v24, v25
    v_cvt_pk_bf16_f32 v25, v26, v27
    v_cvt_pk_bf16_f32 v26, v28, v29
    v_cvt_pk_bf16_f32 v27, v30, v31
    s_waitcnt lgkmcnt(14)
    ds_write_b128 v238, v[24:27] offset:21504
    v_accvgpr_read_b32 v32, a160
    v_accvgpr_read_b32 v33, a161
    v_accvgpr_read_b32 v34, a162
    v_accvgpr_read_b32 v35, a163
    v_accvgpr_read_b32 v36, a184
    v_accvgpr_read_b32 v37, a185
    v_accvgpr_read_b32 v38, a186
    v_accvgpr_read_b32 v39, a187
    v_pk_mul_f32 v[32:33], v[32:33], v[88:89] op_sel_hi:[1,0]
    v_pk_mul_f32 v[34:35], v[34:35], v[88:89] op_sel_hi:[1,0]
    v_pk_mul_f32 v[36:37], v[36:37], v[88:89] op_sel_hi:[1,0]
    v_pk_mul_f32 v[38:39], v[38:39], v[88:89] op_sel_hi:[1,0]
    v_cvt_pk_bf16_f32 v32, v32, v33
    v_cvt_pk_bf16_f32 v33, v34, v35
    v_cvt_pk_bf16_f32 v34, v36, v37
    v_cvt_pk_bf16_f32 v35, v38, v39
    s_waitcnt lgkmcnt(14)
    ds_write_b128 v238, v[32:35] offset:22528
    v_accvgpr_read_b32 v40, a164
    v_accvgpr_read_b32 v41, a165
    v_accvgpr_read_b32 v42, a166
    v_accvgpr_read_b32 v43, a167
    v_accvgpr_read_b32 v44, a188
    v_accvgpr_read_b32 v45, a189
    v_accvgpr_read_b32 v46, a190
    v_accvgpr_read_b32 v47, a191
    v_pk_mul_f32 v[40:41], v[40:41], v[90:91] op_sel_hi:[1,0]
    v_pk_mul_f32 v[42:43], v[42:43], v[90:91] op_sel_hi:[1,0]
    v_pk_mul_f32 v[44:45], v[44:45], v[90:91] op_sel_hi:[1,0]
    v_pk_mul_f32 v[46:47], v[46:47], v[90:91] op_sel_hi:[1,0]
    v_cvt_pk_bf16_f32 v40, v40, v41
    v_cvt_pk_bf16_f32 v41, v42, v43
    v_cvt_pk_bf16_f32 v42, v44, v45
    v_cvt_pk_bf16_f32 v43, v46, v47
    s_waitcnt lgkmcnt(14)
    ds_write_b128 v238, v[40:43] offset:23552
    s_waitcnt vmcnt(8)
    s_waitcnt lgkmcnt(0)
    s_barrier
    ds_read_b128 v[64:67], v248 offset:49152
    ds_read_b128 v[100:103], v234 offset:0
    ds_read_b128 v[104:107], v234 offset:1024
    ds_read_b128 v[108:111], v234 offset:2048
    ds_read_b128 v[112:115], v234 offset:3072
    ds_read_b128 v[116:119], v234 offset:4096
    ds_read_b128 v[120:123], v234 offset:5120
    ds_read_b64_tr_b16 v[48:49], v241 offset:0
    ds_read_b64_tr_b16 v[50:51], v241 offset:2048
    ds_read_b64_tr_b16 v[52:53], v241 offset:4096
    ds_read_b64_tr_b16 v[54:55], v241 offset:6144
    ds_read_b128 v[124:127], v235 offset:0
    ds_read_b128 v[128:131], v235 offset:1024
    ds_read_b128 v[132:135], v235 offset:2048
    s_waitcnt lgkmcnt(13)
    v_or3_b32 v64, v64, v65, v66
    v_or_b32 v64, v64, v67
    s_nop 0
    v_readfirstlane_b32 s34, v64
    s_nop 1
    s_cmp_lg_u32 s34, 0
    s_cbranch_scc1 L_fallback
    ds_read_b128 v[136:139], v235 offset:3072
    s_waitcnt lgkmcnt(6)
    v_mfma_f32_16x16x32_bf16 v[0:3], v[48:51], v[100:103], 0
    ds_read_b128 v[140:143], v235 offset:4096
    ds_read_b128 v[144:147], v235 offset:5120
    v_mfma_f32_16x16x32_bf16 v[4:7], v[48:51], v[104:107], 0
    ds_read_b64_tr_b16 v[56:57], v241 offset:8192
    ds_read_b64_tr_b16 v[58:59], v241 offset:10240
    v_mfma_f32_16x16x32_bf16 v[8:11], v[48:51], v[108:111], 0
    ds_read_b128 v[148:151], v236 offset:0
    ds_read_b128 v[152:155], v236 offset:1024
    v_mfma_f32_16x16x32_bf16 v[12:15], v[48:51], v[112:115], 0
    ds_read_b128 v[156:159], v236 offset:2048
    v_mfma_f32_16x16x32_bf16 v[16:19], v[48:51], v[116:119], 0
    ds_read_b128 v[160:163], v236 offset:3072
    v_mfma_f32_16x16x32_bf16 v[20:23], v[48:51], v[120:123], 0
    ds_read_b128 v[164:167], v236 offset:4096
    s_waitcnt lgkmcnt(12)
    v_mfma_f32_16x16x32_bf16 v[0:3], v[52:55], v[124:127], v[0:3]
    ds_read_b64_tr_b16 v[60:61], v241 offset:12288
    ds_read_b64_tr_b16 v[62:63], v241 offset:14336
    s_waitcnt lgkmcnt(13)
    v_mfma_f32_16x16x32_bf16 v[4:7], v[52:55], v[128:131], v[4:7]
    ds_read_b128 v[168:171], v236 offset:5120
    ds_read_b128 v[172:175], v237 offset:0
    s_waitcnt lgkmcnt(14)
    v_mfma_f32_16x16x32_bf16 v[8:11], v[52:55], v[132:135], v[8:11]
    ds_read_b128 v[176:179], v237 offset:1024
    s_waitcnt lgkmcnt(14)
    v_mfma_f32_16x16x32_bf16 v[12:15], v[52:55], v[136:139], v[12:15]
    ds_read_b128 v[180:183], v237 offset:2048
    s_waitcnt lgkmcnt(14)
    v_mfma_f32_16x16x32_bf16 v[16:19], v[52:55], v[140:143], v[16:19]
    ds_read_b128 v[184:187], v237 offset:3072
    s_waitcnt lgkmcnt(14)
    v_mfma_f32_16x16x32_bf16 v[20:23], v[52:55], v[144:147], v[20:23]
    s_waitcnt vmcnt(4)
    s_barrier
    s_waitcnt lgkmcnt(11)
    v_mfma_f32_16x16x32_bf16 v[0:3], v[56:59], v[148:151], v[0:3]
    ds_read_b64_tr_b16 v[48:49], v241 offset:16384
    ds_read_b64_tr_b16 v[50:51], v241 offset:18432
    s_waitcnt lgkmcnt(12)
    v_mfma_f32_16x16x32_bf16 v[4:7], v[56:59], v[152:155], v[4:7]
    ds_read_b128 v[188:191], v237 offset:4096
    ds_read_b128 v[192:195], v237 offset:5120
    s_waitcnt lgkmcnt(13)
    v_mfma_f32_16x16x32_bf16 v[8:11], v[56:59], v[156:159], v[8:11]
    s_add_u32 m0, s80, 49152
    s_add_u32 s81, s81, 36864
    s_waitcnt lgkmcnt(12)
    v_mfma_f32_16x16x32_bf16 v[12:15], v[56:59], v[160:163], v[12:15]
    s_add_u32 s73, s44, s81
    ds_read_b128 v[196:199], v234 offset:6144
    s_waitcnt lgkmcnt(12)
    v_mfma_f32_16x16x32_bf16 v[16:19], v[56:59], v[164:167], v[16:19]
    buffer_load_dwordx4 v240, s[20:23], s73 offen lds
    s_waitcnt lgkmcnt(9)
    v_mfma_f32_16x16x32_bf16 v[20:23], v[56:59], v[168:171], v[20:23]
    ds_read_b128 v[200:203], v234 offset:7168
    ds_read_b128 v[204:207], v234 offset:8192
    s_waitcnt lgkmcnt(10)
    v_mfma_f32_16x16x32_bf16 v[0:3], v[60:63], v[172:175], v[0:3]
    ds_read_b128 v[208:211], v234 offset:9216
    ds_read_b128 v[212:215], v234 offset:10240
    s_waitcnt lgkmcnt(11)
    v_mfma_f32_16x16x32_bf16 v[4:7], v[60:63], v[176:179], v[4:7]
    ds_read_b64_tr_b16 v[52:53], v241 offset:20480
    ds_read_b64_tr_b16 v[54:55], v241 offset:22528
    s_waitcnt lgkmcnt(12)
    v_mfma_f32_16x16x32_bf16 v[8:11], v[60:63], v[180:183], v[8:11]
    s_add_u32 m0, s80, 53248
    s_add_u32 s73, s45, s81
    s_waitcnt lgkmcnt(11)
    v_mfma_f32_16x16x32_bf16 v[12:15], v[60:63], v[184:187], v[12:15]
    ds_read_b128 v[216:219], v234 offset:11264
    ds_read_b128 v[220:223], v235 offset:6144
    s_waitcnt lgkmcnt(10)
    v_mfma_f32_16x16x32_bf16 v[16:19], v[60:63], v[188:191], v[16:19]
    buffer_load_dwordx4 v240, s[20:23], s73 offen lds
    s_waitcnt lgkmcnt(9)
    v_mfma_f32_16x16x32_bf16 v[20:23], v[60:63], v[192:195], v[20:23]
    ds_read_b128 v[224:227], v235 offset:7168
    ds_read_b128 a[192:195], v235 offset:8192
    s_waitcnt lgkmcnt(10)
    v_mfma_f32_16x16x32_bf16 v[0:3], v[48:51], v[196:199], v[0:3]
    ds_read_b128 a[196:199], v235 offset:9216
    ds_read_b128 a[200:203], v235 offset:10240
    s_waitcnt lgkmcnt(11)
    v_mfma_f32_16x16x32_bf16 v[4:7], v[48:51], v[200:203], v[4:7]
    ds_read_b64_tr_b16 v[56:57], v241 offset:24576
    ds_read_b64_tr_b16 v[58:59], v241 offset:26624
    s_waitcnt lgkmcnt(12)
    v_mfma_f32_16x16x32_bf16 v[8:11], v[48:51], v[204:207], v[8:11]
    s_add_u32 m0, s80, 57344
    s_add_u32 s73, s46, s81
    s_waitcnt lgkmcnt(11)
    v_mfma_f32_16x16x32_bf16 v[12:15], v[48:51], v[208:211], v[12:15]
    ds_read_b128 a[204:207], v235 offset:11264
    ds_read_b128 a[208:211], v236 offset:6144
    s_waitcnt lgkmcnt(12)
    v_mfma_f32_16x16x32_bf16 v[16:19], v[48:51], v[212:215], v[16:19]
    buffer_load_dwordx4 v240, s[20:23], s73 offen lds
    s_waitcnt lgkmcnt(9)
    v_mfma_f32_16x16x32_bf16 v[20:23], v[48:51], v[216:219], v[20:23]
    ds_read_b128 a[212:215], v236 offset:7168
    ds_read_b128 a[216:219], v236 offset:8192
    s_waitcnt lgkmcnt(10)
    v_mfma_f32_16x16x32_bf16 v[0:3], v[52:55], v[220:223], v[0:3]
    ds_read_b128 a[220:223], v236 offset:9216
    ds_read_b128 a[224:227], v236 offset:10240
    s_waitcnt lgkmcnt(11)
    v_mfma_f32_16x16x32_bf16 v[4:7], v[52:55], v[224:227], v[4:7]
    ds_read_b64_tr_b16 v[60:61], v241 offset:28672
    ds_read_b64_tr_b16 v[62:63], v241 offset:30720
    s_waitcnt lgkmcnt(12)
    v_mfma_f32_16x16x32_bf16 v[8:11], v[52:55], a[192:195], v[8:11]
    s_add_u32 m0, s80, 61440
    s_add_u32 s73, s47, s81
    s_waitcnt lgkmcnt(11)
    v_mfma_f32_16x16x32_bf16 v[12:15], v[52:55], a[196:199], v[12:15]
    ds_read_b128 a[228:231], v236 offset:11264
    ds_read_b128 a[232:235], v237 offset:6144
    s_waitcnt lgkmcnt(12)
    v_mfma_f32_16x16x32_bf16 v[16:19], v[52:55], a[200:203], v[16:19]
    buffer_load_dwordx4 v240, s[20:23], s73 offen lds
    s_waitcnt lgkmcnt(9)
    v_mfma_f32_16x16x32_bf16 v[20:23], v[52:55], a[204:207], v[20:23]
    ds_read_b128 a[236:239], v237 offset:7168
    ds_read_b128 a[240:243], v237 offset:8192
    s_waitcnt lgkmcnt(10)
    v_mfma_f32_16x16x32_bf16 v[0:3], v[56:59], a[208:211], v[0:3]
    s_waitcnt vmcnt(4)
    s_barrier
    s_waitcnt lgkmcnt(9)
    v_mfma_f32_16x16x32_bf16 v[4:7], v[56:59], a[212:215], v[4:7]
    ds_read_b128 a[244:247], v237 offset:9216
    ds_read_b128 a[248:251], v237 offset:10240
    s_waitcnt lgkmcnt(10)
    v_mfma_f32_16x16x32_bf16 v[8:11], v[56:59], a[216:219], v[8:11]
    ds_read_b64_tr_b16 v[48:49], v241 offset:32768
    ds_read_b64_tr_b16 v[50:51], v241 offset:34816
    s_waitcnt lgkmcnt(11)
    v_mfma_f32_16x16x32_bf16 v[12:15], v[56:59], a[220:223], v[12:15]
    s_add_u32 m0, s80, 0
    s_add_u32 s81, s5, 1
    s_waitcnt lgkmcnt(10)
    v_mfma_f32_16x16x32_bf16 v[16:19], v[56:59], a[224:227], v[16:19]
    ds_read_b128 a[252:255], v237 offset:11264
    s_and_b32 s81, s81, 7
    s_lshl_b32 s81, s81, 7
    s_waitcnt lgkmcnt(8)
    v_mfma_f32_16x16x32_bf16 v[20:23], v[56:59], a[228:231], v[20:23]
    ds_read_b128 a[0:3], v234 offset:12288
    s_add_u32 s73, s44, s81
    s_waitcnt lgkmcnt(8)
    v_mfma_f32_16x16x32_bf16 v[0:3], v[60:63], a[232:235], v[0:3]
    ds_read_b128 a[4:7], v234 offset:13312
    buffer_load_dwordx4 v240, s[20:23], s73 offen lds
    s_waitcnt lgkmcnt(8)
    v_mfma_f32_16x16x32_bf16 v[4:7], v[60:63], a[236:239], v[4:7]
    ds_read_b128 a[8:11], v234 offset:14336
    ds_read_b128 a[12:15], v234 offset:15360
    s_waitcnt lgkmcnt(9)
    v_mfma_f32_16x16x32_bf16 v[8:11], v[60:63], a[240:243], v[8:11]
    ds_read_b64_tr_b16 v[52:53], v241 offset:36864
    ds_read_b64_tr_b16 v[54:55], v241 offset:38912
    s_waitcnt lgkmcnt(10)
    v_mfma_f32_16x16x32_bf16 v[12:15], v[60:63], a[244:247], v[12:15]
    ds_read_b128 a[16:19], v234 offset:16384
    s_add_u32 m0, s80, 4096
    s_add_u32 s73, s45, s81
    s_waitcnt lgkmcnt(10)
    v_mfma_f32_16x16x32_bf16 v[16:19], v[60:63], a[248:251], v[16:19]
    ds_read_b128 a[20:23], v234 offset:17408
    buffer_load_dwordx4 v240, s[20:23], s73 offen lds
    s_waitcnt lgkmcnt(8)
    v_mfma_f32_16x16x32_bf16 v[20:23], v[60:63], a[252:255], v[20:23]
    ds_read_b128 a[24:27], v235 offset:12288
    ds_read_b128 a[28:31], v235 offset:13312
    s_waitcnt lgkmcnt(9)
    v_mfma_f32_16x16x32_bf16 v[0:3], v[48:51], a[0:3], v[0:3]
    ds_read_b128 a[32:35], v235 offset:14336
    ds_read_b128 a[36:39], v235 offset:15360
    s_waitcnt lgkmcnt(10)
    v_mfma_f32_16x16x32_bf16 v[4:7], v[48:51], a[4:7], v[4:7]
    ds_read_b64_tr_b16 v[56:57], v241 offset:40960
    ds_read_b64_tr_b16 v[58:59], v241 offset:43008
    s_waitcnt lgkmcnt(11)
    v_mfma_f32_16x16x32_bf16 v[8:11], v[48:51], a[8:11], v[8:11]
    ds_read_b128 a[40:43], v235 offset:16384
    ds_read_b128 a[44:47], v235 offset:17408
    s_waitcnt lgkmcnt(12)
    v_mfma_f32_16x16x32_bf16 v[12:15], v[48:51], a[12:15], v[12:15]
    s_add_u32 m0, s80, 8192
    s_add_u32 s73, s46, s81
    s_waitcnt lgkmcnt(9)
    v_mfma_f32_16x16x32_bf16 v[16:19], v[48:51], a[16:19], v[16:19]
    buffer_load_dwordx4 v240, s[20:23], s73 offen lds
    s_waitcnt lgkmcnt(8)
    v_mfma_f32_16x16x32_bf16 v[20:23], v[48:51], a[20:23], v[20:23]
    ds_read_b128 a[48:51], v236 offset:12288
    ds_read_b128 a[52:55], v236 offset:13312
    s_waitcnt lgkmcnt(9)
    v_mfma_f32_16x16x32_bf16 v[0:3], v[52:55], a[24:27], v[0:3]
    ds_read_b128 a[56:59], v236 offset:14336
    ds_read_b128 a[60:63], v236 offset:15360
    s_waitcnt lgkmcnt(10)
    v_mfma_f32_16x16x32_bf16 v[4:7], v[52:55], a[28:31], v[4:7]
    ds_read_b64_tr_b16 v[60:61], v241 offset:45056
    ds_read_b64_tr_b16 v[62:63], v241 offset:47104
    s_waitcnt lgkmcnt(11)
    v_mfma_f32_16x16x32_bf16 v[8:11], v[52:55], a[32:35], v[8:11]
    ds_read_b128 a[64:67], v236 offset:16384
    ds_read_b128 a[68:71], v236 offset:17408
    s_waitcnt lgkmcnt(12)
    v_mfma_f32_16x16x32_bf16 v[12:15], v[52:55], a[36:39], v[12:15]
    s_add_u32 m0, s80, 12288
    s_add_u32 s73, s47, s81
    s_waitcnt lgkmcnt(9)
    v_mfma_f32_16x16x32_bf16 v[16:19], v[52:55], a[40:43], v[16:19]
    buffer_load_dwordx4 v240, s[20:23], s73 offen lds
    s_waitcnt lgkmcnt(8)
    v_mfma_f32_16x16x32_bf16 v[20:23], v[52:55], a[44:47], v[20:23]
    ds_read_b128 a[72:75], v237 offset:12288
    ds_read_b128 a[76:79], v237 offset:13312
    s_waitcnt lgkmcnt(9)
    v_mfma_f32_16x16x32_bf16 v[0:3], v[56:59], a[48:51], v[0:3]
    s_waitcnt vmcnt(4)
    s_barrier
    s_waitcnt lgkmcnt(8)
    v_mfma_f32_16x16x32_bf16 v[4:7], v[56:59], a[52:55], v[4:7]
    ds_read_b128 a[80:83], v237 offset:14336
    ds_read_b128 a[84:87], v237 offset:15360
    s_waitcnt lgkmcnt(9)
    v_mfma_f32_16x16x32_bf16 v[8:11], v[56:59], a[56:59], v[8:11]
    ds_read_b64_tr_b16 v[48:49], v241 offset:49152
    ds_read_b64_tr_b16 v[50:51], v241 offset:51200
    s_waitcnt lgkmcnt(10)
    v_mfma_f32_16x16x32_bf16 v[12:15], v[56:59], a[60:63], v[12:15]
    ds_read_b128 a[88:91], v237 offset:16384
    s_add_u32 m0, s80, 16384
    s_add_u32 s81, s81, 36864
    s_waitcnt lgkmcnt(8)
    v_mfma_f32_16x16x32_bf16 v[16:19], v[56:59], a[64:67], v[16:19]
    ds_read_b128 a[92:95], v237 offset:17408
    s_add_u32 s73, s44, s81
    s_waitcnt lgkmcnt(8)
    v_mfma_f32_16x16x32_bf16 v[20:23], v[56:59], a[68:71], v[20:23]
    ds_read_b128 a[96:99], v234 offset:18432
    buffer_load_dwordx4 v240, s[20:23], s73 offen lds
    s_waitcnt lgkmcnt(8)
    v_mfma_f32_16x16x32_bf16 v[0:3], v[60:63], a[72:75], v[0:3]
    ds_read_b128 a[100:103], v234 offset:19456
    s_waitcnt lgkmcnt(8)
    v_mfma_f32_16x16x32_bf16 v[4:7], v[60:63], a[76:79], v[4:7]
    ds_read_b128 a[104:107], v234 offset:20480
    s_waitcnt lgkmcnt(8)
    v_mfma_f32_16x16x32_bf16 v[8:11], v[60:63], a[80:83], v[8:11]
    ds_read_b128 a[108:111], v234 offset:21504
    ds_read_b64_tr_b16 v[52:53], v241 offset:53248
    ds_read_b64_tr_b16 v[54:55], v241 offset:55296
    s_waitcnt lgkmcnt(10)
    v_mfma_f32_16x16x32_bf16 v[12:15], v[60:63], a[84:87], v[12:15]
    ds_read_b128 a[112:115], v234 offset:22528
    s_add_u32 m0, s80, 20480
    s_add_u32 s73, s45, s81
    s_waitcnt lgkmcnt(8)
    v_mfma_f32_16x16x32_bf16 v[16:19], v[60:63], a[88:91], v[16:19]
    ds_read_b128 a[116:119], v234 offset:23552
    buffer_load_dwordx4 v240, s[20:23], s73 offen lds
    s_waitcnt lgkmcnt(8)
    v_mfma_f32_16x16x32_bf16 v[20:23], v[60:63], a[92:95], v[20:23]
    ds_read_b128 a[120:123], v235 offset:18432
    s_waitcnt lgkmcnt(8)
    v_mfma_f32_16x16x32_bf16 v[0:3], v[48:51], a[96:99], v[0:3]
    ds_read_b128 a[124:127], v235 offset:19456
    s_waitcnt lgkmcnt(8)
    v_mfma_f32_16x16x32_bf16 v[4:7], v[48:51], a[100:103], v[4:7]
    ds_read_b128 a[128:131], v235 offset:20480
    s_waitcnt lgkmcnt(8)
    v_mfma_f32_16x16x32_bf16 v[8:11], v[48:51], a[104:107], v[8:11]
    ds_read_b128 a[132:135], v235 offset:21504
    ds_read_b64_tr_b16 v[56:57], v241 offset:57344
    ds_read_b64_tr_b16 v[58:59], v241 offset:59392
    s_waitcnt lgkmcnt(10)
    v_mfma_f32_16x16x32_bf16 v[12:15], v[48:51], a[108:111], v[12:15]
    ds_read_b128 a[136:139], v235 offset:22528
    s_add_u32 m0, s80, 24576
    s_add_u32 s73, s46, s81
    s_waitcnt lgkmcnt(8)
    v_mfma_f32_16x16x32_bf16 v[16:19], v[48:51], a[112:115], v[16:19]
    ds_read_b128 a[140:143], v235 offset:23552
    buffer_load_dwordx4 v240, s[20:23], s73 offen lds
    s_waitcnt lgkmcnt(8)
    v_mfma_f32_16x16x32_bf16 v[20:23], v[48:51], a[116:119], v[20:23]
    ds_read_b128 a[144:147], v236 offset:18432
    s_waitcnt lgkmcnt(8)
    v_mfma_f32_16x16x32_bf16 v[0:3], v[52:55], a[120:123], v[0:3]
    ds_read_b128 a[148:151], v236 offset:19456
    s_waitcnt lgkmcnt(8)
    v_mfma_f32_16x16x32_bf16 v[4:7], v[52:55], a[124:127], v[4:7]
    ds_read_b128 a[152:155], v236 offset:20480
    s_waitcnt lgkmcnt(8)
    v_mfma_f32_16x16x32_bf16 v[8:11], v[52:55], a[128:131], v[8:11]
    ds_read_b128 a[156:159], v236 offset:21504
    ds_read_b64_tr_b16 v[60:61], v241 offset:61440
    ds_read_b64_tr_b16 v[62:63], v241 offset:63488
    s_waitcnt lgkmcnt(10)
    v_mfma_f32_16x16x32_bf16 v[12:15], v[52:55], a[132:135], v[12:15]
    ds_read_b128 a[160:163], v236 offset:22528
    s_add_u32 m0, s80, 28672
    s_add_u32 s73, s47, s81
    s_waitcnt lgkmcnt(8)
    v_mfma_f32_16x16x32_bf16 v[16:19], v[52:55], a[136:139], v[16:19]
    ds_read_b128 a[164:167], v236 offset:23552
    buffer_load_dwordx4 v240, s[20:23], s73 offen lds
    s_waitcnt lgkmcnt(8)
    v_mfma_f32_16x16x32_bf16 v[20:23], v[52:55], a[140:143], v[20:23]
    ds_read_b128 a[168:171], v237 offset:18432
    s_waitcnt lgkmcnt(8)
    v_mfma_f32_16x16x32_bf16 v[0:3], v[56:59], a[144:147], v[0:3]
    ds_read_b128 a[172:175], v237 offset:19456
    s_waitcnt vmcnt(4)
    s_barrier
    s_waitcnt lgkmcnt(8)
    v_mfma_f32_16x16x32_bf16 v[4:7], v[56:59], a[148:151], v[4:7]
    ds_read_b128 a[176:179], v237 offset:20480
    s_waitcnt lgkmcnt(8)
    v_mfma_f32_16x16x32_bf16 v[8:11], v[56:59], a[152:155], v[8:11]
    ds_read_b128 a[180:183], v237 offset:21504
    ds_read_b64_tr_b16 v[48:49], v241 offset:0
    ds_read_b64_tr_b16 v[50:51], v241 offset:2048
    s_waitcnt lgkmcnt(10)
    v_mfma_f32_16x16x32_bf16 v[12:15], v[56:59], a[156:159], v[12:15]
    ds_read_b128 a[184:187], v237 offset:22528
    s_add_u32 m0, s80, 32768
    s_add_u32 s81, s81, 36864
    s_waitcnt lgkmcnt(8)
    v_mfma_f32_16x16x32_bf16 v[16:19], v[56:59], a[160:163], v[16:19]
    ds_read_b128 a[188:191], v237 offset:23552
    s_add_u32 s73, s44, s81
    s_waitcnt lgkmcnt(8)
    v_mfma_f32_16x16x32_bf16 v[20:23], v[56:59], a[164:167], v[20:23]
    buffer_load_dwordx4 v240, s[20:23], s73 offen lds
    s_waitcnt lgkmcnt(7)
    v_mfma_f32_16x16x32_bf16 v[0:3], v[60:63], a[168:171], v[0:3]
    s_waitcnt lgkmcnt(6)
    v_mfma_f32_16x16x32_bf16 v[4:7], v[60:63], a[172:175], v[4:7]
    s_waitcnt lgkmcnt(5)
    v_mfma_f32_16x16x32_bf16 v[8:11], v[60:63], a[176:179], v[8:11]
    ds_read_b64_tr_b16 v[52:53], v241 offset:4096
    ds_read_b64_tr_b16 v[54:55], v241 offset:6144
    s_waitcnt lgkmcnt(6)
    v_mfma_f32_16x16x32_bf16 v[12:15], v[60:63], a[180:183], v[12:15]
    s_add_u32 m0, s80, 36864
    s_add_u32 s73, s45, s81
    s_waitcnt lgkmcnt(3)
    v_mfma_f32_16x16x32_bf16 v[16:19], v[60:63], a[184:187], v[16:19]
    buffer_load_dwordx4 v240, s[20:23], s73 offen lds
    s_waitcnt lgkmcnt(2)
    v_mfma_f32_16x16x32_bf16 v[20:23], v[60:63], a[188:191], v[20:23]
    v_mfma_f32_16x16x32_bf16 v[24:27], v[48:51], v[100:103], 0
    ds_read_b64_tr_b16 v[56:57], v241 offset:8192
    ds_read_b64_tr_b16 v[58:59], v241 offset:10240
    v_mfma_f32_16x16x32_bf16 v[28:31], v[48:51], v[104:107], 0
    v_mfma_f32_16x16x32_bf16 v[32:35], v[48:51], v[108:111], 0
    s_add_u32 m0, s80, 40960
    s_add_u32 s73, s46, s81
    v_mfma_f32_16x16x32_bf16 v[36:39], v[48:51], v[112:115], 0
    buffer_load_dwordx4 v240, s[20:23], s73 offen lds
    v_mfma_f32_16x16x32_bf16 v[40:43], v[48:51], v[116:119], 0
    v_cvt_pk_bf16_f32 v64, v0, v1
    v_cvt_pk_bf16_f32 v65, v2, v3
    v_mfma_f32_16x16x32_bf16 v[44:47], v[48:51], v[120:123], 0
    v_cvt_pk_bf16_f32 v66, v4, v5
    s_waitcnt lgkmcnt(2)
    v_mfma_f32_16x16x32_bf16 v[24:27], v[52:55], v[124:127], v[24:27]
    v_cvt_pk_bf16_f32 v67, v6, v7
    v_mfma_f32_16x16x32_bf16 v[28:31], v[52:55], v[128:131], v[28:31]
    buffer_store_dwordx4 v[64:67], v243, s[24:27], s0 offen sc1
    v_mfma_f32_16x16x32_bf16 v[32:35], v[52:55], v[132:135], v[32:35]
    ds_read_b64_tr_b16 v[60:61], v241 offset:12288
    ds_read_b64_tr_b16 v[62:63], v241 offset:14336
    v_cvt_pk_bf16_f32 v68, v8, v9
    v_cvt_pk_bf16_f32 v69, v10, v11
    v_mfma_f32_16x16x32_bf16 v[36:39], v[52:55], v[136:139], v[36:39]
    s_add_u32 m0, s80, 45056
    s_add_u32 s73, s47, s81
    v_cvt_pk_bf16_f32 v70, v12, v13
    v_cvt_pk_bf16_f32 v71, v14, v15
    v_mfma_f32_16x16x32_bf16 v[40:43], v[52:55], v[140:143], v[40:43]
    buffer_load_dwordx4 v240, s[20:23], s73 offen lds
    buffer_store_dwordx4 v[68:71], v243, s[24:27], s0 offen offset:1024 sc1
    v_mfma_f32_16x16x32_bf16 v[44:47], v[52:55], v[144:147], v[44:47]
    v_cvt_pk_bf16_f32 v72, v16, v17
    v_cvt_pk_bf16_f32 v73, v18, v19
    s_waitcnt lgkmcnt(2)
    v_mfma_f32_16x16x32_bf16 v[24:27], v[56:59], v[148:151], v[24:27]
    s_waitcnt vmcnt(6)
    s_barrier
    v_cvt_pk_bf16_f32 v74, v20, v21
    v_cvt_pk_bf16_f32 v75, v22, v23
    v_mfma_f32_16x16x32_bf16 v[28:31], v[56:59], v[152:155], v[28:31]
    buffer_store_dwordx4 v[72:75], v243, s[24:27], s0 offen offset:2048 sc1
    v_mfma_f32_16x16x32_bf16 v[32:35], v[56:59], v[156:159], v[32:35]
    ds_read_b64_tr_b16 v[48:49], v241 offset:16384
    ds_read_b64_tr_b16 v[50:51], v241 offset:18432
    v_mfma_f32_16x16x32_bf16 v[36:39], v[56:59], v[160:163], v[36:39]
    s_add_u32 m0, s80, 49152
    s_add_u32 s81, s81, 36864
    v_mfma_f32_16x16x32_bf16 v[40:43], v[56:59], v[164:167], v[40:43]
    s_add_u32 s73, s44, s81
    v_mfma_f32_16x16x32_bf16 v[44:47], v[56:59], v[168:171], v[44:47]
    buffer_load_dwordx4 v240, s[20:23], s73 offen lds
    s_waitcnt lgkmcnt(2)
    v_mfma_f32_16x16x32_bf16 v[24:27], v[60:63], v[172:175], v[24:27]
    s_add_u32 m0, s80, 53248
    s_add_u32 s73, s45, s81
    v_mfma_f32_16x16x32_bf16 v[28:31], v[60:63], v[176:179], v[28:31]
    buffer_load_dwordx4 v240, s[20:23], s73 offen lds
    v_mfma_f32_16x16x32_bf16 v[32:35], v[60:63], v[180:183], v[32:35]
    ds_read_b64_tr_b16 v[52:53], v241 offset:20480
    ds_read_b64_tr_b16 v[54:55], v241 offset:22528
    v_mfma_f32_16x16x32_bf16 v[36:39], v[60:63], v[184:187], v[36:39]
    s_add_u32 m0, s80, 57344
    s_add_u32 s73, s46, s81
    v_mfma_f32_16x16x32_bf16 v[40:43], v[60:63], v[188:191], v[40:43]
    buffer_load_dwordx4 v240, s[20:23], s73 offen lds
    v_mfma_f32_16x16x32_bf16 v[44:47], v[60:63], v[192:195], v[44:47]
    s_waitcnt lgkmcnt(2)
    v_mfma_f32_16x16x32_bf16 v[24:27], v[48:51], v[196:199], v[24:27]
    s_add_u32 m0, s80, 61440
    s_add_u32 s73, s47, s81
    v_mfma_f32_16x16x32_bf16 v[28:31], v[48:51], v[200:203], v[28:31]
    buffer_load_dwordx4 v240, s[20:23], s73 offen lds
    v_mfma_f32_16x16x32_bf16 v[32:35], v[48:51], v[204:207], v[32:35]
    ds_read_b64_tr_b16 v[56:57], v241 offset:24576
    ds_read_b64_tr_b16 v[58:59], v241 offset:26624
    v_mfma_f32_16x16x32_bf16 v[36:39], v[48:51], v[208:211], v[36:39]
    s_add_u32 m0, s80, 65536
    s_add_u32 s81, s5, 2
    v_mfma_f32_16x16x32_bf16 v[40:43], v[48:51], v[212:215], v[40:43]
    s_and_b32 s81, s81, 7
    s_lshl_b32 s81, s81, 7
    v_mfma_f32_16x16x32_bf16 v[44:47], v[48:51], v[216:219], v[44:47]
    s_add_u32 s73, s44, s81
    s_waitcnt lgkmcnt(2)
    v_mfma_f32_16x16x32_bf16 v[24:27], v[52:55], v[220:223], v[24:27]
    buffer_load_dwordx4 v240, s[20:23], s73 offen lds
    s_add_u32 m0, s80, 69632
    s_add_u32 s73, s45, s81
    v_mfma_f32_16x16x32_bf16 v[28:31], v[52:55], v[224:227], v[28:31]
    buffer_load_dwordx4 v240, s[20:23], s73 offen lds
    v_mfma_f32_16x16x32_bf16 v[32:35], v[52:55], a[192:195], v[32:35]
    ds_read_b64_tr_b16 v[60:61], v241 offset:28672
    ds_read_b64_tr_b16 v[62:63], v241 offset:30720
    v_mfma_f32_16x16x32_bf16 v[36:39], v[52:55], a[196:199], v[36:39]
    s_add_u32 m0, s80, 73728
    s_add_u32 s73, s46, s81
    v_mfma_f32_16x16x32_bf16 v[40:43], v[52:55], a[200:203], v[40:43]
    buffer_load_dwordx4 v240, s[20:23], s73 offen lds
    v_mfma_f32_16x16x32_bf16 v[44:47], v[52:55], a[204:207], v[44:47]
    s_waitcnt lgkmcnt(2)
    v_mfma_f32_16x16x32_bf16 v[24:27], v[56:59], a[208:211], v[24:27]
    s_waitcnt vmcnt(9)
    s_barrier
    s_add_u32 m0, s80, 77824
    s_add_u32 s73, s47, s81
    v_mfma_f32_16x16x32_bf16 v[28:31], v[56:59], a[212:215], v[28:31]
    buffer_load_dwordx4 v240, s[20:23], s73 offen lds
    v_mfma_f32_16x16x32_bf16 v[32:35], v[56:59], a[216:219], v[32:35]
    ds_read_b64_tr_b16 v[48:49], v241 offset:32768
    ds_read_b64_tr_b16 v[50:51], v241 offset:34816
    v_mfma_f32_16x16x32_bf16 v[36:39], v[56:59], a[220:223], v[36:39]
    s_add_u32 m0, s80, 81920
    s_add_u32 s81, s81, 36864
    v_mfma_f32_16x16x32_bf16 v[40:43], v[56:59], a[224:227], v[40:43]
    s_add_u32 s73, s44, s81
    v_mfma_f32_16x16x32_bf16 v[44:47], v[56:59], a[228:231], v[44:47]
    buffer_load_dwordx4 v240, s[20:23], s73 offen lds
    s_waitcnt lgkmcnt(2)
    v_mfma_f32_16x16x32_bf16 v[24:27], v[60:63], a[232:235], v[24:27]
    s_add_u32 m0, s80, 86016
    s_add_u32 s73, s45, s81
    v_mfma_f32_16x16x32_bf16 v[28:31], v[60:63], a[236:239], v[28:31]
    buffer_load_dwordx4 v240, s[20:23], s73 offen lds
    v_mfma_f32_16x16x32_bf16 v[32:35], v[60:63], a[240:243], v[32:35]
    ds_read_b64_tr_b16 v[52:53], v241 offset:36864
    ds_read_b64_tr_b16 v[54:55], v241 offset:38912
    v_mfma_f32_16x16x32_bf16 v[36:39], v[60:63], a[244:247], v[36:39]
    s_add_u32 m0, s80, 90112
    s_add_u32 s73, s46, s81
    v_mfma_f32_16x16x32_bf16 v[40:43], v[60:63], a[248:251], v[40:43]
    buffer_load_dwordx4 v240, s[20:23], s73 offen lds
    v_mfma_f32_16x16x32_bf16 v[44:47], v[60:63], a[252:255], v[44:47]
    s_waitcnt lgkmcnt(2)
    v_mfma_f32_16x16x32_bf16 v[24:27], v[48:51], a[0:3], v[24:27]
    s_add_u32 m0, s80, 94208
    s_add_u32 s73, s47, s81
    v_mfma_f32_16x16x32_bf16 v[28:31], v[48:51], a[4:7], v[28:31]
    buffer_load_dwordx4 v240, s[20:23], s73 offen lds
    v_mfma_f32_16x16x32_bf16 v[32:35], v[48:51], a[8:11], v[32:35]
    ds_read_b64_tr_b16 v[56:57], v241 offset:40960
    ds_read_b64_tr_b16 v[58:59], v241 offset:43008
    v_mfma_f32_16x16x32_bf16 v[36:39], v[48:51], a[12:15], v[36:39]
    s_add_u32 m0, s80, 0
    s_add_u32 s81, s81, 36864
    v_mfma_f32_16x16x32_bf16 v[40:43], v[48:51], a[16:19], v[40:43]
    s_add_u32 s73, s44, s81
    v_mfma_f32_16x16x32_bf16 v[44:47], v[48:51], a[20:23], v[44:47]
    buffer_load_dwordx4 v240, s[20:23], s73 offen lds
    s_waitcnt lgkmcnt(2)
    v_mfma_f32_16x16x32_bf16 v[24:27], v[52:55], a[24:27], v[24:27]
    s_add_u32 m0, s80, 4096
    s_add_u32 s73, s45, s81
    v_mfma_f32_16x16x32_bf16 v[28:31], v[52:55], a[28:31], v[28:31]
    buffer_load_dwordx4 v240, s[20:23], s73 offen lds
    v_mfma_f32_16x16x32_bf16 v[32:35], v[52:55], a[32:35], v[32:35]
    ds_read_b64_tr_b16 v[60:61], v241 offset:45056
    ds_read_b64_tr_b16 v[62:63], v241 offset:47104
    v_mfma_f32_16x16x32_bf16 v[36:39], v[52:55], a[36:39], v[36:39]
    s_add_u32 m0, s80, 8192
    s_add_u32 s73, s46, s81
    v_mfma_f32_16x16x32_bf16 v[40:43], v[52:55], a[40:43], v[40:43]
    buffer_load_dwordx4 v240, s[20:23], s73 offen lds
    v_mfma_f32_16x16x32_bf16 v[44:47], v[52:55], a[44:47], v[44:47]
    s_waitcnt lgkmcnt(2)
    v_mfma_f32_16x16x32_bf16 v[24:27], v[56:59], a[48:51], v[24:27]
    s_waitcnt vmcnt(11)
    s_barrier
    s_add_u32 m0, s80, 12288
    s_add_u32 s73, s47, s81
    v_mfma_f32_16x16x32_bf16 v[28:31], v[56:59], a[52:55], v[28:31]
    buffer_load_dwordx4 v240, s[20:23], s73 offen lds
    v_mfma_f32_16x16x32_bf16 v[32:35], v[56:59], a[56:59], v[32:35]
    ds_read_b64_tr_b16 v[48:49], v241 offset:49152
    ds_read_b64_tr_b16 v[50:51], v241 offset:51200
    v_mfma_f32_16x16x32_bf16 v[36:39], v[56:59], a[60:63], v[36:39]
    s_add_u32 m0, s80, 16384
    s_add_u32 s81, s81, 36864
    v_mfma_f32_16x16x32_bf16 v[40:43], v[56:59], a[64:67], v[40:43]
    s_add_u32 s73, s44, s81
    v_mfma_f32_16x16x32_bf16 v[44:47], v[56:59], a[68:71], v[44:47]
    buffer_load_dwordx4 v240, s[20:23], s73 offen lds
    s_waitcnt lgkmcnt(2)
    v_mfma_f32_16x16x32_bf16 v[24:27], v[60:63], a[72:75], v[24:27]
    ds_read_b64_tr_b16 v[52:53], v241 offset:53248
    ds_read_b64_tr_b16 v[54:55], v241 offset:55296
    v_mfma_f32_16x16x32_bf16 v[28:31], v[60:63], a[76:79], v[28:31]
    v_mfma_f32_16x16x32_bf16 v[32:35], v[60:63], a[80:83], v[32:35]
    s_add_u32 m0, s80, 20480
    s_add_u32 s73, s45, s81
    v_mfma_f32_16x16x32_bf16 v[36:39], v[60:63], a[84:87], v[36:39]
    buffer_load_dwordx4 v240, s[20:23], s73 offen lds
    v_mfma_f32_16x16x32_bf16 v[40:43], v[60:63], a[88:91], v[40:43]
    buffer_store_dword v242, v246, s[60:63], s90 offen offset:0 sc1
    v_mfma_f32_16x16x32_bf16 v[44:47], v[60:63], a[92:95], v[44:47]
    s_waitcnt lgkmcnt(2)
    v_mfma_f32_16x16x32_bf16 v[24:27], v[48:51], a[96:99], v[24:27]
    ds_read_b64_tr_b16 v[56:57], v241 offset:57344
    ds_read_b64_tr_b16 v[58:59], v241 offset:59392
    v_mfma_f32_16x16x32_bf16 v[28:31], v[48:51], a[100:103], v[28:31]
    v_mfma_f32_16x16x32_bf16 v[32:35], v[48:51], a[104:107], v[32:35]
    s_add_u32 m0, s80, 24576
    s_add_u32 s73, s46, s81
    v_mfma_f32_16x16x32_bf16 v[36:39], v[48:51], a[108:111], v[36:39]
    buffer_load_dwordx4 v240, s[20:23], s73 offen lds
    v_mfma_f32_16x16x32_bf16 v[40:43], v[48:51], a[112:115], v[40:43]
    v_mfma_f32_16x16x32_bf16 v[44:47], v[48:51], a[116:119], v[44:47]
    s_waitcnt lgkmcnt(2)
    v_mfma_f32_16x16x32_bf16 v[24:27], v[52:55], a[120:123], v[24:27]
    ds_read_b64_tr_b16 v[60:61], v241 offset:61440
    ds_read_b64_tr_b16 v[62:63], v241 offset:63488
    v_mfma_f32_16x16x32_bf16 v[28:31], v[52:55], a[124:127], v[28:31]
    v_mfma_f32_16x16x32_bf16 v[32:35], v[52:55], a[128:131], v[32:35]
    s_add_u32 m0, s80, 28672
    s_add_u32 s73, s47, s81
    v_mfma_f32_16x16x32_bf16 v[36:39], v[52:55], a[132:135], v[36:39]
    buffer_load_dwordx4 v240, s[20:23], s73 offen lds
    v_mfma_f32_16x16x32_bf16 v[40:43], v[52:55], a[136:139], v[40:43]
    v_mfma_f32_16x16x32_bf16 v[44:47], v[52:55], a[140:143], v[44:47]
    s_waitcnt lgkmcnt(2)
    v_mfma_f32_16x16x32_bf16 v[24:27], v[56:59], a[144:147], v[24:27]
    s_waitcnt vmcnt(13)
    s_barrier
    v_mfma_f32_16x16x32_bf16 v[28:31], v[56:59], a[148:151], v[28:31]
    ds_read_b64_tr_b16 v[48:49], v242 offset:0
    ds_read_b64_tr_b16 v[50:51], v242 offset:2048
    v_mfma_f32_16x16x32_bf16 v[32:35], v[56:59], a[152:155], v[32:35]
    s_add_u32 m0, s80, 32768
    s_add_u32 s81, s5, 3
    v_mfma_f32_16x16x32_bf16 v[36:39], v[56:59], a[156:159], v[36:39]
    s_and_b32 s81, s81, 7
    s_lshl_b32 s81, s81, 7
    v_mfma_f32_16x16x32_bf16 v[40:43], v[56:59], a[160:163], v[40:43]
    s_add_u32 s73, s44, s81
    v_mfma_f32_16x16x32_bf16 v[44:47], v[56:59], a[164:167], v[44:47]
    s_waitcnt lgkmcnt(2)
    v_mfma_f32_16x16x32_bf16 v[24:27], v[60:63], a[168:171], v[24:27]
    buffer_load_dwordx4 v240, s[20:23], s73 offen lds
    v_mfma_f32_16x16x32_bf16 v[28:31], v[60:63], a[172:175], v[28:31]
    ds_read_b64_tr_b16 v[52:53], v242 offset:4096
    ds_read_b64_tr_b16 v[54:55], v242 offset:6144
    v_mfma_f32_16x16x32_bf16 v[32:35], v[60:63], a[176:179], v[32:35]
    s_add_u32 m0, s80, 36864
    s_add_u32 s73, s45, s81
    v_mfma_f32_16x16x32_bf16 v[36:39], v[60:63], a[180:183], v[36:39]
    buffer_load_dwordx4 v240, s[20:23], s73 offen lds
    v_mfma_f32_16x16x32_bf16 v[40:43], v[60:63], a[184:187], v[40:43]
    v_mfma_f32_16x16x32_bf16 v[44:47], v[60:63], a[188:191], v[44:47]
    s_waitcnt lgkmcnt(2)
    v_mfma_f32_16x16x32_bf16 v[0:3], v[48:51], v[100:103], 0
    ds_read_b64_tr_b16 v[56:57], v242 offset:8192
    ds_read_b64_tr_b16 v[58:59], v242 offset:10240
    v_mfma_f32_16x16x32_bf16 v[4:7], v[48:51], v[104:107], 0
    v_mfma_f32_16x16x32_bf16 v[8:11], v[48:51], v[108:111], 0
    s_add_u32 m0, s80, 40960
    s_add_u32 s73, s46, s81
    v_mfma_f32_16x16x32_bf16 v[12:15], v[48:51], v[112:115], 0
    buffer_load_dwordx4 v240, s[20:23], s73 offen lds
    v_mfma_f32_16x16x32_bf16 v[16:19], v[48:51], v[116:119], 0
    v_cvt_pk_bf16_f32 v64, v24, v25
    v_cvt_pk_bf16_f32 v65, v26, v27
    v_mfma_f32_16x16x32_bf16 v[20:23], v[48:51], v[120:123], 0
    v_cvt_pk_bf16_f32 v66, v28, v29
    s_waitcnt lgkmcnt(2)
    v_mfma_f32_16x16x32_bf16 v[0:3], v[52:55], v[124:127], v[0:3]
    v_cvt_pk_bf16_f32 v67, v30, v31
    v_mfma_f32_16x16x32_bf16 v[4:7], v[52:55], v[128:131], v[4:7]
    buffer_store_dwordx4 v[64:67], v243, s[24:27], s1 offen sc1
    v_mfma_f32_16x16x32_bf16 v[8:11], v[52:55], v[132:135], v[8:11]
    ds_read_b64_tr_b16 v[60:61], v242 offset:12288
    ds_read_b64_tr_b16 v[62:63], v242 offset:14336
    v_cvt_pk_bf16_f32 v68, v32, v33
    v_cvt_pk_bf16_f32 v69, v34, v35
    v_mfma_f32_16x16x32_bf16 v[12:15], v[52:55], v[136:139], v[12:15]
    s_add_u32 m0, s80, 45056
    s_add_u32 s73, s47, s81
    v_cvt_pk_bf16_f32 v70, v36, v37
    v_cvt_pk_bf16_f32 v71, v38, v39
    v_mfma_f32_16x16x32_bf16 v[16:19], v[52:55], v[140:143], v[16:19]
    buffer_load_dwordx4 v240, s[20:23], s73 offen lds
    buffer_store_dwordx4 v[68:71], v243, s[24:27], s1 offen offset:1024 sc1
    v_mfma_f32_16x16x32_bf16 v[20:23], v[52:55], v[144:147], v[20:23]
    v_cvt_pk_bf16_f32 v72, v40, v41
    v_cvt_pk_bf16_f32 v73, v42, v43
    s_waitcnt lgkmcnt(2)
    v_mfma_f32_16x16x32_bf16 v[0:3], v[56:59], v[148:151], v[0:3]
    s_waitcnt vmcnt(15)
    s_barrier
    v_cvt_pk_bf16_f32 v74, v44, v45
    v_cvt_pk_bf16_f32 v75, v46, v47
    v_mfma_f32_16x16x32_bf16 v[4:7], v[56:59], v[152:155], v[4:7]
    buffer_store_dwordx4 v[72:75], v243, s[24:27], s1 offen offset:2048 sc1
    v_mfma_f32_16x16x32_bf16 v[8:11], v[56:59], v[156:159], v[8:11]
    ds_read_b64_tr_b16 v[48:49], v242 offset:16384
    ds_read_b64_tr_b16 v[50:51], v242 offset:18432
    v_mfma_f32_16x16x32_bf16 v[12:15], v[56:59], v[160:163], v[12:15]
    s_add_u32 m0, s80, 49152
    s_add_u32 s81, s81, 36864
    v_mfma_f32_16x16x32_bf16 v[16:19], v[56:59], v[164:167], v[16:19]
    s_add_u32 s73, s44, s81
    v_mfma_f32_16x16x32_bf16 v[20:23], v[56:59], v[168:171], v[20:23]
    buffer_load_dwordx4 v240, s[20:23], s73 offen lds
    s_waitcnt lgkmcnt(2)
    v_mfma_f32_16x16x32_bf16 v[0:3], v[60:63], v[172:175], v[0:3]
    v_mfma_f32_16x16x32_bf16 v[4:7], v[60:63], v[176:179], v[4:7]
    ds_read_b64_tr_b16 v[52:53], v242 offset:20480
    ds_read_b64_tr_b16 v[54:55], v242 offset:22528
    v_mfma_f32_16x16x32_bf16 v[8:11], v[60:63], v[180:183], v[8:11]
    s_add_u32 m0, s80, 53248
    s_add_u32 s73, s45, s81
    v_mfma_f32_16x16x32_bf16 v[12:15], v[60:63], v[184:187], v[12:15]
    buffer_load_dwordx4 v240, s[20:23], s73 offen lds
    v_mfma_f32_16x16x32_bf16 v[16:19], v[60:63], v[188:191], v[16:19]
    v_mfma_f32_16x16x32_bf16 v[20:23], v[60:63], v[192:195], v[20:23]
    s_waitcnt lgkmcnt(2)
    v_mfma_f32_16x16x32_bf16 v[0:3], v[48:51], v[196:199], v[0:3]
    ds_read_b64_tr_b16 v[56:57], v242 offset:24576
    ds_read_b64_tr_b16 v[58:59], v242 offset:26624
    v_mfma_f32_16x16x32_bf16 v[4:7], v[48:51], v[200:203], v[4:7]
    v_mfma_f32_16x16x32_bf16 v[8:11], v[48:51], v[204:207], v[8:11]
    s_add_u32 m0, s80, 57344
    s_add_u32 s73, s46, s81
    v_mfma_f32_16x16x32_bf16 v[12:15], v[48:51], v[208:211], v[12:15]
    buffer_load_dwordx4 v240, s[20:23], s73 offen lds
    v_mfma_f32_16x16x32_bf16 v[16:19], v[48:51], v[212:215], v[16:19]
    v_mfma_f32_16x16x32_bf16 v[20:23], v[48:51], v[216:219], v[20:23]
    s_waitcnt lgkmcnt(2)
    v_mfma_f32_16x16x32_bf16 v[0:3], v[52:55], v[220:223], v[0:3]
    ds_read_b64_tr_b16 v[60:61], v242 offset:28672
    ds_read_b64_tr_b16 v[62:63], v242 offset:30720
    v_mfma_f32_16x16x32_bf16 v[4:7], v[52:55], v[224:227], v[4:7]
    v_mfma_f32_16x16x32_bf16 v[8:11], v[52:55], a[192:195], v[8:11]
    s_add_u32 m0, s80, 61440
    s_add_u32 s73, s47, s81
    v_mfma_f32_16x16x32_bf16 v[12:15], v[52:55], a[196:199], v[12:15]
    buffer_load_dwordx4 v240, s[20:23], s73 offen lds
    v_mfma_f32_16x16x32_bf16 v[16:19], v[52:55], a[200:203], v[16:19]
    v_mfma_f32_16x16x32_bf16 v[20:23], v[52:55], a[204:207], v[20:23]
    s_waitcnt lgkmcnt(2)
    v_mfma_f32_16x16x32_bf16 v[0:3], v[56:59], a[208:211], v[0:3]
    s_waitcnt vmcnt(16)
    s_barrier
    v_mfma_f32_16x16x32_bf16 v[4:7], v[56:59], a[212:215], v[4:7]
    ds_read_b64_tr_b16 v[48:49], v241 offset:0
    ds_read_b64_tr_b16 v[50:51], v241 offset:2048
    v_mfma_f32_16x16x32_bf16 v[8:11], v[56:59], a[216:219], v[8:11]
    s_add_u32 m0, s80, 65536
    s_add_u32 s81, s81, 36864
    v_mfma_f32_16x16x32_bf16 v[12:15], v[56:59], a[220:223], v[12:15]
    s_add_u32 s73, s44, s81
    v_mfma_f32_16x16x32_bf16 v[16:19], v[56:59], a[224:227], v[16:19]
    buffer_load_dwordx4 v240, s[20:23], s73 offen lds
    v_mfma_f32_16x16x32_bf16 v[20:23], v[56:59], a[228:231], v[20:23]
    s_waitcnt lgkmcnt(2)
    v_mfma_f32_16x16x32_bf16 v[0:3], v[60:63], a[232:235], v[0:3]
    ds_read_b64_tr_b16 v[52:53], v241 offset:4096
    ds_read_b64_tr_b16 v[54:55], v241 offset:6144
    v_mfma_f32_16x16x32_bf16 v[4:7], v[60:63], a[236:239], v[4:7]
    v_mfma_f32_16x16x32_bf16 v[8:11], v[60:63], a[240:243], v[8:11]
    s_add_u32 m0, s80, 69632
    s_add_u32 s73, s45, s81
    v_mfma_f32_16x16x32_bf16 v[12:15], v[60:63], a[244:247], v[12:15]
    buffer_load_dwordx4 v240, s[20:23], s73 offen lds
    v_mfma_f32_16x16x32_bf16 v[16:19], v[60:63], a[248:251], v[16:19]
    v_mfma_f32_16x16x32_bf16 v[20:23], v[60:63], a[252:255], v[20:23]
    s_waitcnt lgkmcnt(2)
    v_mfma_f32_16x16x32_bf16 v[0:3], v[48:51], a[0:3], v[0:3]
    ds_read_b64_tr_b16 v[56:57], v241 offset:8192
    ds_read_b64_tr_b16 v[58:59], v241 offset:10240
    v_mfma_f32_16x16x32_bf16 v[4:7], v[48:51], a[4:7], v[4:7]
    v_mfma_f32_16x16x32_bf16 v[8:11], v[48:51], a[8:11], v[8:11]
    s_add_u32 m0, s80, 73728
    s_add_u32 s73, s46, s81
    v_mfma_f32_16x16x32_bf16 v[12:15], v[48:51], a[12:15], v[12:15]
    buffer_load_dwordx4 v240, s[20:23], s73 offen lds
    v_mfma_f32_16x16x32_bf16 v[16:19], v[48:51], a[16:19], v[16:19]
    v_mfma_f32_16x16x32_bf16 v[20:23], v[48:51], a[20:23], v[20:23]
    s_waitcnt lgkmcnt(2)
    v_mfma_f32_16x16x32_bf16 v[0:3], v[52:55], a[24:27], v[0:3]
    ds_read_b64_tr_b16 v[60:61], v241 offset:12288
    ds_read_b64_tr_b16 v[62:63], v241 offset:14336
    v_mfma_f32_16x16x32_bf16 v[4:7], v[52:55], a[28:31], v[4:7]
    v_mfma_f32_16x16x32_bf16 v[8:11], v[52:55], a[32:35], v[8:11]
    s_add_u32 m0, s80, 77824
    s_add_u32 s73, s47, s81
    v_mfma_f32_16x16x32_bf16 v[12:15], v[52:55], a[36:39], v[12:15]
    buffer_load_dwordx4 v240, s[20:23], s73 offen lds
    v_mfma_f32_16x16x32_bf16 v[16:19], v[52:55], a[40:43], v[16:19]
    v_mfma_f32_16x16x32_bf16 v[20:23], v[52:55], a[44:47], v[20:23]
    s_waitcnt lgkmcnt(2)
    v_mfma_f32_16x16x32_bf16 v[0:3], v[56:59], a[48:51], v[0:3]
    s_waitcnt vmcnt(15)
    s_barrier
    v_mfma_f32_16x16x32_bf16 v[4:7], v[56:59], a[52:55], v[4:7]
    ds_read_b64_tr_b16 v[48:49], v241 offset:16384
    ds_read_b64_tr_b16 v[50:51], v241 offset:18432
    v_mfma_f32_16x16x32_bf16 v[8:11], v[56:59], a[56:59], v[8:11]
    s_add_u32 m0, s80, 81920
    s_add_u32 s81, s81, 36864
    v_mfma_f32_16x16x32_bf16 v[12:15], v[56:59], a[60:63], v[12:15]
    s_add_u32 s73, s44, s81
    v_mfma_f32_16x16x32_bf16 v[16:19], v[56:59], a[64:67], v[16:19]
    buffer_load_dwordx4 v240, s[20:23], s73 offen lds
    v_mfma_f32_16x16x32_bf16 v[20:23], v[56:59], a[68:71], v[20:23]
    s_waitcnt lgkmcnt(2)
    v_mfma_f32_16x16x32_bf16 v[0:3], v[60:63], a[72:75], v[0:3]
    ds_read_b64_tr_b16 v[52:53], v241 offset:20480
    ds_read_b64_tr_b16 v[54:55], v241 offset:22528
    v_mfma_f32_16x16x32_bf16 v[4:7], v[60:63], a[76:79], v[4:7]
    v_mfma_f32_16x16x32_bf16 v[8:11], v[60:63], a[80:83], v[8:11]
    s_add_u32 m0, s80, 86016
    s_add_u32 s73, s45, s81
    v_mfma_f32_16x16x32_bf16 v[12:15], v[60:63], a[84:87], v[12:15]
    buffer_load_dwordx4 v240, s[20:23], s73 offen lds
    v_mfma_f32_16x16x32_bf16 v[16:19], v[60:63], a[88:91], v[16:19]
    s_waitcnt vmcnt(10)
    buffer_store_dword v242, v246, s[60:63], s90 offen offset:128 sc1
    v_mfma_f32_16x16x32_bf16 v[20:23], v[60:63], a[92:95], v[20:23]
    s_waitcnt lgkmcnt(2)
    v_mfma_f32_16x16x32_bf16 v[0:3], v[48:51], a[96:99], v[0:3]
    ds_read_b64_tr_b16 v[56:57], v241 offset:24576
    ds_read_b64_tr_b16 v[58:59], v241 offset:26624
    v_mfma_f32_16x16x32_bf16 v[4:7], v[48:51], a[100:103], v[4:7]
    v_mfma_f32_16x16x32_bf16 v[8:11], v[48:51], a[104:107], v[8:11]
    s_add_u32 m0, s80, 90112
    s_add_u32 s73, s46, s81
    v_mfma_f32_16x16x32_bf16 v[12:15], v[48:51], a[108:111], v[12:15]
    buffer_load_dwordx4 v240, s[20:23], s73 offen lds
    v_mfma_f32_16x16x32_bf16 v[16:19], v[48:51], a[112:115], v[16:19]
    v_mfma_f32_16x16x32_bf16 v[20:23], v[48:51], a[116:119], v[20:23]
    s_waitcnt lgkmcnt(2)
    v_mfma_f32_16x16x32_bf16 v[0:3], v[52:55], a[120:123], v[0:3]
    ds_read_b64_tr_b16 v[60:61], v241 offset:28672
    ds_read_b64_tr_b16 v[62:63], v241 offset:30720
    v_mfma_f32_16x16x32_bf16 v[4:7], v[52:55], a[124:127], v[4:7]
    v_mfma_f32_16x16x32_bf16 v[8:11], v[52:55], a[128:131], v[8:11]
    s_add_u32 m0, s80, 94208
    s_add_u32 s73, s47, s81
    v_mfma_f32_16x16x32_bf16 v[12:15], v[52:55], a[132:135], v[12:15]
    buffer_load_dwordx4 v240, s[20:23], s73 offen lds
    v_mfma_f32_16x16x32_bf16 v[16:19], v[52:55], a[136:139], v[16:19]
    v_mfma_f32_16x16x32_bf16 v[20:23], v[52:55], a[140:143], v[20:23]
    s_waitcnt lgkmcnt(2)
    v_mfma_f32_16x16x32_bf16 v[0:3], v[56:59], a[144:147], v[0:3]
    s_barrier
    v_mfma_f32_16x16x32_bf16 v[4:7], v[56:59], a[148:151], v[4:7]
    ds_read_b64_tr_b16 v[48:49], v241 offset:32768
    ds_read_b64_tr_b16 v[50:51], v241 offset:34816
    v_mfma_f32_16x16x32_bf16 v[8:11], v[56:59], a[152:155], v[8:11]
    s_add_u32 m0, s80, 0
    s_add_u32 s81, s5, 4
    v_mfma_f32_16x16x32_bf16 v[12:15], v[56:59], a[156:159], v[12:15]
    s_and_b32 s81, s81, 7
    s_lshl_b32 s81, s81, 7
    v_mfma_f32_16x16x32_bf16 v[16:19], v[56:59], a[160:163], v[16:19]
    s_add_u32 s73, s44, s81
    v_mfma_f32_16x16x32_bf16 v[20:23], v[56:59], a[164:167], v[20:23]
    s_waitcnt lgkmcnt(2)
    v_mfma_f32_16x16x32_bf16 v[0:3], v[60:63], a[168:171], v[0:3]
    buffer_load_dwordx4 v240, s[20:23], s73 offen lds
    v_mfma_f32_16x16x32_bf16 v[4:7], v[60:63], a[172:175], v[4:7]
    ds_read_b64_tr_b16 v[52:53], v241 offset:36864
    ds_read_b64_tr_b16 v[54:55], v241 offset:38912
    v_mfma_f32_16x16x32_bf16 v[8:11], v[60:63], a[176:179], v[8:11]
    s_add_u32 m0, s80, 4096
    s_add_u32 s73, s45, s81
    v_mfma_f32_16x16x32_bf16 v[12:15], v[60:63], a[180:183], v[12:15]
    buffer_load_dwordx4 v240, s[20:23], s73 offen lds
    v_mfma_f32_16x16x32_bf16 v[16:19], v[60:63], a[184:187], v[16:19]
    v_mfma_f32_16x16x32_bf16 v[20:23], v[60:63], a[188:191], v[20:23]
    s_waitcnt lgkmcnt(2)
    v_mfma_f32_16x16x32_bf16 v[24:27], v[48:51], v[100:103], 0
    ds_read_b64_tr_b16 v[56:57], v241 offset:40960
    ds_read_b64_tr_b16 v[58:59], v241 offset:43008
    v_mfma_f32_16x16x32_bf16 v[28:31], v[48:51], v[104:107], 0
    v_mfma_f32_16x16x32_bf16 v[32:35], v[48:51], v[108:111], 0
    s_add_u32 m0, s80, 8192
    s_add_u32 s73, s46, s81
    v_mfma_f32_16x16x32_bf16 v[36:39], v[48:51], v[112:115], 0
    buffer_load_dwordx4 v240, s[20:23], s73 offen lds
    v_mfma_f32_16x16x32_bf16 v[40:43], v[48:51], v[116:119], 0
    v_cvt_pk_bf16_f32 v64, v0, v1
    v_cvt_pk_bf16_f32 v65, v2, v3
    v_mfma_f32_16x16x32_bf16 v[44:47], v[48:51], v[120:123], 0
    v_cvt_pk_bf16_f32 v66, v4, v5
    s_waitcnt lgkmcnt(2)
    v_mfma_f32_16x16x32_bf16 v[24:27], v[52:55], v[124:127], v[24:27]
    v_cvt_pk_bf16_f32 v67, v6, v7
    v_mfma_f32_16x16x32_bf16 v[28:31], v[52:55], v[128:131], v[28:31]
    buffer_store_dwordx4 v[64:67], v243, s[24:27], s36 offen sc1
    v_mfma_f32_16x16x32_bf16 v[32:35], v[52:55], v[132:135], v[32:35]
    ds_read_b64_tr_b16 v[60:61], v241 offset:45056
    ds_read_b64_tr_b16 v[62:63], v241 offset:47104
    v_cvt_pk_bf16_f32 v68, v8, v9
    v_cvt_pk_bf16_f32 v69, v10, v11
    v_mfma_f32_16x16x32_bf16 v[36:39], v[52:55], v[136:139], v[36:39]
    s_add_u32 m0, s80, 12288
    s_add_u32 s73, s47, s81
    v_cvt_pk_bf16_f32 v70, v12, v13
    v_cvt_pk_bf16_f32 v71, v14, v15
    v_mfma_f32_16x16x32_bf16 v[40:43], v[52:55], v[140:143], v[40:43]
    buffer_load_dwordx4 v240, s[20:23], s73 offen lds
    buffer_store_dwordx4 v[68:71], v243, s[24:27], s36 offen offset:1024 sc1
    v_mfma_f32_16x16x32_bf16 v[44:47], v[52:55], v[144:147], v[44:47]
    v_cvt_pk_bf16_f32 v72, v16, v17
    v_cvt_pk_bf16_f32 v73, v18, v19
    s_waitcnt lgkmcnt(2)
    v_mfma_f32_16x16x32_bf16 v[24:27], v[56:59], v[148:151], v[24:27]
    s_waitcnt vmcnt(15)
    s_barrier
    v_cvt_pk_bf16_f32 v74, v20, v21
    v_cvt_pk_bf16_f32 v75, v22, v23
    v_mfma_f32_16x16x32_bf16 v[28:31], v[56:59], v[152:155], v[28:31]
    buffer_store_dwordx4 v[72:75], v243, s[24:27], s36 offen offset:2048 sc1
    v_mfma_f32_16x16x32_bf16 v[32:35], v[56:59], v[156:159], v[32:35]
    ds_read_b64_tr_b16 v[48:49], v241 offset:49152
    ds_read_b64_tr_b16 v[50:51], v241 offset:51200
    v_mfma_f32_16x16x32_bf16 v[36:39], v[56:59], v[160:163], v[36:39]
    s_add_u32 m0, s80, 16384
    s_add_u32 s81, s81, 36864
    v_mfma_f32_16x16x32_bf16 v[40:43], v[56:59], v[164:167], v[40:43]
    s_add_u32 s73, s44, s81
    v_mfma_f32_16x16x32_bf16 v[44:47], v[56:59], v[168:171], v[44:47]
    buffer_load_dwordx4 v240, s[20:23], s73 offen lds
    s_waitcnt lgkmcnt(2)
    v_mfma_f32_16x16x32_bf16 v[24:27], v[60:63], v[172:175], v[24:27]
    v_mfma_f32_16x16x32_bf16 v[28:31], v[60:63], v[176:179], v[28:31]
    ds_read_b64_tr_b16 v[52:53], v241 offset:53248
    ds_read_b64_tr_b16 v[54:55], v241 offset:55296
    v_mfma_f32_16x16x32_bf16 v[32:35], v[60:63], v[180:183], v[32:35]
    s_add_u32 m0, s80, 20480
    s_add_u32 s73, s45, s81
    v_mfma_f32_16x16x32_bf16 v[36:39], v[60:63], v[184:187], v[36:39]
    buffer_load_dwordx4 v240, s[20:23], s73 offen lds
    v_mfma_f32_16x16x32_bf16 v[40:43], v[60:63], v[188:191], v[40:43]
    v_mfma_f32_16x16x32_bf16 v[44:47], v[60:63], v[192:195], v[44:47]
    s_waitcnt lgkmcnt(2)
    v_mfma_f32_16x16x32_bf16 v[24:27], v[48:51], v[196:199], v[24:27]
    ds_read_b64_tr_b16 v[56:57], v241 offset:57344
    ds_read_b64_tr_b16 v[58:59], v241 offset:59392
    v_mfma_f32_16x16x32_bf16 v[28:31], v[48:51], v[200:203], v[28:31]
    v_mfma_f32_16x16x32_bf16 v[32:35], v[48:51], v[204:207], v[32:35]
    s_add_u32 m0, s80, 24576
    s_add_u32 s73, s46, s81
    v_mfma_f32_16x16x32_bf16 v[36:39], v[48:51], v[208:211], v[36:39]
    buffer_load_dwordx4 v240, s[20:23], s73 offen lds
    v_mfma_f32_16x16x32_bf16 v[40:43], v[48:51], v[212:215], v[40:43]
    v_mfma_f32_16x16x32_bf16 v[44:47], v[48:51], v[216:219], v[44:47]
    s_waitcnt lgkmcnt(2)
    v_mfma_f32_16x16x32_bf16 v[24:27], v[52:55], v[220:223], v[24:27]
    ds_read_b64_tr_b16 v[60:61], v241 offset:61440
    ds_read_b64_tr_b16 v[62:63], v241 offset:63488
    v_mfma_f32_16x16x32_bf16 v[28:31], v[52:55], v[224:227], v[28:31]
    v_mfma_f32_16x16x32_bf16 v[32:35], v[52:55], a[192:195], v[32:35]
    s_add_u32 m0, s80, 28672
    s_add_u32 s73, s47, s81
    v_mfma_f32_16x16x32_bf16 v[36:39], v[52:55], a[196:199], v[36:39]
    buffer_load_dwordx4 v240, s[20:23], s73 offen lds
    v_mfma_f32_16x16x32_bf16 v[40:43], v[52:55], a[200:203], v[40:43]
    v_mfma_f32_16x16x32_bf16 v[44:47], v[52:55], a[204:207], v[44:47]
    s_waitcnt lgkmcnt(2)
    v_mfma_f32_16x16x32_bf16 v[24:27], v[56:59], a[208:211], v[24:27]
    s_waitcnt vmcnt(16)
    s_barrier
    v_mfma_f32_16x16x32_bf16 v[28:31], v[56:59], a[212:215], v[28:31]
    ds_read_b64_tr_b16 v[48:49], v242 offset:0
    ds_read_b64_tr_b16 v[50:51], v242 offset:2048
    v_mfma_f32_16x16x32_bf16 v[32:35], v[56:59], a[216:219], v[32:35]
    s_add_u32 m0, s80, 32768
    s_add_u32 s81, s81, 36864
    v_mfma_f32_16x16x32_bf16 v[36:39], v[56:59], a[220:223], v[36:39]
    s_add_u32 s73, s44, s81
    v_mfma_f32_16x16x32_bf16 v[40:43], v[56:59], a[224:227], v[40:43]
    buffer_load_dwordx4 v240, s[20:23], s73 offen lds
    v_mfma_f32_16x16x32_bf16 v[44:47], v[56:59], a[228:231], v[44:47]
    s_waitcnt lgkmcnt(2)
    v_mfma_f32_16x16x32_bf16 v[24:27], v[60:63], a[232:235], v[24:27]
    ds_read_b64_tr_b16 v[52:53], v242 offset:4096
    ds_read_b64_tr_b16 v[54:55], v242 offset:6144
    v_mfma_f32_16x16x32_bf16 v[28:31], v[60:63], a[236:239], v[28:31]
    v_mfma_f32_16x16x32_bf16 v[32:35], v[60:63], a[240:243], v[32:35]
    s_add_u32 m0, s80, 36864
    s_add_u32 s73, s45, s81
    v_mfma_f32_16x16x32_bf16 v[36:39], v[60:63], a[244:247], v[36:39]
    buffer_load_dwordx4 v240, s[20:23], s73 offen lds
    v_mfma_f32_16x16x32_bf16 v[40:43], v[60:63], a[248:251], v[40:43]
    v_mfma_f32_16x16x32_bf16 v[44:47], v[60:63], a[252:255], v[44:47]
    s_waitcnt lgkmcnt(2)
    v_mfma_f32_16x16x32_bf16 v[24:27], v[48:51], a[0:3], v[24:27]
    ds_read_b64_tr_b16 v[56:57], v242 offset:8192
    ds_read_b64_tr_b16 v[58:59], v242 offset:10240
    v_mfma_f32_16x16x32_bf16 v[28:31], v[48:51], a[4:7], v[28:31]
    v_mfma_f32_16x16x32_bf16 v[32:35], v[48:51], a[8:11], v[32:35]
    s_add_u32 m0, s80, 40960
    s_add_u32 s73, s46, s81
    v_mfma_f32_16x16x32_bf16 v[36:39], v[48:51], a[12:15], v[36:39]
    buffer_load_dwordx4 v240, s[20:23], s73 offen lds
    v_mfma_f32_16x16x32_bf16 v[40:43], v[48:51], a[16:19], v[40:43]
    v_mfma_f32_16x16x32_bf16 v[44:47], v[48:51], a[20:23], v[44:47]
    s_waitcnt lgkmcnt(2)
    v_mfma_f32_16x16x32_bf16 v[24:27], v[52:55], a[24:27], v[24:27]
    ds_read_b64_tr_b16 v[60:61], v242 offset:12288
    ds_read_b64_tr_b16 v[62:63], v242 offset:14336
    v_mfma_f32_16x16x32_bf16 v[28:31], v[52:55], a[28:31], v[28:31]
    v_mfma_f32_16x16x32_bf16 v[32:35], v[52:55], a[32:35], v[32:35]
    s_add_u32 m0, s80, 45056
    s_add_u32 s73, s47, s81
    v_mfma_f32_16x16x32_bf16 v[36:39], v[52:55], a[36:39], v[36:39]
    buffer_load_dwordx4 v240, s[20:23], s73 offen lds
    v_mfma_f32_16x16x32_bf16 v[40:43], v[52:55], a[40:43], v[40:43]
    v_mfma_f32_16x16x32_bf16 v[44:47], v[52:55], a[44:47], v[44:47]
    s_waitcnt lgkmcnt(2)
    v_mfma_f32_16x16x32_bf16 v[24:27], v[56:59], a[48:51], v[24:27]
    s_waitcnt vmcnt(15)
    s_barrier
    v_mfma_f32_16x16x32_bf16 v[28:31], v[56:59], a[52:55], v[28:31]
    ds_read_b64_tr_b16 v[48:49], v242 offset:16384
    ds_read_b64_tr_b16 v[50:51], v242 offset:18432
    v_mfma_f32_16x16x32_bf16 v[32:35], v[56:59], a[56:59], v[32:35]
    s_add_u32 m0, s80, 49152
    s_add_u32 s81, s81, 36864
    v_mfma_f32_16x16x32_bf16 v[36:39], v[56:59], a[60:63], v[36:39]
    s_add_u32 s73, s44, s81
    s_lshl_b32 s86, s88, 3
    v_mfma_f32_16x16x32_bf16 v[40:43], v[56:59], a[64:67], v[40:43]
    buffer_load_dwordx4 v240, s[20:23], s73 offen lds
    v_mfma_f32_16x16x32_bf16 v[44:47], v[56:59], a[68:71], v[44:47]
    buffer_load_dwordx2 v[228:229], v248, s[64:67], s86 offen sc1
    s_waitcnt lgkmcnt(2)
    v_mfma_f32_16x16x32_bf16 v[24:27], v[60:63], a[72:75], v[24:27]
    ds_read_b64_tr_b16 v[52:53], v242 offset:20480
    ds_read_b64_tr_b16 v[54:55], v242 offset:22528
    v_mfma_f32_16x16x32_bf16 v[28:31], v[60:63], a[76:79], v[28:31]
    v_mfma_f32_16x16x32_bf16 v[32:35], v[60:63], a[80:83], v[32:35]
    s_add_u32 m0, s80, 53248
    s_add_u32 s73, s45, s81
    v_mfma_f32_16x16x32_bf16 v[36:39], v[60:63], a[84:87], v[36:39]
    buffer_load_dwordx4 v240, s[20:23], s73 offen lds
    v_mfma_f32_16x16x32_bf16 v[40:43], v[60:63], a[88:91], v[40:43]
    s_waitcnt vmcnt(11)
    buffer_store_dword v242, v246, s[60:63], s90 offen offset:256 sc1
    v_mfma_f32_16x16x32_bf16 v[44:47], v[60:63], a[92:95], v[44:47]
    s_waitcnt lgkmcnt(2)
    v_mfma_f32_16x16x32_bf16 v[24:27], v[48:51], a[96:99], v[24:27]
    ds_read_b64_tr_b16 v[56:57], v242 offset:24576
    ds_read_b64_tr_b16 v[58:59], v242 offset:26624
    v_mfma_f32_16x16x32_bf16 v[28:31], v[48:51], a[100:103], v[28:31]
    v_mfma_f32_16x16x32_bf16 v[32:35], v[48:51], a[104:107], v[32:35]
    s_add_u32 m0, s80, 57344
    s_add_u32 s73, s46, s81
    v_mfma_f32_16x16x32_bf16 v[36:39], v[48:51], a[108:111], v[36:39]
    buffer_load_dwordx4 v240, s[20:23], s73 offen lds
    v_mfma_f32_16x16x32_bf16 v[40:43], v[48:51], a[112:115], v[40:43]
    v_mfma_f32_16x16x32_bf16 v[44:47], v[48:51], a[116:119], v[44:47]
    s_waitcnt lgkmcnt(2)
    v_mfma_f32_16x16x32_bf16 v[24:27], v[52:55], a[120:123], v[24:27]
    ds_read_b64_tr_b16 v[60:61], v242 offset:28672
    ds_read_b64_tr_b16 v[62:63], v242 offset:30720
    v_mfma_f32_16x16x32_bf16 v[28:31], v[52:55], a[124:127], v[28:31]
    v_mfma_f32_16x16x32_bf16 v[32:35], v[52:55], a[128:131], v[32:35]
    s_add_u32 m0, s80, 61440
    s_add_u32 s73, s47, s81
    v_mfma_f32_16x16x32_bf16 v[36:39], v[52:55], a[132:135], v[36:39]
    buffer_load_dwordx4 v240, s[20:23], s73 offen lds
    v_mfma_f32_16x16x32_bf16 v[40:43], v[52:55], a[136:139], v[40:43]
    v_mfma_f32_16x16x32_bf16 v[44:47], v[52:55], a[140:143], v[44:47]
    s_waitcnt lgkmcnt(2)
    v_mfma_f32_16x16x32_bf16 v[24:27], v[56:59], a[144:147], v[24:27]
    s_barrier
    v_mfma_f32_16x16x32_bf16 v[28:31], v[56:59], a[148:151], v[28:31]
    ds_read_b64_tr_b16 v[48:49], v241 offset:0
    ds_read_b64_tr_b16 v[50:51], v241 offset:2048
    v_mfma_f32_16x16x32_bf16 v[32:35], v[56:59], a[152:155], v[32:35]
    s_add_u32 m0, s80, 65536
    s_add_u32 s81, s5, 5
    v_mfma_f32_16x16x32_bf16 v[36:39], v[56:59], a[156:159], v[36:39]
    s_and_b32 s81, s81, 7
    s_lshl_b32 s81, s81, 7
    v_mfma_f32_16x16x32_bf16 v[40:43], v[56:59], a[160:163], v[40:43]
    s_add_u32 s73, s44, s81
    v_mfma_f32_16x16x32_bf16 v[44:47], v[56:59], a[164:167], v[44:47]
    s_waitcnt lgkmcnt(2)
    v_mfma_f32_16x16x32_bf16 v[24:27], v[60:63], a[168:171], v[24:27]
    buffer_load_dwordx4 v240, s[20:23], s73 offen lds
    v_mfma_f32_16x16x32_bf16 v[28:31], v[60:63], a[172:175], v[28:31]
    ds_read_b64_tr_b16 v[52:53], v241 offset:4096
    ds_read_b64_tr_b16 v[54:55], v241 offset:6144
    v_mfma_f32_16x16x32_bf16 v[32:35], v[60:63], a[176:179], v[32:35]
    s_add_u32 m0, s80, 69632
    s_add_u32 s73, s45, s81
    v_mfma_f32_16x16x32_bf16 v[36:39], v[60:63], a[180:183], v[36:39]
    buffer_load_dwordx4 v240, s[20:23], s73 offen lds
    v_mfma_f32_16x16x32_bf16 v[40:43], v[60:63], a[184:187], v[40:43]
    v_mfma_f32_16x16x32_bf16 v[44:47], v[60:63], a[188:191], v[44:47]
    s_waitcnt lgkmcnt(2)
    v_mfma_f32_16x16x32_bf16 v[0:3], v[48:51], v[100:103], 0
    ds_read_b64_tr_b16 v[56:57], v241 offset:8192
    ds_read_b64_tr_b16 v[58:59], v241 offset:10240
    v_mfma_f32_16x16x32_bf16 v[4:7], v[48:51], v[104:107], 0
    v_mfma_f32_16x16x32_bf16 v[8:11], v[48:51], v[108:111], 0
    s_add_u32 m0, s80, 73728
    s_add_u32 s73, s46, s81
    v_mfma_f32_16x16x32_bf16 v[12:15], v[48:51], v[112:115], 0
    buffer_load_dwordx4 v240, s[20:23], s73 offen lds
    v_mfma_f32_16x16x32_bf16 v[16:19], v[48:51], v[116:119], 0
    v_cvt_pk_bf16_f32 v64, v24, v25
    v_cvt_pk_bf16_f32 v65, v26, v27
    v_mfma_f32_16x16x32_bf16 v[20:23], v[48:51], v[120:123], 0
    v_cvt_pk_bf16_f32 v66, v28, v29
    s_waitcnt lgkmcnt(2)
    v_mfma_f32_16x16x32_bf16 v[0:3], v[52:55], v[124:127], v[0:3]
    v_cvt_pk_bf16_f32 v67, v30, v31
    v_mfma_f32_16x16x32_bf16 v[4:7], v[52:55], v[128:131], v[4:7]
    buffer_store_dwordx4 v[64:67], v243, s[24:27], s37 offen sc1
    v_mfma_f32_16x16x32_bf16 v[8:11], v[52:55], v[132:135], v[8:11]
    ds_read_b64_tr_b16 v[60:61], v241 offset:12288
    ds_read_b64_tr_b16 v[62:63], v241 offset:14336
    v_cvt_pk_bf16_f32 v68, v32, v33
    v_cvt_pk_bf16_f32 v69, v34, v35
    v_mfma_f32_16x16x32_bf16 v[12:15], v[52:55], v[136:139], v[12:15]
    s_add_u32 m0, s80, 77824
    s_add_u32 s73, s47, s81
    v_cvt_pk_bf16_f32 v70, v36, v37
    v_cvt_pk_bf16_f32 v71, v38, v39
    v_mfma_f32_16x16x32_bf16 v[16:19], v[52:55], v[140:143], v[16:19]
    buffer_load_dwordx4 v240, s[20:23], s73 offen lds
    buffer_store_dwordx4 v[68:71], v243, s[24:27], s37 offen offset:1024 sc1
    v_mfma_f32_16x16x32_bf16 v[20:23], v[52:55], v[144:147], v[20:23]
    v_cvt_pk_bf16_f32 v72, v40, v41
    v_cvt_pk_bf16_f32 v73, v42, v43
    s_waitcnt lgkmcnt(2)
    v_mfma_f32_16x16x32_bf16 v[0:3], v[56:59], v[148:151], v[0:3]
    s_waitcnt vmcnt(16)
    s_barrier
    v_cvt_pk_bf16_f32 v74, v44, v45
    v_cvt_pk_bf16_f32 v75, v46, v47
    v_mfma_f32_16x16x32_bf16 v[4:7], v[56:59], v[152:155], v[4:7]
    buffer_store_dwordx4 v[72:75], v243, s[24:27], s37 offen offset:2048 sc1
    v_mfma_f32_16x16x32_bf16 v[8:11], v[56:59], v[156:159], v[8:11]
    ds_read_b64_tr_b16 v[48:49], v241 offset:16384
    ds_read_b64_tr_b16 v[50:51], v241 offset:18432
    v_mfma_f32_16x16x32_bf16 v[12:15], v[56:59], v[160:163], v[12:15]
    s_add_u32 m0, s80, 81920
    s_add_u32 s81, s81, 36864
    v_mfma_f32_16x16x32_bf16 v[16:19], v[56:59], v[164:167], v[16:19]
    s_add_u32 s73, s44, s81
    v_mfma_f32_16x16x32_bf16 v[20:23], v[56:59], v[168:171], v[20:23]
    buffer_load_dwordx4 v240, s[20:23], s73 offen lds
    s_waitcnt lgkmcnt(2)
    v_mfma_f32_16x16x32_bf16 v[0:3], v[60:63], v[172:175], v[0:3]
    v_mfma_f32_16x16x32_bf16 v[4:7], v[60:63], v[176:179], v[4:7]
    ds_read_b64_tr_b16 v[52:53], v241 offset:20480
    ds_read_b64_tr_b16 v[54:55], v241 offset:22528
    v_mfma_f32_16x16x32_bf16 v[8:11], v[60:63], v[180:183], v[8:11]
    s_add_u32 m0, s80, 86016
    s_add_u32 s73, s45, s81
    v_mfma_f32_16x16x32_bf16 v[12:15], v[60:63], v[184:187], v[12:15]
    buffer_load_dwordx4 v240, s[20:23], s73 offen lds
    v_mfma_f32_16x16x32_bf16 v[16:19], v[60:63], v[188:191], v[16:19]
    v_mfma_f32_16x16x32_bf16 v[20:23], v[60:63], v[192:195], v[20:23]
    s_waitcnt lgkmcnt(2)
    v_mfma_f32_16x16x32_bf16 v[0:3], v[48:51], v[196:199], v[0:3]
    ds_read_b64_tr_b16 v[56:57], v241 offset:24576
    ds_read_b64_tr_b16 v[58:59], v241 offset:26624
    v_mfma_f32_16x16x32_bf16 v[4:7], v[48:51], v[200:203], v[4:7]
    v_mfma_f32_16x16x32_bf16 v[8:11], v[48:51], v[204:207], v[8:11]
    s_add_u32 m0, s80, 90112
    s_add_u32 s73, s46, s81
    v_mfma_f32_16x16x32_bf16 v[12:15], v[48:51], v[208:211], v[12:15]
    buffer_load_dwordx4 v240, s[20:23], s73 offen lds
    v_mfma_f32_16x16x32_bf16 v[16:19], v[48:51], v[212:215], v[16:19]
    v_mfma_f32_16x16x32_bf16 v[20:23], v[48:51], v[216:219], v[20:23]
    s_waitcnt lgkmcnt(2)
    v_mfma_f32_16x16x32_bf16 v[0:3], v[52:55], v[220:223], v[0:3]
    ds_read_b64_tr_b16 v[60:61], v241 offset:28672
    ds_read_b64_tr_b16 v[62:63], v241 offset:30720
    v_mfma_f32_16x16x32_bf16 v[4:7], v[52:55], v[224:227], v[4:7]
    v_mfma_f32_16x16x32_bf16 v[8:11], v[52:55], a[192:195], v[8:11]
    s_add_u32 m0, s80, 94208
    s_add_u32 s73, s47, s81
    v_mfma_f32_16x16x32_bf16 v[12:15], v[52:55], a[196:199], v[12:15]
    buffer_load_dwordx4 v240, s[20:23], s73 offen lds
    v_mfma_f32_16x16x32_bf16 v[16:19], v[52:55], a[200:203], v[16:19]
    v_mfma_f32_16x16x32_bf16 v[20:23], v[52:55], a[204:207], v[20:23]
    s_waitcnt lgkmcnt(2)
    v_mfma_f32_16x16x32_bf16 v[0:3], v[56:59], a[208:211], v[0:3]
    s_waitcnt vmcnt(17)
    s_barrier
    v_mfma_f32_16x16x32_bf16 v[4:7], v[56:59], a[212:215], v[4:7]
    ds_read_b64_tr_b16 v[48:49], v241 offset:32768
    ds_read_b64_tr_b16 v[50:51], v241 offset:34816
    v_mfma_f32_16x16x32_bf16 v[8:11], v[56:59], a[216:219], v[8:11]
    s_add_u32 m0, s80, 0
    s_add_u32 s81, s81, 36864
    v_mfma_f32_16x16x32_bf16 v[12:15], v[56:59], a[220:223], v[12:15]
    s_add_u32 s73, s44, s81
    v_mfma_f32_16x16x32_bf16 v[16:19], v[56:59], a[224:227], v[16:19]
    buffer_load_dwordx4 v240, s[20:23], s73 offen lds
    v_mfma_f32_16x16x32_bf16 v[20:23], v[56:59], a[228:231], v[20:23]
    s_waitcnt lgkmcnt(2)
    v_mfma_f32_16x16x32_bf16 v[0:3], v[60:63], a[232:235], v[0:3]
    ds_read_b64_tr_b16 v[52:53], v241 offset:36864
    ds_read_b64_tr_b16 v[54:55], v241 offset:38912
    v_mfma_f32_16x16x32_bf16 v[4:7], v[60:63], a[236:239], v[4:7]
    v_mfma_f32_16x16x32_bf16 v[8:11], v[60:63], a[240:243], v[8:11]
    s_add_u32 m0, s80, 4096
    s_add_u32 s73, s45, s81
    v_mfma_f32_16x16x32_bf16 v[12:15], v[60:63], a[244:247], v[12:15]
    buffer_load_dwordx4 v240, s[20:23], s73 offen lds
    v_mfma_f32_16x16x32_bf16 v[16:19], v[60:63], a[248:251], v[16:19]
    v_mfma_f32_16x16x32_bf16 v[20:23], v[60:63], a[252:255], v[20:23]
    s_waitcnt lgkmcnt(2)
    v_mfma_f32_16x16x32_bf16 v[0:3], v[48:51], a[0:3], v[0:3]
    ds_read_b64_tr_b16 v[56:57], v241 offset:40960
    ds_read_b64_tr_b16 v[58:59], v241 offset:43008
    v_mfma_f32_16x16x32_bf16 v[4:7], v[48:51], a[4:7], v[4:7]
    v_mfma_f32_16x16x32_bf16 v[8:11], v[48:51], a[8:11], v[8:11]
    s_add_u32 m0, s80, 8192
    s_add_u32 s73, s46, s81
    v_mfma_f32_16x16x32_bf16 v[12:15], v[48:51], a[12:15], v[12:15]
    buffer_load_dwordx4 v240, s[20:23], s73 offen lds
    v_mfma_f32_16x16x32_bf16 v[16:19], v[48:51], a[16:19], v[16:19]
    v_mfma_f32_16x16x32_bf16 v[20:23], v[48:51], a[20:23], v[20:23]
    s_waitcnt lgkmcnt(2)
    v_mfma_f32_16x16x32_bf16 v[0:3], v[52:55], a[24:27], v[0:3]
    ds_read_b64_tr_b16 v[60:61], v241 offset:45056
    ds_read_b64_tr_b16 v[62:63], v241 offset:47104
    v_mfma_f32_16x16x32_bf16 v[4:7], v[52:55], a[28:31], v[4:7]
    v_mfma_f32_16x16x32_bf16 v[8:11], v[52:55], a[32:35], v[8:11]
    s_add_u32 m0, s80, 12288
    s_add_u32 s73, s47, s81
    v_mfma_f32_16x16x32_bf16 v[12:15], v[52:55], a[36:39], v[12:15]
    buffer_load_dwordx4 v240, s[20:23], s73 offen lds
    v_mfma_f32_16x16x32_bf16 v[16:19], v[52:55], a[40:43], v[16:19]
    s_waitcnt vmcnt(19)
    v_and_b32 v228, v228, v229
    s_nop 0
    v_readfirstlane_b32 s87, v228
    s_nop 1
    s_cmp_eq_u32 s87, 16843009
    s_cbranch_scc0 L_spin0
L_spun0:
    v_mfma_f32_16x16x32_bf16 v[20:23], v[52:55], a[44:47], v[20:23]
    s_waitcnt lgkmcnt(2)
    v_mfma_f32_16x16x32_bf16 v[0:3], v[56:59], a[48:51], v[0:3]
    s_waitcnt vmcnt(15)
    s_barrier
    v_mfma_f32_16x16x32_bf16 v[4:7], v[56:59], a[52:55], v[4:7]
    ds_read_b64_tr_b16 v[48:49], v241 offset:49152
    ds_read_b64_tr_b16 v[50:51], v241 offset:51200
    v_mfma_f32_16x16x32_bf16 v[8:11], v[56:59], a[56:59], v[8:11]
    s_add_u32 m0, s80, 16384
    s_add_u32 s81, s81, 36864
    v_mfma_f32_16x16x32_bf16 v[12:15], v[56:59], a[60:63], v[12:15]
    s_add_u32 s73, s44, s81
    v_mfma_f32_16x16x32_bf16 v[16:19], v[56:59], a[64:67], v[16:19]
    buffer_load_dwordx4 v240, s[20:23], s73 offen lds
    v_mfma_f32_16x16x32_bf16 v[20:23], v[56:59], a[68:71], v[20:23]
    s_waitcnt lgkmcnt(2)
    v_mfma_f32_16x16x32_bf16 v[0:3], v[60:63], a[72:75], v[0:3]
    ds_read_b64_tr_b16 v[52:53], v241 offset:53248
    ds_read_b64_tr_b16 v[54:55], v241 offset:55296
    v_mfma_f32_16x16x32_bf16 v[4:7], v[60:63], a[76:79], v[4:7]
    v_mfma_f32_16x16x32_bf16 v[8:11], v[60:63], a[80:83], v[8:11]
    s_add_u32 m0, s80, 20480
    s_add_u32 s73, s45, s81
    v_mfma_f32_16x16x32_bf16 v[12:15], v[60:63], a[84:87], v[12:15]
    buffer_load_dwordx4 v240, s[20:23], s73 offen lds
    v_mfma_f32_16x16x32_bf16 v[16:19], v[60:63], a[88:91], v[16:19]
    s_waitcnt vmcnt(10)
    buffer_store_dword v242, v246, s[60:63], s90 offen offset:384 sc1
    v_mfma_f32_16x16x32_bf16 v[20:23], v[60:63], a[92:95], v[20:23]
    s_waitcnt lgkmcnt(2)
    v_mfma_f32_16x16x32_bf16 v[0:3], v[48:51], a[96:99], v[0:3]
    ds_read_b64_tr_b16 v[56:57], v241 offset:57344
    ds_read_b64_tr_b16 v[58:59], v241 offset:59392
    v_mfma_f32_16x16x32_bf16 v[4:7], v[48:51], a[100:103], v[4:7]
    v_mfma_f32_16x16x32_bf16 v[8:11], v[48:51], a[104:107], v[8:11]
    s_add_u32 m0, s80, 24576
    s_add_u32 s73, s46, s81
    v_mfma_f32_16x16x32_bf16 v[12:15], v[48:51], a[108:111], v[12:15]
    buffer_load_dwordx4 v240, s[20:23], s73 offen lds
    v_mfma_f32_16x16x32_bf16 v[16:19], v[48:51], a[112:115], v[16:19]
    v_mfma_f32_16x16x32_bf16 v[20:23], v[48:51], a[116:119], v[20:23]
    s_waitcnt lgkmcnt(2)
    v_mfma_f32_16x16x32_bf16 v[0:3], v[52:55], a[120:123], v[0:3]
    ds_read_b64_tr_b16 v[60:61], v241 offset:61440
    ds_read_b64_tr_b16 v[62:63], v241 offset:63488
    v_mfma_f32_16x16x32_bf16 v[4:7], v[52:55], a[124:127], v[4:7]
    v_mfma_f32_16x16x32_bf16 v[8:11], v[52:55], a[128:131], v[8:11]
    s_add_u32 m0, s80, 28672
    s_add_u32 s73, s47, s81
    v_mfma_f32_16x16x32_bf16 v[12:15], v[52:55], a[132:135], v[12:15]
    buffer_load_dwordx4 v240, s[20:23], s73 offen lds
    v_mfma_f32_16x16x32_bf16 v[16:19], v[52:55], a[136:139], v[16:19]
    v_mfma_f32_16x16x32_bf16 v[20:23], v[52:55], a[140:143], v[20:23]
    s_waitcnt lgkmcnt(2)
    v_mfma_f32_16x16x32_bf16 v[0:3], v[56:59], a[144:147], v[0:3]
    s_barrier
    v_mfma_f32_16x16x32_bf16 v[4:7], v[56:59], a[148:151], v[4:7]
    ds_read_b64_tr_b16 v[48:49], v242 offset:0
    ds_read_b64_tr_b16 v[50:51], v242 offset:2048
    v_mfma_f32_16x16x32_bf16 v[8:11], v[56:59], a[152:155], v[8:11]
    s_add_u32 m0, s80, 32768
    s_add_u32 s81, s5, 6
    v_mfma_f32_16x16x32_bf16 v[12:15], v[56:59], a[156:159], v[12:15]
    s_and_b32 s81, s81, 7
    s_lshl_b32 s81, s81, 7
    v_mfma_f32_16x16x32_bf16 v[16:19], v[56:59], a[160:163], v[16:19]
    s_add_u32 s73, s44, s81
    v_mfma_f32_16x16x32_bf16 v[20:23], v[56:59], a[164:167], v[20:23]
    s_waitcnt lgkmcnt(2)
    v_mfma_f32_16x16x32_bf16 v[0:3], v[60:63], a[168:171], v[0:3]
    buffer_load_dwordx4 v240, s[20:23], s73 offen lds
    v_mfma_f32_16x16x32_bf16 v[4:7], v[60:63], a[172:175], v[4:7]
    ds_read_b64_tr_b16 v[52:53], v242 offset:4096
    ds_read_b64_tr_b16 v[54:55], v242 offset:6144
    v_mfma_f32_16x16x32_bf16 v[8:11], v[60:63], a[176:179], v[8:11]
    s_add_u32 m0, s80, 36864
    s_add_u32 s73, s45, s81
    v_mfma_f32_16x16x32_bf16 v[12:15], v[60:63], a[180:183], v[12:15]
    buffer_load_dwordx4 v240, s[20:23], s73 offen lds
    v_mfma_f32_16x16x32_bf16 v[16:19], v[60:63], a[184:187], v[16:19]
    v_mfma_f32_16x16x32_bf16 v[20:23], v[60:63], a[188:191], v[20:23]
    s_waitcnt lgkmcnt(2)
    v_mfma_f32_16x16x32_bf16 v[24:27], v[48:51], v[100:103], 0
    ds_read_b64_tr_b16 v[56:57], v242 offset:8192
    ds_read_b64_tr_b16 v[58:59], v242 offset:10240
    v_mfma_f32_16x16x32_bf16 v[28:31], v[48:51], v[104:107], 0
    v_mfma_f32_16x16x32_bf16 v[32:35], v[48:51], v[108:111], 0
    s_add_u32 m0, s80, 40960
    s_add_u32 s73, s46, s81
    v_mfma_f32_16x16x32_bf16 v[36:39], v[48:51], v[112:115], 0
    buffer_load_dwordx4 v240, s[20:23], s73 offen lds
    v_mfma_f32_16x16x32_bf16 v[40:43], v[48:51], v[116:119], 0
    v_cvt_pk_bf16_f32 v64, v0, v1
    v_cvt_pk_bf16_f32 v65, v2, v3
    v_mfma_f32_16x16x32_bf16 v[44:47], v[48:51], v[120:123], 0
    v_cvt_pk_bf16_f32 v66, v4, v5
    s_waitcnt lgkmcnt(2)
    v_mfma_f32_16x16x32_bf16 v[24:27], v[52:55], v[124:127], v[24:27]
    v_cvt_pk_bf16_f32 v67, v6, v7
    v_mfma_f32_16x16x32_bf16 v[28:31], v[52:55], v[128:131], v[28:31]
    buffer_store_dwordx4 v[64:67], v243, s[24:27], s38 offen sc1
    v_mfma_f32_16x16x32_bf16 v[32:35], v[52:55], v[132:135], v[32:35]
    ds_read_b64_tr_b16 v[60:61], v242 offset:12288
    ds_read_b64_tr_b16 v[62:63], v242 offset:14336
    v_cvt_pk_bf16_f32 v68, v8, v9
    v_cvt_pk_bf16_f32 v69, v10, v11
    v_mfma_f32_16x16x32_bf16 v[36:39], v[52:55], v[136:139], v[36:39]
    s_add_u32 m0, s80, 45056
    s_add_u32 s73, s47, s81
    v_cvt_pk_bf16_f32 v70, v12, v13
    v_cvt_pk_bf16_f32 v71, v14, v15
    v_mfma_f32_16x16x32_bf16 v[40:43], v[52:55], v[140:143], v[40:43]
    buffer_load_dwordx4 v240, s[20:23], s73 offen lds
    buffer_store_dwordx4 v[68:71], v243, s[24:27], s38 offen offset:1024 sc1
    v_mfma_f32_16x16x32_bf16 v[44:47], v[52:55], v[144:147], v[44:47]
    v_cvt_pk_bf16_f32 v72, v16, v17
    v_cvt_pk_bf16_f32 v73, v18, v19
    s_waitcnt lgkmcnt(2)
    v_mfma_f32_16x16x32_bf16 v[24:27], v[56:59], v[148:151], v[24:27]
    s_waitcnt vmcnt(15)
    s_barrier
    v_cvt_pk_bf16_f32 v74, v20, v21
    v_cvt_pk_bf16_f32 v75, v22, v23
    v_mfma_f32_16x16x32_bf16 v[28:31], v[56:59], v[152:155], v[28:31]
    buffer_store_dwordx4 v[72:75], v243, s[24:27], s38 offen offset:2048 sc1
    v_mfma_f32_16x16x32_bf16 v[32:35], v[56:59], v[156:159], v[32:35]
    ds_read_b64_tr_b16 v[48:49], v242 offset:16384
    ds_read_b64_tr_b16 v[50:51], v242 offset:18432
    v_mfma_f32_16x16x32_bf16 v[36:39], v[56:59], v[160:163], v[36:39]
    s_add_u32 m0, s80, 49152
    s_add_u32 s81, s81, 36864
    v_mfma_f32_16x16x32_bf16 v[40:43], v[56:59], v[164:167], v[40:43]
    s_add_u32 s73, s44, s81
    v_mfma_f32_16x16x32_bf16 v[44:47], v[56:59], v[168:171], v[44:47]
    buffer_load_dwordx4 v240, s[20:23], s73 offen lds
    s_waitcnt lgkmcnt(2)
    v_mfma_f32_16x16x32_bf16 v[24:27], v[60:63], v[172:175], v[24:27]
    v_mfma_f32_16x16x32_bf16 v[28:31], v[60:63], v[176:179], v[28:31]
    ds_read_b64_tr_b16 v[52:53], v242 offset:20480
    ds_read_b64_tr_b16 v[54:55], v242 offset:22528
    v_mfma_f32_16x16x32_bf16 v[32:35], v[60:63], v[180:183], v[32:35]
    s_add_u32 m0, s80, 53248
    s_add_u32 s73, s45, s81
    v_mfma_f32_16x16x32_bf16 v[36:39], v[60:63], v[184:187], v[36:39]
    buffer_load_dwordx4 v240, s[20:23], s73 offen lds
    v_mfma_f32_16x16x32_bf16 v[40:43], v[60:63], v[188:191], v[40:43]
    v_mfma_f32_16x16x32_bf16 v[44:47], v[60:63], v[192:195], v[44:47]
    s_waitcnt lgkmcnt(2)
    v_mfma_f32_16x16x32_bf16 v[24:27], v[48:51], v[196:199], v[24:27]
    ds_read_b64_tr_b16 v[56:57], v242 offset:24576
    ds_read_b64_tr_b16 v[58:59], v242 offset:26624
    v_mfma_f32_16x16x32_bf16 v[28:31], v[48:51], v[200:203], v[28:31]
    v_mfma_f32_16x16x32_bf16 v[32:35], v[48:51], v[204:207], v[32:35]
    s_add_u32 m0, s80, 57344
    s_add_u32 s73, s46, s81
    v_mfma_f32_16x16x32_bf16 v[36:39], v[48:51], v[208:211], v[36:39]
    buffer_load_dwordx4 v240, s[20:23], s73 offen lds
    v_mfma_f32_16x16x32_bf16 v[40:43], v[48:51], v[212:215], v[40:43]
    v_mfma_f32_16x16x32_bf16 v[44:47], v[48:51], v[216:219], v[44:47]
    s_waitcnt lgkmcnt(2)
    v_mfma_f32_16x16x32_bf16 v[24:27], v[52:55], v[220:223], v[24:27]
    ds_read_b64_tr_b16 v[60:61], v242 offset:28672
    ds_read_b64_tr_b16 v[62:63], v242 offset:30720
    v_mfma_f32_16x16x32_bf16 v[28:31], v[52:55], v[224:227], v[28:31]
    s_lshl_b32 s85, s3, 10
    v_mfma_f32_16x16x32_bf16 v[32:35], v[52:55], a[192:195], v[32:35]
    s_add_u32 m0, s80, 61440
    s_add_u32 s73, s47, s81
    v_mfma_f32_16x16x32_bf16 v[36:39], v[52:55], a[196:199], v[36:39]
    buffer_load_dword v244, v247, s[60:63], s85 offen sc1
    v_mfma_f32_16x16x32_bf16 v[40:43], v[52:55], a[200:203], v[40:43]
    buffer_load_dwordx4 v240, s[20:23], s73 offen lds
    v_mfma_f32_16x16x32_bf16 v[44:47], v[52:55], a[204:207], v[44:47]
    s_waitcnt lgkmcnt(2)
    v_mfma_f32_16x16x32_bf16 v[24:27], v[56:59], a[208:211], v[24:27]
    s_waitcnt vmcnt(17)
    s_barrier
    v_mfma_f32_16x16x32_bf16 v[28:31], v[56:59], a[212:215], v[28:31]
    ds_read_b64_tr_b16 v[48:49], v241 offset:0
    ds_read_b64_tr_b16 v[50:51], v241 offset:2048
    v_mfma_f32_16x16x32_bf16 v[32:35], v[56:59], a[216:219], v[32:35]
    s_add_u32 m0, s80, 65536
    s_add_u32 s81, s81, 36864
    v_mfma_f32_16x16x32_bf16 v[36:39], v[56:59], a[220:223], v[36:39]
    s_add_u32 s73, s44, s81
    v_mfma_f32_16x16x32_bf16 v[40:43], v[56:59], a[224:227], v[40:43]
    buffer_load_dwordx4 v240, s[20:23], s73 offen lds
    v_mfma_f32_16x16x32_bf16 v[44:47], v[56:59], a[228:231], v[44:47]
    s_waitcnt lgkmcnt(2)
    v_mfma_f32_16x16x32_bf16 v[24:27], v[60:63], a[232:235], v[24:27]
    ds_read_b64_tr_b16 v[52:53], v241 offset:4096
    ds_read_b64_tr_b16 v[54:55], v241 offset:6144
    v_mfma_f32_16x16x32_bf16 v[28:31], v[60:63], a[236:239], v[28:31]
    v_mfma_f32_16x16x32_bf16 v[32:35], v[60:63], a[240:243], v[32:35]
    s_add_u32 m0, s80, 69632
    s_add_u32 s73, s45, s81
    v_mfma_f32_16x16x32_bf16 v[36:39], v[60:63], a[244:247], v[36:39]
    buffer_load_dwordx4 v240, s[20:23], s73 offen lds
    v_mfma_f32_16x16x32_bf16 v[40:43], v[60:63], a[248:251], v[40:43]
    v_mfma_f32_16x16x32_bf16 v[44:47], v[60:63], a[252:255], v[44:47]
    s_waitcnt lgkmcnt(2)
    v_mfma_f32_16x16x32_bf16 v[24:27], v[48:51], a[0:3], v[24:27]
    ds_read_b64_tr_b16 v[56:57], v241 offset:8192
    ds_read_b64_tr_b16 v[58:59], v241 offset:10240
    v_mfma_f32_16x16x32_bf16 v[28:31], v[48:51], a[4:7], v[28:31]
    v_mfma_f32_16x16x32_bf16 v[32:35], v[48:51], a[8:11], v[32:35]
    s_add_u32 m0, s80, 73728
    s_add_u32 s73, s46, s81
    v_mfma_f32_16x16x32_bf16 v[36:39], v[48:51], a[12:15], v[36:39]
    buffer_load_dwordx4 v240, s[20:23], s73 offen lds
    v_mfma_f32_16x16x32_bf16 v[40:43], v[48:51], a[16:19], v[40:43]
    v_mfma_f32_16x16x32_bf16 v[44:47], v[48:51], a[20:23], v[44:47]
    s_waitcnt lgkmcnt(2)
    v_mfma_f32_16x16x32_bf16 v[24:27], v[52:55], a[24:27], v[24:27]
    ds_read_b64_tr_b16 v[60:61], v241 offset:12288
    ds_read_b64_tr_b16 v[62:63], v241 offset:14336
    v_mfma_f32_16x16x32_bf16 v[28:31], v[52:55], a[28:31], v[28:31]
    v_mfma_f32_16x16x32_bf16 v[32:35], v[52:55], a[32:35], v[32:35]
    s_add_u32 m0, s80, 77824
    s_add_u32 s73, s47, s81
    v_mfma_f32_16x16x32_bf16 v[36:39], v[52:55], a[36:39], v[36:39]
    buffer_load_dwordx4 v240, s[20:23], s73 offen lds
    v_mfma_f32_16x16x32_bf16 v[40:43], v[52:55], a[40:43], v[40:43]
    v_mfma_f32_16x16x32_bf16 v[44:47], v[52:55], a[44:47], v[44:47]
    s_waitcnt lgkmcnt(2)
    v_mfma_f32_16x16x32_bf16 v[24:27], v[56:59], a[48:51], v[24:27]
    s_waitcnt vmcnt(16)
    s_barrier
    v_mfma_f32_16x16x32_bf16 v[28:31], v[56:59], a[52:55], v[28:31]
    ds_read_b64_tr_b16 v[48:49], v241 offset:16384
    ds_read_b64_tr_b16 v[50:51], v241 offset:18432
    v_mfma_f32_16x16x32_bf16 v[32:35], v[56:59], a[56:59], v[32:35]
    s_add_u32 m0, s80, 81920
    s_add_u32 s81, s81, 36864
    v_mfma_f32_16x16x32_bf16 v[36:39], v[56:59], a[60:63], v[36:39]
    s_add_u32 s73, s44, s81
    v_mfma_f32_16x16x32_bf16 v[40:43], v[56:59], a[64:67], v[40:43]
    buffer_load_dwordx4 v240, s[20:23], s73 offen lds
    v_mfma_f32_16x16x32_bf16 v[44:47], v[56:59], a[68:71], v[44:47]
    s_waitcnt lgkmcnt(2)
    v_mfma_f32_16x16x32_bf16 v[24:27], v[60:63], a[72:75], v[24:27]
    ds_read_b64_tr_b16 v[52:53], v241 offset:20480
    ds_read_b64_tr_b16 v[54:55], v241 offset:22528
    v_mfma_f32_16x16x32_bf16 v[28:31], v[60:63], a[76:79], v[28:31]
    v_mfma_f32_16x16x32_bf16 v[32:35], v[60:63], a[80:83], v[32:35]
    s_add_u32 m0, s80, 86016
    s_add_u32 s73, s45, s81
    v_mfma_f32_16x16x32_bf16 v[36:39], v[60:63], a[84:87], v[36:39]
    buffer_load_dwordx4 v240, s[20:23], s73 offen lds
    v_mfma_f32_16x16x32_bf16 v[40:43], v[60:63], a[88:91], v[40:43]
    s_waitcnt vmcnt(11)
    buffer_store_dword v242, v246, s[60:63], s90 offen offset:512 sc1
    v_mfma_f32_16x16x32_bf16 v[44:47], v[60:63], a[92:95], v[44:47]
    s_waitcnt lgkmcnt(2)
    v_mfma_f32_16x16x32_bf16 v[24:27], v[48:51], a[96:99], v[24:27]
    s_waitcnt vmcnt(8)
    v_cmp_eq_u32 vcc, 0, v244
    s_nop 1
    s_and_b32 s87, vcc_lo, 0x700
    s_cmp_eq_u32 s87, 0
    s_cbranch_scc0 L_spin1
L_spun1:
    v_mfma_f32_16x16x32_bf16 v[28:31], v[48:51], a[100:103], v[28:31]
    buffer_load_dwordx4 v[228:231], v243, s[24:27], s95 offen sc1
    v_mfma_f32_16x16x32_bf16 v[32:35], v[48:51], a[104:107], v[32:35]
    ds_read_b64_tr_b16 v[56:57], v241 offset:24576
    ds_read_b64_tr_b16 v[58:59], v241 offset:26624
    v_mfma_f32_16x16x32_bf16 v[36:39], v[48:51], a[108:111], v[36:39]
    s_add_u32 m0, s80, 90112
    s_add_u32 s73, s46, s81
    buffer_load_dwordx4 v[232:235], v243, s[24:27], s95 offen offset:1024 sc1
    v_mfma_f32_16x16x32_bf16 v[40:43], v[48:51], a[112:115], v[40:43]
    buffer_load_dwordx4 v240, s[20:23], s73 offen lds
    v_mfma_f32_16x16x32_bf16 v[44:47], v[48:51], a[116:119], v[44:47]
    buffer_load_dwordx4 v[236:239], v243, s[24:27], s95 offen offset:2048 sc1
    s_waitcnt lgkmcnt(2)
    v_mfma_f32_16x16x32_bf16 v[24:27], v[52:55], a[120:123], v[24:27]
    v_mfma_f32_16x16x32_bf16 v[28:31], v[52:55], a[124:127], v[28:31]
    ds_read_b64_tr_b16 v[60:61], v241 offset:28672
    ds_read_b64_tr_b16 v[62:63], v241 offset:30720
    v_mfma_f32_16x16x32_bf16 v[32:35], v[52:55], a[128:131], v[32:35]
    s_add_u32 m0, s80, 94208
    s_add_u32 s73, s47, s81
    v_mfma_f32_16x16x32_bf16 v[36:39], v[52:55], a[132:135], v[36:39]
    buffer_load_dwordx4 v240, s[20:23], s73 offen lds
    v_mfma_f32_16x16x32_bf16 v[40:43], v[52:55], a[136:139], v[40:43]
    v_mfma_f32_16x16x32_bf16 v[44:47], v[52:55], a[140:143], v[44:47]
    s_waitcnt lgkmcnt(2)
    v_mfma_f32_16x16x32_bf16 v[24:27], v[56:59], a[144:147], v[24:27]
    s_barrier
    v_mfma_f32_16x16x32_bf16 v[28:31], v[56:59], a[148:151], v[28:31]
    ds_read_b64_tr_b16 v[48:49], v241 offset:32768
    ds_read_b64_tr_b16 v[50:51], v241 offset:34816
    v_mfma_f32_16x16x32_bf16 v[32:35], v[56:59], a[152:155], v[32:35]
    s_add_u32 m0, s80, 0
    s_add_u32 s81, s5, 7
    v_mfma_f32_16x16x32_bf16 v[36:39], v[56:59], a[156:159], v[36:39]
    s_and_b32 s81, s81, 7
    s_lshl_b32 s81, s81, 7
    v_mfma_f32_16x16x32_bf16 v[40:43], v[56:59], a[160:163], v[40:43]
    s_add_u32 s73, s44, s81
    v_mfma_f32_16x16x32_bf16 v[44:47], v[56:59], a[164:167], v[44:47]
    s_waitcnt lgkmcnt(2)
    v_mfma_f32_16x16x32_bf16 v[24:27], v[60:63], a[168:171], v[24:27]
    buffer_load_dwordx4 v240, s[20:23], s73 offen lds
    v_mfma_f32_16x16x32_bf16 v[28:31], v[60:63], a[172:175], v[28:31]
    ds_read_b64_tr_b16 v[52:53], v241 offset:36864
    ds_read_b64_tr_b16 v[54:55], v241 offset:38912
    v_mfma_f32_16x16x32_bf16 v[32:35], v[60:63], a[176:179], v[32:35]
    s_add_u32 m0, s80, 4096
    s_add_u32 s73, s45, s81
    v_mfma_f32_16x16x32_bf16 v[36:39], v[60:63], a[180:183], v[36:39]
    buffer_load_dwordx4 v240, s[20:23], s73 offen lds
    v_mfma_f32_16x16x32_bf16 v[40:43], v[60:63], a[184:187], v[40:43]
    v_mfma_f32_16x16x32_bf16 v[44:47], v[60:63], a[188:191], v[44:47]
    s_waitcnt lgkmcnt(2)
    v_mfma_f32_16x16x32_bf16 v[0:3], v[48:51], v[100:103], 0
    ds_read_b64_tr_b16 v[56:57], v241 offset:40960
    ds_read_b64_tr_b16 v[58:59], v241 offset:43008
    v_mfma_f32_16x16x32_bf16 v[4:7], v[48:51], v[104:107], 0
    v_mfma_f32_16x16x32_bf16 v[8:11], v[48:51], v[108:111], 0
    s_add_u32 m0, s80, 8192
    s_add_u32 s73, s46, s81
    v_mfma_f32_16x16x32_bf16 v[12:15], v[48:51], v[112:115], 0
    buffer_load_dwordx4 v240, s[20:23], s73 offen lds
    v_mfma_f32_16x16x32_bf16 v[16:19], v[48:51], v[116:119], 0
    v_cvt_pk_bf16_f32 v64, v24, v25
    v_cvt_pk_bf16_f32 v65, v26, v27
    v_mfma_f32_16x16x32_bf16 v[20:23], v[48:51], v[120:123], 0
    v_cvt_pk_bf16_f32 v66, v28, v29
    s_waitcnt lgkmcnt(2)
    v_mfma_f32_16x16x32_bf16 v[0:3], v[52:55], v[124:127], v[0:3]
    v_cvt_pk_bf16_f32 v67, v30, v31
    v_mfma_f32_16x16x32_bf16 v[4:7], v[52:55], v[128:131], v[4:7]
    buffer_store_dwordx4 v[64:67], v243, s[24:27], s39 offen sc1
    v_mfma_f32_16x16x32_bf16 v[8:11], v[52:55], v[132:135], v[8:11]
    ds_read_b64_tr_b16 v[60:61], v241 offset:45056
    ds_read_b64_tr_b16 v[62:63], v241 offset:47104
    v_cvt_pk_bf16_f32 v68, v32, v33
    v_cvt_pk_bf16_f32 v69, v34, v35
    v_mfma_f32_16x16x32_bf16 v[12:15], v[52:55], v[136:139], v[12:15]
    s_add_u32 m0, s80, 12288
    s_add_u32 s73, s47, s81
    v_cvt_pk_bf16_f32 v70, v36, v37
    v_cvt_pk_bf16_f32 v71, v38, v39
    v_mfma_f32_16x16x32_bf16 v[16:19], v[52:55], v[140:143], v[16:19]
    buffer_load_dwordx4 v240, s[20:23], s73 offen lds
    buffer_store_dwordx4 v[68:71], v243, s[24:27], s39 offen offset:1024 sc1
    v_mfma_f32_16x16x32_bf16 v[20:23], v[52:55], v[144:147], v[20:23]
    v_cvt_pk_bf16_f32 v72, v40, v41
    v_cvt_pk_bf16_f32 v73, v42, v43
    s_waitcnt lgkmcnt(2)
    v_mfma_f32_16x16x32_bf16 v[0:3], v[56:59], v[148:151], v[0:3]
    s_waitcnt vmcnt(18)
    s_barrier
    v_cvt_pk_bf16_f32 v74, v44, v45
    v_cvt_pk_bf16_f32 v75, v46, v47
    v_mfma_f32_16x16x32_bf16 v[4:7], v[56:59], v[152:155], v[4:7]
    buffer_store_dwordx4 v[72:75], v243, s[24:27], s39 offen offset:2048 sc1
    v_mfma_f32_16x16x32_bf16 v[8:11], v[56:59], v[156:159], v[8:11]
    ds_read_b64_tr_b16 v[48:49], v241 offset:49152
    ds_read_b64_tr_b16 v[50:51], v241 offset:51200
    v_mfma_f32_16x16x32_bf16 v[12:15], v[56:59], v[160:163], v[12:15]
    s_add_u32 m0, s80, 16384
    s_add_u32 s81, s81, 36864
    v_mfma_f32_16x16x32_bf16 v[16:19], v[56:59], v[164:167], v[16:19]
    s_add_u32 s73, s44, s81
    v_mfma_f32_16x16x32_bf16 v[20:23], v[56:59], v[168:171], v[20:23]
    buffer_load_dwordx4 v240, s[20:23], s73 offen lds
    s_waitcnt lgkmcnt(2)
    v_mfma_f32_16x16x32_bf16 v[0:3], v[60:63], v[172:175], v[0:3]
    v_mfma_f32_16x16x32_bf16 v[4:7], v[60:63], v[176:179], v[4:7]
    ds_read_b64_tr_b16 v[52:53], v241 offset:53248
    ds_read_b64_tr_b16 v[54:55], v241 offset:55296
    v_mfma_f32_16x16x32_bf16 v[8:11], v[60:63], v[180:183], v[8:11]
    s_add_u32 m0, s80, 20480
    s_add_u32 s73, s45, s81
    v_mfma_f32_16x16x32_bf16 v[12:15], v[60:63], v[184:187], v[12:15]
    buffer_load_dwordx4 v240, s[20:23], s73 offen lds
    v_mfma_f32_16x16x32_bf16 v[16:19], v[60:63], v[188:191], v[16:19]
    v_mfma_f32_16x16x32_bf16 v[20:23], v[60:63], v[192:195], v[20:23]
    s_waitcnt lgkmcnt(2)
    v_mfma_f32_16x16x32_bf16 v[0:3], v[48:51], v[196:199], v[0:3]
    ds_read_b64_tr_b16 v[56:57], v241 offset:57344
    ds_read_b64_tr_b16 v[58:59], v241 offset:59392
    v_mfma_f32_16x16x32_bf16 v[4:7], v[48:51], v[200:203], v[4:7]
    v_mfma_f32_16x16x32_bf16 v[8:11], v[48:51], v[204:207], v[8:11]
    s_add_u32 m0, s80, 24576
    s_add_u32 s73, s46, s81
    v_mfma_f32_16x16x32_bf16 v[12:15], v[48:51], v[208:211], v[12:15]
    buffer_load_dwordx4 v240, s[20:23], s73 offen lds
    v_mfma_f32_16x16x32_bf16 v[16:19], v[48:51], v[212:215], v[16:19]
    v_mfma_f32_16x16x32_bf16 v[20:23], v[48:51], v[216:219], v[20:23]
    s_waitcnt vmcnt(11)
    v_mfma_f32_16x16x32_bf16 v[76:79], v[250:253], v[228:231], 0
    v_mfma_f32_16x16x32_bf16 v[80:83], v[248:251], v[228:231], 0
    v_mfma_f32_16x16x32_bf16 v[84:87], v[250:253], v[232:235], 0
    s_add_u32 m0, s80, 28672
    s_add_u32 s73, s47, s81
    v_mfma_f32_16x16x32_bf16 v[88:91], v[248:251], v[232:235], 0
    buffer_load_dwordx4 v240, s[20:23], s73 offen lds
    v_mfma_f32_16x16x32_bf16 v[92:95], v[250:253], v[236:239], 0
    v_mfma_f32_16x16x32_bf16 v[96:99], v[248:251], v[236:239], 0
    s_waitcnt lgkmcnt(2)
    v_mfma_f32_16x16x32_bf16 v[0:3], v[52:55], v[220:223], v[0:3]
    ds_read_b64_tr_b16 v[60:61], v241 offset:61440
    ds_read_b64_tr_b16 v[62:63], v241 offset:63488
    v_mfma_f32_16x16x32_bf16 v[4:7], v[52:55], v[224:227], v[4:7]
    buffer_load_dwordx4 v[228:231], v243, s[24:27], s96 offen sc1
    v_mfma_f32_16x16x32_bf16 v[8:11], v[52:55], a[192:195], v[8:11]
    buffer_load_dwordx4 v[232:235], v243, s[24:27], s96 offen offset:1024 sc1
    v_mfma_f32_16x16x32_bf16 v[12:15], v[52:55], a[196:199], v[12:15]
    v_mfma_f32_16x16x32_bf16 v[16:19], v[52:55], a[200:203], v[16:19]
    buffer_load_dwordx4 v[236:239], v243, s[24:27], s96 offen offset:2048 sc1
    v_mfma_f32_16x16x32_bf16 v[20:23], v[52:55], a[204:207], v[20:23]
    s_waitcnt lgkmcnt(2)
    v_mfma_f32_16x16x32_bf16 v[0:3], v[56:59], a[208:211], v[0:3]
    s_barrier
    v_mfma_f32_16x16x32_bf16 v[4:7], v[56:59], a[212:215], v[4:7]
    ds_read_b64_tr_b16 v[48:49], v242 offset:0
    ds_read_b64_tr_b16 v[50:51], v242 offset:2048
    v_mfma_f32_16x16x32_bf16 v[8:11], v[56:59], a[216:219], v[8:11]
    s_add_u32 m0, s80, 32768
    s_add_u32 s81, s81, 36864
    v_mfma_f32_16x16x32_bf16 v[12:15], v[56:59], a[220:223], v[12:15]
    s_add_u32 s73, s44, s81
    v_mfma_f32_16x16x32_bf16 v[16:19], v[56:59], a[224:227], v[16:19]
    buffer_load_dwordx4 v240, s[20:23], s73 offen lds
    v_mfma_f32_16x16x32_bf16 v[20:23], v[56:59], a[228:231], v[20:23]
    s_waitcnt lgkmcnt(2)
    v_mfma_f32_16x16x32_bf16 v[0:3], v[60:63], a[232:235], v[0:3]
    ds_read_b64_tr_b16 v[52:53], v242 offset:4096
    ds_read_b64_tr_b16 v[54:55], v242 offset:6144
    v_mfma_f32_16x16x32_bf16 v[4:7], v[60:63], a[236:239], v[4:7]
    v_mfma_f32_16x16x32_bf16 v[8:11], v[60:63], a[240:243], v[8:11]
    s_add_u32 m0, s80, 36864
    s_add_u32 s73, s45, s81
    v_mfma_f32_16x16x32_bf16 v[12:15], v[60:63], a[244:247], v[12:15]
    buffer_load_dwordx4 v240, s[20:23], s73 offen lds
    v_mfma_f32_16x16x32_bf16 v[16:19], v[60:63], a[248:251], v[16:19]
    v_mfma_f32_16x16x32_bf16 v[20:23], v[60:63], a[252:255], v[20:23]
    s_waitcnt lgkmcnt(2)
    v_mfma_f32_16x16x32_bf16 v[0:3], v[48:51], a[0:3], v[0:3]
    ds_read_b64_tr_b16 v[56:57], v242 offset:8192
    ds_read_b64_tr_b16 v[58:59], v242 offset:10240
    v_mfma_f32_16x16x32_bf16 v[4:7], v[48:51], a[4:7], v[4:7]
    v_mfma_f32_16x16x32_bf16 v[8:11], v[48:51], a[8:11], v[8:11]
    s_add_u32 m0, s80, 40960
    s_add_u32 s73, s46, s81
    v_mfma_f32_16x16x32_bf16 v[12:15], v[48:51], a[12:15], v[12:15]
    buffer_load_dwordx4 v240, s[20:23], s73 offen lds
    v_mfma_f32_16x16x32_bf16 v[16:19], v[48:51], a[16:19], v[16:19]
    v_mfma_f32_16x16x32_bf16 v[20:23], v[48:51], a[20:23], v[20:23]
    s_waitcnt lgkmcnt(2)
    v_mfma_f32_16x16x32_bf16 v[0:3], v[52:55], a[24:27], v[0:3]
    s_waitcnt vmcnt(10)
    buffer_store_dword v242, v246, s[60:63], s90 offen offset:640 sc1
    v_mfma_f32_16x16x32_bf16 v[4:7], v[52:55], a[28:31], v[4:7]
    ds_read_b64_tr_b16 v[60:61], v242 offset:12288
    ds_read_b64_tr_b16 v[62:63], v242 offset:14336
    v_mfma_f32_16x16x32_bf16 v[8:11], v[52:55], a[32:35], v[8:11]
    s_add_u32 m0, s80, 45056
    s_add_u32 s73, s47, s81
    v_mfma_f32_16x16x32_bf16 v[12:15], v[52:55], a[36:39], v[12:15]
    buffer_load_dwordx4 v240, s[20:23], s73 offen lds
    v_mfma_f32_16x16x32_bf16 v[16:19], v[52:55], a[40:43], v[16:19]
    v_mfma_f32_16x16x32_bf16 v[20:23], v[52:55], a[44:47], v[20:23]
    s_waitcnt lgkmcnt(2)
    v_mfma_f32_16x16x32_bf16 v[0:3], v[56:59], a[48:51], v[0:3]
    s_barrier
    v_mfma_f32_16x16x32_bf16 v[4:7], v[56:59], a[52:55], v[4:7]
    ds_read_b64_tr_b16 v[48:49], v242 offset:16384
    ds_read_b64_tr_b16 v[50:51], v242 offset:18432
    v_mfma_f32_16x16x32_bf16 v[8:11], v[56:59], a[56:59], v[8:11]
    s_add_u32 m0, s80, 49152
    s_add_u32 s81, s81, 36864
    v_mfma_f32_16x16x32_bf16 v[12:15], v[56:59], a[60:63], v[12:15]
    s_add_u32 s73, s44, s81
    v_mfma_f32_16x16x32_bf16 v[16:19], v[56:59], a[64:67], v[16:19]
    buffer_load_dwordx4 v240, s[20:23], s73 offen lds
    v_mfma_f32_16x16x32_bf16 v[20:23], v[56:59], a[68:71], v[20:23]
    s_waitcnt lgkmcnt(2)
    v_mfma_f32_16x16x32_bf16 v[0:3], v[60:63], a[72:75], v[0:3]
    ds_read_b64_tr_b16 v[52:53], v242 offset:20480
    ds_read_b64_tr_b16 v[54:55], v242 offset:22528
    v_mfma_f32_16x16x32_bf16 v[4:7], v[60:63], a[76:79], v[4:7]
    v_mfma_f32_16x16x32_bf16 v[8:11], v[60:63], a[80:83], v[8:11]
    s_add_u32 m0, s80, 53248
    s_add_u32 s73, s45, s81
    v_mfma_f32_16x16x32_bf16 v[12:15], v[60:63], a[84:87], v[12:15]
    buffer_load_dwordx4 v240, s[20:23], s73 offen lds
    v_mfma_f32_16x16x32_bf16 v[16:19], v[60:63], a[88:91], v[16:19]
    v_mfma_f32_16x16x32_bf16 v[20:23], v[60:63], a[92:95], v[20:23]
    s_waitcnt lgkmcnt(2)
    v_mfma_f32_16x16x32_bf16 v[0:3], v[48:51], a[96:99], v[0:3]
    ds_read_b64_tr_b16 v[56:57], v242 offset:24576
    ds_read_b64_tr_b16 v[58:59], v242 offset:26624
    v_mfma_f32_16x16x32_bf16 v[4:7], v[48:51], a[100:103], v[4:7]
    v_mfma_f32_16x16x32_bf16 v[8:11], v[48:51], a[104:107], v[8:11]
    s_add_u32 m0, s80, 57344
    s_add_u32 s73, s46, s81
    v_mfma_f32_16x16x32_bf16 v[12:15], v[48:51], a[108:111], v[12:15]
    buffer_load_dwordx4 v240, s[20:23], s73 offen lds
    v_mfma_f32_16x16x32_bf16 v[16:19], v[48:51], a[112:115], v[16:19]
    v_mfma_f32_16x16x32_bf16 v[20:23], v[48:51], a[116:119], v[20:23]
    s_waitcnt lgkmcnt(2)
    v_mfma_f32_16x16x32_bf16 v[0:3], v[52:55], a[120:123], v[0:3]
    ds_read_b64_tr_b16 v[60:61], v242 offset:28672
    ds_read_b64_tr_b16 v[62:63], v242 offset:30720
    v_mfma_f32_16x16x32_bf16 v[4:7], v[52:55], a[124:127], v[4:7]
    v_mfma_f32_16x16x32_bf16 v[8:11], v[52:55], a[128:131], v[8:11]
    s_add_u32 m0, s80, 61440
    s_add_u32 s73, s47, s81
    v_mfma_f32_16x16x32_bf16 v[12:15], v[52:55], a[132:135], v[12:15]
    buffer_load_dwordx4 v240, s[20:23], s73 offen lds
    v_mfma_f32_16x16x32_bf16 v[16:19], v[52:55], a[136:139], v[16:19]
    v_mfma_f32_16x16x32_bf16 v[20:23], v[52:55], a[140:143], v[20:23]
    s_waitcnt lgkmcnt(2)
    v_mfma_f32_16x16x32_bf16 v[0:3], v[56:59], a[144:147], v[0:3]
    s_barrier
    v_mfma_f32_16x16x32_bf16 v[4:7], v[56:59], a[148:151], v[4:7]
    ds_read_b64_tr_b16 v[48:49], v241 offset:0
    ds_read_b64_tr_b16 v[50:51], v241 offset:2048
    v_mfma_f32_16x16x32_bf16 v[8:11], v[56:59], a[152:155], v[8:11]
    s_add_u32 m0, s80, 65536
    s_add_u32 s81, s5, 8
    v_mfma_f32_16x16x32_bf16 v[12:15], v[56:59], a[156:159], v[12:15]
    s_and_b32 s81, s81, 7
    s_lshl_b32 s81, s81, 7
    v_mfma_f32_16x16x32_bf16 v[16:19], v[56:59], a[160:163], v[16:19]
    s_add_u32 s73, s44, s81
    v_mfma_f32_16x16x32_bf16 v[20:23], v[56:59], a[164:167], v[20:23]
    s_waitcnt vmcnt(9)
    v_mfma_f32_16x16x32_bf16 v[76:79], v[250:253], v[228:231], v[76:79]
    buffer_load_dwordx4 v240, s[20:23], s73 offen lds
    v_mfma_f32_16x16x32_bf16 v[80:83], v[248:251], v[228:231], v[80:83]
    v_mfma_f32_16x16x32_bf16 v[84:87], v[250:253], v[232:235], v[84:87]
    s_add_u32 m0, s80, 69632
    s_add_u32 s73, s45, s81
    v_mfma_f32_16x16x32_bf16 v[88:91], v[248:251], v[232:235], v[88:91]
    buffer_load_dwordx4 v240, s[20:23], s73 offen lds
    v_mfma_f32_16x16x32_bf16 v[92:95], v[250:253], v[236:239], v[92:95]
    v_mfma_f32_16x16x32_bf16 v[96:99], v[248:251], v[236:239], v[96:99]
    s_waitcnt lgkmcnt(2)
    v_mfma_f32_16x16x32_bf16 v[0:3], v[60:63], a[168:171], v[0:3]
    ds_read_b64_tr_b16 v[52:53], v241 offset:4096
    ds_read_b64_tr_b16 v[54:55], v241 offset:6144
    v_mfma_f32_16x16x32_bf16 v[4:7], v[60:63], a[172:175], v[4:7]
    buffer_load_dwordx4 v[228:231], v243, s[24:27], s97 offen sc1
    v_mfma_f32_16x16x32_bf16 v[8:11], v[60:63], a[176:179], v[8:11]
    s_add_u32 m0, s80, 73728
    s_add_u32 s73, s46, s81
    v_mfma_f32_16x16x32_bf16 v[12:15], v[60:63], a[180:183], v[12:15]
    buffer_load_dwordx4 v240, s[20:23], s73 offen lds
    v_mfma_f32_16x16x32_bf16 v[16:19], v[60:63], a[184:187], v[16:19]
    buffer_load_dwordx4 v[232:235], v243, s[24:27], s97 offen offset:1024 sc1
    v_mfma_f32_16x16x32_bf16 v[20:23], v[60:63], a[188:191], v[20:23]
    s_waitcnt lgkmcnt(2)
    v_mfma_f32_16x16x32_bf16 v[24:27], v[48:51], v[100:103], 0
    buffer_load_dwordx4 v[236:239], v243, s[24:27], s97 offen offset:2048 sc1
    v_mfma_f32_16x16x32_bf16 v[28:31], v[48:51], v[104:107], 0
    ds_read_b64_tr_b16 v[56:57], v241 offset:8192
    ds_read_b64_tr_b16 v[58:59], v241 offset:10240
    v_mfma_f32_16x16x32_bf16 v[32:35], v[48:51], v[108:111], 0
    s_add_u32 m0, s80, 77824
    s_add_u32 s73, s47, s81
    v_mfma_f32_16x16x32_bf16 v[36:39], v[48:51], v[112:115], 0
    buffer_load_dwordx4 v240, s[20:23], s73 offen lds
    v_mfma_f32_16x16x32_bf16 v[40:43], v[48:51], v[116:119], 0
    v_cvt_pk_bf16_f32 v64, v0, v1
    v_cvt_pk_bf16_f32 v65, v2, v3
    v_mfma_f32_16x16x32_bf16 v[44:47], v[48:51], v[120:123], 0
    v_cvt_pk_bf16_f32 v66, v4, v5
    s_waitcnt lgkmcnt(2)
    v_mfma_f32_16x16x32_bf16 v[24:27], v[52:55], v[124:127], v[24:27]
    v_cvt_pk_bf16_f32 v67, v6, v7
    v_mfma_f32_16x16x32_bf16 v[28:31], v[52:55], v[128:131], v[28:31]
    buffer_store_dwordx4 v[64:67], v243, s[24:27], s92 offen sc1
    v_mfma_f32_16x16x32_bf16 v[32:35], v[52:55], v[132:135], v[32:35]
    ds_read_b64_tr_b16 v[60:61], v241 offset:12288
    ds_read_b64_tr_b16 v[62:63], v241 offset:14336
    v_cvt_pk_bf16_f32 v68, v8, v9
    v_cvt_pk_bf16_f32 v69, v10, v11
    v_mfma_f32_16x16x32_bf16 v[36:39], v[52:55], v[136:139], v[36:39]
    v_cvt_pk_bf16_f32 v70, v12, v13
    v_cvt_pk_bf16_f32 v71, v14, v15
    v_mfma_f32_16x16x32_bf16 v[40:43], v[52:55], v[140:143], v[40:43]
    buffer_store_dwordx4 v[68:71], v243, s[24:27], s92 offen offset:1024 sc1
    v_mfma_f32_16x16x32_bf16 v[44:47], v[52:55], v[144:147], v[44:47]
    v_cvt_pk_bf16_f32 v72, v16, v17
    v_cvt_pk_bf16_f32 v73, v18, v19
    s_waitcnt lgkmcnt(2)
    v_mfma_f32_16x16x32_bf16 v[24:27], v[56:59], v[148:151], v[24:27]
    s_barrier
    v_cvt_pk_bf16_f32 v74, v20, v21
    v_cvt_pk_bf16_f32 v75, v22, v23
    v_mfma_f32_16x16x32_bf16 v[28:31], v[56:59], v[152:155], v[28:31]
    buffer_store_dwordx4 v[72:75], v243, s[24:27], s92 offen offset:2048 sc1
    v_mfma_f32_16x16x32_bf16 v[32:35], v[56:59], v[156:159], v[32:35]
    ds_read_b64_tr_b16 v[48:49], v241 offset:16384
    ds_read_b64_tr_b16 v[50:51], v241 offset:18432
    v_mfma_f32_16x16x32_bf16 v[36:39], v[56:59], v[160:163], v[36:39]
    s_add_u32 m0, s80, 81920
    s_add_u32 s81, s81, 36864
    v_mfma_f32_16x16x32_bf16 v[40:43], v[56:59], v[164:167], v[40:43]
    s_add_u32 s73, s44, s81
    v_mfma_f32_16x16x32_bf16 v[44:47], v[56:59], v[168:171], v[44:47]
    buffer_load_dwordx4 v240, s[20:23], s73 offen lds
    s_waitcnt lgkmcnt(2)
    v_mfma_f32_16x16x32_bf16 v[24:27], v[60:63], v[172:175], v[24:27]
    ds_read_b64_tr_b16 v[52:53], v241 offset:20480
    ds_read_b64_tr_b16 v[54:55], v241 offset:22528
    v_mfma_f32_16x16x32_bf16 v[28:31], v[60:63], v[176:179], v[28:31]
    v_mfma_f32_16x16x32_bf16 v[32:35], v[60:63], v[180:183], v[32:35]
    s_add_u32 m0, s80, 86016
    s_add_u32 s73, s45, s81
    v_mfma_f32_16x16x32_bf16 v[36:39], v[60:63], v[184:187], v[36:39]
    buffer_load_dwordx4 v240, s[20:23], s73 offen lds
    v_mfma_f32_16x16x32_bf16 v[40:43], v[60:63], v[188:191], v[40:43]
    v_mfma_f32_16x16x32_bf16 v[44:47], v[60:63], v[192:195], v[44:47]
    s_waitcnt lgkmcnt(2)
    v_mfma_f32_16x16x32_bf16 v[24:27], v[48:51], v[196:199], v[24:27]
    ds_read_b64_tr_b16 v[56:57], v241 offset:24576
    ds_read_b64_tr_b16 v[58:59], v241 offset:26624
    v_mfma_f32_16x16x32_bf16 v[28:31], v[48:51], v[200:203], v[28:31]
    v_mfma_f32_16x16x32_bf16 v[32:35], v[48:51], v[204:207], v[32:35]
    s_add_u32 m0, s80, 90112
    s_add_u32 s73, s46, s81
    v_mfma_f32_16x16x32_bf16 v[36:39], v[48:51], v[208:211], v[36:39]
    buffer_load_dwordx4 v240, s[20:23], s73 offen lds
    v_mfma_f32_16x16x32_bf16 v[40:43], v[48:51], v[212:215], v[40:43]
    v_mfma_f32_16x16x32_bf16 v[44:47], v[48:51], v[216:219], v[44:47]
    s_waitcnt lgkmcnt(2)
    v_mfma_f32_16x16x32_bf16 v[24:27], v[52:55], v[220:223], v[24:27]
    ds_read_b64_tr_b16 v[60:61], v241 offset:28672
    ds_read_b64_tr_b16 v[62:63], v241 offset:30720
    v_mfma_f32_16x16x32_bf16 v[28:31], v[52:55], v[224:227], v[28:31]
    buffer_load_dword v244, v247, s[60:63], s85 offen sc1
    v_mfma_f32_16x16x32_bf16 v[32:35], v[52:55], a[192:195], v[32:35]
    s_add_u32 m0, s80, 94208
    s_add_u32 s73, s47, s81
    v_mfma_f32_16x16x32_bf16 v[36:39], v[52:55], a[196:199], v[36:39]
    buffer_load_dwordx4 v240, s[20:23], s73 offen lds
    v_mfma_f32_16x16x32_bf16 v[40:43], v[52:55], a[200:203], v[40:43]
    v_mfma_f32_16x16x32_bf16 v[44:47], v[52:55], a[204:207], v[44:47]
    s_waitcnt lgkmcnt(2)
    v_mfma_f32_16x16x32_bf16 v[24:27], v[56:59], a[208:211], v[24:27]
    s_waitcnt vmcnt(19)
    s_barrier
    v_mfma_f32_16x16x32_bf16 v[28:31], v[56:59], a[212:215], v[28:31]
    ds_read_b64_tr_b16 v[48:49], v241 offset:32768
    ds_read_b64_tr_b16 v[50:51], v241 offset:34816
    v_mfma_f32_16x16x32_bf16 v[32:35], v[56:59], a[216:219], v[32:35]
    s_add_u32 m0, s80, 0
    s_add_u32 s81, s81, 36864
    v_mfma_f32_16x16x32_bf16 v[36:39], v[56:59], a[220:223], v[36:39]
    s_add_u32 s73, s44, s81
    v_mfma_f32_16x16x32_bf16 v[40:43], v[56:59], a[224:227], v[40:43]
    buffer_load_dwordx4 v240, s[20:23], s73 offen lds
    v_mfma_f32_16x16x32_bf16 v[44:47], v[56:59], a[228:231], v[44:47]
    s_waitcnt lgkmcnt(2)
    v_mfma_f32_16x16x32_bf16 v[24:27], v[60:63], a[232:235], v[24:27]
    ds_read_b64_tr_b16 v[52:53], v241 offset:36864
    ds_read_b64_tr_b16 v[54:55], v241 offset:38912
    v_mfma_f32_16x16x32_bf16 v[28:31], v[60:63], a[236:239], v[28:31]
    v_mfma_f32_16x16x32_bf16 v[32:35], v[60:63], a[240:243], v[32:35]
    s_add_u32 m0, s80, 4096
    s_add_u32 s73, s45, s81
    v_mfma_f32_16x16x32_bf16 v[36:39], v[60:63], a[244:247], v[36:39]
    buffer_load_dwordx4 v240, s[20:23], s73 offen lds
    v_mfma_f32_16x16x32_bf16 v[40:43], v[60:63], a[248:251], v[40:43]
    v_mfma_f32_16x16x32_bf16 v[44:47], v[60:63], a[252:255], v[44:47]
    s_waitcnt lgkmcnt(2)
    v_mfma_f32_16x16x32_bf16 v[24:27], v[48:51], a[0:3], v[24:27]
    ds_read_b64_tr_b16 v[56:57], v241 offset:40960
    ds_read_b64_tr_b16 v[58:59], v241 offset:43008
    v_mfma_f32_16x16x32_bf16 v[28:31], v[48:51], a[4:7], v[28:31]
    v_mfma_f32_16x16x32_bf16 v[32:35], v[48:51], a[8:11], v[32:35]
    s_add_u32 m0, s80, 8192
    s_add_u32 s73, s46, s81
    v_mfma_f32_16x16x32_bf16 v[36:39], v[48:51], a[12:15], v[36:39]
    buffer_load_dwordx4 v240, s[20:23], s73 offen lds
    v_mfma_f32_16x16x32_bf16 v[40:43], v[48:51], a[16:19], v[40:43]
    v_mfma_f32_16x16x32_bf16 v[44:47], v[48:51], a[20:23], v[44:47]
    s_waitcnt lgkmcnt(2)
    v_mfma_f32_16x16x32_bf16 v[24:27], v[52:55], a[24:27], v[24:27]
    ds_read_b64_tr_b16 v[60:61], v241 offset:45056
    ds_read_b64_tr_b16 v[62:63], v241 offset:47104
    v_mfma_f32_16x16x32_bf16 v[28:31], v[52:55], a[28:31], v[28:31]
    v_mfma_f32_16x16x32_bf16 v[32:35], v[52:55], a[32:35], v[32:35]
    s_add_u32 m0, s80, 12288
    s_add_u32 s73, s47, s81
    v_mfma_f32_16x16x32_bf16 v[36:39], v[52:55], a[36:39], v[36:39]
    buffer_load_dwordx4 v240, s[20:23], s73 offen lds
    v_mfma_f32_16x16x32_bf16 v[40:43], v[52:55], a[40:43], v[40:43]
    v_mfma_f32_16x16x32_bf16 v[44:47], v[52:55], a[44:47], v[44:47]
    s_waitcnt vmcnt(13)
    v_mfma_f32_16x16x32_bf16 v[76:79], v[250:253], v[228:231], v[76:79]
    s_waitcnt vmcnt(9)
    buffer_store_dword v242, v246, s[60:63], s90 offen offset:768 sc1
    v_mfma_f32_16x16x32_bf16 v[80:83], v[248:251], v[228:231], v[80:83]
    v_mfma_f32_16x16x32_bf16 v[84:87], v[250:253], v[232:235], v[84:87]
    v_mfma_f32_16x16x32_bf16 v[88:91], v[248:251], v[232:235], v[88:91]
    v_mfma_f32_16x16x32_bf16 v[92:95], v[250:253], v[236:239], v[92:95]
    v_mfma_f32_16x16x32_bf16 v[96:99], v[248:251], v[236:239], v[96:99]
    s_waitcnt lgkmcnt(2)
    v_mfma_f32_16x16x32_bf16 v[24:27], v[56:59], a[48:51], v[24:27]
    s_barrier
    v_mfma_f32_16x16x32_bf16 v[28:31], v[56:59], a[52:55], v[28:31]
    ds_read_b64_tr_b16 v[48:49], v241 offset:49152
    ds_read_b64_tr_b16 v[50:51], v241 offset:51200
    v_mfma_f32_16x16x32_bf16 v[32:35], v[56:59], a[56:59], v[32:35]
    s_add_u32 m0, s80, 16384
    s_add_u32 s81, s81, 36864
    v_mfma_f32_16x16x32_bf16 v[36:39], v[56:59], a[60:63], v[36:39]
    s_add_u32 s73, s44, s81
    v_mfma_f32_16x16x32_bf16 v[40:43], v[56:59], a[64:67], v[40:43]
    buffer_load_dwordx4 v240, s[20:23], s73 offen lds
    v_mfma_f32_16x16x32_bf16 v[44:47], v[56:59], a[68:71], v[44:47]
    s_waitcnt lgkmcnt(2)
    v_mfma_f32_16x16x32_bf16 v[24:27], v[60:63], a[72:75], v[24:27]
    ds_read_b64_tr_b16 v[52:53], v241 offset:53248
    ds_read_b64_tr_b16 v[54:55], v241 offset:55296
    v_mfma_f32_16x16x32_bf16 v[28:31], v[60:63], a[76:79], v[28:31]
    v_mfma_f32_16x16x32_bf16 v[32:35], v[60:63], a[80:83], v[32:35]
    s_add_u32 m0, s80, 20480
    s_add_u32 s73, s45, s81
    v_mfma_f32_16x16x32_bf16 v[36:39], v[60:63], a[84:87], v[36:39]
    buffer_load_dwordx4 v240, s[20:23], s73 offen lds
    v_mfma_f32_16x16x32_bf16 v[40:43], v[60:63], a[88:91], v[40:43]
    s_waitcnt vmcnt(8)
    v_cmp_eq_u32 vcc, 0, v244
    s_nop 1
    s_and_b32 s87, vcc_lo, 0x18ff
    s_cmp_eq_u32 s87, 0
    s_cbranch_scc0 L_spin2
L_spun2:
    v_mfma_f32_16x16x32_bf16 v[44:47], v[60:63], a[92:95], v[44:47]
    s_waitcnt lgkmcnt(2)
    v_mfma_f32_16x16x32_bf16 v[24:27], v[48:51], a[96:99], v[24:27]
    buffer_load_dwordx4 v[0:3], v243, s[24:27], s98 offen sc1
    v_mfma_f32_16x16x32_bf16 v[28:31], v[48:51], a[100:103], v[28:31]
    ds_read_b64_tr_b16 v[56:57], v241 offset:57344
    ds_read_b64_tr_b16 v[58:59], v241 offset:59392
    v_mfma_f32_16x16x32_bf16 v[32:35], v[48:51], a[104:107], v[32:35]
    s_add_u32 m0, s80, 24576
    s_add_u32 s73, s46, s81
    v_mfma_f32_16x16x32_bf16 v[36:39], v[48:51], a[108:111], v[36:39]
    buffer_load_dwordx4 v[4:7], v243, s[24:27], s98 offen offset:1024 sc1
    v_mfma_f32_16x16x32_bf16 v[40:43], v[48:51], a[112:115], v[40:43]
    buffer_load_dwordx4 v240, s[20:23], s73 offen lds
    v_mfma_f32_16x16x32_bf16 v[44:47], v[48:51], a[116:119], v[44:47]
    buffer_load_dwordx4 v[8:11], v243, s[24:27], s98 offen offset:2048 sc1
    s_waitcnt lgkmcnt(2)
    v_mfma_f32_16x16x32_bf16 v[24:27], v[52:55], a[120:123], v[24:27]
    buffer_load_dwordx4 v[12:15], v243, s[24:27], s99 offen sc1
    v_mfma_f32_16x16x32_bf16 v[28:31], v[52:55], a[124:127], v[28:31]
    ds_read_b64_tr_b16 v[60:61], v241 offset:61440
    ds_read_b64_tr_b16 v[62:63], v241 offset:63488
    v_mfma_f32_16x16x32_bf16 v[32:35], v[52:55], a[128:131], v[32:35]
    s_add_u32 m0, s80, 28672
    s_add_u32 s73, s47, s81
    v_mfma_f32_16x16x32_bf16 v[36:39], v[52:55], a[132:135], v[36:39]
    buffer_load_dwordx4 v[16:19], v243, s[24:27], s99 offen offset:1024 sc1
    v_mfma_f32_16x16x32_bf16 v[40:43], v[52:55], a[136:139], v[40:43]
    buffer_load_dwordx4 v240, s[20:23], s73 offen lds
    v_mfma_f32_16x16x32_bf16 v[44:47], v[52:55], a[140:143], v[44:47]
    buffer_load_dwordx4 v[20:23], v243, s[24:27], s99 offen offset:2048 sc1
    s_waitcnt lgkmcnt(2)
    v_mfma_f32_16x16x32_bf16 v[24:27], v[56:59], a[144:147], v[24:27]
    s_barrier
    v_mfma_f32_16x16x32_bf16 v[28:31], v[56:59], a[148:151], v[28:31]
    ds_read_b64_tr_b16 v[48:49], v242 offset:0
    ds_read_b64_tr_b16 v[50:51], v242 offset:2048
    v_mfma_f32_16x16x32_bf16 v[32:35], v[56:59], a[152:155], v[32:35]
    v_mfma_f32_16x16x32_bf16 v[36:39], v[56:59], a[156:159], v[36:39]
    v_mfma_f32_16x16x32_bf16 v[40:43], v[56:59], a[160:163], v[40:43]
    v_mfma_f32_16x16x32_bf16 v[44:47], v[56:59], a[164:167], v[44:47]
    s_waitcnt lgkmcnt(2)
    v_mfma_f32_16x16x32_bf16 v[24:27], v[60:63], a[168:171], v[24:27]
    ds_read_b64_tr_b16 v[52:53], v242 offset:4096
    ds_read_b64_tr_b16 v[54:55], v242 offset:6144
    v_mfma_f32_16x16x32_bf16 v[28:31], v[60:63], a[172:175], v[28:31]
    v_mfma_f32_16x16x32_bf16 v[32:35], v[60:63], a[176:179], v[32:35]
    v_mfma_f32_16x16x32_bf16 v[36:39], v[60:63], a[180:183], v[36:39]
    v_mfma_f32_16x16x32_bf16 v[40:43], v[60:63], a[184:187], v[40:43]
    v_mfma_f32_16x16x32_bf16 v[44:47], v[60:63], a[188:191], v[44:47]
    s_waitcnt lgkmcnt(2)
    v_mfma_f32_16x16x32_bf16 v[76:79], v[48:51], v[100:103], v[76:79]
    ds_read_b64_tr_b16 v[56:57], v242 offset:8192
    ds_read_b64_tr_b16 v[58:59], v242 offset:10240
    v_mfma_f32_16x16x32_bf16 v[80:83], v[48:51], v[104:107], v[80:83]
    v_mfma_f32_16x16x32_bf16 v[84:87], v[48:51], v[108:111], v[84:87]
    v_mfma_f32_16x16x32_bf16 v[88:91], v[48:51], v[112:115], v[88:91]
    v_mfma_f32_16x16x32_bf16 v[92:95], v[48:51], v[116:119], v[92:95]
    v_cvt_pk_bf16_f32 v64, v24, v25
    v_cvt_pk_bf16_f32 v65, v26, v27
    v_mfma_f32_16x16x32_bf16 v[96:99], v[48:51], v[120:123], v[96:99]
    v_cvt_pk_bf16_f32 v66, v28, v29
    s_waitcnt lgkmcnt(2)
    v_mfma_f32_16x16x32_bf16 v[76:79], v[52:55], v[124:127], v[76:79]
    v_cvt_pk_bf16_f32 v67, v30, v31
    v_mfma_f32_16x16x32_bf16 v[80:83], v[52:55], v[128:131], v[80:83]
    buffer_store_dwordx4 v[64:67], v243, s[24:27], s93 offen sc1
    v_mfma_f32_16x16x32_bf16 v[84:87], v[52:55], v[132:135], v[84:87]
    ds_read_b64_tr_b16 v[60:61], v242 offset:12288
    ds_read_b64_tr_b16 v[62:63], v242 offset:14336
    v_cvt_pk_bf16_f32 v68, v32, v33
    v_cvt_pk_bf16_f32 v69, v34, v35
    v_mfma_f32_16x16x32_bf16 v[88:91], v[52:55], v[136:139], v[88:91]
    v_cvt_pk_bf16_f32 v70, v36, v37
    v_cvt_pk_bf16_f32 v71, v38, v39
    v_mfma_f32_16x16x32_bf16 v[92:95], v[52:55], v[140:143], v[92:95]
    buffer_store_dwordx4 v[68:71], v243, s[24:27], s93 offen offset:1024 sc1
    v_mfma_f32_16x16x32_bf16 v[96:99], v[52:55], v[144:147], v[96:99]
    v_cvt_pk_bf16_f32 v72, v40, v41
    v_cvt_pk_bf16_f32 v73, v42, v43
    s_waitcnt lgkmcnt(2)
    v_mfma_f32_16x16x32_bf16 v[76:79], v[56:59], v[148:151], v[76:79]
    s_waitcnt vmcnt(17)
    s_barrier
    v_cvt_pk_bf16_f32 v74, v44, v45
    v_cvt_pk_bf16_f32 v75, v46, v47
    s_sub_u32 s85, s5, 6
    s_and_b32 s85, s85, 7
    v_mfma_f32_16x16x32_bf16 v[80:83], v[56:59], v[152:155], v[80:83]
    buffer_store_dwordx4 v[72:75], v243, s[24:27], s93 offen offset:2048 sc1
    s_lshl_b32 s85, s85, 2
    s_add_u32 s85, s85, s3
    v_mfma_f32_16x16x32_bf16 v[84:87], v[56:59], v[156:159], v[84:87]
    ds_read_b64_tr_b16 v[48:49], v242 offset:16384
    ds_read_b64_tr_b16 v[50:51], v242 offset:18432
    s_lshl_b32 s85, s85, 10
    v_mfma_f32_16x16x32_bf16 v[88:91], v[56:59], v[160:163], v[88:91]
    buffer_load_dword v244, v248, s[60:63], s85 offen offset:768 sc1
    v_mfma_f32_16x16x32_bf16 v[92:95], v[56:59], v[164:167], v[92:95]
    v_mfma_f32_16x16x32_bf16 v[96:99], v[56:59], v[168:171], v[96:99]
    s_waitcnt lgkmcnt(2)
    v_mfma_f32_16x16x32_bf16 v[76:79], v[60:63], v[172:175], v[76:79]
    ds_read_b64_tr_b16 v[52:53], v242 offset:20480
    ds_read_b64_tr_b16 v[54:55], v242 offset:22528
    v_mfma_f32_16x16x32_bf16 v[80:83], v[60:63], v[176:179], v[80:83]
    v_mfma_f32_16x16x32_bf16 v[84:87], v[60:63], v[180:183], v[84:87]
    v_mfma_f32_16x16x32_bf16 v[88:91], v[60:63], v[184:187], v[88:91]
    v_mfma_f32_16x16x32_bf16 v[92:95], v[60:63], v[188:191], v[92:95]
    v_mfma_f32_16x16x32_bf16 v[96:99], v[60:63], v[192:195], v[96:99]
    s_waitcnt lgkmcnt(2)
    v_mfma_f32_16x16x32_bf16 v[76:79], v[48:51], v[196:199], v[76:79]
    ds_read_b64_tr_b16 v[56:57], v242 offset:24576
    ds_read_b64_tr_b16 v[58:59], v242 offset:26624
    v_mfma_f32_16x16x32_bf16 v[80:83], v[48:51], v[200:203], v[80:83]
    buffer_load_dwordx4 v[100:103], v243, s[24:27], s94 offen sc1
    v_mfma_f32_16x16x32_bf16 v[84:87], v[48:51], v[204:207], v[84:87]
    s_add_u32 s94, s94, 12288
    v_mfma_f32_16x16x32_bf16 v[88:91], v[48:51], v[208:211], v[88:91]
    buffer_load_dwordx4 v[104:107], v243, s[24:27], s94 offen sc1
    v_mfma_f32_16x16x32_bf16 v[92:95], v[48:51], v[212:215], v[92:95]
    s_add_u32 s94, s94, 12288
    v_mfma_f32_16x16x32_bf16 v[96:99], v[48:51], v[216:219], v[96:99]
    s_waitcnt lgkmcnt(2)
    v_mfma_f32_16x16x32_bf16 v[76:79], v[52:55], v[220:223], v[76:79]
    buffer_load_dwordx4 v[108:111], v243, s[24:27], s94 offen sc1
    v_mfma_f32_16x16x32_bf16 v[80:83], v[52:55], v[224:227], v[80:83]
    ds_read_b64_tr_b16 v[60:61], v242 offset:28672
    ds_read_b64_tr_b16 v[62:63], v242 offset:30720
    v_mfma_f32_16x16x32_bf16 v[84:87], v[52:55], a[192:195], v[84:87]
    s_add_u32 s94, s94, 12288
    v_mfma_f32_16x16x32_bf16 v[88:91], v[52:55], a[196:199], v[88:91]
    buffer_load_dwordx4 v[112:115], v243, s[24:27], s94 offen sc1
    v_mfma_f32_16x16x32_bf16 v[92:95], v[52:55], a[200:203], v[92:95]
    s_add_u32 s94, s94, 12288
    v_mfma_f32_16x16x32_bf16 v[96:99], v[52:55], a[204:207], v[96:99]
    buffer_load_dwordx4 v[116:119], v243, s[24:27], s94 offen sc1
    s_waitcnt lgkmcnt(2)
    v_mfma_f32_16x16x32_bf16 v[76:79], v[56:59], a[208:211], v[76:79]
    s_waitcnt vmcnt(20)
    s_barrier
    s_add_u32 s94, s94, 12288
    v_mfma_f32_16x16x32_bf16 v[80:83], v[56:59], a[212:215], v[80:83]
    buffer_load_dwordx4 v[120:123], v243, s[24:27], s94 offen sc1
    v_mfma_f32_16x16x32_bf16 v[84:87], v[56:59], a[216:219], v[84:87]
    ds_read_b64_tr_b16 v[48:49], v241 offset:0
    ds_read_b64_tr_b16 v[50:51], v241 offset:2048
    s_add_u32 s94, s94, 12288
    v_mfma_f32_16x16x32_bf16 v[88:91], v[56:59], a[220:223], v[88:91]
    buffer_load_dwordx4 v[124:127], v243, s[24:27], s94 offen sc1
    v_mfma_f32_16x16x32_bf16 v[92:95], v[56:59], a[224:227], v[92:95]
    s_waitcnt vmcnt(8)
    buffer_store_dword v242, v246, s[60:63], s90 offen offset:896 sc1
    s_add_u32 s94, s94, 12288
    v_mfma_f32_16x16x32_bf16 v[96:99], v[56:59], a[228:231], v[96:99]
    buffer_load_dwordx4 v[128:131], v243, s[24:27], s94 offen sc1
    s_waitcnt lgkmcnt(2)
    v_mfma_f32_16x16x32_bf16 v[76:79], v[60:63], a[232:235], v[76:79]
    ds_read_b64_tr_b16 v[52:53], v241 offset:4096
    ds_read_b64_tr_b16 v[54:55], v241 offset:6144
    v_mfma_f32_16x16x32_bf16 v[80:83], v[60:63], a[236:239], v[80:83]
    v_mfma_f32_16x16x32_bf16 v[84:87], v[60:63], a[240:243], v[84:87]
    v_mfma_f32_16x16x32_bf16 v[88:91], v[60:63], a[244:247], v[88:91]
    v_mfma_f32_16x16x32_bf16 v[92:95], v[60:63], a[248:251], v[92:95]
    v_mfma_f32_16x16x32_bf16 v[96:99], v[60:63], a[252:255], v[96:99]
    s_waitcnt lgkmcnt(2)
    v_mfma_f32_16x16x32_bf16 v[76:79], v[48:51], a[0:3], v[76:79]
    ds_read_b64_tr_b16 v[56:57], v241 offset:8192
    ds_read_b64_tr_b16 v[58:59], v241 offset:10240
    v_mfma_f32_16x16x32_bf16 v[80:83], v[48:51], a[4:7], v[80:83]
    v_mfma_f32_16x16x32_bf16 v[84:87], v[48:51], a[8:11], v[84:87]
    s_waitcnt vmcnt(9)
    v_readfirstlane_b32 s87, v244
    s_nop 1
    s_cmp_lg_u32 s87, 0
    s_cbranch_scc0 L_spin3
L_spun3:
    v_mfma_f32_16x16x32_bf16 v[88:91], v[48:51], a[12:15], v[88:91]
    buffer_load_dwordx4 v[132:135], v243, s[24:27], s100 offen sc1
    v_mfma_f32_16x16x32_bf16 v[92:95], v[48:51], a[16:19], v[92:95]
    v_mfma_f32_16x16x32_bf16 v[96:99], v[48:51], a[20:23], v[96:99]
    s_waitcnt lgkmcnt(2)
    v_mfma_f32_16x16x32_bf16 v[76:79], v[52:55], a[24:27], v[76:79]
    buffer_load_dwordx4 v[136:139], v243, s[24:27], s100 offen offset:1024 sc1
    v_mfma_f32_16x16x32_bf16 v[80:83], v[52:55], a[28:31], v[80:83]
    ds_read_b64_tr_b16 v[60:61], v241 offset:12288
    ds_read_b64_tr_b16 v[62:63], v241 offset:14336
    v_mfma_f32_16x16x32_bf16 v[84:87], v[52:55], a[32:35], v[84:87]
    buffer_load_dwordx4 v[140:143], v243, s[24:27], s100 offen offset:2048 sc1
    v_mfma_f32_16x16x32_bf16 v[88:91], v[52:55], a[36:39], v[88:91]
    v_mfma_f32_16x16x32_bf16 v[92:95], v[52:55], a[40:43], v[92:95]
    v_mfma_f32_16x16x32_bf16 v[96:99], v[52:55], a[44:47], v[96:99]
    v_mfma_f32_16x16x32_bf16 v[76:79], v[250:253], v[0:3], v[76:79]
    v_mfma_f32_16x16x32_bf16 v[80:83], v[248:251], v[0:3], v[80:83]
    v_mfma_f32_16x16x32_bf16 v[84:87], v[250:253], v[4:7], v[84:87]
    v_mfma_f32_16x16x32_bf16 v[88:91], v[248:251], v[4:7], v[88:91]
    v_mfma_f32_16x16x32_bf16 v[92:95], v[250:253], v[8:11], v[92:95]
    v_mfma_f32_16x16x32_bf16 v[96:99], v[248:251], v[8:11], v[96:99]
    v_mfma_f32_16x16x32_bf16 v[76:79], v[250:253], v[12:15], v[76:79]
    v_mfma_f32_16x16x32_bf16 v[80:83], v[248:251], v[12:15], v[80:83]
    v_mfma_f32_16x16x32_bf16 v[84:87], v[250:253], v[16:19], v[84:87]
    v_mfma_f32_16x16x32_bf16 v[88:91], v[248:251], v[16:19], v[88:91]
    v_mfma_f32_16x16x32_bf16 v[92:95], v[250:253], v[20:23], v[92:95]
    v_mfma_f32_16x16x32_bf16 v[96:99], v[248:251], v[20:23], v[96:99]
    s_waitcnt lgkmcnt(2)
    v_mfma_f32_16x16x32_bf16 v[76:79], v[56:59], a[48:51], v[76:79]
    s_barrier
    v_mfma_f32_16x16x32_bf16 v[80:83], v[56:59], a[52:55], v[80:83]
    ds_read_b64_tr_b16 v[48:49], v241 offset:16384
    ds_read_b64_tr_b16 v[50:51], v241 offset:18432
    v_mfma_f32_16x16x32_bf16 v[84:87], v[56:59], a[56:59], v[84:87]
    v_mfma_f32_16x16x32_bf16 v[88:91], v[56:59], a[60:63], v[88:91]
    v_mfma_f32_16x16x32_bf16 v[92:95], v[56:59], a[64:67], v[92:95]
    v_mfma_f32_16x16x32_bf16 v[96:99], v[56:59], a[68:71], v[96:99]
    s_waitcnt lgkmcnt(2)
    v_mfma_f32_16x16x32_bf16 v[76:79], v[60:63], a[72:75], v[76:79]
    ds_read_b64_tr_b16 v[52:53], v241 offset:20480
    ds_read_b64_tr_b16 v[54:55], v241 offset:22528
    v_mfma_f32_16x16x32_bf16 v[80:83], v[60:63], a[76:79], v[80:83]
    v_mfma_f32_16x16x32_bf16 v[84:87], v[60:63], a[80:83], v[84:87]
    s_sub_u32 s85, s5, 7
    s_and_b32 s85, s85, 7
    v_mfma_f32_16x16x32_bf16 v[88:91], v[60:63], a[84:87], v[88:91]
    s_lshl_b32 s85, s85, 2
    s_add_u32 s85, s85, s3
    v_mfma_f32_16x16x32_bf16 v[92:95], v[60:63], a[88:91], v[92:95]
    s_lshl_b32 s85, s85, 10
    v_mfma_f32_16x16x32_bf16 v[96:99], v[60:63], a[92:95], v[96:99]
    s_waitcnt lgkmcnt(2)
    v_mfma_f32_16x16x32_bf16 v[76:79], v[48:51], a[96:99], v[76:79]
    buffer_load_dword v244, v248, s[60:63], s85 offen offset:896 sc1
    v_mfma_f32_16x16x32_bf16 v[80:83], v[48:51], a[100:103], v[80:83]
    ds_read_b64_tr_b16 v[56:57], v241 offset:24576
    ds_read_b64_tr_b16 v[58:59], v241 offset:26624
    v_mfma_f32_16x16x32_bf16 v[84:87], v[48:51], a[104:107], v[84:87]
    v_mfma_f32_16x16x32_bf16 v[88:91], v[48:51], a[108:111], v[88:91]
    v_mfma_f32_16x16x32_bf16 v[92:95], v[48:51], a[112:115], v[92:95]
    v_mfma_f32_16x16x32_bf16 v[96:99], v[48:51], a[116:119], v[96:99]
    s_waitcnt lgkmcnt(2)
    v_mfma_f32_16x16x32_bf16 v[76:79], v[52:55], a[120:123], v[76:79]
    ds_read_b64_tr_b16 v[60:61], v241 offset:28672
    ds_read_b64_tr_b16 v[62:63], v241 offset:30720
    v_mfma_f32_16x16x32_bf16 v[80:83], v[52:55], a[124:127], v[80:83]
    v_mfma_f32_16x16x32_bf16 v[84:87], v[52:55], a[128:131], v[84:87]
    s_waitcnt vmcnt(0)
    v_readfirstlane_b32 s87, v244
    s_nop 1
    s_cmp_lg_u32 s87, 0
    s_cbranch_scc0 L_spin4
L_spun4:
    v_mfma_f32_16x16x32_bf16 v[88:91], v[52:55], a[132:135], v[88:91]
    buffer_load_dwordx4 v[144:147], v243, s[24:27], s101 offen sc1
    v_mfma_f32_16x16x32_bf16 v[92:95], v[52:55], a[136:139], v[92:95]
    buffer_load_dwordx4 v[148:151], v243, s[24:27], s101 offen offset:1024 sc1
    v_mfma_f32_16x16x32_bf16 v[96:99], v[52:55], a[140:143], v[96:99]
    s_waitcnt lgkmcnt(2)
    v_mfma_f32_16x16x32_bf16 v[76:79], v[56:59], a[144:147], v[76:79]
    buffer_load_dwordx4 v[152:155], v243, s[24:27], s101 offen offset:2048 sc1
    v_mfma_f32_16x16x32_bf16 v[80:83], v[56:59], a[148:151], v[80:83]
    v_mfma_f32_16x16x32_bf16 v[84:87], v[56:59], a[152:155], v[84:87]
    v_mfma_f32_16x16x32_bf16 v[88:91], v[56:59], a[156:159], v[88:91]
    v_mfma_f32_16x16x32_bf16 v[92:95], v[56:59], a[160:163], v[92:95]
    v_mfma_f32_16x16x32_bf16 v[96:99], v[56:59], a[164:167], v[96:99]
    s_waitcnt lgkmcnt(0)
    v_mfma_f32_16x16x32_bf16 v[76:79], v[60:63], a[168:171], v[76:79]
    v_mfma_f32_16x16x32_bf16 v[80:83], v[60:63], a[172:175], v[80:83]
    v_mfma_f32_16x16x32_bf16 v[84:87], v[60:63], a[176:179], v[84:87]
    v_mfma_f32_16x16x32_bf16 v[88:91], v[60:63], a[180:183], v[88:91]
    v_mfma_f32_16x16x32_bf16 v[92:95], v[60:63], a[184:187], v[92:95]
    v_mfma_f32_16x16x32_bf16 v[96:99], v[60:63], a[188:191], v[96:99]
    v_mfma_f32_16x16x32_bf16 v[0:3], v[250:253], v[100:103], 0
    v_mfma_f32_16x16x32_bf16 v[4:7], v[248:251], v[100:103], 0
    v_mfma_f32_16x16x32_bf16 v[0:3], v[250:253], v[104:107], v[0:3]
    v_mfma_f32_16x16x32_bf16 v[4:7], v[248:251], v[104:107], v[4:7]
    v_mfma_f32_16x16x32_bf16 v[0:3], v[250:253], v[108:111], v[0:3]
    v_mfma_f32_16x16x32_bf16 v[4:7], v[248:251], v[108:111], v[4:7]
    v_mfma_f32_16x16x32_bf16 v[0:3], v[250:253], v[112:115], v[0:3]
    v_mfma_f32_16x16x32_bf16 v[4:7], v[248:251], v[112:115], v[4:7]
    v_mfma_f32_16x16x32_bf16 v[0:3], v[250:253], v[116:119], v[0:3]
    v_mfma_f32_16x16x32_bf16 v[4:7], v[248:251], v[116:119], v[4:7]
    v_mfma_f32_16x16x32_bf16 v[0:3], v[250:253], v[120:123], v[0:3]
    v_mfma_f32_16x16x32_bf16 v[4:7], v[248:251], v[120:123], v[4:7]
    v_mfma_f32_16x16x32_bf16 v[0:3], v[250:253], v[124:127], v[0:3]
    v_mfma_f32_16x16x32_bf16 v[4:7], v[248:251], v[124:127], v[4:7]
    v_mfma_f32_16x16x32_bf16 v[0:3], v[250:253], v[128:131], v[0:3]
    v_mfma_f32_16x16x32_bf16 v[4:7], v[248:251], v[128:131], v[4:7]
    v_mfma_f32_16x16x32_bf16 v[76:79], v[250:253], v[132:135], v[76:79]
    v_mfma_f32_16x16x32_bf16 v[80:83], v[248:251], v[132:135], v[80:83]
    v_mfma_f32_16x16x32_bf16 v[84:87], v[250:253], v[136:139], v[84:87]
    v_mfma_f32_16x16x32_bf16 v[88:91], v[248:251], v[136:139], v[88:91]
    v_mfma_f32_16x16x32_bf16 v[92:95], v[250:253], v[140:143], v[92:95]
    v_mfma_f32_16x16x32_bf16 v[96:99], v[248:251], v[140:143], v[96:99]
    s_mul_i32 s82, s5, 73728
    s_add_u32 s82, s82, s89
    s_add_u32 s82, s82, 1024
    s_add_u32 s87, s82, 36864
    v_cvt_pk_bf16_f32 v8, v0, v1
    v_cvt_pk_bf16_f32 v9, v2, v3
    v_cvt_pk_bf16_f32 v10, v4, v5
    v_cvt_pk_bf16_f32 v11, v6, v7
    s_cmp_lt_u32 s5, 3
    s_cbranch_scc0 L_nosh
    buffer_store_dwordx2 v[8:9], v245, s[68:71], s82 offen
    buffer_store_dwordx2 v[10:11], v245, s[68:71], s87 offen
L_nosh:
    s_lshl_b32 s82, s5, 7
    s_add_u32 s82, s82, s89
    s_waitcnt vmcnt(0)
    v_mfma_f32_16x16x32_bf16 v[76:79], v[250:253], v[144:147], v[76:79]
    v_mfma_f32_16x16x32_bf16 v[80:83], v[248:251], v[144:147], v[80:83]
    v_mfma_f32_16x16x32_bf16 v[84:87], v[250:253], v[148:151], v[84:87]
    v_mfma_f32_16x16x32_bf16 v[88:91], v[248:251], v[148:151], v[88:91]
    v_mfma_f32_16x16x32_bf16 v[92:95], v[250:253], v[152:155], v[92:95]
    v_mfma_f32_16x16x32_bf16 v[96:99], v[248:251], v[152:155], v[96:99]
    s_nop 2
    v_cvt_pk_bf16_f32 v12, v76, v77
    v_cvt_pk_bf16_f32 v13, v78, v79
    buffer_store_dwordx2 v[12:13], v245, s[68:71], s82 offen
    s_add_u32 s82, s82, 36864
    v_cvt_pk_bf16_f32 v14, v80, v81
    v_cvt_pk_bf16_f32 v15, v82, v83
    buffer_store_dwordx2 v[14:15], v245, s[68:71], s82 offen
    s_add_u32 s82, s82, 36864
    v_cvt_pk_bf16_f32 v16, v84, v85
    v_cvt_pk_bf16_f32 v17, v86, v87
    buffer_store_dwordx2 v[16:17], v245, s[68:71], s82 offen
    s_add_u32 s82, s82, 36864
    v_cvt_pk_bf16_f32 v18, v88, v89
    v_cvt_pk_bf16_f32 v19, v90, v91
    buffer_store_dwordx2 v[18:19], v245, s[68:71], s82 offen
    s_add_u32 s82, s82, 36864
    v_cvt_pk_bf16_f32 v20, v92, v93
    v_cvt_pk_bf16_f32 v21, v94, v95
    buffer_store_dwordx2 v[20:21], v245, s[68:71], s82 offen
    s_add_u32 s82, s82, 36864
    v_cvt_pk_bf16_f32 v22, v96, v97
    v_cvt_pk_bf16_f32 v23, v98, v99
    buffer_store_dwordx2 v[22:23], v245, s[68:71], s82 offen
L_end:
    s_endpgm
L_fallback:
    s_waitcnt vmcnt(0) lgkmcnt(0)
    s_barrier
    s_mov_b32 s51, 1
    s_mov_b32 s29, s50
    s_add_u32 s30, s29, 4096
    s_mov_b32 s10, 262144
    s_add_u32 m0, s28, 0
    s_nop 0
    buffer_load_dwordx4 v197, s[8:11], s29 offen nt lds
    s_add_u32 m0, s28, 64
    s_nop 0
    buffer_load_dwordx4 v197, s[8:11], s29 offen offset:1024 nt lds
    s_add_u32 m0, s28, 128
    s_nop 0
    buffer_load_dwordx4 v197, s[8:11], s29 offen offset:2048 nt lds
    s_add_u32 m0, s28, 192
    s_nop 0
    buffer_load_dwordx4 v197, s[8:11], s29 offen offset:3072 nt lds
    s_add_u32 m0, s28, 4352
    s_nop 0
    buffer_load_dwordx4 v197, s[8:11], s30 offen nt lds
    s_add_u32 m0, s28, 4416
    s_nop 0
    buffer_load_dwordx4 v197, s[8:11], s30 offen offset:1024 nt lds
    s_add_u32 m0, s28, 4480
    s_nop 0
    buffer_load_dwordx4 v197, s[8:11], s30 offen offset:2048 nt lds
    s_add_u32 m0, s28, 4544
    s_nop 0
    buffer_load_dwordx4 v197, s[8:11], s30 offen offset:3072 nt lds
    s_add_u32 s29, s29, 8192
    s_and_b32 s29, s29, 0x3ffff
    s_add_u32 s30, s29, 4096
    s_add_u32 m0, s28, 8704
    s_nop 0
    buffer_load_dwordx4 v197, s[8:11], s29 offen nt lds
    s_add_u32 m0, s28, 8768
    s_nop 0
    buffer_load_dwordx4 v197, s[8:11], s29 offen offset:1024 nt lds
    s_add_u32 m0, s28, 8832
    s_nop 0
    buffer_load_dwordx4 v197, s[8:11], s29 offen offset:2048 nt lds
    s_add_u32 m0, s28, 8896
    s_nop 0
    buffer_load_dwordx4 v197, s[8:11], s29 offen offset:3072 nt lds
    s_add_u32 m0, s28, 13056
    s_nop 0
    buffer_load_dwordx4 v197, s[8:11], s30 offen nt lds
    s_add_u32 m0, s28, 13120
    s_nop 0
    buffer_load_dwordx4 v197, s[8:11], s30 offen offset:1024 nt lds
    s_add_u32 m0, s28, 13184
    s_nop 0
    buffer_load_dwordx4 v197, s[8:11], s30 offen offset:2048 nt lds
    s_add_u32 m0, s28, 13248
    s_nop 0
    buffer_load_dwordx4 v197, s[8:11], s30 offen offset:3072 nt lds
    s_add_u32 s29, s29, 8192
    s_and_b32 s29, s29, 0x3ffff
    s_add_u32 s30, s29, 4096
    s_add_u32 m0, s28, 17408
    s_nop 0
    buffer_load_dwordx4 v197, s[8:11], s29 offen nt lds
    s_add_u32 m0, s28, 17472
    s_nop 0
    buffer_load_dwordx4 v197, s[8:11], s29 offen offset:1024 nt lds
    s_add_u32 m0, s28, 17536
    s_nop 0
    buffer_load_dwordx4 v197, s[8:11], s29 offen offset:2048 nt lds
    s_add_u32 m0, s28, 17600
    s_nop 0
    buffer_load_dwordx4 v197, s[8:11], s29 offen offset:3072 nt lds
    s_add_u32 m0, s28, 21760
    s_nop 0
    buffer_load_dwordx4 v197, s[8:11], s30 offen nt lds
    s_add_u32 m0, s28, 21824
    s_nop 0
    buffer_load_dwordx4 v197, s[8:11], s30 offen offset:1024 nt lds
    s_add_u32 m0, s28, 21888
    s_nop 0
    buffer_load_dwordx4 v197, s[8:11], s30 offen offset:2048 nt lds
    s_add_u32 m0, s28, 21952
    s_nop 0
    buffer_load_dwordx4 v197, s[8:11], s30 offen offset:3072 nt lds
    s_add_u32 s29, s29, 8192
    s_and_b32 s29, s29, 0x3ffff
    s_add_u32 s30, s29, 4096
    s_cmp_lg_u32 s31, 0
    s_cbranch_scc1 L_skip_t3
    s_add_u32 m0, s28, 26112
    s_nop 0
    buffer_load_dwordx4 v197, s[8:11], s29 offen nt lds
    s_add_u32 m0, s28, 26176
    s_nop 0
    buffer_load_dwordx4 v197, s[8:11], s29 offen offset:1024 nt lds
    s_add_u32 m0, s28, 26240
    s_nop 0
    buffer_load_dwordx4 v197, s[8:11], s29 offen offset:2048 nt lds
    s_add_u32 m0, s28, 26304
    s_nop 0
    buffer_load_dwordx4 v197, s[8:11], s29 offen offset:3072 nt lds
    s_add_u32 m0, s28, 30464
    s_nop 0
    buffer_load_dwordx4 v197, s[8:11], s30 offen nt lds
    s_add_u32 m0, s28, 30528
    s_nop 0
    buffer_load_dwordx4 v197, s[8:11], s30 offen offset:1024 nt lds
    s_add_u32 m0, s28, 30592
    s_nop 0
    buffer_load_dwordx4 v197, s[8:11], s30 offen offset:2048 nt lds
    s_add_u32 m0, s28, 30656
    s_nop 0
    buffer_load_dwordx4 v197, s[8:11], s30 offen offset:3072 nt lds
    s_add_u32 s29, s29, 8192
    s_and_b32 s29, s29, 0x3ffff
    s_add_u32 s30, s29, 4096
L_skip_t3:
    s_waitcnt vmcnt(0)
    s_barrier
    s_mov_b32 s32, 7
    ds_read_b128 v[168:171], v192 offset:0
    ds_read_b128 v[172:175], v192 offset:64
    s_waitcnt lgkmcnt(1)
    v_mfma_f32_16x16x32_bf16 v[0:3], v[168:171], a[192:195], 0
    ds_read_b128 v[176:179], v192 offset:128
    ds_read_b128 v[180:183], v192 offset:192
    v_mfma_f32_16x16x32_bf16 v[4:7], v[168:171], a[208:211], 0
    v_mfma_f32_16x16x32_bf16 v[8:11], v[168:171], a[224:227], 0
    v_and_b32 v184, 15, v198
    v_cmp_eq_u32 vcc, 0, v184
    v_mov_b32 v185, 0x3f803f80
    s_nop 0
    v_cndmask_b32 v184, 0, v185, vcc
    v_mfma_f32_16x16x32_bf16 v[12:15], v[168:171], a[240:243], 0
    v_mov_b32 v185, v184
    v_mfma_f32_16x16x32_bf16 v[16:19], v[168:171], v[200:203], 0
    v_mov_b32 v186, v184
    v_mov_b32 v187, v184
    v_mfma_f32_16x16x32_bf16 v[20:23], v[168:171], v[216:219], 0
    s_waitcnt lgkmcnt(2)
    v_mfma_f32_16x16x32_bf16 v[0:3], v[172:175], a[196:199], v[0:3]
    ds_read_b128 v[168:171], v192 offset:4352
    v_mfma_f32_16x16x32_bf16 v[4:7], v[172:175], a[212:215], v[4:7]
    v_mfma_f32_16x16x32_bf16 v[8:11], v[172:175], a[228:231], v[8:11]
    v_mfma_f32_16x16x32_bf16 v[12:15], v[172:175], a[244:247], v[12:15]
    v_mfma_f32_16x16x32_bf16 v[16:19], v[172:175], v[204:207], v[16:19]
    v_mfma_f32_16x16x32_bf16 v[20:23], v[172:175], v[220:223], v[20:23]
    s_waitcnt lgkmcnt(2)
    v_mfma_f32_16x16x32_bf16 v[0:3], v[176:179], a[200:203], v[0:3]
    ds_read_b128 v[172:175], v192 offset:4416
    v_mfma_f32_16x16x32_bf16 v[4:7], v[176:179], a[216:219], v[4:7]
    v_mfma_f32_16x16x32_bf16 v[8:11], v[176:179], a[232:235], v[8:11]
    v_mfma_f32_16x16x32_bf16 v[12:15], v[176:179], a[248:251], v[12:15]
    v_mfma_f32_16x16x32_bf16 v[16:19], v[176:179], v[208:211], v[16:19]
    v_mfma_f32_16x16x32_bf16 v[20:23], v[176:179], v[224:227], v[20:23]
    s_waitcnt lgkmcnt(2)
    v_mfma_f32_16x16x32_bf16 v[0:3], v[180:183], a[204:207], v[0:3]
    ds_read_b128 v[176:179], v192 offset:4480
    v_mfma_f32_16x16x32_bf16 v[4:7], v[180:183], a[220:223], v[4:7]
    v_mfma_f32_16x16x32_bf16 v[8:11], v[180:183], a[236:239], v[8:11]
    v_mfma_f32_16x16x32_bf16 v[12:15], v[180:183], a[252:255], v[12:15]
    v_mfma_f32_16x16x32_bf16 v[16:19], v[180:183], v[212:215], v[16:19]
    v_mfma_f32_16x16x32_bf16 v[20:23], v[180:183], v[228:231], v[20:23]
    s_waitcnt lgkmcnt(2)
    v_mfma_f32_16x16x32_bf16 v[24:27], v[168:171], a[192:195], 0
    ds_read_b128 v[180:183], v192 offset:4544
    v_mfma_f32_16x16x32_bf16 v[28:31], v[168:171], a[208:211], 0
    v_mfma_f32_16x16x32_bf16 v[32:35], v[168:171], a[224:227], 0
    v_mfma_f32_16x16x32_bf16 v[36:39], v[168:171], a[240:243], 0
    v_mfma_f32_16x16x32_bf16 v[40:43], v[168:171], v[200:203], 0
    v_mfma_f32_16x16x32_bf16 v[44:47], v[168:171], v[216:219], 0
    s_waitcnt lgkmcnt(2)
    v_mfma_f32_16x16x32_bf16 v[24:27], v[172:175], a[196:199], v[24:27]
    v_mfma_f32_16x16x32_bf16 v[28:31], v[172:175], a[212:215], v[28:31]
    v_mfma_f32_16x16x32_bf16 v[32:35], v[172:175], a[228:231], v[32:35]
    v_mfma_f32_16x16x32_bf16 v[36:39], v[172:175], a[244:247], v[36:39]
    v_mfma_f32_16x16x32_bf16 v[40:43], v[172:175], v[204:207], v[40:43]
    ds_read_b128 v[168:171], v192 offset:8704
    v_mfma_f32_16x16x32_bf16 v[44:47], v[172:175], v[220:223], v[44:47]
    s_waitcnt lgkmcnt(2)
    v_mfma_f32_16x16x32_bf16 v[24:27], v[176:179], a[200:203], v[24:27]
    v_mfma_f32_16x16x32_bf16 v[28:31], v[176:179], a[216:219], v[28:31]
    v_mfma_f32_16x16x32_bf16 v[32:35], v[176:179], a[232:235], v[32:35]
    v_mfma_f32_16x16x32_bf16 v[36:39], v[176:179], a[248:251], v[36:39]
    v_mfma_f32_16x16x32_bf16 v[40:43], v[176:179], v[208:211], v[40:43]
    ds_read_b128 v[172:175], v192 offset:8768
    v_mfma_f32_16x16x32_bf16 v[44:47], v[176:179], v[224:227], v[44:47]
    s_waitcnt lgkmcnt(2)
    v_mfma_f32_16x16x32_bf16 v[24:27], v[180:183], a[204:207], v[24:27]
    v_mfma_f32_16x16x32_bf16 v[28:31], v[180:183], a[220:223], v[28:31]
    v_mfma_f32_16x16x32_bf16 v[32:35], v[180:183], a[236:239], v[32:35]
    v_mfma_f32_16x16x32_bf16 v[36:39], v[180:183], a[252:255], v[36:39]
    v_mfma_f32_16x16x32_bf16 v[40:43], v[180:183], v[212:215], v[40:43]
    v_mfma_f32_16x16x32_bf16 v[44:47], v[180:183], v[228:231], v[44:47]
    v_max3_f32 v232, v0, v1, v2
    v_max3_f32 v234, v4, v5, v6
    v_max3_f32 v236, v8, v9, v10
    v_max3_f32 v232, v232, v3, v24
    v_max3_f32 v234, v234, v7, v28
    v_max3_f32 v236, v236, v11, v32
    v_max3_f32 v232, v232, v25, v26
    v_max3_f32 v234, v234, v29, v30
    v_max3_f32 v236, v236, v33, v34
    v_max_f32 v232, v232, v27
    v_max_f32 v234, v234, v31
    v_max_f32 v236, v236, v35
    v_mov_b32 v233, v232
    v_mov_b32 v235, v234
    v_mov_b32 v237, v236
    v_permlane32_swap_b32 v232, v233
    v_permlane32_swap_b32 v234, v235
    v_permlane32_swap_b32 v236, v237
    v_max_f32 v232, v232, v233
    v_max_f32 v234, v234, v235
    v_max_f32 v236, v236, v237
    v_mov_b32 v233, v232
    v_mov_b32 v235, v234
    v_mov_b32 v237, v236
    v_permlane16_swap_b32 v232, v233
    v_permlane16_swap_b32 v234, v235
    v_permlane16_swap_b32 v236, v237
    v_max_f32 v232, v232, v233
    v_max_f32 v234, v234, v235
    v_max_f32 v236, v236, v237
    v_sub_f32 v96, 0, v232
    v_sub_f32 v100, 0, v234
    v_sub_f32 v104, 0, v236
    v_sub_f32 v97, 0, v232
    v_sub_f32 v101, 0, v234
    v_sub_f32 v105, 0, v236
    v_sub_f32 v98, 0, v232
    v_sub_f32 v102, 0, v234
    v_sub_f32 v106, 0, v236
    v_sub_f32 v99, 0, v232
    v_sub_f32 v103, 0, v234
    v_sub_f32 v107, 0, v236
    v_sub_f32 v0, v0, v232
    v_sub_f32 v4, v4, v234
    v_sub_f32 v8, v8, v236
    v_sub_f32 v1, v1, v232
    v_sub_f32 v5, v5, v234
    v_sub_f32 v9, v9, v236
    v_sub_f32 v2, v2, v232
    v_sub_f32 v6, v6, v234
    v_sub_f32 v10, v10, v236
    v_sub_f32 v3, v3, v232
    v_sub_f32 v7, v7, v234
    v_sub_f32 v11, v11, v236
    v_sub_f32 v24, v24, v232
    v_sub_f32 v28, v28, v234
    v_sub_f32 v32, v32, v236
    v_sub_f32 v25, v25, v232
    v_sub_f32 v29, v29, v234
    v_sub_f32 v33, v33, v236
    v_sub_f32 v26, v26, v232
    v_sub_f32 v30, v30, v234
    v_sub_f32 v34, v34, v236
    v_sub_f32 v27, v27, v232
    v_sub_f32 v31, v31, v234
    v_sub_f32 v35, v35, v236
    v_max3_f32 v232, v12, v13, v14
    v_max3_f32 v234, v16, v17, v18
    v_max3_f32 v236, v20, v21, v22
    v_max3_f32 v232, v232, v15, v36
    v_max3_f32 v234, v234, v19, v40
    v_max3_f32 v236, v236, v23, v44
    v_max3_f32 v232, v232, v37, v38
    v_max3_f32 v234, v234, v41, v42
    v_max3_f32 v236, v236, v45, v46
    v_max_f32 v232, v232, v39
    v_max_f32 v234, v234, v43
    v_max_f32 v236, v236, v47
    v_mov_b32 v233, v232
    v_mov_b32 v235, v234
    v_mov_b32 v237, v236
    v_permlane32_swap_b32 v232, v233
    v_permlane32_swap_b32 v234, v235
    v_permlane32_swap_b32 v236, v237
    v_max_f32 v232, v232, v233
    v_max_f32 v234, v234, v235
    v_max_f32 v236, v236, v237
    v_mov_b32 v233, v232
    v_mov_b32 v235, v234
    v_mov_b32 v237, v236
    v_permlane16_swap_b32 v232, v233
    v_permlane16_swap_b32 v234, v235
    v_permlane16_swap_b32 v236, v237
    v_max_f32 v232, v232, v233
    v_max_f32 v234, v234, v235
    v_max_f32 v236, v236, v237
    v_sub_f32 v108, 0, v232
    v_sub_f32 v112, 0, v234
    v_sub_f32 v116, 0, v236
    v_sub_f32 v109, 0, v232
    v_sub_f32 v113, 0, v234
    v_sub_f32 v117, 0, v236
    v_sub_f32 v110, 0, v232
    v_sub_f32 v114, 0, v234
    v_sub_f32 v118, 0, v236
    v_sub_f32 v111, 0, v232
    v_sub_f32 v115, 0, v234
    v_sub_f32 v119, 0, v236
    v_sub_f32 v12, v12, v232
    v_sub_f32 v16, v16, v234
    v_sub_f32 v20, v20, v236
    v_sub_f32 v13, v13, v232
    v_sub_f32 v17, v17, v234
    v_sub_f32 v21, v21, v236
    v_sub_f32 v14, v14, v232
    v_sub_f32 v18, v18, v234
    v_sub_f32 v22, v22, v236
    v_sub_f32 v15, v15, v232
    v_sub_f32 v19, v19, v234
    v_sub_f32 v23, v23, v236
    v_sub_f32 v36, v36, v232
    v_sub_f32 v40, v40, v234
    v_sub_f32 v44, v44, v236
    v_sub_f32 v37, v37, v232
    v_sub_f32 v41, v41, v234
    v_sub_f32 v45, v45, v236
    v_sub_f32 v38, v38, v232
    v_sub_f32 v42, v42, v234
    v_sub_f32 v46, v46, v236
    v_sub_f32 v39, v39, v232
    v_sub_f32 v43, v43, v234
    v_sub_f32 v47, v47, v236
    s_waitcnt lgkmcnt(0)
    s_barrier
    v_mfma_f32_16x16x32_bf16 v[48:51], v[168:171], a[192:195], v[96:99]
    s_add_u32 m0, s40, 0
    ds_read_b128 v[176:179], v192 offset:8832
    v_mfma_f32_16x16x32_bf16 v[52:55], v[168:171], a[208:211], v[100:103]
    v_exp_f32 v0, v0
    v_exp_f32 v1, v1
    v_mfma_f32_16x16x32_bf16 v[56:59], v[168:171], a[224:227], v[104:107]
    s_waitcnt vmcnt(3)
    v_cvt_pk_bf16_f32 v144, v0, v1
    v_mfma_f32_16x16x32_bf16 v[60:63], v[168:171], a[240:243], v[108:111]
    ds_read_b128 v[180:183], v192 offset:8896
    buffer_load_dwordx4 v197, s[8:11], s29 offen nt lds
    v_mfma_f32_16x16x32_bf16 v[64:67], v[168:171], v[200:203], v[112:115]
    v_lshrrev_b32 v188, 3, v198
    v_and_b32 v189, 7, v198
    v_mfma_f32_16x16x32_bf16 v[68:71], v[168:171], v[216:219], v[116:119]
    v_and_b32 v190, 6, v188
    v_xor_b32 v189, v189, v190
    v_mfma_f32_16x16x32_bf16 v[48:51], v[172:175], a[196:199], v[48:51]
    s_add_u32 m0, s40, 64
    v_exp_f32 v2, v2
    v_mfma_f32_16x16x32_bf16 v[52:55], v[172:175], a[212:215], v[52:55]
    s_lshl_b32 s34, s3, 3
    v_add_u32 v188, s34, v188
    v_mfma_f32_16x16x32_bf16 v[56:59], v[172:175], a[228:231], v[56:59]
    v_mul_u32_u24 v188, 1152, v188
    v_lshl_add_u32 v240, v189, 4, v188
    v_mfma_f32_16x16x32_bf16 v[60:63], v[172:175], a[244:247], v[60:63]
    ds_read_b128 v[168:171], v192 offset:13056
    v_exp_f32 v3, v3
    v_mfma_f32_16x16x32_bf16 v[64:67], v[172:175], v[204:207], v[64:67]
    v_bfe_u32 v188, v198, 2, 3
    v_lshrrev_b32 v189, 1, v188
    v_cvt_pk_bf16_f32 v145, v2, v3
    v_mfma_f32_16x16x32_bf16 v[68:71], v[172:175], v[220:223], v[68:71]
    v_xor_b32 v189, s3, v189
    v_lshlrev_b32 v189, 5, v189
    s_waitcnt lgkmcnt(2)
    v_mfma_f32_16x16x32_bf16 v[48:51], v[176:179], a[200:203], v[48:51]
    v_exp_f32 v24, v24
    v_mfma_f32_16x16x32_bf16 v[52:55], v[176:179], a[216:219], v[52:55]
    v_lshl_add_u32 v188, v188, 7, v189
    v_and_b32 v189, 3, v198
    v_lshl_add_u32 v188, v189, 3, v188
    v_mfma_f32_16x16x32_bf16 v[56:59], v[176:179], a[232:235], v[56:59]
    s_waitcnt vmcnt(4)
    buffer_load_dwordx4 v197, s[8:11], s29 offen offset:1024 nt lds
    v_mfma_f32_16x16x32_bf16 v[60:63], v[176:179], a[248:251], v[60:63]
    ds_read_b128 v[172:175], v192 offset:13120
    s_add_u32 m0, s40, 128
    v_mfma_f32_16x16x32_bf16 v[64:67], v[176:179], v[208:211], v[64:67]
    v_lshrrev_b32 v189, 5, v198
    v_lshl_add_u32 v241, v189, 10, v188
    v_mfma_f32_16x16x32_bf16 v[68:71], v[176:179], v[224:227], v[68:71]
    v_add_u32 v242, 65536, v241
    v_lshlrev_b32 v243, 4, v198
    v_exp_f32 v25, v25
    s_waitcnt lgkmcnt(2)
    v_mfma_f32_16x16x32_bf16 v[48:51], v[180:183], a[204:207], v[48:51]
    v_exp_f32 v26, v26
    v_mfma_f32_16x16x32_bf16 v[52:55], v[180:183], a[220:223], v[52:55]
    s_mul_hi_u32 s34, s44, 715827883
    s_add_u32 s34, s34, 65536
    v_mfma_f32_16x16x32_bf16 v[56:59], v[180:183], a[236:239], v[56:59]
    v_add_u32 v234, s34, v243
    v_exp_f32 v27, v27
    v_mfma_f32_16x16x32_bf16 v[60:63], v[180:183], a[252:255], v[60:63]
    ds_read_b128 v[176:179], v192 offset:13184
    v_exp_f32 v4, v4
    v_mfma_f32_16x16x32_bf16 v[64:67], v[180:183], v[212:215], v[64:67]
    s_mul_hi_u32 s34, s45, 715827883
    s_add_u32 s34, s34, 65536
    v_mfma_f32_16x16x32_bf16 v[68:71], v[180:183], v[228:231], v[68:71]
    v_add_u32 v235, s34, v243
    v_exp_f32 v5, v5
    s_waitcnt lgkmcnt(2)
    v_mfma_f32_16x16x32_bf16 v[72:75], v[168:171], a[192:195], v[96:99]
    s_waitcnt vmcnt(4)
    v_cvt_pk_bf16_f32 v146, v24, v25
    v_mfma_f32_16x16x32_bf16 v[76:79], v[168:171], a[208:211], v[100:103]
    s_mul_hi_u32 s34, s46, 715827883
    s_add_u32 s34, s34, 65536
    v_mfma_f32_16x16x32_bf16 v[80:83], v[168:171], a[224:227], v[104:107]
    v_add_u32 v236, s34, v243
    buffer_load_dwordx4 v197, s[8:11], s29 offen offset:2048 nt lds
    v_mfma_f32_16x16x32_bf16 v[84:87], v[168:171], a[240:243], v[108:111]
    ds_read_b128 v[180:183], v192 offset:13248
    s_add_u32 m0, s40, 192
    v_mfma_f32_16x16x32_bf16 v[88:91], v[168:171], v[200:203], v[112:115]
    s_mul_hi_u32 s34, s47, 715827883
    s_add_u32 s34, s34, 65536
    v_add_u32 v237, s34, v243
    v_mfma_f32_16x16x32_bf16 v[92:95], v[168:171], v[216:219], v[116:119]
    v_exp_f32 v6, v6
    s_waitcnt lgkmcnt(2)
    v_mfma_f32_16x16x32_bf16 v[72:75], v[172:175], a[196:199], v[72:75]
    v_exp_f32 v7, v7
    v_cvt_pk_bf16_f32 v147, v26, v27
    v_mfma_f32_16x16x32_bf16 v[76:79], v[172:175], a[212:215], v[76:79]
    s_mul_i32 s34, s3, 24576
    s_add_u32 s34, s34, 65536
    v_mfma_f32_16x16x32_bf16 v[80:83], v[172:175], a[228:231], v[80:83]
    v_add_u32 v238, s34, v243
    v_exp_f32 v28, v28
    v_mfma_f32_16x16x32_bf16 v[84:87], v[172:175], a[244:247], v[84:87]
    ds_read_b64_tr_b16 v[168:169], v193 offset:0
    ds_read_b64_tr_b16 v[170:171], v193 offset:4352
    v_mfma_f32_16x16x32_bf16 v[88:91], v[172:175], v[204:207], v[88:91]
    v_mov_b32 v190, 2147483632
    v_cmp_eq_u32 vcc, 0, v198
    v_cvt_pk_bf16_f32 v148, v4, v5
    v_mfma_f32_16x16x32_bf16 v[92:95], v[172:175], v[220:223], v[92:95]
    s_cmp_eq_u32 s3, 0
    s_cselect_b32 s34, 1, 0
    s_waitcnt lgkmcnt(3)
    v_mfma_f32_16x16x32_bf16 v[72:75], v[176:179], a[200:203], v[72:75]
    v_cndmask_b32 v246, v190, v198, vcc
    s_waitcnt vmcnt(3)
    v_cvt_pk_bf16_f32 v149, v6, v7
    v_mfma_f32_16x16x32_bf16 v[76:79], v[176:179], a[216:219], v[76:79]
    v_cmp_gt_u32 vcc, s34, v198
    v_lshlrev_b32 v188, 7, v198
    s_nop 0
    v_cndmask_b32 v199, v190, v198, vcc
    v_mfma_f32_16x16x32_bf16 v[80:83], v[176:179], a[232:235], v[80:83]
    v_mfma_f32_16x16x32_bf16 v[84:87], v[176:179], a[248:251], v[84:87]
    buffer_load_dwordx4 v197, s[8:11], s29 offen offset:3072 nt lds
    s_add_u32 m0, s40, 4352
    v_mfma_f32_16x16x32_bf16 v[88:91], v[176:179], v[208:211], v[88:91]
    v_cmp_gt_u32 vcc, 36, v198
    s_nop 1
    v_cndmask_b32 v239, v190, v188, vcc
    v_mfma_f32_16x16x32_bf16 v[92:95], v[176:179], v[224:227], v[92:95]
    ds_read_b64_tr_b16 v[172:173], v194 offset:0
    ds_read_b64_tr_b16 v[174:175], v194 offset:4352
    s_waitcnt lgkmcnt(4)
    v_mfma_f32_16x16x32_bf16 v[72:75], v[180:183], a[204:207], v[72:75]
    v_exp_f32 v29, v29
    v_mfma_f32_16x16x32_bf16 v[76:79], v[180:183], a[220:223], v[76:79]
    v_exp_f32 v30, v30
    v_mfma_f32_16x16x32_bf16 v[80:83], v[180:183], a[236:239], v[80:83]
    v_exp_f32 v31, v31
    v_cvt_pk_bf16_f32 v150, v28, v29
    v_mfma_f32_16x16x32_bf16 v[84:87], v[180:183], a[252:255], v[84:87]
    v_exp_f32 v8, v8
    v_mfma_f32_16x16x32_bf16 v[88:91], v[180:183], v[212:215], v[88:91]
    v_exp_f32 v9, v9
    v_exp_f32 v10, v10
    v_exp_f32 v11, v11
    v_exp_f32 v32, v32
    v_exp_f32 v33, v33
    v_exp_f32 v34, v34
    v_exp_f32 v35, v35
    v_cvt_pk_bf16_f32 v151, v30, v31
    v_mfma_f32_16x16x32_bf16 v[92:95], v[180:183], v[228:231], v[92:95]
    v_exp_f32 v12, v12
    v_exp_f32 v13, v13
    v_exp_f32 v14, v14
    v_exp_f32 v15, v15
    v_exp_f32 v36, v36
    v_exp_f32 v37, v37
    v_exp_f32 v38, v38
    v_exp_f32 v39, v39
    v_cvt_pk_bf16_f32 v152, v8, v9
    v_cvt_pk_bf16_f32 v153, v10, v11
    v_cvt_pk_bf16_f32 v154, v32, v33
    v_cvt_pk_bf16_f32 v155, v34, v35
    v_subrev_u32 v188, 7, v198
    v_sub_u32 v189, s5, v188
    s_waitcnt lgkmcnt(2)
    v_mfma_f32_16x16x32_bf16 a[0:3], v[168:171], v[144:147], 0
    v_exp_f32 v16, v16
    v_exp_f32 v17, v17
    v_exp_f32 v18, v18
    v_exp_f32 v19, v19
    v_exp_f32 v40, v40
    v_exp_f32 v41, v41
    v_exp_f32 v42, v42
    v_exp_f32 v43, v43
    v_cvt_pk_bf16_f32 v156, v12, v13
    v_cvt_pk_bf16_f32 v157, v14, v15
    v_cvt_pk_bf16_f32 v158, v36, v37
    v_cvt_pk_bf16_f32 v159, v38, v39
    v_and_b32 v189, 7, v189
    v_lshlrev_b32 v189, 12, v189
    v_mfma_f32_16x16x32_bf16 a[4:7], v[168:171], v[148:151], 0
    v_exp_f32 v20, v20
    v_exp_f32 v21, v21
    v_exp_f32 v22, v22
    v_exp_f32 v23, v23
    v_exp_f32 v44, v44
    v_exp_f32 v45, v45
    v_exp_f32 v46, v46
    v_exp_f32 v47, v47
    v_cvt_pk_bf16_f32 v160, v16, v17
    v_cvt_pk_bf16_f32 v161, v18, v19
    v_cvt_pk_bf16_f32 v162, v40, v41
    v_cvt_pk_bf16_f32 v163, v42, v43
    v_mfma_f32_16x16x32_bf16 a[8:11], v[168:171], v[152:155], 0
    v_cvt_pk_bf16_f32 v164, v20, v21
    v_cvt_pk_bf16_f32 v165, v22, v23
    v_cvt_pk_bf16_f32 v166, v44, v45
    v_cvt_pk_bf16_f32 v167, v46, v47
    v_lshl_add_u32 v189, v188, 7, v189
    v_cmp_gt_u32 vcc, 15, v198
    v_lshlrev_b32 v188, 12, v198
    s_nop 0
    v_cndmask_b32 v189, 0, v189, vcc
    v_mfma_f32_16x16x32_bf16 a[12:15], v[168:171], v[156:159], 0
    v_mfma_f32_16x16x32_bf16 a[16:19], v[168:171], v[160:163], 0
    ds_read_b64_tr_b16 v[176:177], v193 offset:64
    ds_read_b64_tr_b16 v[178:179], v193 offset:4416
    s_waitcnt vmcnt(4)
    v_mfma_f32_16x16x32_bf16 a[20:23], v[168:171], v[164:167], 0
    buffer_load_dwordx4 v197, s[8:11], s30 offen nt lds
    v_cmp_gt_u32 vcc, 8, v198
    s_nop 1
    v_cndmask_b32 v247, v189, v188, vcc
    v_mfma_f32_16x16x32_bf16 v[120:123], v[184:187], v[144:147], 0
    s_add_u32 m0, s40, 4416
    s_waitcnt lgkmcnt(2)
    v_mfma_f32_16x16x32_bf16 a[24:27], v[172:175], v[144:147], 0
    v_mfma_f32_16x16x32_bf16 a[28:31], v[172:175], v[148:151], 0
    v_and_b32 v188, 15, v198
    v_mul_u32_u24 v188, 2304, v188
    v_mfma_f32_16x16x32_bf16 a[32:35], v[172:175], v[152:155], 0
    v_lshrrev_b32 v189, 4, v198
    v_lshl_add_u32 v245, v189, 3, v188
    v_mfma_f32_16x16x32_bf16 a[36:39], v[172:175], v[156:159], 0
    v_mfma_f32_16x16x32_bf16 a[40:43], v[172:175], v[160:163], 0
    ds_read_b64_tr_b16 v[180:181], v194 offset:64
    ds_read_b64_tr_b16 v[182:183], v194 offset:4416
    v_bfe_u32 v188, v198, 2, 2
    v_cmp_eq_u32 vcc, v188, v189
    v_mfma_f32_16x16x32_bf16 a[44:47], v[172:175], v[164:167], 0
    v_and_b32 v188, 1, v198
    v_lshlrev_b32 v188, 4, v188
    v_mfma_f32_16x16x32_bf16 v[124:127], v[184:187], v[148:151], 0
    v_lshlrev_b32_e64 v188, v188, 1
    v_mul_u32_u24 v188, 0x3f80, v188
    s_waitcnt lgkmcnt(2)
    v_mfma_f32_16x16x32_bf16 a[48:51], v[176:179], v[144:147], 0
    v_cndmask_b32 v188, 0, v188, vcc
    v_and_b32 v189, 2, v198
    v_cmp_eq_u32 vcc, 0, v189
    v_mfma_f32_16x16x32_bf16 a[52:55], v[176:179], v[148:151], 0
    s_waitcnt vmcnt(4)
    v_mov_b32 v248, 0
    v_mov_b32 v249, 0
    v_mfma_f32_16x16x32_bf16 a[56:59], v[176:179], v[152:155], 0
    buffer_load_dwordx4 v197, s[8:11], s30 offen offset:1024 nt lds
    v_cndmask_b32 v250, 0, v188, vcc
    v_sub_u32 v251, v188, v250
    v_mfma_f32_16x16x32_bf16 a[60:63], v[176:179], v[156:159], 0
    s_add_u32 m0, s40, 4480
    v_mov_b32 v252, 0
    v_mov_b32 v253, 0
    v_mfma_f32_16x16x32_bf16 a[64:67], v[176:179], v[160:163], 0
    ds_read_b64_tr_b16 v[168:169], v195 offset:0
    ds_read_b64_tr_b16 v[170:171], v195 offset:4352
    s_lshl_b32 s85, s3, 10
    v_mfma_f32_16x16x32_bf16 a[68:71], v[176:179], v[164:167], 0
    v_mfma_f32_16x16x32_bf16 v[128:131], v[184:187], v[152:155], 0
    s_waitcnt lgkmcnt(2)
    v_mfma_f32_16x16x32_bf16 a[72:75], v[180:183], v[144:147], 0
    v_mfma_f32_16x16x32_bf16 a[76:79], v[180:183], v[148:151], 0
    v_mfma_f32_16x16x32_bf16 a[80:83], v[180:183], v[152:155], 0
    v_mfma_f32_16x16x32_bf16 a[84:87], v[180:183], v[156:159], 0
    v_mfma_f32_16x16x32_bf16 a[88:91], v[180:183], v[160:163], 0
    ds_read_b64_tr_b16 v[172:173], v196 offset:0
    ds_read_b64_tr_b16 v[174:175], v196 offset:4352
    v_mfma_f32_16x16x32_bf16 a[92:95], v[180:183], v[164:167], 0
    s_waitcnt vmcnt(3)
    v_mfma_f32_16x16x32_bf16 v[132:135], v[184:187], v[156:159], 0
    buffer_load_dwordx4 v197, s[8:11], s30 offen offset:2048 nt lds
    s_waitcnt lgkmcnt(2)
    v_mfma_f32_16x16x32_bf16 a[96:99], v[168:171], v[144:147], 0
    s_add_u32 m0, s40, 4544
    v_mfma_f32_16x16x32_bf16 a[100:103], v[168:171], v[148:151], 0
    v_mfma_f32_16x16x32_bf16 a[104:107], v[168:171], v[152:155], 0
    v_mfma_f32_16x16x32_bf16 a[108:111], v[168:171], v[156:159], 0
    v_mfma_f32_16x16x32_bf16 a[112:115], v[168:171], v[160:163], 0
    ds_read_b64_tr_b16 v[176:177], v195 offset:64
    ds_read_b64_tr_b16 v[178:179], v195 offset:4416
    v_mfma_f32_16x16x32_bf16 a[116:119], v[168:171], v[164:167], 0
    v_mfma_f32_16x16x32_bf16 v[136:139], v[184:187], v[160:163], 0
    s_waitcnt lgkmcnt(2)
    v_mfma_f32_16x16x32_bf16 a[120:123], v[172:175], v[144:147], 0
    v_mfma_f32_16x16x32_bf16 a[124:127], v[172:175], v[148:151], 0
    v_mfma_f32_16x16x32_bf16 a[128:131], v[172:175], v[152:155], 0
    s_waitcnt vmcnt(4)
    s_waitcnt vmcnt(8)
    s_barrier
    v_mfma_f32_16x16x32_bf16 a[132:135], v[172:175], v[156:159], 0
    ds_read_b64_tr_b16 v[180:181], v196 offset:64
    ds_read_b64_tr_b16 v[182:183], v196 offset:4416
    buffer_load_dwordx4 v197, s[8:11], s30 offen offset:3072 nt lds
    v_mfma_f32_16x16x32_bf16 a[136:139], v[172:175], v[160:163], 0
    v_mfma_f32_16x16x32_bf16 a[140:143], v[172:175], v[164:167], 0
    v_mfma_f32_16x16x32_bf16 v[140:143], v[184:187], v[164:167], 0
    s_waitcnt lgkmcnt(2)
    v_mfma_f32_16x16x32_bf16 a[144:147], v[176:179], v[144:147], 0
    s_add_u32 s29, s29, 8192
    s_and_b32 s29, s29, 0x3ffff
    v_mfma_f32_16x16x32_bf16 a[148:151], v[176:179], v[148:151], 0
    s_add_u32 s30, s29, 4096
    v_mfma_f32_16x16x32_bf16 a[152:155], v[176:179], v[152:155], 0
    ds_read_b128 v[168:171], v192 offset:17408
    v_mfma_f32_16x16x32_bf16 a[156:159], v[176:179], v[156:159], 0
    v_mfma_f32_16x16x32_bf16 a[160:163], v[176:179], v[160:163], 0
    v_mfma_f32_16x16x32_bf16 a[164:167], v[176:179], v[164:167], 0
    s_waitcnt lgkmcnt(1)
    v_mfma_f32_16x16x32_bf16 a[168:171], v[180:183], v[144:147], 0
    s_waitcnt vmcnt(8)
    s_barrier
    v_mfma_f32_16x16x32_bf16 a[172:175], v[180:183], v[148:151], 0
    v_mfma_f32_16x16x32_bf16 a[176:179], v[180:183], v[152:155], 0
    ds_read_b128 v[172:175], v192 offset:17472
    v_max3_f32 v232, v48, v49, v50
    v_max3_f32 v232, v232, v51, v52
    v_max3_f32 v232, v232, v53, v54
    v_max3_f32 v232, v232, v55, v56
    v_max3_f32 v232, v232, v57, v58
    v_max3_f32 v232, v232, v59, v60
    v_max3_f32 v232, v232, v61, v62
    v_max3_f32 v232, v232, v63, v64
    v_max3_f32 v232, v232, v65, v66
    v_max3_f32 v232, v232, v67, v68
    v_max3_f32 v232, v232, v69, v70
    v_max3_f32 v232, v232, v71, v72
    v_max3_f32 v232, v232, v73, v74
    v_max3_f32 v232, v232, v75, v76
    v_max3_f32 v232, v232, v77, v78
    v_max3_f32 v232, v232, v79, v80
    v_max3_f32 v232, v232, v81, v82
    v_max3_f32 v232, v232, v83, v84
    v_max3_f32 v232, v232, v85, v86
    v_max3_f32 v232, v232, v87, v88
    v_max3_f32 v232, v232, v89, v90
    v_max3_f32 v232, v232, v91, v92
    v_max3_f32 v232, v232, v93, v94
    v_max3_f32 v232, v232, v95, v95
    v_mfma_f32_16x16x32_bf16 a[180:183], v[180:183], v[156:159], 0
    v_cmp_lt_f32 vcc, s76, v232
    v_mfma_f32_16x16x32_bf16 a[184:187], v[180:183], v[160:163], 0
    v_mfma_f32_16x16x32_bf16 a[188:191], v[180:183], v[164:167], 0
    s_cbranch_vccnz L_rare_0
L_back_0:
.p2align 3
L_loops0:
    s_waitcnt lgkmcnt(1)
    v_mfma_f32_16x16x32_bf16 v[0:3], v[168:171], a[192:195], v[96:99]
    s_add_u32 m0, s41, 0
    ds_read_b128 v[176:179], v192 offset:17536
    v_mfma_f32_16x16x32_bf16 v[4:7], v[168:171], a[208:211], v[100:103]
    v_exp_f32 v48, v48
    v_exp_f32 v49, v49
    v_mfma_f32_16x16x32_bf16 v[8:11], v[168:171], a[224:227], v[104:107]
    s_waitcnt vmcnt(3)
    v_cvt_pk_bf16_f32 v144, v48, v49
    v_mfma_f32_16x16x32_bf16 v[12:15], v[168:171], a[240:243], v[108:111]
    ds_read_b128 v[180:183], v192 offset:17600
    buffer_load_dwordx4 v197, s[8:11], s29 offen nt lds
    v_mfma_f32_16x16x32_bf16 v[16:19], v[168:171], v[200:203], v[112:115]
    s_add_u32 m0, s41, 64
    v_mfma_f32_16x16x32_bf16 v[20:23], v[168:171], v[216:219], v[116:119]
    v_exp_f32 v50, v50
    v_exp_f32 v51, v51
    s_waitcnt lgkmcnt(2)
    v_mfma_f32_16x16x32_bf16 v[0:3], v[172:175], a[196:199], v[0:3]
    v_exp_f32 v72, v72
    v_mfma_f32_16x16x32_bf16 v[4:7], v[172:175], a[212:215], v[4:7]
    v_exp_f32 v73, v73
    v_mfma_f32_16x16x32_bf16 v[8:11], v[172:175], a[228:231], v[8:11]
    v_exp_f32 v74, v74
    v_cvt_pk_bf16_f32 v145, v50, v51
    v_mfma_f32_16x16x32_bf16 v[12:15], v[172:175], a[244:247], v[12:15]
    ds_read_b128 v[168:171], v192 offset:21760
    v_exp_f32 v75, v75
    v_mfma_f32_16x16x32_bf16 v[16:19], v[172:175], v[204:207], v[16:19]
    v_exp_f32 v52, v52
    v_mfma_f32_16x16x32_bf16 v[20:23], v[172:175], v[220:223], v[20:23]
    v_exp_f32 v53, v53
    s_waitcnt lgkmcnt(2)
    v_mfma_f32_16x16x32_bf16 v[0:3], v[176:179], a[200:203], v[0:3]
    v_exp_f32 v54, v54
    v_cvt_pk_bf16_f32 v146, v72, v73
    v_mfma_f32_16x16x32_bf16 v[4:7], v[176:179], a[216:219], v[4:7]
    s_waitcnt vmcnt(4)
    buffer_load_dwordx4 v197, s[8:11], s29 offen offset:1024 nt lds
    v_mfma_f32_16x16x32_bf16 v[8:11], v[176:179], a[232:235], v[8:11]
    s_add_u32 m0, s41, 128
    v_cvt_pk_bf16_f32 v147, v74, v75
    v_mfma_f32_16x16x32_bf16 v[12:15], v[176:179], a[248:251], v[12:15]
    ds_read_b128 v[172:175], v192 offset:21824
    v_exp_f32 v55, v55
    v_mfma_f32_16x16x32_bf16 v[16:19], v[176:179], v[208:211], v[16:19]
    v_exp_f32 v76, v76
    v_mfma_f32_16x16x32_bf16 v[20:23], v[176:179], v[224:227], v[20:23]
    v_exp_f32 v77, v77
    s_waitcnt lgkmcnt(2)
    v_mfma_f32_16x16x32_bf16 v[0:3], v[180:183], a[204:207], v[0:3]
    v_exp_f32 v78, v78
    v_cvt_pk_bf16_f32 v148, v52, v53
    v_mfma_f32_16x16x32_bf16 v[4:7], v[180:183], a[220:223], v[4:7]
    v_exp_f32 v79, v79
    v_mfma_f32_16x16x32_bf16 v[8:11], v[180:183], a[236:239], v[8:11]
    v_exp_f32 v56, v56
    v_cvt_pk_bf16_f32 v149, v54, v55
    v_mfma_f32_16x16x32_bf16 v[12:15], v[180:183], a[252:255], v[12:15]
    ds_read_b128 v[176:179], v192 offset:21888
    v_exp_f32 v57, v57
    v_mfma_f32_16x16x32_bf16 v[16:19], v[180:183], v[212:215], v[16:19]
    v_exp_f32 v58, v58
    v_mfma_f32_16x16x32_bf16 v[20:23], v[180:183], v[228:231], v[20:23]
    v_exp_f32 v59, v59
    s_waitcnt lgkmcnt(2)
    v_mfma_f32_16x16x32_bf16 v[24:27], v[168:171], a[192:195], v[96:99]
    s_waitcnt vmcnt(4)
    buffer_load_dwordx4 v197, s[8:11], s29 offen offset:2048 nt lds
    v_mfma_f32_16x16x32_bf16 v[28:31], v[168:171], a[208:211], v[100:103]
    s_add_u32 m0, s41, 192
    v_exp_f32 v80, v80
    v_mfma_f32_16x16x32_bf16 v[32:35], v[168:171], a[224:227], v[104:107]
    v_exp_f32 v81, v81
    v_mfma_f32_16x16x32_bf16 v[36:39], v[168:171], a[240:243], v[108:111]
    ds_read_b128 v[180:183], v192 offset:21952
    v_exp_f32 v82, v82
    v_mfma_f32_16x16x32_bf16 v[40:43], v[168:171], v[200:203], v[112:115]
    v_exp_f32 v83, v83
    v_mfma_f32_16x16x32_bf16 v[44:47], v[168:171], v[216:219], v[116:119]
    v_cvt_pk_bf16_f32 v150, v76, v77
    v_cvt_pk_bf16_f32 v151, v78, v79
    s_waitcnt lgkmcnt(2)
    v_mfma_f32_16x16x32_bf16 v[24:27], v[172:175], a[196:199], v[24:27]
    v_exp_f32 v60, v60
    v_cvt_pk_bf16_f32 v152, v56, v57
    v_mfma_f32_16x16x32_bf16 v[28:31], v[172:175], a[212:215], v[28:31]
    v_exp_f32 v61, v61
    v_mfma_f32_16x16x32_bf16 v[32:35], v[172:175], a[228:231], v[32:35]
    v_exp_f32 v62, v62
    v_cvt_pk_bf16_f32 v153, v58, v59
    v_mfma_f32_16x16x32_bf16 v[36:39], v[172:175], a[244:247], v[36:39]
    ds_read_b64_tr_b16 v[168:169], v193 offset:8704
    ds_read_b64_tr_b16 v[170:171], v193 offset:13056
    v_mfma_f32_16x16x32_bf16 v[40:43], v[172:175], v[204:207], v[40:43]
    v_exp_f32 v63, v63
    v_cvt_pk_bf16_f32 v154, v80, v81
    v_mfma_f32_16x16x32_bf16 v[44:47], v[172:175], v[220:223], v[44:47]
    s_waitcnt vmcnt(3)
    buffer_load_dwordx4 v197, s[8:11], s29 offen offset:3072 nt lds
    s_waitcnt lgkmcnt(3)
    v_mfma_f32_16x16x32_bf16 v[24:27], v[176:179], a[200:203], v[24:27]
    s_add_u32 m0, s41, 4352
    v_cvt_pk_bf16_f32 v155, v82, v83
    v_mfma_f32_16x16x32_bf16 v[28:31], v[176:179], a[216:219], v[28:31]
    v_exp_f32 v84, v84
    v_mfma_f32_16x16x32_bf16 v[32:35], v[176:179], a[232:235], v[32:35]
    v_exp_f32 v85, v85
    v_cvt_pk_bf16_f32 v156, v60, v61
    v_mfma_f32_16x16x32_bf16 v[36:39], v[176:179], a[248:251], v[36:39]
    v_exp_f32 v86, v86
    v_mfma_f32_16x16x32_bf16 v[40:43], v[176:179], v[208:211], v[40:43]
    ds_read_b64_tr_b16 v[172:173], v194 offset:8704
    ds_read_b64_tr_b16 v[174:175], v194 offset:13056
    v_cvt_pk_bf16_f32 v157, v62, v63
    v_mfma_f32_16x16x32_bf16 v[44:47], v[176:179], v[224:227], v[44:47]
    v_exp_f32 v87, v87
    s_waitcnt lgkmcnt(4)
    v_mfma_f32_16x16x32_bf16 v[24:27], v[180:183], a[204:207], v[24:27]
    v_exp_f32 v64, v64
    v_cvt_pk_bf16_f32 v158, v84, v85
    v_mfma_f32_16x16x32_bf16 v[28:31], v[180:183], a[220:223], v[28:31]
    v_exp_f32 v65, v65
    v_mfma_f32_16x16x32_bf16 v[32:35], v[180:183], a[236:239], v[32:35]
    v_exp_f32 v66, v66
    v_cvt_pk_bf16_f32 v159, v86, v87
    v_mfma_f32_16x16x32_bf16 v[36:39], v[180:183], a[252:255], v[36:39]
    v_exp_f32 v67, v67
    v_mfma_f32_16x16x32_bf16 v[40:43], v[180:183], v[212:215], v[40:43]
    v_exp_f32 v88, v88
    v_cvt_pk_bf16_f32 v160, v64, v65
    v_mfma_f32_16x16x32_bf16 v[44:47], v[180:183], v[228:231], v[44:47]
    v_exp_f32 v89, v89
    s_waitcnt lgkmcnt(2)
    v_mfma_f32_16x16x32_bf16 a[0:3], v[168:171], v[144:147], a[0:3]
    v_exp_f32 v90, v90
    v_exp_f32 v91, v91
    v_mfma_f32_16x16x32_bf16 a[4:7], v[168:171], v[148:151], a[4:7]
    v_exp_f32 v68, v68
    v_exp_f32 v69, v69
    v_exp_f32 v70, v70
    v_exp_f32 v71, v71
    v_exp_f32 v92, v92
    v_exp_f32 v93, v93
    v_exp_f32 v94, v94
    v_exp_f32 v95, v95
    v_cvt_pk_bf16_f32 v161, v66, v67
    v_cvt_pk_bf16_f32 v162, v88, v89
    v_cvt_pk_bf16_f32 v163, v90, v91
    v_mfma_f32_16x16x32_bf16 a[8:11], v[168:171], v[152:155], a[8:11]
    v_cvt_pk_bf16_f32 v164, v68, v69
    v_cvt_pk_bf16_f32 v165, v70, v71
    v_cvt_pk_bf16_f32 v166, v92, v93
    v_cvt_pk_bf16_f32 v167, v94, v95
    v_mfma_f32_16x16x32_bf16 a[12:15], v[168:171], v[156:159], a[12:15]
    v_mfma_f32_16x16x32_bf16 a[16:19], v[168:171], v[160:163], a[16:19]
    ds_read_b64_tr_b16 v[176:177], v193 offset:8768
    ds_read_b64_tr_b16 v[178:179], v193 offset:13120
    s_waitcnt vmcnt(4)
    v_mfma_f32_16x16x32_bf16 a[20:23], v[168:171], v[164:167], a[20:23]
    buffer_load_dwordx4 v197, s[8:11], s30 offen nt lds
    v_mfma_f32_16x16x32_bf16 v[120:123], v[184:187], v[144:147], v[120:123]
    s_add_u32 m0, s41, 4416
    s_waitcnt lgkmcnt(2)
    v_mfma_f32_16x16x32_bf16 a[24:27], v[172:175], v[144:147], a[24:27]
    v_mfma_f32_16x16x32_bf16 a[28:31], v[172:175], v[148:151], a[28:31]
    v_mfma_f32_16x16x32_bf16 a[32:35], v[172:175], v[152:155], a[32:35]
    v_mfma_f32_16x16x32_bf16 a[36:39], v[172:175], v[156:159], a[36:39]
    v_mfma_f32_16x16x32_bf16 a[40:43], v[172:175], v[160:163], a[40:43]
    ds_read_b64_tr_b16 v[180:181], v194 offset:8768
    ds_read_b64_tr_b16 v[182:183], v194 offset:13120
    v_mfma_f32_16x16x32_bf16 a[44:47], v[172:175], v[164:167], a[44:47]
    v_mfma_f32_16x16x32_bf16 v[124:127], v[184:187], v[148:151], v[124:127]
    s_waitcnt lgkmcnt(2)
    v_mfma_f32_16x16x32_bf16 a[48:51], v[176:179], v[144:147], a[48:51]
    s_waitcnt vmcnt(4)
    buffer_load_dwordx4 v197, s[8:11], s30 offen offset:1024 nt lds
    v_mfma_f32_16x16x32_bf16 a[52:55], v[176:179], v[148:151], a[52:55]
    s_add_u32 m0, s41, 4480
    ds_read_b64_tr_b16 v[168:169], v195 offset:8704
    ds_read_b64_tr_b16 v[170:171], v195 offset:13056
    v_mfma_f32_16x16x32_bf16 a[56:59], v[176:179], v[152:155], a[56:59]
    v_max3_f32 v232, v0, v1, v2
    v_max3_f32 v232, v232, v3, v4
    v_mfma_f32_16x16x32_bf16 a[60:63], v[176:179], v[156:159], a[60:63]
    v_max3_f32 v232, v232, v5, v6
    v_max3_f32 v232, v232, v7, v8
    v_mfma_f32_16x16x32_bf16 a[64:67], v[176:179], v[160:163], a[64:67]
    v_max3_f32 v232, v232, v9, v10
    v_max3_f32 v232, v232, v11, v12
    v_max3_f32 v232, v232, v13, v14
    v_mfma_f32_16x16x32_bf16 a[68:71], v[176:179], v[164:167], a[68:71]
    v_max3_f32 v232, v232, v15, v16
    v_max3_f32 v232, v232, v17, v18
    v_mfma_f32_16x16x32_bf16 v[128:131], v[184:187], v[152:155], v[128:131]
    ds_read_b64_tr_b16 v[172:173], v196 offset:8704
    ds_read_b64_tr_b16 v[174:175], v196 offset:13056
    s_waitcnt vmcnt(3)
    s_waitcnt lgkmcnt(4)
    v_mfma_f32_16x16x32_bf16 a[72:75], v[180:183], v[144:147], a[72:75]
    buffer_load_dwordx4 v197, s[8:11], s30 offen offset:2048 nt lds
    v_mfma_f32_16x16x32_bf16 a[76:79], v[180:183], v[148:151], a[76:79]
    s_add_u32 m0, s41, 4544
    v_max3_f32 v232, v232, v19, v20
    v_max3_f32 v232, v232, v21, v22
    v_mfma_f32_16x16x32_bf16 a[80:83], v[180:183], v[152:155], a[80:83]
    v_max3_f32 v232, v232, v23, v24
    v_max3_f32 v232, v232, v25, v26
    v_mfma_f32_16x16x32_bf16 a[84:87], v[180:183], v[156:159], a[84:87]
    v_max3_f32 v232, v232, v27, v28
    v_max3_f32 v232, v232, v29, v30
    v_max3_f32 v232, v232, v31, v32
    v_mfma_f32_16x16x32_bf16 a[88:91], v[180:183], v[160:163], a[88:91]
    v_max3_f32 v232, v232, v33, v34
    v_max3_f32 v232, v232, v35, v36
    v_mfma_f32_16x16x32_bf16 a[92:95], v[180:183], v[164:167], a[92:95]
    v_max3_f32 v232, v232, v37, v38
    v_max3_f32 v232, v232, v39, v40
    v_max3_f32 v232, v232, v41, v42
    v_mfma_f32_16x16x32_bf16 v[132:135], v[184:187], v[156:159], v[132:135]
    ds_read_b64_tr_b16 v[176:177], v195 offset:8768
    ds_read_b64_tr_b16 v[178:179], v195 offset:13120
    s_waitcnt lgkmcnt(4)
    v_mfma_f32_16x16x32_bf16 a[96:99], v[168:171], v[144:147], a[96:99]
    v_max3_f32 v232, v232, v43, v44
    v_max3_f32 v232, v232, v45, v46
    v_max3_f32 v232, v232, v47, v47
    v_mfma_f32_16x16x32_bf16 a[100:103], v[168:171], v[148:151], a[100:103]
    v_cmp_lt_f32 vcc, s76, v232
    v_mfma_f32_16x16x32_bf16 a[104:107], v[168:171], v[152:155], a[104:107]
    v_mfma_f32_16x16x32_bf16 a[108:111], v[168:171], v[156:159], a[108:111]
    s_waitcnt vmcnt(4)
    buffer_load_dwordx4 v197, s[8:11], s30 offen offset:3072 nt lds
    v_mfma_f32_16x16x32_bf16 a[112:115], v[168:171], v[160:163], a[112:115]
    v_mfma_f32_16x16x32_bf16 a[116:119], v[168:171], v[164:167], a[116:119]
    ds_read_b64_tr_b16 v[180:181], v196 offset:8768
    ds_read_b64_tr_b16 v[182:183], v196 offset:13120
    v_mfma_f32_16x16x32_bf16 v[136:139], v[184:187], v[160:163], v[136:139]
    s_waitcnt lgkmcnt(4)
    v_mfma_f32_16x16x32_bf16 a[120:123], v[172:175], v[144:147], a[120:123]
    v_mfma_f32_16x16x32_bf16 a[124:127], v[172:175], v[148:151], a[124:127]
    v_mfma_f32_16x16x32_bf16 a[128:131], v[172:175], v[152:155], a[128:131]
    v_mfma_f32_16x16x32_bf16 a[132:135], v[172:175], v[156:159], a[132:135]
    v_mfma_f32_16x16x32_bf16 a[136:139], v[172:175], v[160:163], a[136:139]
    ds_read_b128 v[168:171], v192 offset:26112
    v_mfma_f32_16x16x32_bf16 a[140:143], v[172:175], v[164:167], a[140:143]
    s_add_u32 s29, s29, 8192
    s_and_b32 s29, s29, 0x3ffff
    s_add_u32 s30, s29, 4096
    v_mfma_f32_16x16x32_bf16 v[140:143], v[184:187], v[164:167], v[140:143]
    s_waitcnt lgkmcnt(3)
    v_mfma_f32_16x16x32_bf16 a[144:147], v[176:179], v[144:147], a[144:147]
    v_mfma_f32_16x16x32_bf16 a[148:151], v[176:179], v[148:151], a[148:151]
    v_mfma_f32_16x16x32_bf16 a[152:155], v[176:179], v[152:155], a[152:155]
    v_mfma_f32_16x16x32_bf16 a[156:159], v[176:179], v[156:159], a[156:159]
    ds_read_b128 v[172:175], v192 offset:26176
    v_mfma_f32_16x16x32_bf16 a[160:163], v[176:179], v[160:163], a[160:163]
    v_mfma_f32_16x16x32_bf16 a[164:167], v[176:179], v[164:167], a[164:167]
    s_waitcnt lgkmcnt(2)
    v_mfma_f32_16x16x32_bf16 a[168:171], v[180:183], v[144:147], a[168:171]
    s_waitcnt vmcnt(8)
    s_barrier
    v_mfma_f32_16x16x32_bf16 a[172:175], v[180:183], v[148:151], a[172:175]
    v_mfma_f32_16x16x32_bf16 a[176:179], v[180:183], v[152:155], a[176:179]
    v_mfma_f32_16x16x32_bf16 a[180:183], v[180:183], v[156:159], a[180:183]
    v_mfma_f32_16x16x32_bf16 a[184:187], v[180:183], v[160:163], a[184:187]
    v_mfma_f32_16x16x32_bf16 a[188:191], v[180:183], v[164:167], a[188:191]
    s_cbranch_vccnz L_rare_1
L_back_1:
    s_waitcnt lgkmcnt(1)
    v_mfma_f32_16x16x32_bf16 v[48:51], v[168:171], a[192:195], v[96:99]
    s_add_u32 m0, s42, 0
    ds_read_b128 v[176:179], v192 offset:26240
    v_mfma_f32_16x16x32_bf16 v[52:55], v[168:171], a[208:211], v[100:103]
    v_exp_f32 v0, v0
    v_exp_f32 v1, v1
    v_mfma_f32_16x16x32_bf16 v[56:59], v[168:171], a[224:227], v[104:107]
    s_waitcnt vmcnt(3)
    v_cvt_pk_bf16_f32 v144, v0, v1
    v_mfma_f32_16x16x32_bf16 v[60:63], v[168:171], a[240:243], v[108:111]
    ds_read_b128 v[180:183], v192 offset:26304
    buffer_load_dwordx4 v197, s[8:11], s29 offen nt lds
    v_mfma_f32_16x16x32_bf16 v[64:67], v[168:171], v[200:203], v[112:115]
    s_add_u32 m0, s42, 64
    v_mfma_f32_16x16x32_bf16 v[68:71], v[168:171], v[216:219], v[116:119]
    v_exp_f32 v2, v2
    v_exp_f32 v3, v3
    s_waitcnt lgkmcnt(2)
    v_mfma_f32_16x16x32_bf16 v[48:51], v[172:175], a[196:199], v[48:51]
    v_exp_f32 v24, v24
    v_mfma_f32_16x16x32_bf16 v[52:55], v[172:175], a[212:215], v[52:55]
    v_exp_f32 v25, v25
    v_mfma_f32_16x16x32_bf16 v[56:59], v[172:175], a[228:231], v[56:59]
    v_exp_f32 v26, v26
    v_cvt_pk_bf16_f32 v145, v2, v3
    v_mfma_f32_16x16x32_bf16 v[60:63], v[172:175], a[244:247], v[60:63]
    ds_read_b128 v[168:171], v192 offset:30464
    v_exp_f32 v27, v27
    v_mfma_f32_16x16x32_bf16 v[64:67], v[172:175], v[204:207], v[64:67]
    v_exp_f32 v4, v4
    v_mfma_f32_16x16x32_bf16 v[68:71], v[172:175], v[220:223], v[68:71]
    v_exp_f32 v5, v5
    s_waitcnt lgkmcnt(2)
    v_mfma_f32_16x16x32_bf16 v[48:51], v[176:179], a[200:203], v[48:51]
    v_exp_f32 v6, v6
    v_cvt_pk_bf16_f32 v146, v24, v25
    v_mfma_f32_16x16x32_bf16 v[52:55], v[176:179], a[216:219], v[52:55]
    s_waitcnt vmcnt(4)
    buffer_load_dwordx4 v197, s[8:11], s29 offen offset:1024 nt lds
    v_mfma_f32_16x16x32_bf16 v[56:59], v[176:179], a[232:235], v[56:59]
    s_add_u32 m0, s42, 128
    v_cvt_pk_bf16_f32 v147, v26, v27
    v_mfma_f32_16x16x32_bf16 v[60:63], v[176:179], a[248:251], v[60:63]
    ds_read_b128 v[172:175], v192 offset:30528
    v_exp_f32 v7, v7
    v_mfma_f32_16x16x32_bf16 v[64:67], v[176:179], v[208:211], v[64:67]
    v_exp_f32 v28, v28
    v_mfma_f32_16x16x32_bf16 v[68:71], v[176:179], v[224:227], v[68:71]
    v_exp_f32 v29, v29
    s_waitcnt lgkmcnt(2)
    v_mfma_f32_16x16x32_bf16 v[48:51], v[180:183], a[204:207], v[48:51]
    v_exp_f32 v30, v30
    v_cvt_pk_bf16_f32 v148, v4, v5
    v_mfma_f32_16x16x32_bf16 v[52:55], v[180:183], a[220:223], v[52:55]
    v_exp_f32 v31, v31
    v_mfma_f32_16x16x32_bf16 v[56:59], v[180:183], a[236:239], v[56:59]
    v_exp_f32 v8, v8
    v_cvt_pk_bf16_f32 v149, v6, v7
    v_mfma_f32_16x16x32_bf16 v[60:63], v[180:183], a[252:255], v[60:63]
    ds_read_b128 v[176:179], v192 offset:30592
    v_exp_f32 v9, v9
    v_mfma_f32_16x16x32_bf16 v[64:67], v[180:183], v[212:215], v[64:67]
    v_exp_f32 v10, v10
    v_mfma_f32_16x16x32_bf16 v[68:71], v[180:183], v[228:231], v[68:71]
    v_exp_f32 v11, v11
    s_waitcnt lgkmcnt(2)
    v_mfma_f32_16x16x32_bf16 v[72:75], v[168:171], a[192:195], v[96:99]
    s_waitcnt vmcnt(4)
    buffer_load_dwordx4 v197, s[8:11], s29 offen offset:2048 nt lds
    v_mfma_f32_16x16x32_bf16 v[76:79], v[168:171], a[208:211], v[100:103]
    s_add_u32 m0, s42, 192
    v_exp_f32 v32, v32
    v_mfma_f32_16x16x32_bf16 v[80:83], v[168:171], a[224:227], v[104:107]
    v_exp_f32 v33, v33
    v_mfma_f32_16x16x32_bf16 v[84:87], v[168:171], a[240:243], v[108:111]
    ds_read_b128 v[180:183], v192 offset:30656
    v_exp_f32 v34, v34
    v_mfma_f32_16x16x32_bf16 v[88:91], v[168:171], v[200:203], v[112:115]
    v_exp_f32 v35, v35
    v_mfma_f32_16x16x32_bf16 v[92:95], v[168:171], v[216:219], v[116:119]
    v_cvt_pk_bf16_f32 v150, v28, v29
    v_cvt_pk_bf16_f32 v151, v30, v31
    s_waitcnt lgkmcnt(2)
    v_mfma_f32_16x16x32_bf16 v[72:75], v[172:175], a[196:199], v[72:75]
    v_exp_f32 v12, v12
    v_cvt_pk_bf16_f32 v152, v8, v9
    v_mfma_f32_16x16x32_bf16 v[76:79], v[172:175], a[212:215], v[76:79]
    v_exp_f32 v13, v13
    v_mfma_f32_16x16x32_bf16 v[80:83], v[172:175], a[228:231], v[80:83]
    v_exp_f32 v14, v14
    v_cvt_pk_bf16_f32 v153, v10, v11
    v_mfma_f32_16x16x32_bf16 v[84:87], v[172:175], a[244:247], v[84:87]
    ds_read_b64_tr_b16 v[168:169], v193 offset:17408
    ds_read_b64_tr_b16 v[170:171], v193 offset:21760
    v_mfma_f32_16x16x32_bf16 v[88:91], v[172:175], v[204:207], v[88:91]
    v_exp_f32 v15, v15
    v_cvt_pk_bf16_f32 v154, v32, v33
    v_mfma_f32_16x16x32_bf16 v[92:95], v[172:175], v[220:223], v[92:95]
    s_waitcnt vmcnt(3)
    buffer_load_dwordx4 v197, s[8:11], s29 offen offset:3072 nt lds
    s_waitcnt lgkmcnt(3)
    v_mfma_f32_16x16x32_bf16 v[72:75], v[176:179], a[200:203], v[72:75]
    s_add_u32 m0, s42, 4352
    v_cvt_pk_bf16_f32 v155, v34, v35
    v_mfma_f32_16x16x32_bf16 v[76:79], v[176:179], a[216:219], v[76:79]
    v_exp_f32 v36, v36
    v_mfma_f32_16x16x32_bf16 v[80:83], v[176:179], a[232:235], v[80:83]
    v_exp_f32 v37, v37
    v_cvt_pk_bf16_f32 v156, v12, v13
    v_mfma_f32_16x16x32_bf16 v[84:87], v[176:179], a[248:251], v[84:87]
    v_exp_f32 v38, v38
    v_mfma_f32_16x16x32_bf16 v[88:91], v[176:179], v[208:211], v[88:91]
    ds_read_b64_tr_b16 v[172:173], v194 offset:17408
    ds_read_b64_tr_b16 v[174:175], v194 offset:21760
    v_cvt_pk_bf16_f32 v157, v14, v15
    v_mfma_f32_16x16x32_bf16 v[92:95], v[176:179], v[224:227], v[92:95]
    v_exp_f32 v39, v39
    s_waitcnt lgkmcnt(4)
    v_mfma_f32_16x16x32_bf16 v[72:75], v[180:183], a[204:207], v[72:75]
    v_exp_f32 v16, v16
    v_cvt_pk_bf16_f32 v158, v36, v37
    v_mfma_f32_16x16x32_bf16 v[76:79], v[180:183], a[220:223], v[76:79]
    v_exp_f32 v17, v17
    v_mfma_f32_16x16x32_bf16 v[80:83], v[180:183], a[236:239], v[80:83]
    v_exp_f32 v18, v18
    v_cvt_pk_bf16_f32 v159, v38, v39
    v_mfma_f32_16x16x32_bf16 v[84:87], v[180:183], a[252:255], v[84:87]
    v_exp_f32 v19, v19
    v_mfma_f32_16x16x32_bf16 v[88:91], v[180:183], v[212:215], v[88:91]
    v_exp_f32 v40, v40
    v_cvt_pk_bf16_f32 v160, v16, v17
    v_mfma_f32_16x16x32_bf16 v[92:95], v[180:183], v[228:231], v[92:95]
    v_exp_f32 v41, v41
    s_waitcnt lgkmcnt(2)
    v_mfma_f32_16x16x32_bf16 a[0:3], v[168:171], v[144:147], a[0:3]
    v_exp_f32 v42, v42
    v_exp_f32 v43, v43
    v_mfma_f32_16x16x32_bf16 a[4:7], v[168:171], v[148:151], a[4:7]
    v_exp_f32 v20, v20
    v_exp_f32 v21, v21
    v_exp_f32 v22, v22
    v_exp_f32 v23, v23
    v_exp_f32 v44, v44
    v_exp_f32 v45, v45
    v_exp_f32 v46, v46
    v_exp_f32 v47, v47
    v_cvt_pk_bf16_f32 v161, v18, v19
    v_cvt_pk_bf16_f32 v162, v40, v41
    v_cvt_pk_bf16_f32 v163, v42, v43
    v_mfma_f32_16x16x32_bf16 a[8:11], v[168:171], v[152:155], a[8:11]
    v_cvt_pk_bf16_f32 v164, v20, v21
    v_cvt_pk_bf16_f32 v165, v22, v23
    v_cvt_pk_bf16_f32 v166, v44, v45
    v_cvt_pk_bf16_f32 v167, v46, v47
    v_mfma_f32_16x16x32_bf16 a[12:15], v[168:171], v[156:159], a[12:15]
    v_mfma_f32_16x16x32_bf16 a[16:19], v[168:171], v[160:163], a[16:19]
    ds_read_b64_tr_b16 v[176:177], v193 offset:17472
    ds_read_b64_tr_b16 v[178:179], v193 offset:21824
    s_waitcnt vmcnt(4)
    v_mfma_f32_16x16x32_bf16 a[20:23], v[168:171], v[164:167], a[20:23]
    buffer_load_dwordx4 v197, s[8:11], s30 offen nt lds
    v_mfma_f32_16x16x32_bf16 v[120:123], v[184:187], v[144:147], v[120:123]
    s_add_u32 m0, s42, 4416
    s_waitcnt lgkmcnt(2)
    v_mfma_f32_16x16x32_bf16 a[24:27], v[172:175], v[144:147], a[24:27]
    v_mfma_f32_16x16x32_bf16 a[28:31], v[172:175], v[148:151], a[28:31]
    v_mfma_f32_16x16x32_bf16 a[32:35], v[172:175], v[152:155], a[32:35]
    v_mfma_f32_16x16x32_bf16 a[36:39], v[172:175], v[156:159], a[36:39]
    v_mfma_f32_16x16x32_bf16 a[40:43], v[172:175], v[160:163], a[40:43]
    ds_read_b64_tr_b16 v[180:181], v194 offset:17472
    ds_read_b64_tr_b16 v[182:183], v194 offset:21824
    v_mfma_f32_16x16x32_bf16 a[44:47], v[172:175], v[164:167], a[44:47]
    v_mfma_f32_16x16x32_bf16 v[124:127], v[184:187], v[148:151], v[124:127]
    s_waitcnt lgkmcnt(2)
    v_mfma_f32_16x16x32_bf16 a[48:51], v[176:179], v[144:147], a[48:51]
    s_waitcnt vmcnt(4)
    buffer_load_dwordx4 v197, s[8:11], s30 offen offset:1024 nt lds
    v_mfma_f32_16x16x32_bf16 a[52:55], v[176:179], v[148:151], a[52:55]
    s_add_u32 m0, s42, 4480
    ds_read_b64_tr_b16 v[168:169], v195 offset:17408
    ds_read_b64_tr_b16 v[170:171], v195 offset:21760
    v_mfma_f32_16x16x32_bf16 a[56:59], v[176:179], v[152:155], a[56:59]
    v_max3_f32 v232, v48, v49, v50
    v_max3_f32 v232, v232, v51, v52
    v_mfma_f32_16x16x32_bf16 a[60:63], v[176:179], v[156:159], a[60:63]
    v_max3_f32 v232, v232, v53, v54
    v_max3_f32 v232, v232, v55, v56
    v_mfma_f32_16x16x32_bf16 a[64:67], v[176:179], v[160:163], a[64:67]
    v_max3_f32 v232, v232, v57, v58
    v_max3_f32 v232, v232, v59, v60
    v_max3_f32 v232, v232, v61, v62
    v_mfma_f32_16x16x32_bf16 a[68:71], v[176:179], v[164:167], a[68:71]
    v_max3_f32 v232, v232, v63, v64
    v_max3_f32 v232, v232, v65, v66
    v_mfma_f32_16x16x32_bf16 v[128:131], v[184:187], v[152:155], v[128:131]
    ds_read_b64_tr_b16 v[172:173], v196 offset:17408
    ds_read_b64_tr_b16 v[174:175], v196 offset:21760
    s_waitcnt vmcnt(3)
    s_waitcnt lgkmcnt(4)
    v_mfma_f32_16x16x32_bf16 a[72:75], v[180:183], v[144:147], a[72:75]
    buffer_load_dwordx4 v197, s[8:11], s30 offen offset:2048 nt lds
    v_mfma_f32_16x16x32_bf16 a[76:79], v[180:183], v[148:151], a[76:79]
    s_add_u32 m0, s42, 4544
    v_max3_f32 v232, v232, v67, v68
    v_max3_f32 v232, v232, v69, v70
    v_mfma_f32_16x16x32_bf16 a[80:83], v[180:183], v[152:155], a[80:83]
    v_max3_f32 v232, v232, v71, v72
    v_max3_f32 v232, v232, v73, v74
    v_mfma_f32_16x16x32_bf16 a[84:87], v[180:183], v[156:159], a[84:87]
    v_max3_f32 v232, v232, v75, v76
    v_max3_f32 v232, v232, v77, v78
    v_max3_f32 v232, v232, v79, v80
    v_mfma_f32_16x16x32_bf16 a[88:91], v[180:183], v[160:163], a[88:91]
    v_max3_f32 v232, v232, v81, v82
    v_max3_f32 v232, v232, v83, v84
    v_mfma_f32_16x16x32_bf16 a[92:95], v[180:183], v[164:167], a[92:95]
    v_max3_f32 v232, v232, v85, v86
    v_max3_f32 v232, v232, v87, v88
    v_max3_f32 v232, v232, v89, v90
    v_mfma_f32_16x16x32_bf16 v[132:135], v[184:187], v[156:159], v[132:135]
    ds_read_b64_tr_b16 v[176:177], v195 offset:17472
    ds_read_b64_tr_b16 v[178:179], v195 offset:21824
    s_waitcnt lgkmcnt(4)
    v_mfma_f32_16x16x32_bf16 a[96:99], v[168:171], v[144:147], a[96:99]
    v_max3_f32 v232, v232, v91, v92
    v_max3_f32 v232, v232, v93, v94
    v_max3_f32 v232, v232, v95, v95
    v_mfma_f32_16x16x32_bf16 a[100:103], v[168:171], v[148:151], a[100:103]
    v_cmp_lt_f32 vcc, s76, v232
    v_mfma_f32_16x16x32_bf16 a[104:107], v[168:171], v[152:155], a[104:107]
    v_mfma_f32_16x16x32_bf16 a[108:111], v[168:171], v[156:159], a[108:111]
    s_waitcnt vmcnt(4)
    buffer_load_dwordx4 v197, s[8:11], s30 offen offset:3072 nt lds
    v_mfma_f32_16x16x32_bf16 a[112:115], v[168:171], v[160:163], a[112:115]
    v_mfma_f32_16x16x32_bf16 a[116:119], v[168:171], v[164:167], a[116:119]
    ds_read_b64_tr_b16 v[180:181], v196 offset:17472
    ds_read_b64_tr_b16 v[182:183], v196 offset:21824
    v_mfma_f32_16x16x32_bf16 v[136:139], v[184:187], v[160:163], v[136:139]
    s_waitcnt lgkmcnt(4)
    v_mfma_f32_16x16x32_bf16 a[120:123], v[172:175], v[144:147], a[120:123]
    v_mfma_f32_16x16x32_bf16 a[124:127], v[172:175], v[148:151], a[124:127]
    v_mfma_f32_16x16x32_bf16 a[128:131], v[172:175], v[152:155], a[128:131]
    v_mfma_f32_16x16x32_bf16 a[132:135], v[172:175], v[156:159], a[132:135]
    v_mfma_f32_16x16x32_bf16 a[136:139], v[172:175], v[160:163], a[136:139]
    ds_read_b128 v[168:171], v192 offset:0
    v_mfma_f32_16x16x32_bf16 a[140:143], v[172:175], v[164:167], a[140:143]
    s_add_u32 s29, s29, 8192
    s_and_b32 s29, s29, 0x3ffff
    s_add_u32 s30, s29, 4096
    v_mfma_f32_16x16x32_bf16 v[140:143], v[184:187], v[164:167], v[140:143]
    s_waitcnt lgkmcnt(3)
    v_mfma_f32_16x16x32_bf16 a[144:147], v[176:179], v[144:147], a[144:147]
    v_mfma_f32_16x16x32_bf16 a[148:151], v[176:179], v[148:151], a[148:151]
    v_mfma_f32_16x16x32_bf16 a[152:155], v[176:179], v[152:155], a[152:155]
    v_mfma_f32_16x16x32_bf16 a[156:159], v[176:179], v[156:159], a[156:159]
    ds_read_b128 v[172:175], v192 offset:64
    v_mfma_f32_16x16x32_bf16 a[160:163], v[176:179], v[160:163], a[160:163]
    v_mfma_f32_16x16x32_bf16 a[164:167], v[176:179], v[164:167], a[164:167]
    s_waitcnt lgkmcnt(2)
    v_mfma_f32_16x16x32_bf16 a[168:171], v[180:183], v[144:147], a[168:171]
    s_waitcnt vmcnt(8)
    s_barrier
    v_mfma_f32_16x16x32_bf16 a[172:175], v[180:183], v[148:151], a[172:175]
    v_mfma_f32_16x16x32_bf16 a[176:179], v[180:183], v[152:155], a[176:179]
    v_mfma_f32_16x16x32_bf16 a[180:183], v[180:183], v[156:159], a[180:183]
    v_mfma_f32_16x16x32_bf16 a[184:187], v[180:183], v[160:163], a[184:187]
    v_mfma_f32_16x16x32_bf16 a[188:191], v[180:183], v[164:167], a[188:191]
    s_cbranch_vccnz L_rare_2
L_back_2:
    s_waitcnt lgkmcnt(1)
    v_mfma_f32_16x16x32_bf16 v[0:3], v[168:171], a[192:195], v[96:99]
    s_add_u32 m0, s43, 0
    ds_read_b128 v[176:179], v192 offset:128
    v_mfma_f32_16x16x32_bf16 v[4:7], v[168:171], a[208:211], v[100:103]
    v_exp_f32 v48, v48
    v_exp_f32 v49, v49
    v_mfma_f32_16x16x32_bf16 v[8:11], v[168:171], a[224:227], v[104:107]
    s_waitcnt vmcnt(3)
    v_cvt_pk_bf16_f32 v144, v48, v49
    v_mfma_f32_16x16x32_bf16 v[12:15], v[168:171], a[240:243], v[108:111]
    ds_read_b128 v[180:183], v192 offset:192
    buffer_load_dwordx4 v197, s[8:11], s29 offen nt lds
    v_mfma_f32_16x16x32_bf16 v[16:19], v[168:171], v[200:203], v[112:115]
    s_add_u32 m0, s43, 64
    v_mfma_f32_16x16x32_bf16 v[20:23], v[168:171], v[216:219], v[116:119]
    v_exp_f32 v50, v50
    v_exp_f32 v51, v51
    s_waitcnt lgkmcnt(2)
    v_mfma_f32_16x16x32_bf16 v[0:3], v[172:175], a[196:199], v[0:3]
    v_exp_f32 v72, v72
    v_mfma_f32_16x16x32_bf16 v[4:7], v[172:175], a[212:215], v[4:7]
    v_exp_f32 v73, v73
    v_mfma_f32_16x16x32_bf16 v[8:11], v[172:175], a[228:231], v[8:11]
    v_exp_f32 v74, v74
    v_cvt_pk_bf16_f32 v145, v50, v51
    v_mfma_f32_16x16x32_bf16 v[12:15], v[172:175], a[244:247], v[12:15]
    ds_read_b128 v[168:171], v192 offset:4352
    v_exp_f32 v75, v75
    v_mfma_f32_16x16x32_bf16 v[16:19], v[172:175], v[204:207], v[16:19]
    v_exp_f32 v52, v52
    v_mfma_f32_16x16x32_bf16 v[20:23], v[172:175], v[220:223], v[20:23]
    v_exp_f32 v53, v53
    s_waitcnt lgkmcnt(2)
    v_mfma_f32_16x16x32_bf16 v[0:3], v[176:179], a[200:203], v[0:3]
    v_exp_f32 v54, v54
    v_cvt_pk_bf16_f32 v146, v72, v73
    v_mfma_f32_16x16x32_bf16 v[4:7], v[176:179], a[216:219], v[4:7]
    s_waitcnt vmcnt(4)
    buffer_load_dwordx4 v197, s[8:11], s29 offen offset:1024 nt lds
    v_mfma_f32_16x16x32_bf16 v[8:11], v[176:179], a[232:235], v[8:11]
    s_add_u32 m0, s43, 128
    v_cvt_pk_bf16_f32 v147, v74, v75
    v_mfma_f32_16x16x32_bf16 v[12:15], v[176:179], a[248:251], v[12:15]
    ds_read_b128 v[172:175], v192 offset:4416
    v_exp_f32 v55, v55
    v_mfma_f32_16x16x32_bf16 v[16:19], v[176:179], v[208:211], v[16:19]
    v_exp_f32 v76, v76
    v_mfma_f32_16x16x32_bf16 v[20:23], v[176:179], v[224:227], v[20:23]
    v_exp_f32 v77, v77
    s_waitcnt lgkmcnt(2)
    v_mfma_f32_16x16x32_bf16 v[0:3], v[180:183], a[204:207], v[0:3]
    v_exp_f32 v78, v78
    v_cvt_pk_bf16_f32 v148, v52, v53
    v_mfma_f32_16x16x32_bf16 v[4:7], v[180:183], a[220:223], v[4:7]
    v_exp_f32 v79, v79
    v_mfma_f32_16x16x32_bf16 v[8:11], v[180:183], a[236:239], v[8:11]
    v_exp_f32 v56, v56
    v_cvt_pk_bf16_f32 v149, v54, v55
    v_mfma_f32_16x16x32_bf16 v[12:15], v[180:183], a[252:255], v[12:15]
    ds_read_b128 v[176:179], v192 offset:4480
    v_exp_f32 v57, v57
    v_mfma_f32_16x16x32_bf16 v[16:19], v[180:183], v[212:215], v[16:19]
    v_exp_f32 v58, v58
    v_mfma_f32_16x16x32_bf16 v[20:23], v[180:183], v[228:231], v[20:23]
    v_exp_f32 v59, v59
    s_waitcnt lgkmcnt(2)
    v_mfma_f32_16x16x32_bf16 v[24:27], v[168:171], a[192:195], v[96:99]
    s_waitcnt vmcnt(4)
    buffer_load_dwordx4 v197, s[8:11], s29 offen offset:2048 nt lds
    v_mfma_f32_16x16x32_bf16 v[28:31], v[168:171], a[208:211], v[100:103]
    s_add_u32 m0, s43, 192
    v_exp_f32 v80, v80
    v_mfma_f32_16x16x32_bf16 v[32:35], v[168:171], a[224:227], v[104:107]
    v_exp_f32 v81, v81
    v_mfma_f32_16x16x32_bf16 v[36:39], v[168:171], a[240:243], v[108:111]
    ds_read_b128 v[180:183], v192 offset:4544
    v_exp_f32 v82, v82
    v_mfma_f32_16x16x32_bf16 v[40:43], v[168:171], v[200:203], v[112:115]
    v_exp_f32 v83, v83
    v_mfma_f32_16x16x32_bf16 v[44:47], v[168:171], v[216:219], v[116:119]
    v_cvt_pk_bf16_f32 v150, v76, v77
    v_cvt_pk_bf16_f32 v151, v78, v79
    s_waitcnt lgkmcnt(2)
    v_mfma_f32_16x16x32_bf16 v[24:27], v[172:175], a[196:199], v[24:27]
    v_exp_f32 v60, v60
    v_cvt_pk_bf16_f32 v152, v56, v57
    v_mfma_f32_16x16x32_bf16 v[28:31], v[172:175], a[212:215], v[28:31]
    v_exp_f32 v61, v61
    v_mfma_f32_16x16x32_bf16 v[32:35], v[172:175], a[228:231], v[32:35]
    v_exp_f32 v62, v62
    v_cvt_pk_bf16_f32 v153, v58, v59
    v_mfma_f32_16x16x32_bf16 v[36:39], v[172:175], a[244:247], v[36:39]
    ds_read_b64_tr_b16 v[168:169], v193 offset:26112
    ds_read_b64_tr_b16 v[170:171], v193 offset:30464
    v_mfma_f32_16x16x32_bf16 v[40:43], v[172:175], v[204:207], v[40:43]
    v_exp_f32 v63, v63
    v_cvt_pk_bf16_f32 v154, v80, v81
    v_mfma_f32_16x16x32_bf16 v[44:47], v[172:175], v[220:223], v[44:47]
    s_waitcnt vmcnt(3)
    buffer_load_dwordx4 v197, s[8:11], s29 offen offset:3072 nt lds
    s_waitcnt lgkmcnt(3)
    v_mfma_f32_16x16x32_bf16 v[24:27], v[176:179], a[200:203], v[24:27]
    s_add_u32 m0, s43, 4352
    v_cvt_pk_bf16_f32 v155, v82, v83
    v_mfma_f32_16x16x32_bf16 v[28:31], v[176:179], a[216:219], v[28:31]
    v_exp_f32 v84, v84
    v_mfma_f32_16x16x32_bf16 v[32:35], v[176:179], a[232:235], v[32:35]
    v_exp_f32 v85, v85
    v_cvt_pk_bf16_f32 v156, v60, v61
    v_mfma_f32_16x16x32_bf16 v[36:39], v[176:179], a[248:251], v[36:39]
    v_exp_f32 v86, v86
    v_mfma_f32_16x16x32_bf16 v[40:43], v[176:179], v[208:211], v[40:43]
    ds_read_b64_tr_b16 v[172:173], v194 offset:26112
    ds_read_b64_tr_b16 v[174:175], v194 offset:30464
    v_cvt_pk_bf16_f32 v157, v62, v63
    v_mfma_f32_16x16x32_bf16 v[44:47], v[176:179], v[224:227], v[44:47]
    v_exp_f32 v87, v87
    s_waitcnt lgkmcnt(4)
    v_mfma_f32_16x16x32_bf16 v[24:27], v[180:183], a[204:207], v[24:27]
    v_exp_f32 v64, v64
    v_cvt_pk_bf16_f32 v158, v84, v85
    v_mfma_f32_16x16x32_bf16 v[28:31], v[180:183], a[220:223], v[28:31]
    v_exp_f32 v65, v65
    v_mfma_f32_16x16x32_bf16 v[32:35], v[180:183], a[236:239], v[32:35]
    v_exp_f32 v66, v66
    v_cvt_pk_bf16_f32 v159, v86, v87
    v_mfma_f32_16x16x32_bf16 v[36:39], v[180:183], a[252:255], v[36:39]
    v_exp_f32 v67, v67
    v_mfma_f32_16x16x32_bf16 v[40:43], v[180:183], v[212:215], v[40:43]
    v_exp_f32 v88, v88
    v_cvt_pk_bf16_f32 v160, v64, v65
    v_mfma_f32_16x16x32_bf16 v[44:47], v[180:183], v[228:231], v[44:47]
    v_exp_f32 v89, v89
    s_waitcnt lgkmcnt(2)
    v_mfma_f32_16x16x32_bf16 a[0:3], v[168:171], v[144:147], a[0:3]
    v_exp_f32 v90, v90
    v_exp_f32 v91, v91
    v_mfma_f32_16x16x32_bf16 a[4:7], v[168:171], v[148:151], a[4:7]
    v_exp_f32 v68, v68
    v_exp_f32 v69, v69
    v_exp_f32 v70, v70
    v_exp_f32 v71, v71
    v_exp_f32 v92, v92
    v_exp_f32 v93, v93
    v_exp_f32 v94, v94
    v_exp_f32 v95, v95
    v_cvt_pk_bf16_f32 v161, v66, v67
    v_cvt_pk_bf16_f32 v162, v88, v89
    v_cvt_pk_bf16_f32 v163, v90, v91
    v_mfma_f32_16x16x32_bf16 a[8:11], v[168:171], v[152:155], a[8:11]
    v_cvt_pk_bf16_f32 v164, v68, v69
    v_cvt_pk_bf16_f32 v165, v70, v71
    v_cvt_pk_bf16_f32 v166, v92, v93
    v_cvt_pk_bf16_f32 v167, v94, v95
    v_mfma_f32_16x16x32_bf16 a[12:15], v[168:171], v[156:159], a[12:15]
    v_mfma_f32_16x16x32_bf16 a[16:19], v[168:171], v[160:163], a[16:19]
    ds_read_b64_tr_b16 v[176:177], v193 offset:26176
    ds_read_b64_tr_b16 v[178:179], v193 offset:30528
    s_waitcnt vmcnt(4)
    v_mfma_f32_16x16x32_bf16 a[20:23], v[168:171], v[164:167], a[20:23]
    buffer_load_dwordx4 v197, s[8:11], s30 offen nt lds
    v_mfma_f32_16x16x32_bf16 v[120:123], v[184:187], v[144:147], v[120:123]
    s_add_u32 m0, s43, 4416
    s_waitcnt lgkmcnt(2)
    v_mfma_f32_16x16x32_bf16 a[24:27], v[172:175], v[144:147], a[24:27]
    v_mfma_f32_16x16x32_bf16 a[28:31], v[172:175], v[148:151], a[28:31]
    v_mfma_f32_16x16x32_bf16 a[32:35], v[172:175], v[152:155], a[32:35]
    v_mfma_f32_16x16x32_bf16 a[36:39], v[172:175], v[156:159], a[36:39]
    v_mfma_f32_16x16x32_bf16 a[40:43], v[172:175], v[160:163], a[40:43]
    ds_read_b64_tr_b16 v[180:181], v194 offset:26176
    ds_read_b64_tr_b16 v[182:183], v194 offset:30528
    v_mfma_f32_16x16x32_bf16 a[44:47], v[172:175], v[164:167], a[44:47]
    v_mfma_f32_16x16x32_bf16 v[124:127], v[184:187], v[148:151], v[124:127]
    s_waitcnt lgkmcnt(2)
    v_mfma_f32_16x16x32_bf16 a[48:51], v[176:179], v[144:147], a[48:51]
    s_waitcnt vmcnt(4)
    buffer_load_dwordx4 v197, s[8:11], s30 offen offset:1024 nt lds
    v_mfma_f32_16x16x32_bf16 a[52:55], v[176:179], v[148:151], a[52:55]
    s_add_u32 m0, s43, 4480
    ds_read_b64_tr_b16 v[168:169], v195 offset:26112
    ds_read_b64_tr_b16 v[170:171], v195 offset:30464
    v_mfma_f32_16x16x32_bf16 a[56:59], v[176:179], v[152:155], a[56:59]
    v_max3_f32 v232, v0, v1, v2
    v_max3_f32 v232, v232, v3, v4
    v_mfma_f32_16x16x32_bf16 a[60:63], v[176:179], v[156:159], a[60:63]
    v_max3_f32 v232, v232, v5, v6
    v_max3_f32 v232, v232, v7, v8
    v_mfma_f32_16x16x32_bf16 a[64:67], v[176:179], v[160:163], a[64:67]
    v_max3_f32 v232, v232, v9, v10
    v_max3_f32 v232, v232, v11, v12
    v_max3_f32 v232, v232, v13, v14
    v_mfma_f32_16x16x32_bf16 a[68:71], v[176:179], v[164:167], a[68:71]
    v_max3_f32 v232, v232, v15, v16
    v_max3_f32 v232, v232, v17, v18
    v_mfma_f32_16x16x32_bf16 v[128:131], v[184:187], v[152:155], v[128:131]
    ds_read_b64_tr_b16 v[172:173], v196 offset:26112
    ds_read_b64_tr_b16 v[174:175], v196 offset:30464
    s_waitcnt vmcnt(3)
    s_waitcnt lgkmcnt(4)
    v_mfma_f32_16x16x32_bf16 a[72:75], v[180:183], v[144:147], a[72:75]
    buffer_load_dwordx4 v197, s[8:11], s30 offen offset:2048 nt lds
    v_mfma_f32_16x16x32_bf16 a[76:79], v[180:183], v[148:151], a[76:79]
    s_add_u32 m0, s43, 4544
    v_max3_f32 v232, v232, v19, v20
    v_max3_f32 v232, v232, v21, v22
    v_mfma_f32_16x16x32_bf16 a[80:83], v[180:183], v[152:155], a[80:83]
    v_max3_f32 v232, v232, v23, v24
    v_max3_f32 v232, v232, v25, v26
    v_mfma_f32_16x16x32_bf16 a[84:87], v[180:183], v[156:159], a[84:87]
    v_max3_f32 v232, v232, v27, v28
    v_max3_f32 v232, v232, v29, v30
    v_max3_f32 v232, v232, v31, v32
    v_mfma_f32_16x16x32_bf16 a[88:91], v[180:183], v[160:163], a[88:91]
    v_max3_f32 v232, v232, v33, v34
    v_max3_f32 v232, v232, v35, v36
    v_mfma_f32_16x16x32_bf16 a[92:95], v[180:183], v[164:167], a[92:95]
    v_max3_f32 v232, v232, v37, v38
    v_max3_f32 v232, v232, v39, v40
    v_max3_f32 v232, v232, v41, v42
    v_mfma_f32_16x16x32_bf16 v[132:135], v[184:187], v[156:159], v[132:135]
    ds_read_b64_tr_b16 v[176:177], v195 offset:26176
    ds_read_b64_tr_b16 v[178:179], v195 offset:30528
    s_waitcnt lgkmcnt(4)
    v_mfma_f32_16x16x32_bf16 a[96:99], v[168:171], v[144:147], a[96:99]
    v_max3_f32 v232, v232, v43, v44
    v_max3_f32 v232, v232, v45, v46
    v_max3_f32 v232, v232, v47, v47
    v_mfma_f32_16x16x32_bf16 a[100:103], v[168:171], v[148:151], a[100:103]
    v_cmp_lt_f32 vcc, s76, v232
    v_mfma_f32_16x16x32_bf16 a[104:107], v[168:171], v[152:155], a[104:107]
    v_mfma_f32_16x16x32_bf16 a[108:111], v[168:171], v[156:159], a[108:111]
    s_waitcnt vmcnt(4)
    buffer_load_dwordx4 v197, s[8:11], s30 offen offset:3072 nt lds
    v_mfma_f32_16x16x32_bf16 a[112:115], v[168:171], v[160:163], a[112:115]
    v_mfma_f32_16x16x32_bf16 a[116:119], v[168:171], v[164:167], a[116:119]
    ds_read_b64_tr_b16 v[180:181], v196 offset:26176
    ds_read_b64_tr_b16 v[182:183], v196 offset:30528
    v_mfma_f32_16x16x32_bf16 v[136:139], v[184:187], v[160:163], v[136:139]
    s_waitcnt lgkmcnt(4)
    v_mfma_f32_16x16x32_bf16 a[120:123], v[172:175], v[144:147], a[120:123]
    v_mfma_f32_16x16x32_bf16 a[124:127], v[172:175], v[148:151], a[124:127]
    v_mfma_f32_16x16x32_bf16 a[128:131], v[172:175], v[152:155], a[128:131]
    v_mfma_f32_16x16x32_bf16 a[132:135], v[172:175], v[156:159], a[132:135]
    v_mfma_f32_16x16x32_bf16 a[136:139], v[172:175], v[160:163], a[136:139]
    ds_read_b128 v[168:171], v192 offset:8704
    v_mfma_f32_16x16x32_bf16 a[140:143], v[172:175], v[164:167], a[140:143]
    s_add_u32 s29, s29, 8192
    s_and_b32 s29, s29, 0x3ffff
    s_add_u32 s30, s29, 4096
    v_mfma_f32_16x16x32_bf16 v[140:143], v[184:187], v[164:167], v[140:143]
    s_waitcnt lgkmcnt(3)
    v_mfma_f32_16x16x32_bf16 a[144:147], v[176:179], v[144:147], a[144:147]
    v_mfma_f32_16x16x32_bf16 a[148:151], v[176:179], v[148:151], a[148:151]
    v_mfma_f32_16x16x32_bf16 a[152:155], v[176:179], v[152:155], a[152:155]
    v_mfma_f32_16x16x32_bf16 a[156:159], v[176:179], v[156:159], a[156:159]
    ds_read_b128 v[172:175], v192 offset:8768
    v_mfma_f32_16x16x32_bf16 a[160:163], v[176:179], v[160:163], a[160:163]
    v_mfma_f32_16x16x32_bf16 a[164:167], v[176:179], v[164:167], a[164:167]
    s_waitcnt lgkmcnt(2)
    v_mfma_f32_16x16x32_bf16 a[168:171], v[180:183], v[144:147], a[168:171]
    s_waitcnt vmcnt(8)
    s_barrier
    v_mfma_f32_16x16x32_bf16 a[172:175], v[180:183], v[148:151], a[172:175]
    v_mfma_f32_16x16x32_bf16 a[176:179], v[180:183], v[152:155], a[176:179]
    v_mfma_f32_16x16x32_bf16 a[180:183], v[180:183], v[156:159], a[180:183]
    v_mfma_f32_16x16x32_bf16 a[184:187], v[180:183], v[160:163], a[184:187]
    v_mfma_f32_16x16x32_bf16 a[188:191], v[180:183], v[164:167], a[188:191]
    s_cbranch_vccnz L_rare_3
L_back_3:
    s_waitcnt lgkmcnt(1)
    v_mfma_f32_16x16x32_bf16 v[48:51], v[168:171], a[192:195], v[96:99]
    s_cmp_eq_u32 s32, s84
    s_cselect_b32 s10, 0, s10
    ds_read_b128 v[176:179], v192 offset:8832
    v_mfma_f32_16x16x32_bf16 v[52:55], v[168:171], a[208:211], v[100:103]
    s_add_u32 m0, s40, 0
    v_exp_f32 v0, v0
    v_mfma_f32_16x16x32_bf16 v[56:59], v[168:171], a[224:227], v[104:107]
    s_waitcnt vmcnt(3)
    v_mfma_f32_16x16x32_bf16 v[60:63], v[168:171], a[240:243], v[108:111]
    ds_read_b128 v[180:183], v192 offset:8896
    buffer_load_dwordx4 v197, s[8:11], s29 offen nt lds
    v_mfma_f32_16x16x32_bf16 v[64:67], v[168:171], v[200:203], v[112:115]
    s_add_u32 m0, s40, 64
    v_exp_f32 v1, v1
    v_mfma_f32_16x16x32_bf16 v[68:71], v[168:171], v[216:219], v[116:119]
    v_exp_f32 v2, v2
    s_waitcnt lgkmcnt(2)
    v_mfma_f32_16x16x32_bf16 v[48:51], v[172:175], a[196:199], v[48:51]
    v_exp_f32 v3, v3
    v_cvt_pk_bf16_f32 v144, v0, v1
    v_mfma_f32_16x16x32_bf16 v[52:55], v[172:175], a[212:215], v[52:55]
    v_exp_f32 v24, v24
    v_mfma_f32_16x16x32_bf16 v[56:59], v[172:175], a[228:231], v[56:59]
    v_exp_f32 v25, v25
    v_cvt_pk_bf16_f32 v145, v2, v3
    v_mfma_f32_16x16x32_bf16 v[60:63], v[172:175], a[244:247], v[60:63]
    ds_read_b128 v[168:171], v192 offset:13056
    v_exp_f32 v26, v26
    v_mfma_f32_16x16x32_bf16 v[64:67], v[172:175], v[204:207], v[64:67]
    v_exp_f32 v27, v27
    v_mfma_f32_16x16x32_bf16 v[68:71], v[172:175], v[220:223], v[68:71]
    v_exp_f32 v4, v4
    s_waitcnt lgkmcnt(2)
    v_mfma_f32_16x16x32_bf16 v[48:51], v[176:179], a[200:203], v[48:51]
    v_exp_f32 v5, v5
    v_cvt_pk_bf16_f32 v146, v24, v25
    v_mfma_f32_16x16x32_bf16 v[52:55], v[176:179], a[216:219], v[52:55]
    s_waitcnt vmcnt(4)
    buffer_load_dwordx4 v197, s[8:11], s29 offen offset:1024 nt lds
    v_mfma_f32_16x16x32_bf16 v[56:59], v[176:179], a[232:235], v[56:59]
    s_add_u32 m0, s40, 128
    v_cvt_pk_bf16_f32 v147, v26, v27
    v_mfma_f32_16x16x32_bf16 v[60:63], v[176:179], a[248:251], v[60:63]
    ds_read_b128 v[172:175], v192 offset:13120
    v_exp_f32 v6, v6
    v_mfma_f32_16x16x32_bf16 v[64:67], v[176:179], v[208:211], v[64:67]
    v_exp_f32 v7, v7
    v_mfma_f32_16x16x32_bf16 v[68:71], v[176:179], v[224:227], v[68:71]
    v_exp_f32 v28, v28
    s_waitcnt lgkmcnt(2)
    v_mfma_f32_16x16x32_bf16 v[48:51], v[180:183], a[204:207], v[48:51]
    v_exp_f32 v29, v29
    v_cvt_pk_bf16_f32 v148, v4, v5
    v_mfma_f32_16x16x32_bf16 v[52:55], v[180:183], a[220:223], v[52:55]
    v_exp_f32 v30, v30
    v_mfma_f32_16x16x32_bf16 v[56:59], v[180:183], a[236:239], v[56:59]
    v_exp_f32 v31, v31
    v_cvt_pk_bf16_f32 v149, v6, v7
    v_mfma_f32_16x16x32_bf16 v[60:63], v[180:183], a[252:255], v[60:63]
    ds_read_b128 v[176:179], v192 offset:13184
    v_exp_f32 v8, v8
    v_mfma_f32_16x16x32_bf16 v[64:67], v[180:183], v[212:215], v[64:67]
    v_exp_f32 v9, v9
    v_mfma_f32_16x16x32_bf16 v[68:71], v[180:183], v[228:231], v[68:71]
    v_exp_f32 v10, v10
    s_waitcnt lgkmcnt(2)
    v_mfma_f32_16x16x32_bf16 v[72:75], v[168:171], a[192:195], v[96:99]
    s_waitcnt vmcnt(4)
    buffer_load_dwordx4 v197, s[8:11], s29 offen offset:2048 nt lds
    v_mfma_f32_16x16x32_bf16 v[76:79], v[168:171], a[208:211], v[100:103]
    s_add_u32 m0, s40, 192
    v_exp_f32 v11, v11
    v_mfma_f32_16x16x32_bf16 v[80:83], v[168:171], a[224:227], v[104:107]
    v_exp_f32 v32, v32
    v_mfma_f32_16x16x32_bf16 v[84:87], v[168:171], a[240:243], v[108:111]
    ds_read_b128 v[180:183], v192 offset:13248
    v_exp_f32 v33, v33
    v_mfma_f32_16x16x32_bf16 v[88:91], v[168:171], v[200:203], v[112:115]
    v_exp_f32 v34, v34
    v_mfma_f32_16x16x32_bf16 v[92:95], v[168:171], v[216:219], v[116:119]
    v_exp_f32 v35, v35
    s_waitcnt lgkmcnt(2)
    v_mfma_f32_16x16x32_bf16 v[72:75], v[172:175], a[196:199], v[72:75]
    v_cvt_pk_bf16_f32 v150, v28, v29
    v_cvt_pk_bf16_f32 v151, v30, v31
    v_cvt_pk_bf16_f32 v152, v8, v9
    v_mfma_f32_16x16x32_bf16 v[76:79], v[172:175], a[212:215], v[76:79]
    v_exp_f32 v12, v12
    v_mfma_f32_16x16x32_bf16 v[80:83], v[172:175], a[228:231], v[80:83]
    v_exp_f32 v13, v13
    v_cvt_pk_bf16_f32 v153, v10, v11
    v_mfma_f32_16x16x32_bf16 v[84:87], v[172:175], a[244:247], v[84:87]
    ds_read_b64_tr_b16 v[168:169], v193 offset:0
    ds_read_b64_tr_b16 v[170:171], v193 offset:4352
    v_mfma_f32_16x16x32_bf16 v[88:91], v[172:175], v[204:207], v[88:91]
    v_exp_f32 v14, v14
    v_cvt_pk_bf16_f32 v154, v32, v33
    v_mfma_f32_16x16x32_bf16 v[92:95], v[172:175], v[220:223], v[92:95]
    s_waitcnt vmcnt(3)
    buffer_load_dwordx4 v197, s[8:11], s29 offen offset:3072 nt lds
    s_waitcnt lgkmcnt(3)
    v_mfma_f32_16x16x32_bf16 v[72:75], v[176:179], a[200:203], v[72:75]
    s_add_u32 m0, s40, 4352
    v_cvt_pk_bf16_f32 v155, v34, v35
    v_mfma_f32_16x16x32_bf16 v[76:79], v[176:179], a[216:219], v[76:79]
    v_exp_f32 v15, v15
    v_mfma_f32_16x16x32_bf16 v[80:83], v[176:179], a[232:235], v[80:83]
    v_exp_f32 v36, v36
    v_cvt_pk_bf16_f32 v156, v12, v13
    v_mfma_f32_16x16x32_bf16 v[84:87], v[176:179], a[248:251], v[84:87]
    v_exp_f32 v37, v37
    v_mfma_f32_16x16x32_bf16 v[88:91], v[176:179], v[208:211], v[88:91]
    ds_read_b64_tr_b16 v[172:173], v194 offset:0
    ds_read_b64_tr_b16 v[174:175], v194 offset:4352
    v_cvt_pk_bf16_f32 v157, v14, v15
    v_mfma_f32_16x16x32_bf16 v[92:95], v[176:179], v[224:227], v[92:95]
    v_exp_f32 v38, v38
    s_waitcnt lgkmcnt(4)
    v_mfma_f32_16x16x32_bf16 v[72:75], v[180:183], a[204:207], v[72:75]
    v_exp_f32 v39, v39
    v_cvt_pk_bf16_f32 v158, v36, v37
    v_mfma_f32_16x16x32_bf16 v[76:79], v[180:183], a[220:223], v[76:79]
    v_exp_f32 v16, v16
    v_mfma_f32_16x16x32_bf16 v[80:83], v[180:183], a[236:239], v[80:83]
    v_exp_f32 v17, v17
    v_cvt_pk_bf16_f32 v159, v38, v39
    v_mfma_f32_16x16x32_bf16 v[84:87], v[180:183], a[252:255], v[84:87]
    v_exp_f32 v18, v18
    v_mfma_f32_16x16x32_bf16 v[88:91], v[180:183], v[212:215], v[88:91]
    v_exp_f32 v19, v19
    v_cvt_pk_bf16_f32 v160, v16, v17
    v_mfma_f32_16x16x32_bf16 v[92:95], v[180:183], v[228:231], v[92:95]
    v_exp_f32 v40, v40
    s_waitcnt lgkmcnt(2)
    v_mfma_f32_16x16x32_bf16 a[0:3], v[168:171], v[144:147], a[0:3]
    v_exp_f32 v41, v41
    v_exp_f32 v42, v42
    v_exp_f32 v43, v43
    v_mfma_f32_16x16x32_bf16 a[4:7], v[168:171], v[148:151], a[4:7]
    v_exp_f32 v20, v20
    v_exp_f32 v21, v21
    v_exp_f32 v22, v22
    v_exp_f32 v23, v23
    v_exp_f32 v44, v44
    v_exp_f32 v45, v45
    v_exp_f32 v46, v46
    v_exp_f32 v47, v47
    v_cvt_pk_bf16_f32 v161, v18, v19
    v_cvt_pk_bf16_f32 v162, v40, v41
    v_cvt_pk_bf16_f32 v163, v42, v43
    v_mfma_f32_16x16x32_bf16 a[8:11], v[168:171], v[152:155], a[8:11]
    v_cvt_pk_bf16_f32 v164, v20, v21
    v_cvt_pk_bf16_f32 v165, v22, v23
    v_cvt_pk_bf16_f32 v166, v44, v45
    v_cvt_pk_bf16_f32 v167, v46, v47
    v_mfma_f32_16x16x32_bf16 a[12:15], v[168:171], v[156:159], a[12:15]
    v_mfma_f32_16x16x32_bf16 a[16:19], v[168:171], v[160:163], a[16:19]
    ds_read_b64_tr_b16 v[176:177], v193 offset:64
    ds_read_b64_tr_b16 v[178:179], v193 offset:4416
    s_waitcnt vmcnt(4)
    v_mfma_f32_16x16x32_bf16 a[20:23], v[168:171], v[164:167], a[20:23]
    buffer_load_dwordx4 v197, s[8:11], s30 offen nt lds
    v_mfma_f32_16x16x32_bf16 v[120:123], v[184:187], v[144:147], v[120:123]
    s_add_u32 m0, s40, 4416
    s_waitcnt lgkmcnt(2)
    v_mfma_f32_16x16x32_bf16 a[24:27], v[172:175], v[144:147], a[24:27]
    v_mfma_f32_16x16x32_bf16 a[28:31], v[172:175], v[148:151], a[28:31]
    v_mfma_f32_16x16x32_bf16 a[32:35], v[172:175], v[152:155], a[32:35]
    v_mfma_f32_16x16x32_bf16 a[36:39], v[172:175], v[156:159], a[36:39]
    v_mfma_f32_16x16x32_bf16 a[40:43], v[172:175], v[160:163], a[40:43]
    ds_read_b64_tr_b16 v[180:181], v194 offset:64
    ds_read_b64_tr_b16 v[182:183], v194 offset:4416
    v_mfma_f32_16x16x32_bf16 a[44:47], v[172:175], v[164:167], a[44:47]
    v_mfma_f32_16x16x32_bf16 v[124:127], v[184:187], v[148:151], v[124:127]
    s_waitcnt lgkmcnt(2)
    v_mfma_f32_16x16x32_bf16 a[48:51], v[176:179], v[144:147], a[48:51]
    s_waitcnt vmcnt(4)
    v_mfma_f32_16x16x32_bf16 a[52:55], v[176:179], v[148:151], a[52:55]
    buffer_load_dwordx4 v197, s[8:11], s30 offen offset:1024 nt lds
    v_mfma_f32_16x16x32_bf16 a[56:59], v[176:179], v[152:155], a[56:59]
    s_add_u32 m0, s40, 4480
    ds_read_b64_tr_b16 v[168:169], v195 offset:0
    ds_read_b64_tr_b16 v[170:171], v195 offset:4352
    v_mfma_f32_16x16x32_bf16 a[60:63], v[176:179], v[156:159], a[60:63]
    v_max3_f32 v232, v48, v49, v50
    v_max3_f32 v232, v232, v51, v52
    v_mfma_f32_16x16x32_bf16 a[64:67], v[176:179], v[160:163], a[64:67]
    v_max3_f32 v232, v232, v53, v54
    v_max3_f32 v232, v232, v55, v56
    v_max3_f32 v232, v232, v57, v58
    v_mfma_f32_16x16x32_bf16 a[68:71], v[176:179], v[164:167], a[68:71]
    v_max3_f32 v232, v232, v59, v60
    v_max3_f32 v232, v232, v61, v62
    v_mfma_f32_16x16x32_bf16 v[128:131], v[184:187], v[152:155], v[128:131]
    ds_read_b64_tr_b16 v[172:173], v196 offset:0
    ds_read_b64_tr_b16 v[174:175], v196 offset:4352
    s_waitcnt vmcnt(3)
    s_waitcnt lgkmcnt(4)
    v_mfma_f32_16x16x32_bf16 a[72:75], v[180:183], v[144:147], a[72:75]
    buffer_load_dwordx4 v197, s[8:11], s30 offen offset:2048 nt lds
    v_mfma_f32_16x16x32_bf16 a[76:79], v[180:183], v[148:151], a[76:79]
    s_add_u32 m0, s40, 4544
    v_max3_f32 v232, v232, v63, v64
    v_max3_f32 v232, v232, v65, v66
    v_mfma_f32_16x16x32_bf16 a[80:83], v[180:183], v[152:155], a[80:83]
    v_max3_f32 v232, v232, v67, v68
    v_max3_f32 v232, v232, v69, v70
    v_mfma_f32_16x16x32_bf16 a[84:87], v[180:183], v[156:159], a[84:87]
    v_max3_f32 v232, v232, v71, v72
    v_max3_f32 v232, v232, v73, v74
    v_max3_f32 v232, v232, v75, v76
    v_mfma_f32_16x16x32_bf16 a[88:91], v[180:183], v[160:163], a[88:91]
    v_max3_f32 v232, v232, v77, v78
    v_max3_f32 v232, v232, v79, v80
    v_mfma_f32_16x16x32_bf16 a[92:95], v[180:183], v[164:167], a[92:95]
    v_max3_f32 v232, v232, v81, v82
    v_max3_f32 v232, v232, v83, v84
    v_max3_f32 v232, v232, v85, v86
    v_mfma_f32_16x16x32_bf16 v[132:135], v[184:187], v[156:159], v[132:135]
    ds_read_b64_tr_b16 v[176:177], v195 offset:64
    ds_read_b64_tr_b16 v[178:179], v195 offset:4416
    s_waitcnt lgkmcnt(4)
    v_mfma_f32_16x16x32_bf16 a[96:99], v[168:171], v[144:147], a[96:99]
    v_max3_f32 v232, v232, v87, v88
    v_max3_f32 v232, v232, v89, v90
    v_max3_f32 v232, v232, v91, v92
    v_mfma_f32_16x16x32_bf16 a[100:103], v[168:171], v[148:151], a[100:103]
    v_max3_f32 v232, v232, v93, v94
    v_max3_f32 v232, v232, v95, v95
    v_mfma_f32_16x16x32_bf16 a[104:107], v[168:171], v[152:155], a[104:107]
    v_cmp_lt_f32 vcc, s76, v232
    v_mfma_f32_16x16x32_bf16 a[108:111], v[168:171], v[156:159], a[108:111]
    s_waitcnt vmcnt(4)
    buffer_load_dwordx4 v197, s[8:11], s30 offen offset:3072 nt lds
    v_mfma_f32_16x16x32_bf16 a[112:115], v[168:171], v[160:163], a[112:115]
    v_mfma_f32_16x16x32_bf16 a[116:119], v[168:171], v[164:167], a[116:119]
    ds_read_b64_tr_b16 v[180:181], v196 offset:64
    ds_read_b64_tr_b16 v[182:183], v196 offset:4416
    v_mfma_f32_16x16x32_bf16 v[136:139], v[184:187], v[160:163], v[136:139]
    s_waitcnt lgkmcnt(4)
    v_mfma_f32_16x16x32_bf16 a[120:123], v[172:175], v[144:147], a[120:123]
    v_mfma_f32_16x16x32_bf16 a[124:127], v[172:175], v[148:151], a[124:127]
    v_mfma_f32_16x16x32_bf16 a[128:131], v[172:175], v[152:155], a[128:131]
    v_mfma_f32_16x16x32_bf16 a[132:135], v[172:175], v[156:159], a[132:135]
    v_mfma_f32_16x16x32_bf16 a[136:139], v[172:175], v[160:163], a[136:139]
    ds_read_b128 v[168:171], v192 offset:17408
    v_mfma_f32_16x16x32_bf16 a[140:143], v[172:175], v[164:167], a[140:143]
    s_add_u32 s29, s29, 8192
    s_and_b32 s29, s29, 0x3ffff
    s_add_u32 s30, s29, 4096
    v_mfma_f32_16x16x32_bf16 v[140:143], v[184:187], v[164:167], v[140:143]
    s_waitcnt lgkmcnt(3)
    v_mfma_f32_16x16x32_bf16 a[144:147], v[176:179], v[144:147], a[144:147]
    v_mfma_f32_16x16x32_bf16 a[148:151], v[176:179], v[148:151], a[148:151]
    v_mfma_f32_16x16x32_bf16 a[152:155], v[176:179], v[152:155], a[152:155]
    v_mfma_f32_16x16x32_bf16 a[156:159], v[176:179], v[156:159], a[156:159]
    ds_read_b128 v[172:175], v192 offset:17472
    v_mfma_f32_16x16x32_bf16 a[160:163], v[176:179], v[160:163], a[160:163]
    v_mfma_f32_16x16x32_bf16 a[164:167], v[176:179], v[164:167], a[164:167]
    s_waitcnt lgkmcnt(2)
    v_mfma_f32_16x16x32_bf16 a[168:171], v[180:183], v[144:147], a[168:171]
    s_waitcnt vmcnt(8)
    s_barrier
    v_mfma_f32_16x16x32_bf16 a[172:175], v[180:183], v[148:151], a[172:175]
    v_mfma_f32_16x16x32_bf16 a[176:179], v[180:183], v[152:155], a[176:179]
    v_mfma_f32_16x16x32_bf16 a[180:183], v[180:183], v[156:159], a[180:183]
    v_mfma_f32_16x16x32_bf16 a[184:187], v[180:183], v[160:163], a[184:187]
    v_mfma_f32_16x16x32_bf16 a[188:191], v[180:183], v[164:167], a[188:191]
    s_cbranch_vccnz L_rare_4
L_back_4:
    s_sub_u32 s32, s32, 1
    s_cmp_lg_u32 s32, 0
    s_cbranch_scc1 L_loops0
    s_waitcnt lgkmcnt(1)
    v_mfma_f32_16x16x32_bf16 v[0:3], v[168:171], a[192:195], v[96:99]
    ds_read_b128 v[176:179], v192 offset:17536
    v_exp_f32 v48, v48
    v_mfma_f32_16x16x32_bf16 v[4:7], v[168:171], a[208:211], v[100:103]
    v_exp_f32 v49, v49
    v_mfma_f32_16x16x32_bf16 v[8:11], v[168:171], a[224:227], v[104:107]
    v_mov_b32 v188, 1
    s_lshl_b32 s87, s88, 3
    s_add_u32 s87, s87, s5
    v_mfma_f32_16x16x32_bf16 v[12:15], v[168:171], a[240:243], v[108:111]
    ds_read_b128 v[180:183], v192 offset:17600
    buffer_store_byte v188, v199, s[64:67], s87 offen sc1
    v_mfma_f32_16x16x32_bf16 v[16:19], v[168:171], v[200:203], v[112:115]
    v_exp_f32 v50, v50
    v_mfma_f32_16x16x32_bf16 v[20:23], v[168:171], v[216:219], v[116:119]
    v_exp_f32 v51, v51
    s_waitcnt lgkmcnt(2)
    v_mfma_f32_16x16x32_bf16 v[0:3], v[172:175], a[196:199], v[0:3]
    v_exp_f32 v72, v72
    v_cvt_pk_bf16_f32 v144, v48, v49
    v_mfma_f32_16x16x32_bf16 v[4:7], v[172:175], a[212:215], v[4:7]
    v_exp_f32 v73, v73
    v_mfma_f32_16x16x32_bf16 v[8:11], v[172:175], a[228:231], v[8:11]
    v_exp_f32 v74, v74
    v_cvt_pk_bf16_f32 v145, v50, v51
    v_mfma_f32_16x16x32_bf16 v[12:15], v[172:175], a[244:247], v[12:15]
    ds_read_b128 v[168:171], v192 offset:21760
    v_exp_f32 v75, v75
    v_mfma_f32_16x16x32_bf16 v[16:19], v[172:175], v[204:207], v[16:19]
    v_exp_f32 v52, v52
    v_mfma_f32_16x16x32_bf16 v[20:23], v[172:175], v[220:223], v[20:23]
    v_exp_f32 v53, v53
    s_waitcnt lgkmcnt(2)
    v_mfma_f32_16x16x32_bf16 v[0:3], v[176:179], a[200:203], v[0:3]
    buffer_load_dword v244, v247, s[60:63], s85 offen sc1
    v_cvt_pk_bf16_f32 v146, v72, v73
    v_mfma_f32_16x16x32_bf16 v[4:7], v[176:179], a[216:219], v[4:7]
    v_exp_f32 v54, v54
    v_mfma_f32_16x16x32_bf16 v[8:11], v[176:179], a[232:235], v[8:11]
    v_exp_f32 v55, v55
    v_cvt_pk_bf16_f32 v147, v74, v75
    v_mfma_f32_16x16x32_bf16 v[12:15], v[176:179], a[248:251], v[12:15]
    ds_read_b128 v[172:175], v192 offset:21824
    v_exp_f32 v76, v76
    v_mfma_f32_16x16x32_bf16 v[16:19], v[176:179], v[208:211], v[16:19]
    v_exp_f32 v77, v77
    v_mfma_f32_16x16x32_bf16 v[20:23], v[176:179], v[224:227], v[20:23]
    v_exp_f32 v78, v78
    s_waitcnt lgkmcnt(2)
    v_mfma_f32_16x16x32_bf16 v[0:3], v[180:183], a[204:207], v[0:3]
    v_exp_f32 v79, v79
    v_cvt_pk_bf16_f32 v148, v52, v53
    v_mfma_f32_16x16x32_bf16 v[4:7], v[180:183], a[220:223], v[4:7]
    v_exp_f32 v56, v56
    v_mfma_f32_16x16x32_bf16 v[8:11], v[180:183], a[236:239], v[8:11]
    v_exp_f32 v57, v57
    v_cvt_pk_bf16_f32 v149, v54, v55
    v_mfma_f32_16x16x32_bf16 v[12:15], v[180:183], a[252:255], v[12:15]
    ds_read_b128 v[176:179], v192 offset:21888
    v_exp_f32 v58, v58
    v_mfma_f32_16x16x32_bf16 v[16:19], v[180:183], v[212:215], v[16:19]
    v_exp_f32 v59, v59
    v_mfma_f32_16x16x32_bf16 v[20:23], v[180:183], v[228:231], v[20:23]
    v_exp_f32 v80, v80
    s_waitcnt lgkmcnt(2)
    v_mfma_f32_16x16x32_bf16 v[24:27], v[168:171], a[192:195], v[96:99]
    v_exp_f32 v81, v81
    v_cvt_pk_bf16_f32 v150, v76, v77
    v_mfma_f32_16x16x32_bf16 v[28:31], v[168:171], a[208:211], v[100:103]
    v_exp_f32 v82, v82
    v_mfma_f32_16x16x32_bf16 v[32:35], v[168:171], a[224:227], v[104:107]
    v_exp_f32 v83, v83
    v_cvt_pk_bf16_f32 v151, v78, v79
    v_mfma_f32_16x16x32_bf16 v[36:39], v[168:171], a[240:243], v[108:111]
    ds_read_b128 v[180:183], v192 offset:21952
    v_exp_f32 v60, v60
    v_mfma_f32_16x16x32_bf16 v[40:43], v[168:171], v[200:203], v[112:115]
    v_exp_f32 v61, v61
    v_mfma_f32_16x16x32_bf16 v[44:47], v[168:171], v[216:219], v[116:119]
    v_exp_f32 v62, v62
    s_waitcnt lgkmcnt(2)
    v_mfma_f32_16x16x32_bf16 v[24:27], v[172:175], a[196:199], v[24:27]
    v_exp_f32 v63, v63
    v_cvt_pk_bf16_f32 v152, v56, v57
    v_mfma_f32_16x16x32_bf16 v[28:31], v[172:175], a[212:215], v[28:31]
    v_exp_f32 v84, v84
    v_mfma_f32_16x16x32_bf16 v[32:35], v[172:175], a[228:231], v[32:35]
    v_exp_f32 v85, v85
    v_cvt_pk_bf16_f32 v153, v58, v59
    v_mfma_f32_16x16x32_bf16 v[36:39], v[172:175], a[244:247], v[36:39]
    ds_read_b64_tr_b16 v[168:169], v193 offset:8704
    ds_read_b64_tr_b16 v[170:171], v193 offset:13056
    v_mfma_f32_16x16x32_bf16 v[40:43], v[172:175], v[204:207], v[40:43]
    v_exp_f32 v86, v86
    v_cvt_pk_bf16_f32 v154, v80, v81
    v_mfma_f32_16x16x32_bf16 v[44:47], v[172:175], v[220:223], v[44:47]
    v_exp_f32 v87, v87
    s_waitcnt lgkmcnt(3)
    v_mfma_f32_16x16x32_bf16 v[24:27], v[176:179], a[200:203], v[24:27]
    v_cvt_pk_bf16_f32 v155, v82, v83
    v_exp_f32 v64, v64
    v_mfma_f32_16x16x32_bf16 v[28:31], v[176:179], a[216:219], v[28:31]
    v_exp_f32 v65, v65
    v_mfma_f32_16x16x32_bf16 v[32:35], v[176:179], a[232:235], v[32:35]
    v_exp_f32 v66, v66
    v_cvt_pk_bf16_f32 v156, v60, v61
    v_mfma_f32_16x16x32_bf16 v[36:39], v[176:179], a[248:251], v[36:39]
    v_exp_f32 v67, v67
    v_mfma_f32_16x16x32_bf16 v[40:43], v[176:179], v[208:211], v[40:43]
    ds_read_b64_tr_b16 v[172:173], v194 offset:8704
    ds_read_b64_tr_b16 v[174:175], v194 offset:13056
    v_cvt_pk_bf16_f32 v157, v62, v63
    v_mfma_f32_16x16x32_bf16 v[44:47], v[176:179], v[224:227], v[44:47]
    v_exp_f32 v88, v88
    s_waitcnt lgkmcnt(4)
    v_mfma_f32_16x16x32_bf16 v[24:27], v[180:183], a[204:207], v[24:27]
    v_exp_f32 v89, v89
    v_cvt_pk_bf16_f32 v158, v84, v85
    v_mfma_f32_16x16x32_bf16 v[28:31], v[180:183], a[220:223], v[28:31]
    v_exp_f32 v90, v90
    v_mfma_f32_16x16x32_bf16 v[32:35], v[180:183], a[236:239], v[32:35]
    v_exp_f32 v91, v91
    v_cvt_pk_bf16_f32 v159, v86, v87
    v_mfma_f32_16x16x32_bf16 v[36:39], v[180:183], a[252:255], v[36:39]
    v_exp_f32 v68, v68
    v_mfma_f32_16x16x32_bf16 v[40:43], v[180:183], v[212:215], v[40:43]
    v_exp_f32 v69, v69
    v_cvt_pk_bf16_f32 v160, v64, v65
    v_mfma_f32_16x16x32_bf16 v[44:47], v[180:183], v[228:231], v[44:47]
    v_exp_f32 v70, v70
    s_waitcnt lgkmcnt(2)
    v_mfma_f32_16x16x32_bf16 a[0:3], v[168:171], v[144:147], a[0:3]
    v_exp_f32 v71, v71
    v_cvt_pk_bf16_f32 v161, v66, v67
    v_mfma_f32_16x16x32_bf16 a[4:7], v[168:171], v[148:151], a[4:7]
    v_exp_f32 v92, v92
    v_exp_f32 v93, v93
    v_exp_f32 v94, v94
    v_exp_f32 v95, v95
    v_cvt_pk_bf16_f32 v162, v88, v89
    v_cvt_pk_bf16_f32 v163, v90, v91
    v_mfma_f32_16x16x32_bf16 a[8:11], v[168:171], v[152:155], a[8:11]
    v_cvt_pk_bf16_f32 v164, v68, v69
    v_cvt_pk_bf16_f32 v165, v70, v71
    v_cvt_pk_bf16_f32 v166, v92, v93
    v_cvt_pk_bf16_f32 v167, v94, v95
    v_mfma_f32_16x16x32_bf16 a[12:15], v[168:171], v[156:159], a[12:15]
    v_mfma_f32_16x16x32_bf16 a[16:19], v[168:171], v[160:163], a[16:19]
    ds_read_b64_tr_b16 v[176:177], v193 offset:8768
    ds_read_b64_tr_b16 v[178:179], v193 offset:13120
    v_mfma_f32_16x16x32_bf16 a[20:23], v[168:171], v[164:167], a[20:23]
    v_mfma_f32_16x16x32_bf16 v[120:123], v[184:187], v[144:147], v[120:123]
    s_waitcnt lgkmcnt(2)
    v_mfma_f32_16x16x32_bf16 a[24:27], v[172:175], v[144:147], a[24:27]
    ds_read_b64_tr_b16 v[180:181], v194 offset:8768
    ds_read_b64_tr_b16 v[182:183], v194 offset:13120
    v_mfma_f32_16x16x32_bf16 a[28:31], v[172:175], v[148:151], a[28:31]
    v_max3_f32 v232, v0, v1, v2
    v_max3_f32 v232, v232, v3, v4
    v_mfma_f32_16x16x32_bf16 a[32:35], v[172:175], v[152:155], a[32:35]
    v_max3_f32 v232, v232, v5, v6
    v_max3_f32 v232, v232, v7, v8
    v_mfma_f32_16x16x32_bf16 a[36:39], v[172:175], v[156:159], a[36:39]
    v_max3_f32 v232, v232, v9, v10
    v_max3_f32 v232, v232, v11, v12
    v_max3_f32 v232, v232, v13, v14
    v_mfma_f32_16x16x32_bf16 a[40:43], v[172:175], v[160:163], a[40:43]
    v_max3_f32 v232, v232, v15, v16
    v_max3_f32 v232, v232, v17, v18
    v_mfma_f32_16x16x32_bf16 a[44:47], v[172:175], v[164:167], a[44:47]
    v_max3_f32 v232, v232, v19, v20
    v_max3_f32 v232, v232, v21, v22
    v_max3_f32 v232, v232, v23, v24
    v_mfma_f32_16x16x32_bf16 v[124:127], v[184:187], v[148:151], v[124:127]
    ds_read_b64_tr_b16 v[168:169], v195 offset:8704
    ds_read_b64_tr_b16 v[170:171], v195 offset:13056
    s_waitcnt lgkmcnt(4)
    v_mfma_f32_16x16x32_bf16 a[48:51], v[176:179], v[144:147], a[48:51]
    v_max3_f32 v232, v232, v25, v26
    v_max3_f32 v232, v232, v27, v28
    v_max3_f32 v232, v232, v29, v30
    v_mfma_f32_16x16x32_bf16 a[52:55], v[176:179], v[148:151], a[52:55]
    v_max3_f32 v232, v232, v31, v32
    v_max3_f32 v232, v232, v33, v34
    v_mfma_f32_16x16x32_bf16 a[56:59], v[176:179], v[152:155], a[56:59]
    v_max3_f32 v232, v232, v35, v36
    v_max3_f32 v232, v232, v37, v38
    v_max3_f32 v232, v232, v39, v40
    v_mfma_f32_16x16x32_bf16 a[60:63], v[176:179], v[156:159], a[60:63]
    v_max3_f32 v232, v232, v41, v42
    v_max3_f32 v232, v232, v43, v44
    v_mfma_f32_16x16x32_bf16 a[64:67], v[176:179], v[160:163], a[64:67]
    v_max3_f32 v232, v232, v45, v46
    v_max3_f32 v232, v232, v47, v47
    v_cmp_lt_f32 vcc, s76, v232
    v_mfma_f32_16x16x32_bf16 a[68:71], v[176:179], v[164:167], a[68:71]
    v_mfma_f32_16x16x32_bf16 v[128:131], v[184:187], v[152:155], v[128:131]
    ds_read_b64_tr_b16 v[172:173], v196 offset:8704
    ds_read_b64_tr_b16 v[174:175], v196 offset:13056
    s_waitcnt lgkmcnt(4)
    v_mfma_f32_16x16x32_bf16 a[72:75], v[180:183], v[144:147], a[72:75]
    v_mfma_f32_16x16x32_bf16 a[76:79], v[180:183], v[148:151], a[76:79]
    v_mfma_f32_16x16x32_bf16 a[80:83], v[180:183], v[152:155], a[80:83]
    v_mfma_f32_16x16x32_bf16 a[84:87], v[180:183], v[156:159], a[84:87]
    v_mfma_f32_16x16x32_bf16 a[88:91], v[180:183], v[160:163], a[88:91]
    v_mfma_f32_16x16x32_bf16 a[92:95], v[180:183], v[164:167], a[92:95]
    v_mfma_f32_16x16x32_bf16 v[132:135], v[184:187], v[156:159], v[132:135]
    ds_read_b64_tr_b16 v[176:177], v195 offset:8768
    ds_read_b64_tr_b16 v[178:179], v195 offset:13120
    s_waitcnt lgkmcnt(4)
    v_mfma_f32_16x16x32_bf16 a[96:99], v[168:171], v[144:147], a[96:99]
    v_mfma_f32_16x16x32_bf16 a[100:103], v[168:171], v[148:151], a[100:103]
    v_mfma_f32_16x16x32_bf16 a[104:107], v[168:171], v[152:155], a[104:107]
    v_mfma_f32_16x16x32_bf16 a[108:111], v[168:171], v[156:159], a[108:111]
    v_mfma_f32_16x16x32_bf16 a[112:115], v[168:171], v[160:163], a[112:115]
    v_mfma_f32_16x16x32_bf16 a[116:119], v[168:171], v[164:167], a[116:119]
    ds_read_b64_tr_b16 v[180:181], v196 offset:8768
    ds_read_b64_tr_b16 v[182:183], v196 offset:13120
    v_mfma_f32_16x16x32_bf16 v[136:139], v[184:187], v[160:163], v[136:139]
    s_waitcnt lgkmcnt(4)
    v_mfma_f32_16x16x32_bf16 a[120:123], v[172:175], v[144:147], a[120:123]
    v_mfma_f32_16x16x32_bf16 a[124:127], v[172:175], v[148:151], a[124:127]
    v_mfma_f32_16x16x32_bf16 a[128:131], v[172:175], v[152:155], a[128:131]
    v_mfma_f32_16x16x32_bf16 a[132:135], v[172:175], v[156:159], a[132:135]
    v_mfma_f32_16x16x32_bf16 a[136:139], v[172:175], v[160:163], a[136:139]
    ds_read_b128 v[168:171], v192 offset:26112
    v_mfma_f32_16x16x32_bf16 a[140:143], v[172:175], v[164:167], a[140:143]
    v_mfma_f32_16x16x32_bf16 v[140:143], v[184:187], v[164:167], v[140:143]
    s_waitcnt lgkmcnt(3)
    v_mfma_f32_16x16x32_bf16 a[144:147], v[176:179], v[144:147], a[144:147]
    v_mfma_f32_16x16x32_bf16 a[148:151], v[176:179], v[148:151], a[148:151]
    v_mfma_f32_16x16x32_bf16 a[152:155], v[176:179], v[152:155], a[152:155]
    v_mfma_f32_16x16x32_bf16 a[156:159], v[176:179], v[156:159], a[156:159]
    ds_read_b128 v[172:175], v192 offset:26176
    v_mfma_f32_16x16x32_bf16 a[160:163], v[176:179], v[160:163], a[160:163]
    v_mfma_f32_16x16x32_bf16 a[164:167], v[176:179], v[164:167], a[164:167]
    s_waitcnt lgkmcnt(2)
    v_mfma_f32_16x16x32_bf16 a[168:171], v[180:183], v[144:147], a[168:171]
    s_waitcnt vmcnt(10)
    s_barrier
    v_mfma_f32_16x16x32_bf16 a[172:175], v[180:183], v[148:151], a[172:175]
    v_mfma_f32_16x16x32_bf16 a[176:179], v[180:183], v[152:155], a[176:179]
    v_mfma_f32_16x16x32_bf16 a[180:183], v[180:183], v[156:159], a[180:183]
    v_mfma_f32_16x16x32_bf16 a[184:187], v[180:183], v[160:163], a[184:187]
    v_mfma_f32_16x16x32_bf16 a[188:191], v[180:183], v[164:167], a[188:191]
    s_cbranch_vccnz L_rare_29
L_back_29:
    s_waitcnt lgkmcnt(1)
    v_mfma_f32_16x16x32_bf16 v[48:51], v[168:171], a[192:195], v[96:99]
    ds_read_b128 v[176:179], v192 offset:26240
    v_exp_f32 v0, v0
    v_mfma_f32_16x16x32_bf16 v[52:55], v[168:171], a[208:211], v[100:103]
    v_exp_f32 v1, v1
    v_mfma_f32_16x16x32_bf16 v[56:59], v[168:171], a[224:227], v[104:107]
    v_exp_f32 v2, v2
    v_cvt_pk_bf16_f32 v144, v0, v1
    v_mfma_f32_16x16x32_bf16 v[60:63], v[168:171], a[240:243], v[108:111]
    ds_read_b128 v[180:183], v192 offset:26304
    v_exp_f32 v3, v3
    v_mfma_f32_16x16x32_bf16 v[64:67], v[168:171], v[200:203], v[112:115]
    v_exp_f32 v24, v24
    v_mfma_f32_16x16x32_bf16 v[68:71], v[168:171], v[216:219], v[116:119]
    v_exp_f32 v25, v25
    s_waitcnt lgkmcnt(2)
    v_mfma_f32_16x16x32_bf16 v[48:51], v[172:175], a[196:199], v[48:51]
    v_exp_f32 v26, v26
    v_cvt_pk_bf16_f32 v145, v2, v3
    v_mfma_f32_16x16x32_bf16 v[52:55], v[172:175], a[212:215], v[52:55]
    v_exp_f32 v27, v27
    v_mfma_f32_16x16x32_bf16 v[56:59], v[172:175], a[228:231], v[56:59]
    s_lshl_b32 s34, s4, 2
    s_add_u32 s34, s34, s3
    v_cvt_pk_bf16_f32 v146, v24, v25
    v_mfma_f32_16x16x32_bf16 v[60:63], v[172:175], a[244:247], v[60:63]
    s_mul_i32 s34, s34, 9216
    s_add_u32 s34, s34, 0
    v_mfma_f32_16x16x32_bf16 v[64:67], v[172:175], v[204:207], v[64:67]
    ds_read_b128 v[168:171], v192 offset:30464
    buffer_load_dword v244, v239, s[20:23], s34 offen
    v_mfma_f32_16x16x32_bf16 v[68:71], v[172:175], v[220:223], v[68:71]
    v_exp_f32 v4, v4
    s_waitcnt lgkmcnt(2)
    v_mfma_f32_16x16x32_bf16 v[48:51], v[176:179], a[200:203], v[48:51]
    s_lshl_b32 s34, s4, 2
    s_add_u32 s34, s34, s3
    v_cvt_pk_bf16_f32 v147, v26, v27
    v_mfma_f32_16x16x32_bf16 v[52:55], v[176:179], a[216:219], v[52:55]
    s_mul_i32 s34, s34, 9216
    s_add_u32 s34, s34, 4608
    v_mfma_f32_16x16x32_bf16 v[56:59], v[176:179], a[232:235], v[56:59]
    buffer_load_dword v244, v239, s[20:23], s34 offen
    v_mfma_f32_16x16x32_bf16 v[60:63], v[176:179], a[248:251], v[60:63]
    ds_read_b128 v[172:175], v192 offset:30528
    v_exp_f32 v5, v5
    v_mfma_f32_16x16x32_bf16 v[64:67], v[176:179], v[208:211], v[64:67]
    v_exp_f32 v6, v6
    v_cvt_pk_bf16_f32 v148, v4, v5
    v_mfma_f32_16x16x32_bf16 v[68:71], v[176:179], v[224:227], v[68:71]
    v_exp_f32 v7, v7
    s_waitcnt lgkmcnt(2)
    v_mfma_f32_16x16x32_bf16 v[48:51], v[180:183], a[204:207], v[48:51]
    v_exp_f32 v28, v28
    v_cvt_pk_bf16_f32 v149, v6, v7
    v_mfma_f32_16x16x32_bf16 v[52:55], v[180:183], a[220:223], v[52:55]
    v_exp_f32 v29, v29
    v_mfma_f32_16x16x32_bf16 v[56:59], v[180:183], a[236:239], v[56:59]
    v_exp_f32 v30, v30
    v_cvt_pk_bf16_f32 v150, v28, v29
    v_mfma_f32_16x16x32_bf16 v[60:63], v[180:183], a[252:255], v[60:63]
    ds_read_b128 v[176:179], v192 offset:30592
    v_exp_f32 v31, v31
    v_mfma_f32_16x16x32_bf16 v[64:67], v[180:183], v[212:215], v[64:67]
    v_exp_f32 v8, v8
    v_mfma_f32_16x16x32_bf16 v[68:71], v[180:183], v[228:231], v[68:71]
    v_exp_f32 v9, v9
    s_waitcnt lgkmcnt(2)
    v_mfma_f32_16x16x32_bf16 v[72:75], v[168:171], a[192:195], v[96:99]
    v_exp_f32 v10, v10
    v_cvt_pk_bf16_f32 v151, v30, v31
    v_mfma_f32_16x16x32_bf16 v[76:79], v[168:171], a[208:211], v[100:103]
    v_exp_f32 v11, v11
    v_mfma_f32_16x16x32_bf16 v[80:83], v[168:171], a[224:227], v[104:107]
    v_exp_f32 v32, v32
    v_cvt_pk_bf16_f32 v152, v8, v9
    v_mfma_f32_16x16x32_bf16 v[84:87], v[168:171], a[240:243], v[108:111]
    ds_read_b128 v[180:183], v192 offset:30656
    v_exp_f32 v33, v33
    v_mfma_f32_16x16x32_bf16 v[88:91], v[168:171], v[200:203], v[112:115]
    v_exp_f32 v34, v34
    v_mfma_f32_16x16x32_bf16 v[92:95], v[168:171], v[216:219], v[116:119]
    v_exp_f32 v35, v35
    s_waitcnt lgkmcnt(2)
    v_mfma_f32_16x16x32_bf16 v[72:75], v[172:175], a[196:199], v[72:75]
    v_exp_f32 v12, v12
    v_cvt_pk_bf16_f32 v153, v10, v11
    v_mfma_f32_16x16x32_bf16 v[76:79], v[172:175], a[212:215], v[76:79]
    v_exp_f32 v13, v13
    v_mfma_f32_16x16x32_bf16 v[80:83], v[172:175], a[228:231], v[80:83]
    v_exp_f32 v14, v14
    v_cvt_pk_bf16_f32 v154, v32, v33
    v_mfma_f32_16x16x32_bf16 v[84:87], v[172:175], a[244:247], v[84:87]
    ds_read_b64_tr_b16 v[168:169], v193 offset:17408
    ds_read_b64_tr_b16 v[170:171], v193 offset:21760
    v_mfma_f32_16x16x32_bf16 v[88:91], v[172:175], v[204:207], v[88:91]
    v_exp_f32 v15, v15
    v_cvt_pk_bf16_f32 v155, v34, v35
    v_mfma_f32_16x16x32_bf16 v[92:95], v[172:175], v[220:223], v[92:95]
    v_exp_f32 v36, v36
    s_waitcnt lgkmcnt(3)
    v_mfma_f32_16x16x32_bf16 v[72:75], v[176:179], a[200:203], v[72:75]
    v_exp_f32 v37, v37
    v_cvt_pk_bf16_f32 v156, v12, v13
    v_mfma_f32_16x16x32_bf16 v[76:79], v[176:179], a[216:219], v[76:79]
    v_exp_f32 v38, v38
    v_mfma_f32_16x16x32_bf16 v[80:83], v[176:179], a[232:235], v[80:83]
    v_exp_f32 v39, v39
    v_cvt_pk_bf16_f32 v157, v14, v15
    v_mfma_f32_16x16x32_bf16 v[84:87], v[176:179], a[248:251], v[84:87]
    v_exp_f32 v16, v16
    v_mfma_f32_16x16x32_bf16 v[88:91], v[176:179], v[208:211], v[88:91]
    ds_read_b64_tr_b16 v[172:173], v194 offset:17408
    ds_read_b64_tr_b16 v[174:175], v194 offset:21760
    v_cvt_pk_bf16_f32 v158, v36, v37
    v_mfma_f32_16x16x32_bf16 v[92:95], v[176:179], v[224:227], v[92:95]
    v_exp_f32 v17, v17
    s_waitcnt lgkmcnt(4)
    v_mfma_f32_16x16x32_bf16 v[72:75], v[180:183], a[204:207], v[72:75]
    v_exp_f32 v18, v18
    v_cvt_pk_bf16_f32 v159, v38, v39
    v_mfma_f32_16x16x32_bf16 v[76:79], v[180:183], a[220:223], v[76:79]
    v_exp_f32 v19, v19
    v_mfma_f32_16x16x32_bf16 v[80:83], v[180:183], a[236:239], v[80:83]
    v_exp_f32 v40, v40
    v_cvt_pk_bf16_f32 v160, v16, v17
    v_mfma_f32_16x16x32_bf16 v[84:87], v[180:183], a[252:255], v[84:87]
    v_exp_f32 v41, v41
    v_mfma_f32_16x16x32_bf16 v[88:91], v[180:183], v[212:215], v[88:91]
    v_exp_f32 v42, v42
    v_cvt_pk_bf16_f32 v161, v18, v19
    v_mfma_f32_16x16x32_bf16 v[92:95], v[180:183], v[228:231], v[92:95]
    v_exp_f32 v43, v43
    s_waitcnt lgkmcnt(2)
    v_mfma_f32_16x16x32_bf16 a[0:3], v[168:171], v[144:147], a[0:3]
    v_exp_f32 v20, v20
    v_cvt_pk_bf16_f32 v162, v40, v41
    v_mfma_f32_16x16x32_bf16 a[4:7], v[168:171], v[148:151], a[4:7]
    v_exp_f32 v21, v21
    v_exp_f32 v22, v22
    v_exp_f32 v23, v23
    v_exp_f32 v44, v44
    v_exp_f32 v45, v45
    v_exp_f32 v46, v46
    v_exp_f32 v47, v47
    v_cvt_pk_bf16_f32 v163, v42, v43
    v_mfma_f32_16x16x32_bf16 a[8:11], v[168:171], v[152:155], a[8:11]
    v_cvt_pk_bf16_f32 v164, v20, v21
    v_cvt_pk_bf16_f32 v165, v22, v23
    v_cvt_pk_bf16_f32 v166, v44, v45
    v_cvt_pk_bf16_f32 v167, v46, v47
    v_mfma_f32_16x16x32_bf16 a[12:15], v[168:171], v[156:159], a[12:15]
    v_mfma_f32_16x16x32_bf16 a[16:19], v[168:171], v[160:163], a[16:19]
    ds_read_b64_tr_b16 v[176:177], v193 offset:17472
    ds_read_b64_tr_b16 v[178:179], v193 offset:21824
    v_mfma_f32_16x16x32_bf16 a[20:23], v[168:171], v[164:167], a[20:23]
    v_mfma_f32_16x16x32_bf16 v[120:123], v[184:187], v[144:147], v[120:123]
    s_waitcnt lgkmcnt(2)
    v_mfma_f32_16x16x32_bf16 a[24:27], v[172:175], v[144:147], a[24:27]
    v_mfma_f32_16x16x32_bf16 a[28:31], v[172:175], v[148:151], a[28:31]
    v_mfma_f32_16x16x32_bf16 a[32:35], v[172:175], v[152:155], a[32:35]
    ds_read_b64_tr_b16 v[180:181], v194 offset:17472
    ds_read_b64_tr_b16 v[182:183], v194 offset:21824
    v_mfma_f32_16x16x32_bf16 a[36:39], v[172:175], v[156:159], a[36:39]
    v_max3_f32 v232, v48, v49, v50
    v_max3_f32 v232, v232, v51, v52
    v_mfma_f32_16x16x32_bf16 a[40:43], v[172:175], v[160:163], a[40:43]
    v_max3_f32 v232, v232, v53, v54
    v_max3_f32 v232, v232, v55, v56
    v_mfma_f32_16x16x32_bf16 a[44:47], v[172:175], v[164:167], a[44:47]
    v_max3_f32 v232, v232, v57, v58
    v_max3_f32 v232, v232, v59, v60
    v_max3_f32 v232, v232, v61, v62
    v_mfma_f32_16x16x32_bf16 v[124:127], v[184:187], v[148:151], v[124:127]
    ds_read_b64_tr_b16 v[168:169], v195 offset:17408
    ds_read_b64_tr_b16 v[170:171], v195 offset:21760
    s_waitcnt lgkmcnt(4)
    v_mfma_f32_16x16x32_bf16 a[48:51], v[176:179], v[144:147], a[48:51]
    v_max3_f32 v232, v232, v63, v64
    v_max3_f32 v232, v232, v65, v66
    v_max3_f32 v232, v232, v67, v68
    v_mfma_f32_16x16x32_bf16 a[52:55], v[176:179], v[148:151], a[52:55]
    v_max3_f32 v232, v232, v69, v70
    v_max3_f32 v232, v232, v71, v72
    v_mfma_f32_16x16x32_bf16 a[56:59], v[176:179], v[152:155], a[56:59]
    v_max3_f32 v232, v232, v73, v74
    v_max3_f32 v232, v232, v75, v76
    v_max3_f32 v232, v232, v77, v78
    v_mfma_f32_16x16x32_bf16 a[60:63], v[176:179], v[156:159], a[60:63]
    v_max3_f32 v232, v232, v79, v80
    v_max3_f32 v232, v232, v81, v82
    v_mfma_f32_16x16x32_bf16 a[64:67], v[176:179], v[160:163], a[64:67]
    v_max3_f32 v232, v232, v83, v84
    v_max3_f32 v232, v232, v85, v86
    v_max3_f32 v232, v232, v87, v88
    v_mfma_f32_16x16x32_bf16 a[68:71], v[176:179], v[164:167], a[68:71]
    v_max3_f32 v232, v232, v89, v90
    v_max3_f32 v232, v232, v91, v92
    v_mfma_f32_16x16x32_bf16 v[128:131], v[184:187], v[152:155], v[128:131]
    ds_read_b64_tr_b16 v[172:173], v196 offset:17408
    ds_read_b64_tr_b16 v[174:175], v196 offset:21760
    v_max3_f32 v232, v232, v93, v94
    s_waitcnt lgkmcnt(4)
    v_mfma_f32_16x16x32_bf16 a[72:75], v[180:183], v[144:147], a[72:75]
    v_max3_f32 v232, v232, v95, v95
    v_cmp_lt_f32 vcc, s76, v232
    v_mfma_f32_16x16x32_bf16 a[76:79], v[180:183], v[148:151], a[76:79]
    v_mfma_f32_16x16x32_bf16 a[80:83], v[180:183], v[152:155], a[80:83]
    v_mfma_f32_16x16x32_bf16 a[84:87], v[180:183], v[156:159], a[84:87]
    v_mfma_f32_16x16x32_bf16 a[88:91], v[180:183], v[160:163], a[88:91]
    v_mfma_f32_16x16x32_bf16 a[92:95], v[180:183], v[164:167], a[92:95]
    v_mfma_f32_16x16x32_bf16 v[132:135], v[184:187], v[156:159], v[132:135]
    ds_read_b64_tr_b16 v[176:177], v195 offset:17472
    ds_read_b64_tr_b16 v[178:179], v195 offset:21824
    s_waitcnt lgkmcnt(4)
    v_mfma_f32_16x16x32_bf16 a[96:99], v[168:171], v[144:147], a[96:99]
    v_mfma_f32_16x16x32_bf16 a[100:103], v[168:171], v[148:151], a[100:103]
    v_mfma_f32_16x16x32_bf16 a[104:107], v[168:171], v[152:155], a[104:107]
    v_mfma_f32_16x16x32_bf16 a[108:111], v[168:171], v[156:159], a[108:111]
    v_mfma_f32_16x16x32_bf16 a[112:115], v[168:171], v[160:163], a[112:115]
    v_mfma_f32_16x16x32_bf16 a[116:119], v[168:171], v[164:167], a[116:119]
    ds_read_b64_tr_b16 v[180:181], v196 offset:17472
    ds_read_b64_tr_b16 v[182:183], v196 offset:21824
    v_mfma_f32_16x16x32_bf16 v[136:139], v[184:187], v[160:163], v[136:139]
    s_waitcnt lgkmcnt(4)
    v_mfma_f32_16x16x32_bf16 a[120:123], v[172:175], v[144:147], a[120:123]
    v_mfma_f32_16x16x32_bf16 a[124:127], v[172:175], v[148:151], a[124:127]
    v_mfma_f32_16x16x32_bf16 a[128:131], v[172:175], v[152:155], a[128:131]
    v_mfma_f32_16x16x32_bf16 a[132:135], v[172:175], v[156:159], a[132:135]
    v_mfma_f32_16x16x32_bf16 a[136:139], v[172:175], v[160:163], a[136:139]
    v_mfma_f32_16x16x32_bf16 a[140:143], v[172:175], v[164:167], a[140:143]
    v_mfma_f32_16x16x32_bf16 v[140:143], v[184:187], v[164:167], v[140:143]
    s_waitcnt lgkmcnt(2)
    v_mfma_f32_16x16x32_bf16 a[144:147], v[176:179], v[144:147], a[144:147]
    v_mfma_f32_16x16x32_bf16 a[148:151], v[176:179], v[148:151], a[148:151]
    v_mfma_f32_16x16x32_bf16 a[152:155], v[176:179], v[152:155], a[152:155]
    v_mfma_f32_16x16x32_bf16 a[156:159], v[176:179], v[156:159], a[156:159]
    v_mfma_f32_16x16x32_bf16 a[160:163], v[176:179], v[160:163], a[160:163]
    v_mfma_f32_16x16x32_bf16 a[164:167], v[176:179], v[164:167], a[164:167]
    s_waitcnt lgkmcnt(0)
    v_mfma_f32_16x16x32_bf16 a[168:171], v[180:183], v[144:147], a[168:171]
    s_waitcnt vmcnt(4)
    s_barrier
    v_mfma_f32_16x16x32_bf16 a[172:175], v[180:183], v[148:151], a[172:175]
    v_mfma_f32_16x16x32_bf16 a[176:179], v[180:183], v[152:155], a[176:179]
    v_mfma_f32_16x16x32_bf16 a[180:183], v[180:183], v[156:159], a[180:183]
    v_mfma_f32_16x16x32_bf16 a[184:187], v[180:183], v[160:163], a[184:187]
    v_mfma_f32_16x16x32_bf16 a[188:191], v[180:183], v[164:167], a[188:191]
    s_cbranch_vccnz L_rare_30
L_back_30:
    ds_read_b64_tr_b16 v[168:169], v193 offset:26112
    ds_read_b64_tr_b16 v[170:171], v193 offset:30464
    ds_read_b64_tr_b16 v[172:173], v194 offset:26112
    ds_read_b64_tr_b16 v[174:175], v194 offset:30464
    v_exp_f32 v48, v48
    v_exp_f32 v49, v49
    v_exp_f32 v50, v50
    v_exp_f32 v51, v51
    v_exp_f32 v72, v72
    v_exp_f32 v73, v73
    v_exp_f32 v74, v74
    v_exp_f32 v75, v75
    v_exp_f32 v52, v52
    v_exp_f32 v53, v53
    v_exp_f32 v54, v54
    v_exp_f32 v55, v55
    v_exp_f32 v76, v76
    v_exp_f32 v77, v77
    v_exp_f32 v78, v78
    v_exp_f32 v79, v79
    v_cvt_pk_bf16_f32 v144, v48, v49
    v_cvt_pk_bf16_f32 v145, v50, v51
    v_cvt_pk_bf16_f32 v146, v72, v73
    v_cvt_pk_bf16_f32 v147, v74, v75
    v_exp_f32 v56, v56
    v_exp_f32 v57, v57
    v_exp_f32 v58, v58
    v_exp_f32 v59, v59
    v_exp_f32 v80, v80
    v_exp_f32 v81, v81
    v_exp_f32 v82, v82
    v_exp_f32 v83, v83
    v_cvt_pk_bf16_f32 v148, v52, v53
    v_cvt_pk_bf16_f32 v149, v54, v55
    v_cvt_pk_bf16_f32 v150, v76, v77
    v_cvt_pk_bf16_f32 v151, v78, v79
    v_exp_f32 v60, v60
    v_exp_f32 v61, v61
    v_exp_f32 v62, v62
    v_exp_f32 v63, v63
    v_exp_f32 v84, v84
    v_exp_f32 v85, v85
    v_exp_f32 v86, v86
    v_exp_f32 v87, v87
    v_cvt_pk_bf16_f32 v152, v56, v57
    v_cvt_pk_bf16_f32 v153, v58, v59
    v_cvt_pk_bf16_f32 v154, v80, v81
    v_cvt_pk_bf16_f32 v155, v82, v83
    s_waitcnt lgkmcnt(2)
    v_mfma_f32_16x16x32_bf16 a[0:3], v[168:171], v[144:147], a[0:3]
    v_exp_f32 v64, v64
    v_exp_f32 v65, v65
    v_exp_f32 v66, v66
    v_exp_f32 v67, v67
    v_exp_f32 v88, v88
    v_exp_f32 v89, v89
    v_exp_f32 v90, v90
    v_exp_f32 v91, v91
    v_cvt_pk_bf16_f32 v156, v60, v61
    v_cvt_pk_bf16_f32 v157, v62, v63
    v_cvt_pk_bf16_f32 v158, v84, v85
    v_cvt_pk_bf16_f32 v159, v86, v87
    v_mfma_f32_16x16x32_bf16 a[4:7], v[168:171], v[148:151], a[4:7]
    v_exp_f32 v68, v68
    v_exp_f32 v69, v69
    v_exp_f32 v70, v70
    v_exp_f32 v71, v71
    v_exp_f32 v92, v92
    v_exp_f32 v93, v93
    v_exp_f32 v94, v94
    v_exp_f32 v95, v95
    v_cvt_pk_bf16_f32 v160, v64, v65
    v_cvt_pk_bf16_f32 v161, v66, v67
    v_cvt_pk_bf16_f32 v162, v88, v89
    v_cvt_pk_bf16_f32 v163, v90, v91
    v_mfma_f32_16x16x32_bf16 a[8:11], v[168:171], v[152:155], a[8:11]
    v_cvt_pk_bf16_f32 v164, v68, v69
    v_cvt_pk_bf16_f32 v165, v70, v71
    v_cvt_pk_bf16_f32 v166, v92, v93
    v_cvt_pk_bf16_f32 v167, v94, v95
    v_mfma_f32_16x16x32_bf16 a[12:15], v[168:171], v[156:159], a[12:15]
    v_mfma_f32_16x16x32_bf16 a[16:19], v[168:171], v[160:163], a[16:19]
    v_mfma_f32_16x16x32_bf16 a[20:23], v[168:171], v[164:167], a[20:23]
    v_mfma_f32_16x16x32_bf16 v[120:123], v[184:187], v[144:147], v[120:123]
    v_mfma_f32_16x16x32_bf16 v[124:127], v[184:187], v[148:151], v[124:127]
    v_mfma_f32_16x16x32_bf16 v[128:131], v[184:187], v[152:155], v[128:131]
    ds_read_b64_tr_b16 v[176:177], v193 offset:26176
    ds_read_b64_tr_b16 v[178:179], v193 offset:30528
    s_add_u32 m0, s80, 0
    s_mov_b32 s81, 1024
    v_mfma_f32_16x16x32_bf16 v[132:135], v[184:187], v[156:159], v[132:135]
    s_add_u32 s73, s44, s81
    v_mfma_f32_16x16x32_bf16 v[136:139], v[184:187], v[160:163], v[136:139]
    buffer_load_dwordx4 v240, s[20:23], s73 offen lds
    v_mfma_f32_16x16x32_bf16 v[140:143], v[184:187], v[164:167], v[140:143]
    s_add_u32 m0, s80, 4096
    s_add_u32 s73, s45, s81
    s_waitcnt lgkmcnt(2)
    v_mfma_f32_16x16x32_bf16 a[24:27], v[172:175], v[144:147], a[24:27]
    buffer_load_dwordx4 v240, s[20:23], s73 offen lds
    v_mfma_f32_16x16x32_bf16 a[28:31], v[172:175], v[148:151], a[28:31]
    v_mfma_f32_16x16x32_bf16 a[32:35], v[172:175], v[152:155], a[32:35]
    ds_read_b64_tr_b16 v[180:181], v194 offset:26176
    ds_read_b64_tr_b16 v[182:183], v194 offset:30528
    s_add_u32 m0, s80, 8192
    s_add_u32 s73, s46, s81
    v_mfma_f32_16x16x32_bf16 a[36:39], v[172:175], v[156:159], a[36:39]
    buffer_load_dwordx4 v240, s[20:23], s73 offen lds
    v_mfma_f32_16x16x32_bf16 a[40:43], v[172:175], v[160:163], a[40:43]
    v_mfma_f32_16x16x32_bf16 a[44:47], v[172:175], v[164:167], a[44:47]
    s_add_u32 m0, s80, 12288
    s_add_u32 s73, s47, s81
    s_waitcnt lgkmcnt(2)
    v_mfma_f32_16x16x32_bf16 a[48:51], v[176:179], v[144:147], a[48:51]
    buffer_load_dwordx4 v240, s[20:23], s73 offen lds
    v_mfma_f32_16x16x32_bf16 a[52:55], v[176:179], v[148:151], a[52:55]
    v_mfma_f32_16x16x32_bf16 a[56:59], v[176:179], v[152:155], a[56:59]
    ds_read_b64_tr_b16 v[168:169], v195 offset:26112
    ds_read_b64_tr_b16 v[170:171], v195 offset:30464
    s_add_u32 m0, s80, 16384
    s_add_u32 s81, s81, 36864
    v_mfma_f32_16x16x32_bf16 a[60:63], v[176:179], v[156:159], a[60:63]
    s_add_u32 s73, s44, s81
    v_mfma_f32_16x16x32_bf16 a[64:67], v[176:179], v[160:163], a[64:67]
    buffer_load_dwordx4 v240, s[20:23], s73 offen lds
    v_mfma_f32_16x16x32_bf16 a[68:71], v[176:179], v[164:167], a[68:71]
    s_add_u32 m0, s80, 20480
    s_add_u32 s73, s45, s81
    s_waitcnt lgkmcnt(2)
    v_mfma_f32_16x16x32_bf16 a[72:75], v[180:183], v[144:147], a[72:75]
    buffer_load_dwordx4 v240, s[20:23], s73 offen lds
    v_mfma_f32_16x16x32_bf16 a[76:79], v[180:183], v[148:151], a[76:79]
    v_mfma_f32_16x16x32_bf16 a[80:83], v[180:183], v[152:155], a[80:83]
    ds_read_b64_tr_b16 v[172:173], v196 offset:26112
    ds_read_b64_tr_b16 v[174:175], v196 offset:30464
    s_add_u32 m0, s80, 24576
    s_add_u32 s73, s46, s81
    v_mfma_f32_16x16x32_bf16 a[84:87], v[180:183], v[156:159], a[84:87]
    buffer_load_dwordx4 v240, s[20:23], s73 offen lds
    v_mfma_f32_16x16x32_bf16 a[88:91], v[180:183], v[160:163], a[88:91]
    v_mfma_f32_16x16x32_bf16 a[92:95], v[180:183], v[164:167], a[92:95]
    s_add_u32 m0, s80, 28672
    s_add_u32 s73, s47, s81
    s_waitcnt lgkmcnt(2)
    v_mfma_f32_16x16x32_bf16 a[96:99], v[168:171], v[144:147], a[96:99]
    buffer_load_dwordx4 v240, s[20:23], s73 offen lds
    v_mfma_f32_16x16x32_bf16 a[100:103], v[168:171], v[148:151], a[100:103]
    v_mfma_f32_16x16x32_bf16 a[104:107], v[168:171], v[152:155], a[104:107]
    ds_read_b64_tr_b16 v[176:177], v195 offset:26176
    ds_read_b64_tr_b16 v[178:179], v195 offset:30528
    s_add_u32 m0, s80, 32768
    s_add_u32 s81, s81, 36864
    v_mfma_f32_16x16x32_bf16 a[108:111], v[168:171], v[156:159], a[108:111]
    s_add_u32 s73, s44, s81
    v_mfma_f32_16x16x32_bf16 a[112:115], v[168:171], v[160:163], a[112:115]
    buffer_load_dwordx4 v240, s[20:23], s73 offen lds
    v_mfma_f32_16x16x32_bf16 a[116:119], v[168:171], v[164:167], a[116:119]
    s_add_u32 m0, s80, 36864
    s_add_u32 s73, s45, s81
    s_waitcnt lgkmcnt(2)
    v_mfma_f32_16x16x32_bf16 a[120:123], v[172:175], v[144:147], a[120:123]
    buffer_load_dwordx4 v240, s[20:23], s73 offen lds
    v_mfma_f32_16x16x32_bf16 a[124:127], v[172:175], v[148:151], a[124:127]
    v_mfma_f32_16x16x32_bf16 a[128:131], v[172:175], v[152:155], a[128:131]
    ds_read_b64_tr_b16 v[180:181], v196 offset:26176
    ds_read_b64_tr_b16 v[182:183], v196 offset:30528
    s_add_u32 m0, s80, 40960
    s_add_u32 s73, s46, s81
    v_mfma_f32_16x16x32_bf16 a[132:135], v[172:175], v[156:159], a[132:135]
    buffer_load_dwordx4 v240, s[20:23], s73 offen lds
    v_mfma_f32_16x16x32_bf16 a[136:139], v[172:175], v[160:163], a[136:139]
    v_mfma_f32_16x16x32_bf16 a[140:143], v[172:175], v[164:167], a[140:143]
    s_add_u32 m0, s80, 45056
    s_add_u32 s73, s47, s81
    s_waitcnt lgkmcnt(2)
    v_mfma_f32_16x16x32_bf16 a[144:147], v[176:179], v[144:147], a[144:147]
    buffer_load_dwordx4 v240, s[20:23], s73 offen lds
    v_mfma_f32_16x16x32_bf16 a[148:151], v[176:179], v[148:151], a[148:151]
    v_mfma_f32_16x16x32_bf16 a[152:155], v[176:179], v[152:155], a[152:155]
    v_mfma_f32_16x16x32_bf16 a[156:159], v[176:179], v[156:159], a[156:159]
    v_mfma_f32_16x16x32_bf16 a[160:163], v[176:179], v[160:163], a[160:163]
    v_mfma_f32_16x16x32_bf16 a[164:167], v[176:179], v[164:167], a[164:167]
    v_mov_b32 v121, v120
    s_waitcnt lgkmcnt(0)
    v_mfma_f32_16x16x32_bf16 a[168:171], v[180:183], v[144:147], a[168:171]
    s_barrier
    v_mov_b32 v125, v124
    v_mfma_f32_16x16x32_bf16 a[172:175], v[180:183], v[148:151], a[172:175]
    v_mov_b32 v129, v128
    v_mov_b32 v133, v132
    v_mov_b32 v137, v136
    v_mfma_f32_16x16x32_bf16 a[176:179], v[180:183], v[152:155], a[176:179]
    v_mov_b32 v141, v140
    v_permlane32_swap_b32 v120, v121
    v_mfma_f32_16x16x32_bf16 a[180:183], v[180:183], v[156:159], a[180:183]
    v_permlane32_swap_b32 v124, v125
    v_permlane32_swap_b32 v128, v129
    v_mfma_f32_16x16x32_bf16 a[184:187], v[180:183], v[160:163], a[184:187]
    v_permlane32_swap_b32 v132, v133
    v_permlane32_swap_b32 v136, v137
    v_mfma_f32_16x16x32_bf16 a[188:191], v[180:183], v[164:167], a[188:191]
    v_permlane32_swap_b32 v140, v141
    v_add_f32 v120, v120, v121
    v_add_f32 v124, v124, v125
    v_add_f32 v128, v128, v129
    v_add_f32 v132, v132, v133
    v_add_f32 v136, v136, v137
    v_add_f32 v140, v140, v141
    v_mov_b32 v121, v120
    v_mov_b32 v125, v124
    v_mov_b32 v129, v128
    v_mov_b32 v133, v132
    v_mov_b32 v137, v136
    v_mov_b32 v141, v140
    v_permlane16_swap_b32 v120, v121
    v_permlane16_swap_b32 v124, v125
    v_permlane16_swap_b32 v128, v129
    v_permlane16_swap_b32 v132, v133
    v_permlane16_swap_b32 v136, v137
    v_permlane16_swap_b32 v140, v141
    v_add_f32 v120, v120, v121
    v_add_f32 v124, v124, v125
    v_add_f32 v128, v128, v129
    v_add_f32 v132, v132, v133
    v_add_f32 v136, v136, v137
    v_add_f32 v140, v140, v141
    v_rcp_f32 v80, v120
    v_rcp_f32 v82, v124
    v_rcp_f32 v84, v128
    v_rcp_f32 v86, v132
    v_rcp_f32 v88, v136
    v_rcp_f32 v90, v140
    s_waitcnt lgkmcnt(0)
    s_nop 15
    s_branch L_norm
L_rare_0:
    s_call_b64 s[78:79], L_rescale_1
    s_branch L_back_0
L_rare_1:
    s_call_b64 s[78:79], L_rescale_0
    s_branch L_back_1
L_rare_2:
    s_call_b64 s[78:79], L_rescale_1
    s_branch L_back_2
L_rare_3:
    s_call_b64 s[78:79], L_rescale_0
    s_branch L_back_3
L_rare_4:
    s_call_b64 s[78:79], L_rescale_1
    s_branch L_back_4
L_rare_29:
    s_call_b64 s[78:79], L_rescale_0
    s_branch L_back_29
L_rare_30:
    s_call_b64 s[78:79], L_rescale_1
    s_branch L_back_30
L_rescale_0:
    s_nop 15
    v_max3_f32 v188, v0, v1, v2
    v_max3_f32 v188, v188, v3, v24
    v_max3_f32 v188, v188, v25, v26
    v_max3_f32 v188, v188, v27, 0
    v_mov_b32 v189, v188
    s_nop 1
    v_permlane32_swap_b32 v188, v189
    v_max_f32 v188, v188, v189
    v_mov_b32 v189, v188
    s_nop 1
    v_permlane16_swap_b32 v188, v189
    v_max_f32 v188, v188, v189
    v_exp_f32 v190, -v188
    v_sub_f32 v96, v96, v188
    v_sub_f32 v97, v97, v188
    v_sub_f32 v98, v98, v188
    v_sub_f32 v99, v99, v188
    v_sub_f32 v0, v0, v188
    v_sub_f32 v1, v1, v188
    v_sub_f32 v2, v2, v188
    v_sub_f32 v3, v3, v188
    v_sub_f32 v24, v24, v188
    v_sub_f32 v25, v25, v188
    v_sub_f32 v26, v26, v188
    v_sub_f32 v27, v27, v188
    v_mul_f32 v120, v120, v190
    v_mul_f32 v121, v121, v190
    v_mul_f32 v122, v122, v190
    v_mul_f32 v123, v123, v190
    v_accvgpr_read_b32 v232, a0
    v_accvgpr_read_b32 v233, a1
    v_mul_f32 v232, v232, v190
    v_mul_f32 v233, v233, v190
    v_accvgpr_write_b32 a0, v232
    v_accvgpr_write_b32 a1, v233
    v_accvgpr_read_b32 v232, a2
    v_accvgpr_read_b32 v233, a3
    v_mul_f32 v232, v232, v190
    v_mul_f32 v233, v233, v190
    v_accvgpr_write_b32 a2, v232
    v_accvgpr_write_b32 a3, v233
    v_accvgpr_read_b32 v232, a24
    v_accvgpr_read_b32 v233, a25
    v_mul_f32 v232, v232, v190
    v_mul_f32 v233, v233, v190
    v_accvgpr_write_b32 a24, v232
    v_accvgpr_write_b32 a25, v233
    v_accvgpr_read_b32 v232, a26
    v_accvgpr_read_b32 v233, a27
    v_mul_f32 v232, v232, v190
    v_mul_f32 v233, v233, v190
    v_accvgpr_write_b32 a26, v232
    v_accvgpr_write_b32 a27, v233
    v_accvgpr_read_b32 v232, a48
    v_accvgpr_read_b32 v233, a49
    v_mul_f32 v232, v232, v190
    v_mul_f32 v233, v233, v190
    v_accvgpr_write_b32 a48, v232
    v_accvgpr_write_b32 a49, v233
    v_accvgpr_read_b32 v232, a50
    v_accvgpr_read_b32 v233, a51
    v_mul_f32 v232, v232, v190
    v_mul_f32 v233, v233, v190
    v_accvgpr_write_b32 a50, v232
    v_accvgpr_write_b32 a51, v233
    v_accvgpr_read_b32 v232, a72
    v_accvgpr_read_b32 v233, a73
    v_mul_f32 v232, v232, v190
    v_mul_f32 v233, v233, v190
    v_accvgpr_write_b32 a72, v232
    v_accvgpr_write_b32 a73, v233
    v_accvgpr_read_b32 v232, a74
    v_accvgpr_read_b32 v233, a75
    v_mul_f32 v232, v232, v190
    v_mul_f32 v233, v233, v190
    v_accvgpr_write_b32 a74, v232
    v_accvgpr_write_b32 a75, v233
    v_accvgpr_read_b32 v232, a96
    v_accvgpr_read_b32 v233, a97
    v_mul_f32 v232, v232, v190
    v_mul_f32 v233, v233, v190
    v_accvgpr_write_b32 a96, v232
    v_accvgpr_write_b32 a97, v233
    v_accvgpr_read_b32 v232, a98
    v_accvgpr_read_b32 v233, a99
    v_mul_f32 v232, v232, v190
    v_mul_f32 v233, v233, v190
    v_accvgpr_write_b32 a98, v232
    v_accvgpr_write_b32 a99, v233
    v_accvgpr_read_b32 v232, a120
    v_accvgpr_read_b32 v233, a121
    v_mul_f32 v232, v232, v190
    v_mul_f32 v233, v233, v190
    v_accvgpr_write_b32 a120, v232
    v_accvgpr_write_b32 a121, v233
    v_accvgpr_read_b32 v232, a122
    v_accvgpr_read_b32 v233, a123
    v_mul_f32 v232, v232, v190
    v_mul_f32 v233, v233, v190
    v_accvgpr_write_b32 a122, v232
    v_accvgpr_write_b32 a123, v233
    v_accvgpr_read_b32 v232, a144
    v_accvgpr_read_b32 v233, a145
    v_mul_f32 v232, v232, v190
    v_mul_f32 v233, v233, v190
    v_accvgpr_write_b32 a144, v232
    v_accvgpr_write_b32 a145, v233
    v_accvgpr_read_b32 v232, a146
    v_accvgpr_read_b32 v233, a147
    v_mul_f32 v232, v232, v190
    v_mul_f32 v233, v233, v190
    v_accvgpr_write_b32 a146, v232
    v_accvgpr_write_b32 a147, v233
    v_accvgpr_read_b32 v232, a168
    v_accvgpr_read_b32 v233, a169
    v_mul_f32 v232, v232, v190
    v_mul_f32 v233, v233, v190
    v_accvgpr_write_b32 a168, v232
    v_accvgpr_write_b32 a169, v233
    v_accvgpr_read_b32 v232, a170
    v_accvgpr_read_b32 v233, a171
    v_mul_f32 v232, v232, v190
    v_mul_f32 v233, v233, v190
    v_accvgpr_write_b32 a170, v232
    v_accvgpr_write_b32 a171, v233
    v_max3_f32 v188, v4, v5, v6
    v_max3_f32 v188, v188, v7, v28
    v_max3_f32 v188, v188, v29, v30
    v_max3_f32 v188, v188, v31, 0
    v_mov_b32 v189, v188
    s_nop 1
    v_permlane32_swap_b32 v188, v189
    v_max_f32 v188, v188, v189
    v_mov_b32 v189, v188
    s_nop 1
    v_permlane16_swap_b32 v188, v189
    v_max_f32 v188, v188, v189
    v_exp_f32 v190, -v188
    v_sub_f32 v100, v100, v188
    v_sub_f32 v101, v101, v188
    v_sub_f32 v102, v102, v188
    v_sub_f32 v103, v103, v188
    v_sub_f32 v4, v4, v188
    v_sub_f32 v5, v5, v188
    v_sub_f32 v6, v6, v188
    v_sub_f32 v7, v7, v188
    v_sub_f32 v28, v28, v188
    v_sub_f32 v29, v29, v188
    v_sub_f32 v30, v30, v188
    v_sub_f32 v31, v31, v188
    v_mul_f32 v124, v124, v190
    v_mul_f32 v125, v125, v190
    v_mul_f32 v126, v126, v190
    v_mul_f32 v127, v127, v190
    v_accvgpr_read_b32 v232, a4
    v_accvgpr_read_b32 v233, a5
    v_mul_f32 v232, v232, v190
    v_mul_f32 v233, v233, v190
    v_accvgpr_write_b32 a4, v232
    v_accvgpr_write_b32 a5, v233
    v_accvgpr_read_b32 v232, a6
    v_accvgpr_read_b32 v233, a7
    v_mul_f32 v232, v232, v190
    v_mul_f32 v233, v233, v190
    v_accvgpr_write_b32 a6, v232
    v_accvgpr_write_b32 a7, v233
    v_accvgpr_read_b32 v232, a28
    v_accvgpr_read_b32 v233, a29
    v_mul_f32 v232, v232, v190
    v_mul_f32 v233, v233, v190
    v_accvgpr_write_b32 a28, v232
    v_accvgpr_write_b32 a29, v233
    v_accvgpr_read_b32 v232, a30
    v_accvgpr_read_b32 v233, a31
    v_mul_f32 v232, v232, v190
    v_mul_f32 v233, v233, v190
    v_accvgpr_write_b32 a30, v232
    v_accvgpr_write_b32 a31, v233
    v_accvgpr_read_b32 v232, a52
    v_accvgpr_read_b32 v233, a53
    v_mul_f32 v232, v232, v190
    v_mul_f32 v233, v233, v190
    v_accvgpr_write_b32 a52, v232
    v_accvgpr_write_b32 a53, v233
    v_accvgpr_read_b32 v232, a54
    v_accvgpr_read_b32 v233, a55
    v_mul_f32 v232, v232, v190
    v_mul_f32 v233, v233, v190
    v_accvgpr_write_b32 a54, v232
    v_accvgpr_write_b32 a55, v233
    v_accvgpr_read_b32 v232, a76
    v_accvgpr_read_b32 v233, a77
    v_mul_f32 v232, v232, v190
    v_mul_f32 v233, v233, v190
    v_accvgpr_write_b32 a76, v232
    v_accvgpr_write_b32 a77, v233
    v_accvgpr_read_b32 v232, a78
    v_accvgpr_read_b32 v233, a79
    v_mul_f32 v232, v232, v190
    v_mul_f32 v233, v233, v190
    v_accvgpr_write_b32 a78, v232
    v_accvgpr_write_b32 a79, v233
    v_accvgpr_read_b32 v232, a100
    v_accvgpr_read_b32 v233, a101
    v_mul_f32 v232, v232, v190
    v_mul_f32 v233, v233, v190
    v_accvgpr_write_b32 a100, v232
    v_accvgpr_write_b32 a101, v233
    v_accvgpr_read_b32 v232, a102
    v_accvgpr_read_b32 v233, a103
    v_mul_f32 v232, v232, v190
    v_mul_f32 v233, v233, v190
    v_accvgpr_write_b32 a102, v232
    v_accvgpr_write_b32 a103, v233
    v_accvgpr_read_b32 v232, a124
    v_accvgpr_read_b32 v233, a125
    v_mul_f32 v232, v232, v190
    v_mul_f32 v233, v233, v190
    v_accvgpr_write_b32 a124, v232
    v_accvgpr_write_b32 a125, v233
    v_accvgpr_read_b32 v232, a126
    v_accvgpr_read_b32 v233, a127
    v_mul_f32 v232, v232, v190
    v_mul_f32 v233, v233, v190
    v_accvgpr_write_b32 a126, v232
    v_accvgpr_write_b32 a127, v233
    v_accvgpr_read_b32 v232, a148
    v_accvgpr_read_b32 v233, a149
    v_mul_f32 v232, v232, v190
    v_mul_f32 v233, v233, v190
    v_accvgpr_write_b32 a148, v232
    v_accvgpr_write_b32 a149, v233
    v_accvgpr_read_b32 v232, a150
    v_accvgpr_read_b32 v233, a151
    v_mul_f32 v232, v232, v190
    v_mul_f32 v233, v233, v190
    v_accvgpr_write_b32 a150, v232
    v_accvgpr_write_b32 a151, v233
    v_accvgpr_read_b32 v232, a172
    v_accvgpr_read_b32 v233, a173
    v_mul_f32 v232, v232, v190
    v_mul_f32 v233, v233, v190
    v_accvgpr_write_b32 a172, v232
    v_accvgpr_write_b32 a173, v233
    v_accvgpr_read_b32 v232, a174
    v_accvgpr_read_b32 v233, a175
    v_mul_f32 v232, v232, v190
    v_mul_f32 v233, v233, v190
    v_accvgpr_write_b32 a174, v232
    v_accvgpr_write_b32 a175, v233
    v_max3_f32 v188, v8, v9, v10
    v_max3_f32 v188, v188, v11, v32
    v_max3_f32 v188, v188, v33, v34
    v_max3_f32 v188, v188, v35, 0
    v_mov_b32 v189, v188
    s_nop 1
    v_permlane32_swap_b32 v188, v189
    v_max_f32 v188, v188, v189
    v_mov_b32 v189, v188
    s_nop 1
    v_permlane16_swap_b32 v188, v189
    v_max_f32 v188, v188, v189
    v_exp_f32 v190, -v188
    v_sub_f32 v104, v104, v188
    v_sub_f32 v105, v105, v188
    v_sub_f32 v106, v106, v188
    v_sub_f32 v107, v107, v188
    v_sub_f32 v8, v8, v188
    v_sub_f32 v9, v9, v188
    v_sub_f32 v10, v10, v188
    v_sub_f32 v11, v11, v188
    v_sub_f32 v32, v32, v188
    v_sub_f32 v33, v33, v188
    v_sub_f32 v34, v34, v188
    v_sub_f32 v35, v35, v188
    v_mul_f32 v128, v128, v190
    v_mul_f32 v129, v129, v190
    v_mul_f32 v130, v130, v190
    v_mul_f32 v131, v131, v190
    v_accvgpr_read_b32 v232, a8
    v_accvgpr_read_b32 v233, a9
    v_mul_f32 v232, v232, v190
    v_mul_f32 v233, v233, v190
    v_accvgpr_write_b32 a8, v232
    v_accvgpr_write_b32 a9, v233
    v_accvgpr_read_b32 v232, a10
    v_accvgpr_read_b32 v233, a11
    v_mul_f32 v232, v232, v190
    v_mul_f32 v233, v233, v190
    v_accvgpr_write_b32 a10, v232
    v_accvgpr_write_b32 a11, v233
    v_accvgpr_read_b32 v232, a32
    v_accvgpr_read_b32 v233, a33
    v_mul_f32 v232, v232, v190
    v_mul_f32 v233, v233, v190
    v_accvgpr_write_b32 a32, v232
    v_accvgpr_write_b32 a33, v233
    v_accvgpr_read_b32 v232, a34
    v_accvgpr_read_b32 v233, a35
    v_mul_f32 v232, v232, v190
    v_mul_f32 v233, v233, v190
    v_accvgpr_write_b32 a34, v232
    v_accvgpr_write_b32 a35, v233
    v_accvgpr_read_b32 v232, a56
    v_accvgpr_read_b32 v233, a57
    v_mul_f32 v232, v232, v190
    v_mul_f32 v233, v233, v190
    v_accvgpr_write_b32 a56, v232
    v_accvgpr_write_b32 a57, v233
    v_accvgpr_read_b32 v232, a58
    v_accvgpr_read_b32 v233, a59
    v_mul_f32 v232, v232, v190
    v_mul_f32 v233, v233, v190
    v_accvgpr_write_b32 a58, v232
    v_accvgpr_write_b32 a59, v233
    v_accvgpr_read_b32 v232, a80
    v_accvgpr_read_b32 v233, a81
    v_mul_f32 v232, v232, v190
    v_mul_f32 v233, v233, v190
    v_accvgpr_write_b32 a80, v232
    v_accvgpr_write_b32 a81, v233
    v_accvgpr_read_b32 v232, a82
    v_accvgpr_read_b32 v233, a83
    v_mul_f32 v232, v232, v190
    v_mul_f32 v233, v233, v190
    v_accvgpr_write_b32 a82, v232
    v_accvgpr_write_b32 a83, v233
    v_accvgpr_read_b32 v232, a104
    v_accvgpr_read_b32 v233, a105
    v_mul_f32 v232, v232, v190
    v_mul_f32 v233, v233, v190
    v_accvgpr_write_b32 a104, v232
    v_accvgpr_write_b32 a105, v233
    v_accvgpr_read_b32 v232, a106
    v_accvgpr_read_b32 v233, a107
    v_mul_f32 v232, v232, v190
    v_mul_f32 v233, v233, v190
    v_accvgpr_write_b32 a106, v232
    v_accvgpr_write_b32 a107, v233
    v_accvgpr_read_b32 v232, a128
    v_accvgpr_read_b32 v233, a129
    v_mul_f32 v232, v232, v190
    v_mul_f32 v233, v233, v190
    v_accvgpr_write_b32 a128, v232
    v_accvgpr_write_b32 a129, v233
    v_accvgpr_read_b32 v232, a130
    v_accvgpr_read_b32 v233, a131
    v_mul_f32 v232, v232, v190
    v_mul_f32 v233, v233, v190
    v_accvgpr_write_b32 a130, v232
    v_accvgpr_write_b32 a131, v233
    v_accvgpr_read_b32 v232, a152
    v_accvgpr_read_b32 v233, a153
    v_mul_f32 v232, v232, v190
    v_mul_f32 v233, v233, v190
    v_accvgpr_write_b32 a152, v232
    v_accvgpr_write_b32 a153, v233
    v_accvgpr_read_b32 v232, a154
    v_accvgpr_read_b32 v233, a155
    v_mul_f32 v232, v232, v190
    v_mul_f32 v233, v233, v190
    v_accvgpr_write_b32 a154, v232
    v_accvgpr_write_b32 a155, v233
    v_accvgpr_read_b32 v232, a176
    v_accvgpr_read_b32 v233, a177
    v_mul_f32 v232, v232, v190
    v_mul_f32 v233, v233, v190
    v_accvgpr_write_b32 a176, v232
    v_accvgpr_write_b32 a177, v233
    v_accvgpr_read_b32 v232, a178
    v_accvgpr_read_b32 v233, a179
    v_mul_f32 v232, v232, v190
    v_mul_f32 v233, v233, v190
    v_accvgpr_write_b32 a178, v232
    v_accvgpr_write_b32 a179, v233
    v_max3_f32 v188, v12, v13, v14
    v_max3_f32 v188, v188, v15, v36
    v_max3_f32 v188, v188, v37, v38
    v_max3_f32 v188, v188, v39, 0
    v_mov_b32 v189, v188
    s_nop 1
    v_permlane32_swap_b32 v188, v189
    v_max_f32 v188, v188, v189
    v_mov_b32 v189, v188
    s_nop 1
    v_permlane16_swap_b32 v188, v189
    v_max_f32 v188, v188, v189
    v_exp_f32 v190, -v188
    v_sub_f32 v108, v108, v188
    v_sub_f32 v109, v109, v188
    v_sub_f32 v110, v110, v188
    v_sub_f32 v111, v111, v188
    v_sub_f32 v12, v12, v188
    v_sub_f32 v13, v13, v188
    v_sub_f32 v14, v14, v188
    v_sub_f32 v15, v15, v188
    v_sub_f32 v36, v36, v188
    v_sub_f32 v37, v37, v188
    v_sub_f32 v38, v38, v188
    v_sub_f32 v39, v39, v188
    v_mul_f32 v132, v132, v190
    v_mul_f32 v133, v133, v190
    v_mul_f32 v134, v134, v190
    v_mul_f32 v135, v135, v190
    v_accvgpr_read_b32 v232, a12
    v_accvgpr_read_b32 v233, a13
    v_mul_f32 v232, v232, v190
    v_mul_f32 v233, v233, v190
    v_accvgpr_write_b32 a12, v232
    v_accvgpr_write_b32 a13, v233
    v_accvgpr_read_b32 v232, a14
    v_accvgpr_read_b32 v233, a15
    v_mul_f32 v232, v232, v190
    v_mul_f32 v233, v233, v190
    v_accvgpr_write_b32 a14, v232
    v_accvgpr_write_b32 a15, v233
    v_accvgpr_read_b32 v232, a36
    v_accvgpr_read_b32 v233, a37
    v_mul_f32 v232, v232, v190
    v_mul_f32 v233, v233, v190
    v_accvgpr_write_b32 a36, v232
    v_accvgpr_write_b32 a37, v233
    v_accvgpr_read_b32 v232, a38
    v_accvgpr_read_b32 v233, a39
    v_mul_f32 v232, v232, v190
    v_mul_f32 v233, v233, v190
    v_accvgpr_write_b32 a38, v232
    v_accvgpr_write_b32 a39, v233
    v_accvgpr_read_b32 v232, a60
    v_accvgpr_read_b32 v233, a61
    v_mul_f32 v232, v232, v190
    v_mul_f32 v233, v233, v190
    v_accvgpr_write_b32 a60, v232
    v_accvgpr_write_b32 a61, v233
    v_accvgpr_read_b32 v232, a62
    v_accvgpr_read_b32 v233, a63
    v_mul_f32 v232, v232, v190
    v_mul_f32 v233, v233, v190
    v_accvgpr_write_b32 a62, v232
    v_accvgpr_write_b32 a63, v233
    v_accvgpr_read_b32 v232, a84
    v_accvgpr_read_b32 v233, a85
    v_mul_f32 v232, v232, v190
    v_mul_f32 v233, v233, v190
    v_accvgpr_write_b32 a84, v232
    v_accvgpr_write_b32 a85, v233
    v_accvgpr_read_b32 v232, a86
    v_accvgpr_read_b32 v233, a87
    v_mul_f32 v232, v232, v190
    v_mul_f32 v233, v233, v190
    v_accvgpr_write_b32 a86, v232
    v_accvgpr_write_b32 a87, v233
    v_accvgpr_read_b32 v232, a108
    v_accvgpr_read_b32 v233, a109
    v_mul_f32 v232, v232, v190
    v_mul_f32 v233, v233, v190
    v_accvgpr_write_b32 a108, v232
    v_accvgpr_write_b32 a109, v233
    v_accvgpr_read_b32 v232, a110
    v_accvgpr_read_b32 v233, a111
    v_mul_f32 v232, v232, v190
    v_mul_f32 v233, v233, v190
    v_accvgpr_write_b32 a110, v232
    v_accvgpr_write_b32 a111, v233
    v_accvgpr_read_b32 v232, a132
    v_accvgpr_read_b32 v233, a133
    v_mul_f32 v232, v232, v190
    v_mul_f32 v233, v233, v190
    v_accvgpr_write_b32 a132, v232
    v_accvgpr_write_b32 a133, v233
    v_accvgpr_read_b32 v232, a134
    v_accvgpr_read_b32 v233, a135
    v_mul_f32 v232, v232, v190
    v_mul_f32 v233, v233, v190
    v_accvgpr_write_b32 a134, v232
    v_accvgpr_write_b32 a135, v233
    v_accvgpr_read_b32 v232, a156
    v_accvgpr_read_b32 v233, a157
    v_mul_f32 v232, v232, v190
    v_mul_f32 v233, v233, v190
    v_accvgpr_write_b32 a156, v232
    v_accvgpr_write_b32 a157, v233
    v_accvgpr_read_b32 v232, a158
    v_accvgpr_read_b32 v233, a159
    v_mul_f32 v232, v232, v190
    v_mul_f32 v233, v233, v190
    v_accvgpr_write_b32 a158, v232
    v_accvgpr_write_b32 a159, v233
    v_accvgpr_read_b32 v232, a180
    v_accvgpr_read_b32 v233, a181
    v_mul_f32 v232, v232, v190
    v_mul_f32 v233, v233, v190
    v_accvgpr_write_b32 a180, v232
    v_accvgpr_write_b32 a181, v233
    v_accvgpr_read_b32 v232, a182
    v_accvgpr_read_b32 v233, a183
    v_mul_f32 v232, v232, v190
    v_mul_f32 v233, v233, v190
    v_accvgpr_write_b32 a182, v232
    v_accvgpr_write_b32 a183, v233
    v_max3_f32 v188, v16, v17, v18
    v_max3_f32 v188, v188, v19, v40
    v_max3_f32 v188, v188, v41, v42
    v_max3_f32 v188, v188, v43, 0
    v_mov_b32 v189, v188
    s_nop 1
    v_permlane32_swap_b32 v188, v189
    v_max_f32 v188, v188, v189
    v_mov_b32 v189, v188
    s_nop 1
    v_permlane16_swap_b32 v188, v189
    v_max_f32 v188, v188, v189
    v_exp_f32 v190, -v188
    v_sub_f32 v112, v112, v188
    v_sub_f32 v113, v113, v188
    v_sub_f32 v114, v114, v188
    v_sub_f32 v115, v115, v188
    v_sub_f32 v16, v16, v188
    v_sub_f32 v17, v17, v188
    v_sub_f32 v18, v18, v188
    v_sub_f32 v19, v19, v188
    v_sub_f32 v40, v40, v188
    v_sub_f32 v41, v41, v188
    v_sub_f32 v42, v42, v188
    v_sub_f32 v43, v43, v188
    v_mul_f32 v136, v136, v190
    v_mul_f32 v137, v137, v190
    v_mul_f32 v138, v138, v190
    v_mul_f32 v139, v139, v190
    v_accvgpr_read_b32 v232, a16
    v_accvgpr_read_b32 v233, a17
    v_mul_f32 v232, v232, v190
    v_mul_f32 v233, v233, v190
    v_accvgpr_write_b32 a16, v232
    v_accvgpr_write_b32 a17, v233
    v_accvgpr_read_b32 v232, a18
    v_accvgpr_read_b32 v233, a19
    v_mul_f32 v232, v232, v190
    v_mul_f32 v233, v233, v190
    v_accvgpr_write_b32 a18, v232
    v_accvgpr_write_b32 a19, v233
    v_accvgpr_read_b32 v232, a40
    v_accvgpr_read_b32 v233, a41
    v_mul_f32 v232, v232, v190
    v_mul_f32 v233, v233, v190
    v_accvgpr_write_b32 a40, v232
    v_accvgpr_write_b32 a41, v233
    v_accvgpr_read_b32 v232, a42
    v_accvgpr_read_b32 v233, a43
    v_mul_f32 v232, v232, v190
    v_mul_f32 v233, v233, v190
    v_accvgpr_write_b32 a42, v232
    v_accvgpr_write_b32 a43, v233
    v_accvgpr_read_b32 v232, a64
    v_accvgpr_read_b32 v233, a65
    v_mul_f32 v232, v232, v190
    v_mul_f32 v233, v233, v190
    v_accvgpr_write_b32 a64, v232
    v_accvgpr_write_b32 a65, v233
    v_accvgpr_read_b32 v232, a66
    v_accvgpr_read_b32 v233, a67
    v_mul_f32 v232, v232, v190
    v_mul_f32 v233, v233, v190
    v_accvgpr_write_b32 a66, v232
    v_accvgpr_write_b32 a67, v233
    v_accvgpr_read_b32 v232, a88
    v_accvgpr_read_b32 v233, a89
    v_mul_f32 v232, v232, v190
    v_mul_f32 v233, v233, v190
    v_accvgpr_write_b32 a88, v232
    v_accvgpr_write_b32 a89, v233
    v_accvgpr_read_b32 v232, a90
    v_accvgpr_read_b32 v233, a91
    v_mul_f32 v232, v232, v190
    v_mul_f32 v233, v233, v190
    v_accvgpr_write_b32 a90, v232
    v_accvgpr_write_b32 a91, v233
    v_accvgpr_read_b32 v232, a112
    v_accvgpr_read_b32 v233, a113
    v_mul_f32 v232, v232, v190
    v_mul_f32 v233, v233, v190
    v_accvgpr_write_b32 a112, v232
    v_accvgpr_write_b32 a113, v233
    v_accvgpr_read_b32 v232, a114
    v_accvgpr_read_b32 v233, a115
    v_mul_f32 v232, v232, v190
    v_mul_f32 v233, v233, v190
    v_accvgpr_write_b32 a114, v232
    v_accvgpr_write_b32 a115, v233
    v_accvgpr_read_b32 v232, a136
    v_accvgpr_read_b32 v233, a137
    v_mul_f32 v232, v232, v190
    v_mul_f32 v233, v233, v190
    v_accvgpr_write_b32 a136, v232
    v_accvgpr_write_b32 a137, v233
    v_accvgpr_read_b32 v232, a138
    v_accvgpr_read_b32 v233, a139
    v_mul_f32 v232, v232, v190
    v_mul_f32 v233, v233, v190
    v_accvgpr_write_b32 a138, v232
    v_accvgpr_write_b32 a139, v233
    v_accvgpr_read_b32 v232, a160
    v_accvgpr_read_b32 v233, a161
    v_mul_f32 v232, v232, v190
    v_mul_f32 v233, v233, v190
    v_accvgpr_write_b32 a160, v232
    v_accvgpr_write_b32 a161, v233
    v_accvgpr_read_b32 v232, a162
    v_accvgpr_read_b32 v233, a163
    v_mul_f32 v232, v232, v190
    v_mul_f32 v233, v233, v190
    v_accvgpr_write_b32 a162, v232
    v_accvgpr_write_b32 a163, v233
    v_accvgpr_read_b32 v232, a184
    v_accvgpr_read_b32 v233, a185
    v_mul_f32 v232, v232, v190
    v_mul_f32 v233, v233, v190
    v_accvgpr_write_b32 a184, v232
    v_accvgpr_write_b32 a185, v233
    v_accvgpr_read_b32 v232, a186
    v_accvgpr_read_b32 v233, a187
    v_mul_f32 v232, v232, v190
    v_mul_f32 v233, v233, v190
    v_accvgpr_write_b32 a186, v232
    v_accvgpr_write_b32 a187, v233
    v_max3_f32 v188, v20, v21, v22
    v_max3_f32 v188, v188, v23, v44
    v_max3_f32 v188, v188, v45, v46
    v_max3_f32 v188, v188, v47, 0
    v_mov_b32 v189, v188
    s_nop 1
    v_permlane32_swap_b32 v188, v189
    v_max_f32 v188, v188, v189
    v_mov_b32 v189, v188
    s_nop 1
    v_permlane16_swap_b32 v188, v189
    v_max_f32 v188, v188, v189
    v_exp_f32 v190, -v188
    v_sub_f32 v116, v116, v188
    v_sub_f32 v117, v117, v188
    v_sub_f32 v118, v118, v188
    v_sub_f32 v119, v119, v188
    v_sub_f32 v20, v20, v188
    v_sub_f32 v21, v21, v188
    v_sub_f32 v22, v22, v188
    v_sub_f32 v23, v23, v188
    v_sub_f32 v44, v44, v188
    v_sub_f32 v45, v45, v188
    v_sub_f32 v46, v46, v188
    v_sub_f32 v47, v47, v188
    v_mul_f32 v140, v140, v190
    v_mul_f32 v141, v141, v190
    v_mul_f32 v142, v142, v190
    v_mul_f32 v143, v143, v190
    v_accvgpr_read_b32 v232, a20
    v_accvgpr_read_b32 v233, a21
    v_mul_f32 v232, v232, v190
    v_mul_f32 v233, v233, v190
    v_accvgpr_write_b32 a20, v232
    v_accvgpr_write_b32 a21, v233
    v_accvgpr_read_b32 v232, a22
    v_accvgpr_read_b32 v233, a23
    v_mul_f32 v232, v232, v190
    v_mul_f32 v233, v233, v190
    v_accvgpr_write_b32 a22, v232
    v_accvgpr_write_b32 a23, v233
    v_accvgpr_read_b32 v232, a44
    v_accvgpr_read_b32 v233, a45
    v_mul_f32 v232, v232, v190
    v_mul_f32 v233, v233, v190
    v_accvgpr_write_b32 a44, v232
    v_accvgpr_write_b32 a45, v233
    v_accvgpr_read_b32 v232, a46
    v_accvgpr_read_b32 v233, a47
    v_mul_f32 v232, v232, v190
    v_mul_f32 v233, v233, v190
    v_accvgpr_write_b32 a46, v232
    v_accvgpr_write_b32 a47, v233
    v_accvgpr_read_b32 v232, a68
    v_accvgpr_read_b32 v233, a69
    v_mul_f32 v232, v232, v190
    v_mul_f32 v233, v233, v190
    v_accvgpr_write_b32 a68, v232
    v_accvgpr_write_b32 a69, v233
    v_accvgpr_read_b32 v232, a70
    v_accvgpr_read_b32 v233, a71
    v_mul_f32 v232, v232, v190
    v_mul_f32 v233, v233, v190
    v_accvgpr_write_b32 a70, v232
    v_accvgpr_write_b32 a71, v233
    v_accvgpr_read_b32 v232, a92
    v_accvgpr_read_b32 v233, a93
    v_mul_f32 v232, v232, v190
    v_mul_f32 v233, v233, v190
    v_accvgpr_write_b32 a92, v232
    v_accvgpr_write_b32 a93, v233
    v_accvgpr_read_b32 v232, a94
    v_accvgpr_read_b32 v233, a95
    v_mul_f32 v232, v232, v190
    v_mul_f32 v233, v233, v190
    v_accvgpr_write_b32 a94, v232
    v_accvgpr_write_b32 a95, v233
    v_accvgpr_read_b32 v232, a116
    v_accvgpr_read_b32 v233, a117
    v_mul_f32 v232, v232, v190
    v_mul_f32 v233, v233, v190
    v_accvgpr_write_b32 a116, v232
    v_accvgpr_write_b32 a117, v233
    v_accvgpr_read_b32 v232, a118
    v_accvgpr_read_b32 v233, a119
    v_mul_f32 v232, v232, v190
    v_mul_f32 v233, v233, v190
    v_accvgpr_write_b32 a118, v232
    v_accvgpr_write_b32 a119, v233
    v_accvgpr_read_b32 v232, a140
    v_accvgpr_read_b32 v233, a141
    v_mul_f32 v232, v232, v190
    v_mul_f32 v233, v233, v190
    v_accvgpr_write_b32 a140, v232
    v_accvgpr_write_b32 a141, v233
    v_accvgpr_read_b32 v232, a142
    v_accvgpr_read_b32 v233, a143
    v_mul_f32 v232, v232, v190
    v_mul_f32 v233, v233, v190
    v_accvgpr_write_b32 a142, v232
    v_accvgpr_write_b32 a143, v233
    v_accvgpr_read_b32 v232, a164
    v_accvgpr_read_b32 v233, a165
    v_mul_f32 v232, v232, v190
    v_mul_f32 v233, v233, v190
    v_accvgpr_write_b32 a164, v232
    v_accvgpr_write_b32 a165, v233
    v_accvgpr_read_b32 v232, a166
    v_accvgpr_read_b32 v233, a167
    v_mul_f32 v232, v232, v190
    v_mul_f32 v233, v233, v190
    v_accvgpr_write_b32 a166, v232
    v_accvgpr_write_b32 a167, v233
    v_accvgpr_read_b32 v232, a188
    v_accvgpr_read_b32 v233, a189
    v_mul_f32 v232, v232, v190
    v_mul_f32 v233, v233, v190
    v_accvgpr_write_b32 a188, v232
    v_accvgpr_write_b32 a189, v233
    v_accvgpr_read_b32 v232, a190
    v_accvgpr_read_b32 v233, a191
    v_mul_f32 v232, v232, v190
    v_mul_f32 v233, v233, v190
    v_accvgpr_write_b32 a190, v232
    v_accvgpr_write_b32 a191, v233
    s_nop 1
    s_setpc_b64 s[78:79]
L_rescale_1:
    s_nop 15
    v_max3_f32 v188, v48, v49, v50
    v_max3_f32 v188, v188, v51, v72
    v_max3_f32 v188, v188, v73, v74
    v_max3_f32 v188, v188, v75, 0
    v_mov_b32 v189, v188
    s_nop 1
    v_permlane32_swap_b32 v188, v189
    v_max_f32 v188, v188, v189
    v_mov_b32 v189, v188
    s_nop 1
    v_permlane16_swap_b32 v188, v189
    v_max_f32 v188, v188, v189
    v_exp_f32 v190, -v188
    v_sub_f32 v96, v96, v188
    v_sub_f32 v97, v97, v188
    v_sub_f32 v98, v98, v188
    v_sub_f32 v99, v99, v188
    v_sub_f32 v48, v48, v188
    v_sub_f32 v49, v49, v188
    v_sub_f32 v50, v50, v188
    v_sub_f32 v51, v51, v188
    v_sub_f32 v72, v72, v188
    v_sub_f32 v73, v73, v188
    v_sub_f32 v74, v74, v188
    v_sub_f32 v75, v75, v188
    v_mul_f32 v120, v120, v190
    v_mul_f32 v121, v121, v190
    v_mul_f32 v122, v122, v190
    v_mul_f32 v123, v123, v190
    v_accvgpr_read_b32 v232, a0
    v_accvgpr_read_b32 v233, a1
    v_mul_f32 v232, v232, v190
    v_mul_f32 v233, v233, v190
    v_accvgpr_write_b32 a0, v232
    v_accvgpr_write_b32 a1, v233
    v_accvgpr_read_b32 v232, a2
    v_accvgpr_read_b32 v233, a3
    v_mul_f32 v232, v232, v190
    v_mul_f32 v233, v233, v190
    v_accvgpr_write_b32 a2, v232
    v_accvgpr_write_b32 a3, v233
    v_accvgpr_read_b32 v232, a24
    v_accvgpr_read_b32 v233, a25
    v_mul_f32 v232, v232, v190
    v_mul_f32 v233, v233, v190
    v_accvgpr_write_b32 a24, v232
    v_accvgpr_write_b32 a25, v233
    v_accvgpr_read_b32 v232, a26
    v_accvgpr_read_b32 v233, a27
    v_mul_f32 v232, v232, v190
    v_mul_f32 v233, v233, v190
    v_accvgpr_write_b32 a26, v232
    v_accvgpr_write_b32 a27, v233
    v_accvgpr_read_b32 v232, a48
    v_accvgpr_read_b32 v233, a49
    v_mul_f32 v232, v232, v190
    v_mul_f32 v233, v233, v190
    v_accvgpr_write_b32 a48, v232
    v_accvgpr_write_b32 a49, v233
    v_accvgpr_read_b32 v232, a50
    v_accvgpr_read_b32 v233, a51
    v_mul_f32 v232, v232, v190
    v_mul_f32 v233, v233, v190
    v_accvgpr_write_b32 a50, v232
    v_accvgpr_write_b32 a51, v233
    v_accvgpr_read_b32 v232, a72
    v_accvgpr_read_b32 v233, a73
    v_mul_f32 v232, v232, v190
    v_mul_f32 v233, v233, v190
    v_accvgpr_write_b32 a72, v232
    v_accvgpr_write_b32 a73, v233
    v_accvgpr_read_b32 v232, a74
    v_accvgpr_read_b32 v233, a75
    v_mul_f32 v232, v232, v190
    v_mul_f32 v233, v233, v190
    v_accvgpr_write_b32 a74, v232
    v_accvgpr_write_b32 a75, v233
    v_accvgpr_read_b32 v232, a96
    v_accvgpr_read_b32 v233, a97
    v_mul_f32 v232, v232, v190
    v_mul_f32 v233, v233, v190
    v_accvgpr_write_b32 a96, v232
    v_accvgpr_write_b32 a97, v233
    v_accvgpr_read_b32 v232, a98
    v_accvgpr_read_b32 v233, a99
    v_mul_f32 v232, v232, v190
    v_mul_f32 v233, v233, v190
    v_accvgpr_write_b32 a98, v232
    v_accvgpr_write_b32 a99, v233
    v_accvgpr_read_b32 v232, a120
    v_accvgpr_read_b32 v233, a121
    v_mul_f32 v232, v232, v190
    v_mul_f32 v233, v233, v190
    v_accvgpr_write_b32 a120, v232
    v_accvgpr_write_b32 a121, v233
    v_accvgpr_read_b32 v232, a122
    v_accvgpr_read_b32 v233, a123
    v_mul_f32 v232, v232, v190
    v_mul_f32 v233, v233, v190
    v_accvgpr_write_b32 a122, v232
    v_accvgpr_write_b32 a123, v233
    v_accvgpr_read_b32 v232, a144
    v_accvgpr_read_b32 v233, a145
    v_mul_f32 v232, v232, v190
    v_mul_f32 v233, v233, v190
    v_accvgpr_write_b32 a144, v232
    v_accvgpr_write_b32 a145, v233
    v_accvgpr_read_b32 v232, a146
    v_accvgpr_read_b32 v233, a147
    v_mul_f32 v232, v232, v190
    v_mul_f32 v233, v233, v190
    v_accvgpr_write_b32 a146, v232
    v_accvgpr_write_b32 a147, v233
    v_accvgpr_read_b32 v232, a168
    v_accvgpr_read_b32 v233, a169
    v_mul_f32 v232, v232, v190
    v_mul_f32 v233, v233, v190
    v_accvgpr_write_b32 a168, v232
    v_accvgpr_write_b32 a169, v233
    v_accvgpr_read_b32 v232, a170
    v_accvgpr_read_b32 v233, a171
    v_mul_f32 v232, v232, v190
    v_mul_f32 v233, v233, v190
    v_accvgpr_write_b32 a170, v232
    v_accvgpr_write_b32 a171, v233
    v_max3_f32 v188, v52, v53, v54
    v_max3_f32 v188, v188, v55, v76
    v_max3_f32 v188, v188, v77, v78
    v_max3_f32 v188, v188, v79, 0
    v_mov_b32 v189, v188
    s_nop 1
    v_permlane32_swap_b32 v188, v189
    v_max_f32 v188, v188, v189
    v_mov_b32 v189, v188
    s_nop 1
    v_permlane16_swap_b32 v188, v189
    v_max_f32 v188, v188, v189
    v_exp_f32 v190, -v188
    v_sub_f32 v100, v100, v188
    v_sub_f32 v101, v101, v188
    v_sub_f32 v102, v102, v188
    v_sub_f32 v103, v103, v188
    v_sub_f32 v52, v52, v188
    v_sub_f32 v53, v53, v188
    v_sub_f32 v54, v54, v188
    v_sub_f32 v55, v55, v188
    v_sub_f32 v76, v76, v188
    v_sub_f32 v77, v77, v188
    v_sub_f32 v78, v78, v188
    v_sub_f32 v79, v79, v188
    v_mul_f32 v124, v124, v190
    v_mul_f32 v125, v125, v190
    v_mul_f32 v126, v126, v190
    v_mul_f32 v127, v127, v190
    v_accvgpr_read_b32 v232, a4
    v_accvgpr_read_b32 v233, a5
    v_mul_f32 v232, v232, v190
    v_mul_f32 v233, v233, v190
    v_accvgpr_write_b32 a4, v232
    v_accvgpr_write_b32 a5, v233
    v_accvgpr_read_b32 v232, a6
    v_accvgpr_read_b32 v233, a7
    v_mul_f32 v232, v232, v190
    v_mul_f32 v233, v233, v190
    v_accvgpr_write_b32 a6, v232
    v_accvgpr_write_b32 a7, v233
    v_accvgpr_read_b32 v232, a28
    v_accvgpr_read_b32 v233, a29
    v_mul_f32 v232, v232, v190
    v_mul_f32 v233, v233, v190
    v_accvgpr_write_b32 a28, v232
    v_accvgpr_write_b32 a29, v233
    v_accvgpr_read_b32 v232, a30
    v_accvgpr_read_b32 v233, a31
    v_mul_f32 v232, v232, v190
    v_mul_f32 v233, v233, v190
    v_accvgpr_write_b32 a30, v232
    v_accvgpr_write_b32 a31, v233
    v_accvgpr_read_b32 v232, a52
    v_accvgpr_read_b32 v233, a53
    v_mul_f32 v232, v232, v190
    v_mul_f32 v233, v233, v190
    v_accvgpr_write_b32 a52, v232
    v_accvgpr_write_b32 a53, v233
    v_accvgpr_read_b32 v232, a54
    v_accvgpr_read_b32 v233, a55
    v_mul_f32 v232, v232, v190
    v_mul_f32 v233, v233, v190
    v_accvgpr_write_b32 a54, v232
    v_accvgpr_write_b32 a55, v233
    v_accvgpr_read_b32 v232, a76
    v_accvgpr_read_b32 v233, a77
    v_mul_f32 v232, v232, v190
    v_mul_f32 v233, v233, v190
    v_accvgpr_write_b32 a76, v232
    v_accvgpr_write_b32 a77, v233
    v_accvgpr_read_b32 v232, a78
    v_accvgpr_read_b32 v233, a79
    v_mul_f32 v232, v232, v190
    v_mul_f32 v233, v233, v190
    v_accvgpr_write_b32 a78, v232
    v_accvgpr_write_b32 a79, v233
    v_accvgpr_read_b32 v232, a100
    v_accvgpr_read_b32 v233, a101
    v_mul_f32 v232, v232, v190
    v_mul_f32 v233, v233, v190
    v_accvgpr_write_b32 a100, v232
    v_accvgpr_write_b32 a101, v233
    v_accvgpr_read_b32 v232, a102
    v_accvgpr_read_b32 v233, a103
    v_mul_f32 v232, v232, v190
    v_mul_f32 v233, v233, v190
    v_accvgpr_write_b32 a102, v232
    v_accvgpr_write_b32 a103, v233
    v_accvgpr_read_b32 v232, a124
    v_accvgpr_read_b32 v233, a125
    v_mul_f32 v232, v232, v190
    v_mul_f32 v233, v233, v190
    v_accvgpr_write_b32 a124, v232
    v_accvgpr_write_b32 a125, v233
    v_accvgpr_read_b32 v232, a126
    v_accvgpr_read_b32 v233, a127
    v_mul_f32 v232, v232, v190
    v_mul_f32 v233, v233, v190
    v_accvgpr_write_b32 a126, v232
    v_accvgpr_write_b32 a127, v233
    v_accvgpr_read_b32 v232, a148
    v_accvgpr_read_b32 v233, a149
    v_mul_f32 v232, v232, v190
    v_mul_f32 v233, v233, v190
    v_accvgpr_write_b32 a148, v232
    v_accvgpr_write_b32 a149, v233
    v_accvgpr_read_b32 v232, a150
    v_accvgpr_read_b32 v233, a151
    v_mul_f32 v232, v232, v190
    v_mul_f32 v233, v233, v190
    v_accvgpr_write_b32 a150, v232
    v_accvgpr_write_b32 a151, v233
    v_accvgpr_read_b32 v232, a172
    v_accvgpr_read_b32 v233, a173
    v_mul_f32 v232, v232, v190
    v_mul_f32 v233, v233, v190
    v_accvgpr_write_b32 a172, v232
    v_accvgpr_write_b32 a173, v233
    v_accvgpr_read_b32 v232, a174
    v_accvgpr_read_b32 v233, a175
    v_mul_f32 v232, v232, v190
    v_mul_f32 v233, v233, v190
    v_accvgpr_write_b32 a174, v232
    v_accvgpr_write_b32 a175, v233
    v_max3_f32 v188, v56, v57, v58
    v_max3_f32 v188, v188, v59, v80
    v_max3_f32 v188, v188, v81, v82
    v_max3_f32 v188, v188, v83, 0
    v_mov_b32 v189, v188
    s_nop 1
    v_permlane32_swap_b32 v188, v189
    v_max_f32 v188, v188, v189
    v_mov_b32 v189, v188
    s_nop 1
    v_permlane16_swap_b32 v188, v189
    v_max_f32 v188, v188, v189
    v_exp_f32 v190, -v188
    v_sub_f32 v104, v104, v188
    v_sub_f32 v105, v105, v188
    v_sub_f32 v106, v106, v188
    v_sub_f32 v107, v107, v188
    v_sub_f32 v56, v56, v188
    v_sub_f32 v57, v57, v188
    v_sub_f32 v58, v58, v188
    v_sub_f32 v59, v59, v188
    v_sub_f32 v80, v80, v188
    v_sub_f32 v81, v81, v188
    v_sub_f32 v82, v82, v188
    v_sub_f32 v83, v83, v188
    v_mul_f32 v128, v128, v190
    v_mul_f32 v129, v129, v190
    v_mul_f32 v130, v130, v190
    v_mul_f32 v131, v131, v190
    v_accvgpr_read_b32 v232, a8
    v_accvgpr_read_b32 v233, a9
    v_mul_f32 v232, v232, v190
    v_mul_f32 v233, v233, v190
    v_accvgpr_write_b32 a8, v232
    v_accvgpr_write_b32 a9, v233
    v_accvgpr_read_b32 v232, a10
    v_accvgpr_read_b32 v233, a11
    v_mul_f32 v232, v232, v190
    v_mul_f32 v233, v233, v190
    v_accvgpr_write_b32 a10, v232
    v_accvgpr_write_b32 a11, v233
    v_accvgpr_read_b32 v232, a32
    v_accvgpr_read_b32 v233, a33
    v_mul_f32 v232, v232, v190
    v_mul_f32 v233, v233, v190
    v_accvgpr_write_b32 a32, v232
    v_accvgpr_write_b32 a33, v233
    v_accvgpr_read_b32 v232, a34
    v_accvgpr_read_b32 v233, a35
    v_mul_f32 v232, v232, v190
    v_mul_f32 v233, v233, v190
    v_accvgpr_write_b32 a34, v232
    v_accvgpr_write_b32 a35, v233
    v_accvgpr_read_b32 v232, a56
    v_accvgpr_read_b32 v233, a57
    v_mul_f32 v232, v232, v190
    v_mul_f32 v233, v233, v190
    v_accvgpr_write_b32 a56, v232
    v_accvgpr_write_b32 a57, v233
    v_accvgpr_read_b32 v232, a58
    v_accvgpr_read_b32 v233, a59
    v_mul_f32 v232, v232, v190
    v_mul_f32 v233, v233, v190
    v_accvgpr_write_b32 a58, v232
    v_accvgpr_write_b32 a59, v233
    v_accvgpr_read_b32 v232, a80
    v_accvgpr_read_b32 v233, a81
    v_mul_f32 v232, v232, v190
    v_mul_f32 v233, v233, v190
    v_accvgpr_write_b32 a80, v232
    v_accvgpr_write_b32 a81, v233
    v_accvgpr_read_b32 v232, a82
    v_accvgpr_read_b32 v233, a83
    v_mul_f32 v232, v232, v190
    v_mul_f32 v233, v233, v190
    v_accvgpr_write_b32 a82, v232
    v_accvgpr_write_b32 a83, v233
    v_accvgpr_read_b32 v232, a104
    v_accvgpr_read_b32 v233, a105
    v_mul_f32 v232, v232, v190
    v_mul_f32 v233, v233, v190
    v_accvgpr_write_b32 a104, v232
    v_accvgpr_write_b32 a105, v233
    v_accvgpr_read_b32 v232, a106
    v_accvgpr_read_b32 v233, a107
    v_mul_f32 v232, v232, v190
    v_mul_f32 v233, v233, v190
    v_accvgpr_write_b32 a106, v232
    v_accvgpr_write_b32 a107, v233
    v_accvgpr_read_b32 v232, a128
    v_accvgpr_read_b32 v233, a129
    v_mul_f32 v232, v232, v190
    v_mul_f32 v233, v233, v190
    v_accvgpr_write_b32 a128, v232
    v_accvgpr_write_b32 a129, v233
    v_accvgpr_read_b32 v232, a130
    v_accvgpr_read_b32 v233, a131
    v_mul_f32 v232, v232, v190
    v_mul_f32 v233, v233, v190
    v_accvgpr_write_b32 a130, v232
    v_accvgpr_write_b32 a131, v233
    v_accvgpr_read_b32 v232, a152
    v_accvgpr_read_b32 v233, a153
    v_mul_f32 v232, v232, v190
    v_mul_f32 v233, v233, v190
    v_accvgpr_write_b32 a152, v232
    v_accvgpr_write_b32 a153, v233
    v_accvgpr_read_b32 v232, a154
    v_accvgpr_read_b32 v233, a155
    v_mul_f32 v232, v232, v190
    v_mul_f32 v233, v233, v190
    v_accvgpr_write_b32 a154, v232
    v_accvgpr_write_b32 a155, v233
    v_accvgpr_read_b32 v232, a176
    v_accvgpr_read_b32 v233, a177
    v_mul_f32 v232, v232, v190
    v_mul_f32 v233, v233, v190
    v_accvgpr_write_b32 a176, v232
    v_accvgpr_write_b32 a177, v233
    v_accvgpr_read_b32 v232, a178
    v_accvgpr_read_b32 v233, a179
    v_mul_f32 v232, v232, v190
    v_mul_f32 v233, v233, v190
    v_accvgpr_write_b32 a178, v232
    v_accvgpr_write_b32 a179, v233
    v_max3_f32 v188, v60, v61, v62
    v_max3_f32 v188, v188, v63, v84
    v_max3_f32 v188, v188, v85, v86
    v_max3_f32 v188, v188, v87, 0
    v_mov_b32 v189, v188
    s_nop 1
    v_permlane32_swap_b32 v188, v189
    v_max_f32 v188, v188, v189
    v_mov_b32 v189, v188
    s_nop 1
    v_permlane16_swap_b32 v188, v189
    v_max_f32 v188, v188, v189
    v_exp_f32 v190, -v188
    v_sub_f32 v108, v108, v188
    v_sub_f32 v109, v109, v188
    v_sub_f32 v110, v110, v188
    v_sub_f32 v111, v111, v188
    v_sub_f32 v60, v60, v188
    v_sub_f32 v61, v61, v188
    v_sub_f32 v62, v62, v188
    v_sub_f32 v63, v63, v188
    v_sub_f32 v84, v84, v188
    v_sub_f32 v85, v85, v188
    v_sub_f32 v86, v86, v188
    v_sub_f32 v87, v87, v188
    v_mul_f32 v132, v132, v190
    v_mul_f32 v133, v133, v190
    v_mul_f32 v134, v134, v190
    v_mul_f32 v135, v135, v190
    v_accvgpr_read_b32 v232, a12
    v_accvgpr_read_b32 v233, a13
    v_mul_f32 v232, v232, v190
    v_mul_f32 v233, v233, v190
    v_accvgpr_write_b32 a12, v232
    v_accvgpr_write_b32 a13, v233
    v_accvgpr_read_b32 v232, a14
    v_accvgpr_read_b32 v233, a15
    v_mul_f32 v232, v232, v190
    v_mul_f32 v233, v233, v190
    v_accvgpr_write_b32 a14, v232
    v_accvgpr_write_b32 a15, v233
    v_accvgpr_read_b32 v232, a36
    v_accvgpr_read_b32 v233, a37
    v_mul_f32 v232, v232, v190
    v_mul_f32 v233, v233, v190
    v_accvgpr_write_b32 a36, v232
    v_accvgpr_write_b32 a37, v233
    v_accvgpr_read_b32 v232, a38
    v_accvgpr_read_b32 v233, a39
    v_mul_f32 v232, v232, v190
    v_mul_f32 v233, v233, v190
    v_accvgpr_write_b32 a38, v232
    v_accvgpr_write_b32 a39, v233
    v_accvgpr_read_b32 v232, a60
    v_accvgpr_read_b32 v233, a61
    v_mul_f32 v232, v232, v190
    v_mul_f32 v233, v233, v190
    v_accvgpr_write_b32 a60, v232
    v_accvgpr_write_b32 a61, v233
    v_accvgpr_read_b32 v232, a62
    v_accvgpr_read_b32 v233, a63
    v_mul_f32 v232, v232, v190
    v_mul_f32 v233, v233, v190
    v_accvgpr_write_b32 a62, v232
    v_accvgpr_write_b32 a63, v233
    v_accvgpr_read_b32 v232, a84
    v_accvgpr_read_b32 v233, a85
    v_mul_f32 v232, v232, v190
    v_mul_f32 v233, v233, v190
    v_accvgpr_write_b32 a84, v232
    v_accvgpr_write_b32 a85, v233
    v_accvgpr_read_b32 v232, a86
    v_accvgpr_read_b32 v233, a87
    v_mul_f32 v232, v232, v190
    v_mul_f32 v233, v233, v190
    v_accvgpr_write_b32 a86, v232
    v_accvgpr_write_b32 a87, v233
    v_accvgpr_read_b32 v232, a108
    v_accvgpr_read_b32 v233, a109
    v_mul_f32 v232, v232, v190
    v_mul_f32 v233, v233, v190
    v_accvgpr_write_b32 a108, v232
    v_accvgpr_write_b32 a109, v233
    v_accvgpr_read_b32 v232, a110
    v_accvgpr_read_b32 v233, a111
    v_mul_f32 v232, v232, v190
    v_mul_f32 v233, v233, v190
    v_accvgpr_write_b32 a110, v232
    v_accvgpr_write_b32 a111, v233
    v_accvgpr_read_b32 v232, a132
    v_accvgpr_read_b32 v233, a133
    v_mul_f32 v232, v232, v190
    v_mul_f32 v233, v233, v190
    v_accvgpr_write_b32 a132, v232
    v_accvgpr_write_b32 a133, v233
    v_accvgpr_read_b32 v232, a134
    v_accvgpr_read_b32 v233, a135
    v_mul_f32 v232, v232, v190
    v_mul_f32 v233, v233, v190
    v_accvgpr_write_b32 a134, v232
    v_accvgpr_write_b32 a135, v233
    v_accvgpr_read_b32 v232, a156
    v_accvgpr_read_b32 v233, a157
    v_mul_f32 v232, v232, v190
    v_mul_f32 v233, v233, v190
    v_accvgpr_write_b32 a156, v232
    v_accvgpr_write_b32 a157, v233
    v_accvgpr_read_b32 v232, a158
    v_accvgpr_read_b32 v233, a159
    v_mul_f32 v232, v232, v190
    v_mul_f32 v233, v233, v190
    v_accvgpr_write_b32 a158, v232
    v_accvgpr_write_b32 a159, v233
    v_accvgpr_read_b32 v232, a180
    v_accvgpr_read_b32 v233, a181
    v_mul_f32 v232, v232, v190
    v_mul_f32 v233, v233, v190
    v_accvgpr_write_b32 a180, v232
    v_accvgpr_write_b32 a181, v233
    v_accvgpr_read_b32 v232, a182
    v_accvgpr_read_b32 v233, a183
    v_mul_f32 v232, v232, v190
    v_mul_f32 v233, v233, v190
    v_accvgpr_write_b32 a182, v232
    v_accvgpr_write_b32 a183, v233
    v_max3_f32 v188, v64, v65, v66
    v_max3_f32 v188, v188, v67, v88
    v_max3_f32 v188, v188, v89, v90
    v_max3_f32 v188, v188, v91, 0
    v_mov_b32 v189, v188
    s_nop 1
    v_permlane32_swap_b32 v188, v189
    v_max_f32 v188, v188, v189
    v_mov_b32 v189, v188
    s_nop 1
    v_permlane16_swap_b32 v188, v189
    v_max_f32 v188, v188, v189
    v_exp_f32 v190, -v188
    v_sub_f32 v112, v112, v188
    v_sub_f32 v113, v113, v188
    v_sub_f32 v114, v114, v188
    v_sub_f32 v115, v115, v188
    v_sub_f32 v64, v64, v188
    v_sub_f32 v65, v65, v188
    v_sub_f32 v66, v66, v188
    v_sub_f32 v67, v67, v188
    v_sub_f32 v88, v88, v188
    v_sub_f32 v89, v89, v188
    v_sub_f32 v90, v90, v188
    v_sub_f32 v91, v91, v188
    v_mul_f32 v136, v136, v190
    v_mul_f32 v137, v137, v190
    v_mul_f32 v138, v138, v190
    v_mul_f32 v139, v139, v190
    v_accvgpr_read_b32 v232, a16
    v_accvgpr_read_b32 v233, a17
    v_mul_f32 v232, v232, v190
    v_mul_f32 v233, v233, v190
    v_accvgpr_write_b32 a16, v232
    v_accvgpr_write_b32 a17, v233
    v_accvgpr_read_b32 v232, a18
    v_accvgpr_read_b32 v233, a19
    v_mul_f32 v232, v232, v190
    v_mul_f32 v233, v233, v190
    v_accvgpr_write_b32 a18, v232
    v_accvgpr_write_b32 a19, v233
    v_accvgpr_read_b32 v232, a40
    v_accvgpr_read_b32 v233, a41
    v_mul_f32 v232, v232, v190
    v_mul_f32 v233, v233, v190
    v_accvgpr_write_b32 a40, v232
    v_accvgpr_write_b32 a41, v233
    v_accvgpr_read_b32 v232, a42
    v_accvgpr_read_b32 v233, a43
    v_mul_f32 v232, v232, v190
    v_mul_f32 v233, v233, v190
    v_accvgpr_write_b32 a42, v232
    v_accvgpr_write_b32 a43, v233
    v_accvgpr_read_b32 v232, a64
    v_accvgpr_read_b32 v233, a65
    v_mul_f32 v232, v232, v190
    v_mul_f32 v233, v233, v190
    v_accvgpr_write_b32 a64, v232
    v_accvgpr_write_b32 a65, v233
    v_accvgpr_read_b32 v232, a66
    v_accvgpr_read_b32 v233, a67
    v_mul_f32 v232, v232, v190
    v_mul_f32 v233, v233, v190
    v_accvgpr_write_b32 a66, v232
    v_accvgpr_write_b32 a67, v233
    v_accvgpr_read_b32 v232, a88
    v_accvgpr_read_b32 v233, a89
    v_mul_f32 v232, v232, v190
    v_mul_f32 v233, v233, v190
    v_accvgpr_write_b32 a88, v232
    v_accvgpr_write_b32 a89, v233
    v_accvgpr_read_b32 v232, a90
    v_accvgpr_read_b32 v233, a91
    v_mul_f32 v232, v232, v190
    v_mul_f32 v233, v233, v190
    v_accvgpr_write_b32 a90, v232
    v_accvgpr_write_b32 a91, v233
    v_accvgpr_read_b32 v232, a112
    v_accvgpr_read_b32 v233, a113
    v_mul_f32 v232, v232, v190
    v_mul_f32 v233, v233, v190
    v_accvgpr_write_b32 a112, v232
    v_accvgpr_write_b32 a113, v233
    v_accvgpr_read_b32 v232, a114
    v_accvgpr_read_b32 v233, a115
    v_mul_f32 v232, v232, v190
    v_mul_f32 v233, v233, v190
    v_accvgpr_write_b32 a114, v232
    v_accvgpr_write_b32 a115, v233
    v_accvgpr_read_b32 v232, a136
    v_accvgpr_read_b32 v233, a137
    v_mul_f32 v232, v232, v190
    v_mul_f32 v233, v233, v190
    v_accvgpr_write_b32 a136, v232
    v_accvgpr_write_b32 a137, v233
    v_accvgpr_read_b32 v232, a138
    v_accvgpr_read_b32 v233, a139
    v_mul_f32 v232, v232, v190
    v_mul_f32 v233, v233, v190
    v_accvgpr_write_b32 a138, v232
    v_accvgpr_write_b32 a139, v233
    v_accvgpr_read_b32 v232, a160
    v_accvgpr_read_b32 v233, a161
    v_mul_f32 v232, v232, v190
    v_mul_f32 v233, v233, v190
    v_accvgpr_write_b32 a160, v232
    v_accvgpr_write_b32 a161, v233
    v_accvgpr_read_b32 v232, a162
    v_accvgpr_read_b32 v233, a163
    v_mul_f32 v232, v232, v190
    v_mul_f32 v233, v233, v190
    v_accvgpr_write_b32 a162, v232
    v_accvgpr_write_b32 a163, v233
    v_accvgpr_read_b32 v232, a184
    v_accvgpr_read_b32 v233, a185
    v_mul_f32 v232, v232, v190
    v_mul_f32 v233, v233, v190
    v_accvgpr_write_b32 a184, v232
    v_accvgpr_write_b32 a185, v233
    v_accvgpr_read_b32 v232, a186
    v_accvgpr_read_b32 v233, a187
    v_mul_f32 v232, v232, v190
    v_mul_f32 v233, v233, v190
    v_accvgpr_write_b32 a186, v232
    v_accvgpr_write_b32 a187, v233
    v_max3_f32 v188, v68, v69, v70
    v_max3_f32 v188, v188, v71, v92
    v_max3_f32 v188, v188, v93, v94
    v_max3_f32 v188, v188, v95, 0
    v_mov_b32 v189, v188
    s_nop 1
    v_permlane32_swap_b32 v188, v189
    v_max_f32 v188, v188, v189
    v_mov_b32 v189, v188
    s_nop 1
    v_permlane16_swap_b32 v188, v189
    v_max_f32 v188, v188, v189
    v_exp_f32 v190, -v188
    v_sub_f32 v116, v116, v188
    v_sub_f32 v117, v117, v188
    v_sub_f32 v118, v118, v188
    v_sub_f32 v119, v119, v188
    v_sub_f32 v68, v68, v188
    v_sub_f32 v69, v69, v188
    v_sub_f32 v70, v70, v188
    v_sub_f32 v71, v71, v188
    v_sub_f32 v92, v92, v188
    v_sub_f32 v93, v93, v188
    v_sub_f32 v94, v94, v188
    v_sub_f32 v95, v95, v188
    v_mul_f32 v140, v140, v190
    v_mul_f32 v141, v141, v190
    v_mul_f32 v142, v142, v190
    v_mul_f32 v143, v143, v190
    v_accvgpr_read_b32 v232, a20
    v_accvgpr_read_b32 v233, a21
    v_mul_f32 v232, v232, v190
    v_mul_f32 v233, v233, v190
    v_accvgpr_write_b32 a20, v232
    v_accvgpr_write_b32 a21, v233
    v_accvgpr_read_b32 v232, a22
    v_accvgpr_read_b32 v233, a23
    v_mul_f32 v232, v232, v190
    v_mul_f32 v233, v233, v190
    v_accvgpr_write_b32 a22, v232
    v_accvgpr_write_b32 a23, v233
    v_accvgpr_read_b32 v232, a44
    v_accvgpr_read_b32 v233, a45
    v_mul_f32 v232, v232, v190
    v_mul_f32 v233, v233, v190
    v_accvgpr_write_b32 a44, v232
    v_accvgpr_write_b32 a45, v233
    v_accvgpr_read_b32 v232, a46
    v_accvgpr_read_b32 v233, a47
    v_mul_f32 v232, v232, v190
    v_mul_f32 v233, v233, v190
    v_accvgpr_write_b32 a46, v232
    v_accvgpr_write_b32 a47, v233
    v_accvgpr_read_b32 v232, a68
    v_accvgpr_read_b32 v233, a69
    v_mul_f32 v232, v232, v190
    v_mul_f32 v233, v233, v190
    v_accvgpr_write_b32 a68, v232
    v_accvgpr_write_b32 a69, v233
    v_accvgpr_read_b32 v232, a70
    v_accvgpr_read_b32 v233, a71
    v_mul_f32 v232, v232, v190
    v_mul_f32 v233, v233, v190
    v_accvgpr_write_b32 a70, v232
    v_accvgpr_write_b32 a71, v233
    v_accvgpr_read_b32 v232, a92
    v_accvgpr_read_b32 v233, a93
    v_mul_f32 v232, v232, v190
    v_mul_f32 v233, v233, v190
    v_accvgpr_write_b32 a92, v232
    v_accvgpr_write_b32 a93, v233
    v_accvgpr_read_b32 v232, a94
    v_accvgpr_read_b32 v233, a95
    v_mul_f32 v232, v232, v190
    v_mul_f32 v233, v233, v190
    v_accvgpr_write_b32 a94, v232
    v_accvgpr_write_b32 a95, v233
    v_accvgpr_read_b32 v232, a116
    v_accvgpr_read_b32 v233, a117
    v_mul_f32 v232, v232, v190
    v_mul_f32 v233, v233, v190
    v_accvgpr_write_b32 a116, v232
    v_accvgpr_write_b32 a117, v233
    v_accvgpr_read_b32 v232, a118
    v_accvgpr_read_b32 v233, a119
    v_mul_f32 v232, v232, v190
    v_mul_f32 v233, v233, v190
    v_accvgpr_write_b32 a118, v232
    v_accvgpr_write_b32 a119, v233
    v_accvgpr_read_b32 v232, a140
    v_accvgpr_read_b32 v233, a141
    v_mul_f32 v232, v232, v190
    v_mul_f32 v233, v233, v190
    v_accvgpr_write_b32 a140, v232
    v_accvgpr_write_b32 a141, v233
    v_accvgpr_read_b32 v232, a142
    v_accvgpr_read_b32 v233, a143
    v_mul_f32 v232, v232, v190
    v_mul_f32 v233, v233, v190
    v_accvgpr_write_b32 a142, v232
    v_accvgpr_write_b32 a143, v233
    v_accvgpr_read_b32 v232, a164
    v_accvgpr_read_b32 v233, a165
    v_mul_f32 v232, v232, v190
    v_mul_f32 v233, v233, v190
    v_accvgpr_write_b32 a164, v232
    v_accvgpr_write_b32 a165, v233
    v_accvgpr_read_b32 v232, a166
    v_accvgpr_read_b32 v233, a167
    v_mul_f32 v232, v232, v190
    v_mul_f32 v233, v233, v190
    v_accvgpr_write_b32 a166, v232
    v_accvgpr_write_b32 a167, v233
    v_accvgpr_read_b32 v232, a188
    v_accvgpr_read_b32 v233, a189
    v_mul_f32 v232, v232, v190
    v_mul_f32 v233, v233, v190
    v_accvgpr_write_b32 a188, v232
    v_accvgpr_write_b32 a189, v233
    v_accvgpr_read_b32 v232, a190
    v_accvgpr_read_b32 v233, a191
    v_mul_f32 v232, v232, v190
    v_mul_f32 v233, v233, v190
    v_accvgpr_write_b32 a190, v232
    v_accvgpr_write_b32 a191, v233
    s_nop 1
    s_setpc_b64 s[78:79]
L_spin0:
    s_mov_b32 s53, 2000000
L_spinl0:
    s_sleep 1
    buffer_load_dwordx2 v[228:229], v248, s[64:67], s86 offen sc1
    s_waitcnt vmcnt(0)
    v_and_b32 v228, v228, v229
    s_nop 0
    v_readfirstlane_b32 s87, v228
    s_nop 1
    s_cmp_eq_u32 s87, 16843009
    s_cbranch_scc1 L_spun0
    s_sub_u32 s53, s53, 1
    s_cmp_lg_u32 s53, 0
    s_cbranch_scc1 L_spinl0
    s_branch L_spun0
L_spin1:
    s_mov_b32 s53, 2000000
L_spinl1:
    s_sleep 1
    buffer_load_dword v244, v247, s[60:63], s85 offen sc1
    s_waitcnt vmcnt(0)
    v_cmp_eq_u32 vcc, 0, v244
    s_nop 1
    s_and_b32 s87, vcc_lo, 0x700
    s_cmp_eq_u32 s87, 0
    s_cbranch_scc1 L_spun1
    s_sub_u32 s53, s53, 1
    s_cmp_lg_u32 s53, 0
    s_cbranch_scc1 L_spinl1
    s_branch L_spun1
L_spin2:
    s_mov_b32 s53, 2000000
L_spinl2:
    s_sleep 1
    buffer_load_dword v244, v247, s[60:63], s85 offen sc1
    s_waitcnt vmcnt(0)
    v_cmp_eq_u32 vcc, 0, v244
    s_nop 1
    s_and_b32 s87, vcc_lo, 0x18ff
    s_cmp_eq_u32 s87, 0
    s_cbranch_scc1 L_spun2
    s_sub_u32 s53, s53, 1
    s_cmp_lg_u32 s53, 0
    s_cbranch_scc1 L_spinl2
    s_branch L_spun2
L_spin3:
    s_mov_b32 s53, 2000000
L_spinl3:
    s_sleep 1
    buffer_load_dword v244, v248, s[60:63], s85 offen offset:768 sc1
    s_waitcnt vmcnt(0)
    v_readfirstlane_b32 s87, v244
    s_nop 1
    s_cmp_lg_u32 s87, 0
    s_cbranch_scc1 L_spun3
    s_sub_u32 s53, s53, 1
    s_cmp_lg_u32 s53, 0
    s_cbranch_scc1 L_spinl3
    s_branch L_spun3
L_spin4:
    s_mov_b32 s53, 2000000
L_spinl4:
    s_sleep 1
    buffer_load_dword v244, v248, s[60:63], s85 offen offset:896 sc1
    s_waitcnt vmcnt(0)
    v_readfirstlane_b32 s87, v244
    s_nop 1
    s_cmp_lg_u32 s87, 0
    s_cbranch_scc1 L_spun4
    s_sub_u32 s53, s53, 1
    s_cmp_lg_u32 s53, 0
    s_cbranch_scc1 L_spinl4
    s_branch L_spun4
.section .rodata,"a"
.p2align 6
.amdhsa_kernel concat_heads__gqa_block_cached__gqa_block_cached__near_ridge_kernel
  .amdhsa_next_free_vgpr 512
  .amdhsa_next_free_sgpr 102
  .amdhsa_accum_offset 256
  .amdhsa_group_segment_fixed_size 0
  .amdhsa_kernarg_size 104
  .amdhsa_user_sgpr_count 2
  .amdhsa_user_sgpr_kernarg_segment_ptr 1
  .amdhsa_system_sgpr_workgroup_id_x 1
.end_amdhsa_kernel
```
